```python
import torch

def _softmax(x, axis=-1):
    return torch.softmax(x, dim=axis)

def _gelu(x):
    return torch.nn.functional.gelu(x, approximate='tanh')

def _silu(x):
    return torch.nn.functional.silu(x)

def _sigmoid(x):
    return torch.sigmoid(x)

def _layernorm(x, axis=-1, eps=1e-05):
    m = x.mean(dim=axis, keepdim=True)
    v = x.var(dim=axis, keepdim=True, unbiased=False)
    return (x - m) / torch.sqrt(v + eps)

def _scatter_add(tgt, idx, src, axis=0):
    return tgt.clone().index_add_(axis, idx, src)

def _segment_sum(src, seg, n):
    out = torch.zeros((n,) + src.shape[1:], dtype=src.dtype)
    return out.index_add_(0, seg, src)

def _pad(x, pw):
    flat = tuple((v for pair in reversed(pw) for v in pair))
    return torch.nn.functional.pad(x, flat)
kernel_name = 'adaLN_cond__sliding_block_cached__swiglu_ffn__prompt'

def setup_inputs():

    _w = lambda a: (lambda t: t.to(torch.bfloat16) if t.is_floating_point() else t)(torch.as_tensor(a))

    def _A_setup():
        B, Sq, D = (1, 2048, 1024)
        Hq, Hkv, Sk, Dh = (32, 4, 2048, 128)
        assert Hq % Hkv == 0, (Hq, Hkv)
        return {'x': _w((lambda *s: torch.randn(*s, dtype=torch.bfloat16) * 0.05)(B, Sq, D)), 'k_cache': _w((lambda *s: torch.randn(*s, dtype=torch.bfloat16) * 3.2)(B, Hkv, Sk, Dh)), 'v_cache': _w((lambda *s: torch.randn(*s, dtype=torch.bfloat16) * 0.4)(B, Hkv, Sk, Dh)), 'wq': _w((lambda *s: torch.randn(*s, dtype=torch.bfloat16) * 3.2)(D, Hq * Dh) * D ** (-0.5)), 'wo': _w((lambda *s: torch.randn(*s, dtype=torch.bfloat16) * 0.4)(Hq * Dh, D) * (Hq * Dh) ** (-0.5))}
    _A_in = _A_setup()

    def _B_setup():
        B, S, D, F = (1, 2048, 1024, 3584)
        return {'x': _w((lambda *s: torch.randn(*s, dtype=torch.bfloat16) * 0.05)(B, S, D)), 'w_gate': _w((lambda *s: torch.randn(*s, dtype=torch.bfloat16) * 0.05)(D, F)), 'w_up': _w((lambda *s: torch.randn(*s, dtype=torch.bfloat16) * 0.05)(D, F)), 'w_down': _w((lambda *s: torch.randn(*s, dtype=torch.bfloat16) * 0.05)(F, D))}
    _B_in = _B_setup()
    return {'A_x': _A_in['x'], 'A_k_cache': _A_in['k_cache'], 'A_v_cache': _A_in['v_cache'], 'A_wq': _A_in['wq'], 'A_wo': _A_in['wo'], 'B_x': _B_in['x'], 'B_w_gate': _B_in['w_gate'], 'B_w_up': _B_in['w_up'], 'B_w_down': _B_in['w_down'], 'c': _w((lambda *s: torch.randn(*s, dtype=torch.bfloat16) * 0.1)(1, 1024) * 8.0), 'w_mod': _w((lambda *s: torch.randn(*s, dtype=torch.bfloat16) * 0.1)(1024, 6 * 1024) * 1024 ** (-0.5) * 8.0)}

def reference(A_x, A_k_cache, A_v_cache, A_wq, A_wo, B_x, B_w_gate, B_w_up, B_w_down, c, w_mod):

    def _A_ref(x, k_cache, v_cache, wq, wo):
        B, Sq, D = x.shape
        Hq, Dh = (32, 128)
        Hkv, Sk = (k_cache.shape[1], k_cache.shape[2])
        W = min(4096, max(256, Sk // 4))
        rep = Hq // Hkv
        q = (lambda x, *d: x.permute(*d))((x @ wq).reshape(B, Sq, Hq, Dh), 0, 2, 1, 3)
        k = (lambda x, n, axis: torch.repeat_interleave(x, n, dim=axis))(k_cache[:, :, Sk - W:, :], rep, axis=1)
        v = (lambda x, n, axis: torch.repeat_interleave(x, n, dim=axis))(v_cache[:, :, Sk - W:, :], rep, axis=1)
        scores = torch.einsum('bhqd,bhkd->bhqk', q, k) * Dh ** (-0.5)
        p = _softmax(scores, axis=-1)
        o = torch.einsum('bhqk,bhkd->bhqd', p, v)
        return (lambda x, *d: x.permute(*d))(o, 0, 2, 1, 3).reshape(B, Sq, Hq * Dh) @ wo

    def _B_ref(x, w_gate, w_up, w_down):
        g = _silu(x @ w_gate)
        u = x @ w_up
        return g * u @ w_down
    x = A_x
    mod = (_silu(c) @ w_mod).reshape(c.shape[0], 6, 1, -1)
    sa, ca, ga, sb, cb, gb = (mod[:, 0].clone(), mod[:, 1].clone(), mod[:, 2].clone(), mod[:, 3].clone(), mod[:, 4].clone(), mod[:, 5].clone())
    h = _layernorm(x, axis=-1) * (1 + ca) + sa
    x = x + ga * _A_ref(h, A_k_cache, A_v_cache, A_wq, A_wo)
    h = _layernorm(x, axis=-1) * (1 + cb) + sb
    x = x + gb * _B_ref(h, B_w_gate, B_w_up, B_w_down)
    return x
```

```asm
; @launch grid=(256,1,1) block=(256,1,1) lds=163840
.amdgcn_target "amdgcn-amd-amdhsa--gfx950"
.text
.globl adaLN_cond__sliding_block_cached__swiglu_ffn__prompt_kernel
.p2align 8
.type adaLN_cond__sliding_block_cached__swiglu_ffn__prompt_kernel,@function
adaLN_cond__sliding_block_cached__swiglu_ffn__prompt_kernel:
s_cmp_ge_u32 s2, 256
s_cbranch_scc1 adaLN_cond__sliding_block_cached__swiglu_ffn__prompt_kernel_end
s_load_dwordx8 s[80:87], s[0:1], 64
s_load_dwordx16 s[64:79], s[0:1], 0
s_load_dwordx4 s[88:91], s[0:1], 96
v_lshrrev_b32 v2, 6, v0
v_and_b32 v1, 63, v0
s_lshr_b32 s21, s2, 3
v_readfirstlane_b32 s26, v2
s_cmp_lg_u32 s26, 0
s_cbranch_scc1 adaLN_cond__sliding_block_cached__swiglu_ffn__prompt_kernel_ct_2
s_getpc_b64 s[6:7]
adaLN_cond__sliding_block_cached__swiglu_ffn__prompt_kernel_pc_1:
s_add_u32 s6, s6, adaLN_cond__sliding_block_cached__swiglu_ffn__prompt_kernel_c1-adaLN_cond__sliding_block_cached__swiglu_ffn__prompt_kernel_pc_1
s_addc_u32 s7, s7, 0
v_lshlrev_b32 v30, 5, v1
v_add_u32 v30, s21, v30
v_lshlrev_b32 v30, 7, v30
v_cmp_gt_u32 vcc, adaLN_cond__sliding_block_cached__swiglu_ffn__prompt_kernel_cend-adaLN_cond__sliding_block_cached__swiglu_ffn__prompt_kernel_c1, v30
s_and_saveexec_b64 s[4:5], vcc
s_cbranch_execz adaLN_cond__sliding_block_cached__swiglu_ffn__prompt_kernel_ct_2_r
global_load_dword v31, v30, s[6:7]
adaLN_cond__sliding_block_cached__swiglu_ffn__prompt_kernel_ct_2_r:
s_mov_b64 exec, s[4:5]
adaLN_cond__sliding_block_cached__swiglu_ffn__prompt_kernel_ct_2:
adaLN_cond__sliding_block_cached__swiglu_ffn__prompt_kernel_c1:
s_and_b32 s20, s2, 7
s_lshr_b32 s22, s20, 1
s_and_b32 s23, s20, 1
s_and_b32 s24, s21, 3
s_lshl_b32 s27, s23, 2
s_add_u32 s24, s24, s27
s_lshr_b32 s25, s21, 2
s_waitcnt lgkmcnt(0)
s_cmp_ge_u32 s2, 128
s_cbranch_scc1 adaLN_cond__sliding_block_cached__swiglu_ffn__prompt_kernel_kv
s_mov_b32 s8, s84
s_mov_b32 s9, s85
s_mov_b32 s10, 0xc00000
s_mov_b32 s11, 0x20000
s_mov_b32 s12, s82
s_mov_b32 s13, s83
s_mov_b32 s14, 0x800
s_mov_b32 s15, 0x20000
s_and_b32 s38, s2, 31
s_lshr_b32 s39, s2, 5
s_lshl_b32 s47, s39, 8
s_lshl_b32 s48, s38, 7
s_lshl_b32 s49, s39, 13
s_lshl_b32 s38, s38, 8
s_add_u32 s49, s49, s38
v_and_b32 v160, 7, v0
v_lshrrev_b32 v161, 3, v0
v_mul_u32_u24 v162, 98304, v161
v_lshl_add_u32 v162, v160, 4, v162
v_mul_u32_u24 v163, 16, v161
s_mul_i32 s36, s47, 12288
s_add_u32 s36, s36, s48
s_lshl_b32 s37, s47, 1
buffer_load_dwordx4 v[168:171], v163, s[12:15], s37 offen offset:0
buffer_load_dwordx4 v[96:99], v162, s[8:11], s36 offen
s_add_u32 s36, s36, 12288
buffer_load_dwordx4 v[100:103], v162, s[8:11], s36 offen
s_add_u32 s36, s36, 12288
buffer_load_dwordx4 v[104:107], v162, s[8:11], s36 offen
s_add_u32 s36, s36, 12288
buffer_load_dwordx4 v[108:111], v162, s[8:11], s36 offen
s_add_u32 s36, s36, 12288
buffer_load_dwordx4 v[112:115], v162, s[8:11], s36 offen
s_add_u32 s36, s36, 12288
buffer_load_dwordx4 v[116:119], v162, s[8:11], s36 offen
s_add_u32 s36, s36, 12288
buffer_load_dwordx4 v[120:123], v162, s[8:11], s36 offen
s_add_u32 s36, s36, 12288
buffer_load_dwordx4 v[124:127], v162, s[8:11], s36 offen
v_lshrrev_b32 v2, 6, v0
v_and_b32 v3, 7, v1
v_lshrrev_b32 v4, 3, v1
v_lshrrev_b32 v5, 1, v4
v_lshlrev_b32 v5, 10, v5
v_and_b32 v6, 1, v4
v_lshl_add_u32 v5, v6, 9, v5
v_lshl_add_u32 v5, v3, 4, v5
v_lshl_add_u32 v5, v2, 14, v5
v_lshlrev_b32 v6, 11, v4
v_lshl_add_u32 v6, v3, 4, v6
v_lshl_add_u32 v6, v2, 9, v6
v_lshrrev_b32 v240, 3, v1
v_mul_u32_u24 v240, 144, v240
v_and_b32 v241, 7, v1
v_lshl_add_u32 v240, v241, 4, v240
v_mul_u32_u24 v241, 144, v241
v_lshrrev_b32 v29, 3, v1
v_lshl_add_u32 v241, v29, 4, v241
s_mul_i32 s27, s26, 4608
s_add_u32 s27, s27, 126976
v_add_u32 v240, s27, v240
v_add_u32 v241, s27, v241
v_lshlrev_b32 v7, 4, v0
v_lshlrev_b32 v8, 10, v2
v_lshl_add_u32 v8, v4, 5, v8
v_add_u32 v8, 147456, v8
v_add_u32 v11, 147456, v7
v_lshlrev_b32 v9, 5, v3
v_add_u32 v9, 159744, v9
v_lshl_add_u32 v10, v2, 3, v9
s_lshl_b32 s45, s24, 5
s_lshl_b32 s46, s22, 3
s_add_u32 s45, s45, s46
s_add_u32 s45, s45, s25
s_lshr_b32 s40, s45, 2
s_lshl_b32 s40, s40, 16
s_and_b32 s46, s45, 3
s_lshl_b32 s46, s46, 7
s_add_u32 s40, s40, s46
s_add_u32 s41, s40, 4096
s_add_u32 s42, s40, 8192
s_add_u32 s43, s40, 12288
s_lshl_b32 s44, s45, 14
s_mov_b32 s16, s64
s_mov_b32 s17, s65
s_mov_b32 s18, 0x400000
s_mov_b32 s19, 0x20000
buffer_load_dwordx4 v[64:67], v6, s[16:19], s44 offen offset:0
buffer_load_dwordx4 v[68:71], v6, s[16:19], s44 offen offset:128
buffer_load_dwordx4 v[72:75], v6, s[16:19], s44 offen offset:256
buffer_load_dwordx4 v[76:79], v6, s[16:19], s44 offen offset:384
s_or_b32 s27, s2, s26
s_cmp_lg_u32 s27, 0
s_cbranch_scc1 adaLN_cond__sliding_block_cached__swiglu_ffn__prompt_kernel_z_3
s_add_u32 s16, s90, 0x20000
s_addc_u32 s17, s91, 0
s_mov_b32 s18, 0x6000
s_mov_b32 s19, 0x20000
v_lshlrev_b32 v16, 7, v1
v_mov_b32 v17, 0
buffer_store_dword v17, v16, s[16:19], 0 offen offset:0 sc1
v_add_u32 v19, 8192, v16
buffer_store_dword v17, v19, s[16:19], 0 offen sc1
v_add_u32 v20, 16384, v16
buffer_store_dword v17, v20, s[16:19], 0 offen sc1
s_waitcnt vmcnt(0)
adaLN_cond__sliding_block_cached__swiglu_ffn__prompt_kernel_z_3:
s_mov_b32 s16, s90
s_mov_b32 s17, s91
s_mov_b32 s18, 0x8000
s_mov_b32 s19, 0x20000
v_and_b32 v160, 7, v0
v_lshrrev_b32 v161, 3, v0
s_waitcnt vmcnt(12)
v_lshlrev_b32 v176, 16, v168
v_and_b32 v177, 0xffff0000, v168
v_lshlrev_b32 v178, 16, v169
v_and_b32 v179, 0xffff0000, v169
v_lshlrev_b32 v180, 16, v170
v_and_b32 v181, 0xffff0000, v170
v_lshlrev_b32 v182, 16, v171
v_and_b32 v183, 0xffff0000, v171
v_mul_f32 v192, 0xbfb8aa3b, v176
v_mul_f32 v193, 0xbfb8aa3b, v177
v_mul_f32 v194, 0xbfb8aa3b, v178
v_mul_f32 v195, 0xbfb8aa3b, v179
v_mul_f32 v196, 0xbfb8aa3b, v180
v_mul_f32 v197, 0xbfb8aa3b, v181
v_mul_f32 v198, 0xbfb8aa3b, v182
v_mul_f32 v199, 0xbfb8aa3b, v183
v_exp_f32 v192, v192
v_exp_f32 v193, v193
v_exp_f32 v194, v194
v_exp_f32 v195, v195
v_exp_f32 v196, v196
v_exp_f32 v197, v197
v_exp_f32 v198, v198
v_exp_f32 v199, v199
s_nop 0
v_add_f32 v192, 1.0, v192
v_add_f32 v193, 1.0, v193
v_add_f32 v194, 1.0, v194
v_add_f32 v195, 1.0, v195
v_add_f32 v196, 1.0, v196
v_add_f32 v197, 1.0, v197
v_add_f32 v198, 1.0, v198
v_add_f32 v199, 1.0, v199
v_rcp_f32 v192, v192
v_rcp_f32 v193, v193
v_rcp_f32 v194, v194
v_rcp_f32 v195, v195
v_rcp_f32 v196, v196
v_rcp_f32 v197, v197
v_rcp_f32 v198, v198
v_rcp_f32 v199, v199
s_nop 0
v_mul_f32 v176, v176, v192
v_mul_f32 v177, v177, v193
v_mul_f32 v178, v178, v194
v_mul_f32 v179, v179, v195
v_mul_f32 v180, v180, v196
v_mul_f32 v181, v181, v197
v_mul_f32 v182, v182, v198
v_mul_f32 v183, v183, v199
v_cvt_pk_bf16_f32 v192, v176, v177
v_cvt_pk_bf16_f32 v193, v178, v179
v_cvt_pk_bf16_f32 v194, v180, v181
v_cvt_pk_bf16_f32 v195, v182, v183
v_lshlrev_b32 v176, 16, v192
v_and_b32 v177, 0xffff0000, v192
v_lshlrev_b32 v178, 16, v193
v_and_b32 v179, 0xffff0000, v193
v_lshlrev_b32 v180, 16, v194
v_and_b32 v181, 0xffff0000, v194
v_lshlrev_b32 v182, 16, v195
v_and_b32 v183, 0xffff0000, v195
v_mov_b32 v208, 0
v_mov_b32 v209, 0
v_mov_b32 v210, 0
v_mov_b32 v211, 0
v_mov_b32 v212, 0
v_mov_b32 v213, 0
v_mov_b32 v214, 0
v_mov_b32 v215, 0
s_waitcnt vmcnt(11)
v_lshlrev_b32 v216, 16, v96
v_and_b32 v217, 0xffff0000, v96
v_fmac_f32 v208, v216, v176
v_fmac_f32 v209, v217, v176
v_lshlrev_b32 v218, 16, v97
v_and_b32 v219, 0xffff0000, v97
v_fmac_f32 v210, v218, v176
v_fmac_f32 v211, v219, v176
v_lshlrev_b32 v216, 16, v98
v_and_b32 v217, 0xffff0000, v98
v_fmac_f32 v212, v216, v176
v_fmac_f32 v213, v217, v176
v_lshlrev_b32 v218, 16, v99
v_and_b32 v219, 0xffff0000, v99
v_fmac_f32 v214, v218, v176
v_fmac_f32 v215, v219, v176
s_waitcnt vmcnt(10)
v_lshlrev_b32 v216, 16, v100
v_and_b32 v217, 0xffff0000, v100
v_fmac_f32 v208, v216, v177
v_fmac_f32 v209, v217, v177
v_lshlrev_b32 v218, 16, v101
v_and_b32 v219, 0xffff0000, v101
v_fmac_f32 v210, v218, v177
v_fmac_f32 v211, v219, v177
v_lshlrev_b32 v216, 16, v102
v_and_b32 v217, 0xffff0000, v102
v_fmac_f32 v212, v216, v177
v_fmac_f32 v213, v217, v177
v_lshlrev_b32 v218, 16, v103
v_and_b32 v219, 0xffff0000, v103
v_fmac_f32 v214, v218, v177
v_fmac_f32 v215, v219, v177
s_waitcnt vmcnt(9)
v_lshlrev_b32 v216, 16, v104
v_and_b32 v217, 0xffff0000, v104
v_fmac_f32 v208, v216, v178
v_fmac_f32 v209, v217, v178
v_lshlrev_b32 v218, 16, v105
v_and_b32 v219, 0xffff0000, v105
v_fmac_f32 v210, v218, v178
v_fmac_f32 v211, v219, v178
v_lshlrev_b32 v216, 16, v106
v_and_b32 v217, 0xffff0000, v106
v_fmac_f32 v212, v216, v178
v_fmac_f32 v213, v217, v178
v_lshlrev_b32 v218, 16, v107
v_and_b32 v219, 0xffff0000, v107
v_fmac_f32 v214, v218, v178
v_fmac_f32 v215, v219, v178
s_waitcnt vmcnt(8)
v_lshlrev_b32 v216, 16, v108
v_and_b32 v217, 0xffff0000, v108
v_fmac_f32 v208, v216, v179
v_fmac_f32 v209, v217, v179
v_lshlrev_b32 v218, 16, v109
v_and_b32 v219, 0xffff0000, v109
v_fmac_f32 v210, v218, v179
v_fmac_f32 v211, v219, v179
v_lshlrev_b32 v216, 16, v110
v_and_b32 v217, 0xffff0000, v110
v_fmac_f32 v212, v216, v179
v_fmac_f32 v213, v217, v179
v_lshlrev_b32 v218, 16, v111
v_and_b32 v219, 0xffff0000, v111
v_fmac_f32 v214, v218, v179
v_fmac_f32 v215, v219, v179
s_waitcnt vmcnt(7)
v_lshlrev_b32 v216, 16, v112
v_and_b32 v217, 0xffff0000, v112
v_fmac_f32 v208, v216, v180
v_fmac_f32 v209, v217, v180
v_lshlrev_b32 v218, 16, v113
v_and_b32 v219, 0xffff0000, v113
v_fmac_f32 v210, v218, v180
v_fmac_f32 v211, v219, v180
v_lshlrev_b32 v216, 16, v114
v_and_b32 v217, 0xffff0000, v114
v_fmac_f32 v212, v216, v180
v_fmac_f32 v213, v217, v180
v_lshlrev_b32 v218, 16, v115
v_and_b32 v219, 0xffff0000, v115
v_fmac_f32 v214, v218, v180
v_fmac_f32 v215, v219, v180
s_waitcnt vmcnt(6)
v_lshlrev_b32 v216, 16, v116
v_and_b32 v217, 0xffff0000, v116
v_fmac_f32 v208, v216, v181
v_fmac_f32 v209, v217, v181
v_lshlrev_b32 v218, 16, v117
v_and_b32 v219, 0xffff0000, v117
v_fmac_f32 v210, v218, v181
v_fmac_f32 v211, v219, v181
v_lshlrev_b32 v216, 16, v118
v_and_b32 v217, 0xffff0000, v118
v_fmac_f32 v212, v216, v181
v_fmac_f32 v213, v217, v181
v_lshlrev_b32 v218, 16, v119
v_and_b32 v219, 0xffff0000, v119
v_fmac_f32 v214, v218, v181
v_fmac_f32 v215, v219, v181
s_waitcnt vmcnt(5)
v_lshlrev_b32 v216, 16, v120
v_and_b32 v217, 0xffff0000, v120
v_fmac_f32 v208, v216, v182
v_fmac_f32 v209, v217, v182
v_lshlrev_b32 v218, 16, v121
v_and_b32 v219, 0xffff0000, v121
v_fmac_f32 v210, v218, v182
v_fmac_f32 v211, v219, v182
v_lshlrev_b32 v216, 16, v122
v_and_b32 v217, 0xffff0000, v122
v_fmac_f32 v212, v216, v182
v_fmac_f32 v213, v217, v182
v_lshlrev_b32 v218, 16, v123
v_and_b32 v219, 0xffff0000, v123
v_fmac_f32 v214, v218, v182
v_fmac_f32 v215, v219, v182
s_waitcnt vmcnt(4)
v_lshlrev_b32 v216, 16, v124
v_and_b32 v217, 0xffff0000, v124
v_fmac_f32 v208, v216, v183
v_fmac_f32 v209, v217, v183
v_lshlrev_b32 v218, 16, v125
v_and_b32 v219, 0xffff0000, v125
v_fmac_f32 v210, v218, v183
v_fmac_f32 v211, v219, v183
v_lshlrev_b32 v216, 16, v126
v_and_b32 v217, 0xffff0000, v126
v_fmac_f32 v212, v216, v183
v_fmac_f32 v213, v217, v183
v_lshlrev_b32 v218, 16, v127
v_and_b32 v219, 0xffff0000, v127
v_fmac_f32 v214, v218, v183
v_fmac_f32 v215, v219, v183
v_lshlrev_b32 v164, 8, v161
v_lshl_add_u32 v164, v160, 5, v164
v_add_u32 v164, 147456, v164
ds_write_b128 v164, v[208:211]
ds_write_b128 v164, v[212:215] offset:16
s_waitcnt lgkmcnt(0)
s_barrier
s_cmp_lg_u32 s26, 0
s_cbranch_scc1 adaLN_cond__sliding_block_cached__swiglu_ffn__prompt_kernel_skip_4
v_lshlrev_b32 v166, 2, v1
v_add_u32 v164, 147456, v166
ds_read_b32 v96, v164 offset:0
ds_read_b32 v97, v164 offset:256
ds_read_b32 v98, v164 offset:512
ds_read_b32 v99, v164 offset:768
ds_read_b32 v100, v164 offset:1024
ds_read_b32 v101, v164 offset:1280
ds_read_b32 v102, v164 offset:1536
ds_read_b32 v103, v164 offset:1792
ds_read_b32 v104, v164 offset:2048
ds_read_b32 v105, v164 offset:2304
ds_read_b32 v106, v164 offset:2560
ds_read_b32 v107, v164 offset:2816
ds_read_b32 v108, v164 offset:3072
ds_read_b32 v109, v164 offset:3328
ds_read_b32 v110, v164 offset:3584
ds_read_b32 v111, v164 offset:3840
s_waitcnt lgkmcnt(7)
ds_read_b32 v112, v164 offset:4096
ds_read_b32 v113, v164 offset:4352
ds_read_b32 v114, v164 offset:4608
ds_read_b32 v115, v164 offset:4864
ds_read_b32 v116, v164 offset:5120
ds_read_b32 v117, v164 offset:5376
ds_read_b32 v118, v164 offset:5632
ds_read_b32 v119, v164 offset:5888
s_waitcnt lgkmcnt(7)
ds_read_b32 v120, v164 offset:6144
ds_read_b32 v121, v164 offset:6400
ds_read_b32 v122, v164 offset:6656
ds_read_b32 v123, v164 offset:6912
ds_read_b32 v124, v164 offset:7168
ds_read_b32 v125, v164 offset:7424
ds_read_b32 v126, v164 offset:7680
ds_read_b32 v127, v164 offset:7936
s_waitcnt lgkmcnt(0)
v_add_f32 v96, v96, v112
v_add_f32 v97, v97, v113
v_add_f32 v98, v98, v114
v_add_f32 v99, v99, v115
v_add_f32 v100, v100, v116
v_add_f32 v101, v101, v117
v_add_f32 v102, v102, v118
v_add_f32 v103, v103, v119
v_add_f32 v104, v104, v120
v_add_f32 v105, v105, v121
v_add_f32 v106, v106, v122
v_add_f32 v107, v107, v123
v_add_f32 v108, v108, v124
v_add_f32 v109, v109, v125
v_add_f32 v110, v110, v126
v_add_f32 v111, v111, v127
v_add_f32 v96, v96, v104
v_add_f32 v97, v97, v105
v_add_f32 v98, v98, v106
v_add_f32 v99, v99, v107
v_add_f32 v100, v100, v108
v_add_f32 v101, v101, v109
v_add_f32 v102, v102, v110
v_add_f32 v103, v103, v111
v_add_f32 v96, v96, v100
v_add_f32 v97, v97, v101
v_add_f32 v98, v98, v102
v_add_f32 v99, v99, v103
v_add_f32 v96, v96, v98
v_add_f32 v97, v97, v99
v_add_f32 v96, v96, v97
buffer_store_dword v96, v166, s[16:19], s49 offen sc1
adaLN_cond__sliding_block_cached__swiglu_ffn__prompt_kernel_skip_4:
s_cmp_lg_u32 s26, 0
s_cbranch_scc1 adaLN_cond__sliding_block_cached__swiglu_ffn__prompt_kernel_arr_5
s_waitcnt vmcnt(0)
s_mov_b32 s6, s88
s_mov_b32 s7, s89
v_mov_b32 v2, 0
v_mov_b32 v3, 1
s_mov_b64 exec, 1
global_atomic_add v29, v2, v3, s[6:7] sc0 sc1
s_waitcnt vmcnt(0)
v_readfirstlane_b32 s27, v29
s_nop 3
s_cmp_lg_u32 s27, 127
s_cbranch_scc1 adaLN_cond__sliding_block_cached__swiglu_ffn__prompt_kernel_arr_5_n
global_store_dword v2, v3, s[6:7] offset:128 sc1
adaLN_cond__sliding_block_cached__swiglu_ffn__prompt_kernel_arr_5_n:
s_mov_b64 exec, -1
adaLN_cond__sliding_block_cached__swiglu_ffn__prompt_kernel_arr_5:
s_cmp_eq_u32 s26, 0
s_cbranch_scc1 adaLN_cond__sliding_block_cached__swiglu_ffn__prompt_kernel_w0_6
s_waitcnt vmcnt(0)
adaLN_cond__sliding_block_cached__swiglu_ffn__prompt_kernel_w0_6:
s_branch adaLN_cond__sliding_block_cached__swiglu_ffn__prompt_kernel_pf
adaLN_cond__sliding_block_cached__swiglu_ffn__prompt_kernel_kv:
s_sub_u32 s50, s2, 128
s_lshl_b32 s50, s50, 2
s_add_u32 s50, s50, s26
s_mov_b32 s8, s66
s_mov_b32 s9, s67
s_mov_b32 s10, 0x200000
s_mov_b32 s11, 0x20000
s_mov_b32 s12, s68
s_mov_b32 s13, s69
s_mov_b32 s14, 0x200000
s_mov_b32 s15, 0x20000
s_add_u32 s16, s90, 0x5b00000
s_addc_u32 s17, s91, 0
s_mov_b32 s18, 0x100000
s_mov_b32 s19, 0x20000
s_lshr_b32 s51, s50, 7
s_bfe_u32 s52, s50, 0x40003
s_lshl_b32 s54, s51, 19
s_lshl_b32 s55, s52, 13
s_add_u32 s54, s54, s55
s_add_u32 s54, s54, 0x60000
v_lshrrev_b32 v160, 3, v1
v_and_b32 v161, 7, v1
v_lshlrev_b32 v162, 8, v160
v_lshl_add_u32 v162, v161, 4, v162
s_bfe_u32 s53, s50, 0x20001
s_and_b32 s56, s50, 1
s_lshl_b32 s55, s53, 11
s_add_u32 s55, s55, s54
s_lshl_b32 s57, s56, 7
s_add_u32 s55, s55, s57
buffer_load_dwordx4 v[168:171], v162, s[8:11], s55 offen
v_lshrrev_b32 v163, 2, v1
v_lshlrev_b32 v163, 8, v163
v_and_b32 v164, 3, v1
v_lshl_add_u32 v163, v164, 4, v163
s_bfe_u32 s55, s50, 0x10002
s_lshl_b32 s55, s55, 12
s_and_b32 s57, s50, 3
s_lshl_b32 s57, s57, 6
s_add_u32 s55, s55, s57
s_add_u32 s55, s55, s54
s_mul_i32 s57, s26, 4608
s_add_u32 s57, s57, 129280
s_mov_b32 m0, s57
s_nop 0
buffer_load_dwordx4 v163, s[12:15], s55 offen lds
s_mov_b32 s58, s16
s_mov_b32 s59, s17
s_mov_b32 s60, s18
v_lshrrev_b32 v2, 6, v0
v_and_b32 v3, 7, v1
v_lshrrev_b32 v4, 3, v1
v_lshrrev_b32 v5, 1, v4
v_lshlrev_b32 v5, 10, v5
v_and_b32 v6, 1, v4
v_lshl_add_u32 v5, v6, 9, v5
v_lshl_add_u32 v5, v3, 4, v5
v_lshl_add_u32 v5, v2, 14, v5
v_lshlrev_b32 v6, 11, v4
v_lshl_add_u32 v6, v3, 4, v6
v_lshl_add_u32 v6, v2, 9, v6
v_lshrrev_b32 v240, 3, v1
v_mul_u32_u24 v240, 144, v240
v_and_b32 v241, 7, v1
v_lshl_add_u32 v240, v241, 4, v240
v_mul_u32_u24 v241, 144, v241
v_lshrrev_b32 v29, 3, v1
v_lshl_add_u32 v241, v29, 4, v241
s_mul_i32 s27, s26, 4608
s_add_u32 s27, s27, 126976
v_add_u32 v240, s27, v240
v_add_u32 v241, s27, v241
v_lshlrev_b32 v7, 4, v0
v_lshlrev_b32 v8, 10, v2
v_lshl_add_u32 v8, v4, 5, v8
v_add_u32 v8, 147456, v8
v_add_u32 v11, 147456, v7
v_lshlrev_b32 v9, 5, v3
v_add_u32 v9, 159744, v9
v_lshl_add_u32 v10, v2, 3, v9
s_lshl_b32 s45, s24, 5
s_lshl_b32 s46, s22, 3
s_add_u32 s45, s45, s46
s_add_u32 s45, s45, s25
s_lshr_b32 s40, s45, 2
s_lshl_b32 s40, s40, 16
s_and_b32 s46, s45, 3
s_lshl_b32 s46, s46, 7
s_add_u32 s40, s40, s46
s_add_u32 s41, s40, 4096
s_add_u32 s42, s40, 8192
s_add_u32 s43, s40, 12288
s_lshl_b32 s44, s45, 14
s_mov_b32 s16, s64
s_mov_b32 s17, s65
s_mov_b32 s18, 0x400000
s_mov_b32 s19, 0x20000
buffer_load_dwordx4 v[64:67], v6, s[16:19], s44 offen offset:0
buffer_load_dwordx4 v[68:71], v6, s[16:19], s44 offen offset:128
buffer_load_dwordx4 v[72:75], v6, s[16:19], s44 offen offset:256
buffer_load_dwordx4 v[76:79], v6, s[16:19], s44 offen offset:384
s_mov_b32 s16, s58
s_mov_b32 s17, s59
s_mov_b32 s18, s60
v_lshrrev_b32 v164, 5, v1
v_lshlrev_b32 v164, 2, v164
v_bfe_u32 v165, v1, 2, 2
v_add_u32 v164, v164, v165
v_lshlrev_b32 v164, 6, v164
v_bfe_u32 v165, v1, 4, 1
v_lshl_add_u32 v164, v165, 5, v164
v_and_b32 v165, 1, v1
v_lshl_add_u32 v164, v165, 4, v164
v_bfe_u32 v165, v1, 1, 1
v_lshl_add_u32 v164, v165, 3, v164
v_add_u32 v164, s57, v164
v_lshrrev_b32 v166, 4, v1
v_lshlrev_b32 v166, 10, v166
v_bfe_u32 v165, v1, 3, 1
v_lshl_add_u32 v166, v165, 9, v166
v_lshl_add_u32 v166, v161, 4, v166
s_lshr_b32 s55, s50, 3
s_lshl_b32 s55, s55, 13
s_lshl_b32 s57, s56, 12
s_add_u32 s55, s55, s57
s_lshl_b32 s57, s53, 7
s_add_u32 s55, s55, s57
s_waitcnt vmcnt(5)
ds_write_b128 v240, v[168:171] offset:0
s_waitcnt lgkmcnt(0)
ds_read_b128 v[168:171], v241 offset:0
s_waitcnt lgkmcnt(0)
buffer_store_dwordx4 v[168:171], v166, s[16:19], s55 offen sc1
s_waitcnt vmcnt(5)
ds_read_b64_tr_b16 v[172:173], v164
ds_read_b64_tr_b16 v[174:175], v164 offset:512
v_lshlrev_b32 v165, 4, v1
s_lshl_b32 s55, s50, 10
s_add_u32 s55, s55, 0x80000
s_waitcnt lgkmcnt(0)
buffer_store_dwordx4 v[172:175], v165, s[16:19], s55 offen sc1
s_waitcnt vmcnt(0)
s_barrier
s_cmp_lg_u32 s26, 0
s_cbranch_scc1 adaLN_cond__sliding_block_cached__swiglu_ffn__prompt_kernel_arr_7
s_add_u32 s6, s88, 4
s_addc_u32 s7, s89, 0
v_mov_b32 v2, 0
v_mov_b32 v3, 1
s_mov_b64 exec, 1
global_atomic_add v2, v3, s[6:7] sc1
s_mov_b64 exec, -1
adaLN_cond__sliding_block_cached__swiglu_ffn__prompt_kernel_arr_7:
adaLN_cond__sliding_block_cached__swiglu_ffn__prompt_kernel_pf:
ds_write_b128 v240, v[64:67] offset:0
ds_write_b128 v240, v[68:71] offset:1152
ds_write_b128 v240, v[72:75] offset:2304
ds_write_b128 v240, v[76:79] offset:3456
s_waitcnt lgkmcnt(0)
ds_read_b128 v[64:67], v241 offset:0
ds_read_b128 v[68:71], v241 offset:1152
ds_read_b128 v[72:75], v241 offset:2304
ds_read_b128 v[76:79], v241 offset:3456
s_waitcnt lgkmcnt(0)
v_lshlrev_b32 v32, 16, v64
v_and_b32 v33, 0xffff0000, v64
v_lshlrev_b32 v34, 16, v65
v_and_b32 v35, 0xffff0000, v65
v_lshlrev_b32 v36, 16, v66
v_and_b32 v37, 0xffff0000, v66
v_lshlrev_b32 v38, 16, v67
v_and_b32 v39, 0xffff0000, v67
v_lshlrev_b32 v40, 16, v68
v_and_b32 v41, 0xffff0000, v68
v_lshlrev_b32 v42, 16, v69
v_and_b32 v43, 0xffff0000, v69
v_lshlrev_b32 v44, 16, v70
v_and_b32 v45, 0xffff0000, v70
v_lshlrev_b32 v46, 16, v71
v_and_b32 v47, 0xffff0000, v71
v_lshlrev_b32 v48, 16, v72
v_and_b32 v49, 0xffff0000, v72
v_lshlrev_b32 v50, 16, v73
v_and_b32 v51, 0xffff0000, v73
v_lshlrev_b32 v52, 16, v74
v_and_b32 v53, 0xffff0000, v74
v_lshlrev_b32 v54, 16, v75
v_and_b32 v55, 0xffff0000, v75
v_lshlrev_b32 v56, 16, v76
v_and_b32 v57, 0xffff0000, v76
v_lshlrev_b32 v58, 16, v77
v_and_b32 v59, 0xffff0000, v77
v_lshlrev_b32 v60, 16, v78
v_and_b32 v61, 0xffff0000, v78
v_lshlrev_b32 v62, 16, v79
v_and_b32 v63, 0xffff0000, v79
v_pk_add_f32 v[16:17], v[32:33], v[34:35] op_sel_hi:[1,1]
v_pk_add_f32 v[18:19], v[36:37], v[38:39] op_sel_hi:[1,1]
v_pk_add_f32 v[20:21], v[40:41], v[42:43] op_sel_hi:[1,1]
v_pk_add_f32 v[22:23], v[44:45], v[46:47] op_sel_hi:[1,1]
v_pk_add_f32 v[16:17], v[16:17], v[48:49] op_sel_hi:[1,1]
v_pk_add_f32 v[18:19], v[18:19], v[52:53] op_sel_hi:[1,1]
v_pk_add_f32 v[20:21], v[20:21], v[56:57] op_sel_hi:[1,1]
v_pk_add_f32 v[22:23], v[22:23], v[60:61] op_sel_hi:[1,1]
v_pk_add_f32 v[16:17], v[16:17], v[50:51] op_sel_hi:[1,1]
v_pk_add_f32 v[18:19], v[18:19], v[54:55] op_sel_hi:[1,1]
v_pk_add_f32 v[20:21], v[20:21], v[58:59] op_sel_hi:[1,1]
v_pk_add_f32 v[22:23], v[22:23], v[62:63] op_sel_hi:[1,1]
v_pk_add_f32 v[16:17], v[16:17], v[18:19] op_sel_hi:[1,1]
v_pk_add_f32 v[20:21], v[20:21], v[22:23] op_sel_hi:[1,1]
v_pk_add_f32 v[16:17], v[16:17], v[20:21] op_sel_hi:[1,1]
v_add_f32 v16, v16, v17
v_mul_f32 v24, 0xbd000000, v16
v_pk_add_f32 v[32:33], v[32:33], v[24:25] op_sel_hi:[1,0]
v_pk_add_f32 v[34:35], v[34:35], v[24:25] op_sel_hi:[1,0]
v_pk_add_f32 v[36:37], v[36:37], v[24:25] op_sel_hi:[1,0]
v_pk_add_f32 v[38:39], v[38:39], v[24:25] op_sel_hi:[1,0]
v_pk_add_f32 v[40:41], v[40:41], v[24:25] op_sel_hi:[1,0]
v_pk_add_f32 v[42:43], v[42:43], v[24:25] op_sel_hi:[1,0]
v_pk_add_f32 v[44:45], v[44:45], v[24:25] op_sel_hi:[1,0]
v_pk_add_f32 v[46:47], v[46:47], v[24:25] op_sel_hi:[1,0]
v_pk_add_f32 v[48:49], v[48:49], v[24:25] op_sel_hi:[1,0]
v_pk_add_f32 v[50:51], v[50:51], v[24:25] op_sel_hi:[1,0]
v_pk_add_f32 v[52:53], v[52:53], v[24:25] op_sel_hi:[1,0]
v_pk_add_f32 v[54:55], v[54:55], v[24:25] op_sel_hi:[1,0]
v_pk_add_f32 v[56:57], v[56:57], v[24:25] op_sel_hi:[1,0]
v_pk_add_f32 v[58:59], v[58:59], v[24:25] op_sel_hi:[1,0]
v_pk_add_f32 v[60:61], v[60:61], v[24:25] op_sel_hi:[1,0]
v_pk_add_f32 v[62:63], v[62:63], v[24:25] op_sel_hi:[1,0]
v_pk_mul_f32 v[16:17], v[32:33], v[32:33] op_sel_hi:[1,1]
v_pk_mul_f32 v[18:19], v[34:35], v[34:35] op_sel_hi:[1,1]
v_pk_fma_f32 v[16:17], v[36:37], v[36:37], v[16:17] op_sel_hi:[1,1,1]
v_pk_fma_f32 v[18:19], v[38:39], v[38:39], v[18:19] op_sel_hi:[1,1,1]
v_pk_fma_f32 v[16:17], v[40:41], v[40:41], v[16:17] op_sel_hi:[1,1,1]
v_pk_fma_f32 v[18:19], v[42:43], v[42:43], v[18:19] op_sel_hi:[1,1,1]
v_pk_fma_f32 v[16:17], v[44:45], v[44:45], v[16:17] op_sel_hi:[1,1,1]
v_pk_fma_f32 v[18:19], v[46:47], v[46:47], v[18:19] op_sel_hi:[1,1,1]
v_pk_fma_f32 v[16:17], v[48:49], v[48:49], v[16:17] op_sel_hi:[1,1,1]
v_pk_fma_f32 v[18:19], v[50:51], v[50:51], v[18:19] op_sel_hi:[1,1,1]
v_pk_fma_f32 v[16:17], v[52:53], v[52:53], v[16:17] op_sel_hi:[1,1,1]
v_pk_fma_f32 v[18:19], v[54:55], v[54:55], v[18:19] op_sel_hi:[1,1,1]
v_pk_fma_f32 v[16:17], v[56:57], v[56:57], v[16:17] op_sel_hi:[1,1,1]
v_pk_fma_f32 v[18:19], v[58:59], v[58:59], v[18:19] op_sel_hi:[1,1,1]
v_pk_fma_f32 v[16:17], v[60:61], v[60:61], v[16:17] op_sel_hi:[1,1,1]
v_pk_fma_f32 v[18:19], v[62:63], v[62:63], v[18:19] op_sel_hi:[1,1,1]
v_pk_add_f32 v[16:17], v[16:17], v[18:19] op_sel_hi:[1,1]
v_add_f32 v27, v16, v17
v_sub_f32 v26, 0, v24
v_mov_b32 v30, v26
s_nop 1
v_mov_b32_dpp v20, v26 row_ror:8 row_mask:0xf bank_mask:0xf
v_mov_b32_dpp v21, v27 row_ror:8 row_mask:0xf bank_mask:0xf
v_sub_f32 v22, v26, v20
v_add_f32 v26, v26, v20
v_add_f32 v27, v27, v21
v_mul_f32 v22, v22, v22
v_mul_f32 v26, 0.5, v26
v_fmac_f32 v27, 0x41800000, v22
v_mov_b32 v20, v26
v_mov_b32 v21, v27
s_nop 1
v_permlane16_swap_b32 v26, v20
v_permlane16_swap_b32 v27, v21
s_nop 1
v_sub_f32 v22, v26, v20
v_add_f32 v26, v26, v20
v_add_f32 v27, v27, v21
v_mul_f32 v22, v22, v22
v_mul_f32 v26, 0.5, v26
v_fmac_f32 v27, 0x42000000, v22
v_mov_b32 v20, v26
v_mov_b32 v21, v27
s_nop 1
v_permlane32_swap_b32 v26, v20
v_permlane32_swap_b32 v27, v21
s_nop 1
v_sub_f32 v22, v26, v20
v_add_f32 v26, v26, v20
v_add_f32 v27, v27, v21
v_mul_f32 v22, v22, v22
v_mul_f32 v26, 0.5, v26
v_fmac_f32 v27, 0x42800000, v22
ds_write_b64 v10, v[26:27]
s_waitcnt lgkmcnt(0)
s_barrier
ds_read_b128 v[16:19], v9
ds_read_b128 v[20:23], v9 offset:16
s_waitcnt lgkmcnt(0)
v_add_f32 v24, v16, v18
v_add_f32 v25, v20, v22
v_add_f32 v24, v24, v25
v_mul_f32 v24, 0.25, v24
v_add_f32 v25, v17, v19
v_add_f32 v26, v21, v23
v_add_f32 v25, v25, v26
v_sub_f32 v16, v16, v24
v_sub_f32 v18, v18, v24
v_sub_f32 v20, v20, v24
v_sub_f32 v22, v22, v24
v_mul_f32 v26, v16, v16
v_fmac_f32 v26, v18, v18
v_fmac_f32 v26, v20, v20
v_fmac_f32 v26, v22, v22
v_fmac_f32 v25, 0x43800000, v26
v_mov_b32 v26, 0x3727c5ac
v_fmac_f32 v26, 0x3a800000, v25
v_rsq_f32 v28, v26
v_sub_f32 v30, v30, v24
s_mov_b32 s63, s24
s_cmp_eq_u32 s26, 0
s_cbranch_scc1 adaLN_cond__sliding_block_cached__swiglu_ffn__prompt_kernel_wq_8
s_mov_b32 s16, s70
s_mov_b32 s17, s71
s_mov_b32 s18, 0x800000
s_mov_b32 s19, 0x20000
v_lshrrev_b32 v15, 4, v0
v_and_b32 v12, 15, v0
v_lshlrev_b32 v15, 13, v15
v_lshl_add_u32 v15, v12, 7, v15
s_lshl_b32 s36, s21, 17
s_lshl_b32 s37, s22, 11
s_add_u32 s36, s36, s37
s_lshl_b32 s37, s23, 22
s_add_u32 s36, s36, s37
buffer_load_dword v13, v15, s[16:19], s36 offen
s_cmp_lg_u32 s26, 1
s_cbranch_scc1 adaLN_cond__sliding_block_cached__swiglu_ffn__prompt_kernel_wq_8
v_subrev_u32 v15, 0x8000, v15
buffer_load_dword v14, v15, s[16:19], s36 offen
adaLN_cond__sliding_block_cached__swiglu_ffn__prompt_kernel_wq_8:
s_cmp_lg_u32 s26, 0
s_cbranch_scc1 adaLN_cond__sliding_block_cached__swiglu_ffn__prompt_kernel_ws_11
s_mov_b32 s6, s88
s_mov_b32 s7, s89
v_mov_b32 v2, 0
s_mov_b32 s27, 0
s_mov_b64 exec, 1
adaLN_cond__sliding_block_cached__swiglu_ffn__prompt_kernel_wt_9:
global_load_dword v3, v2, s[6:7] offset:128 sc1
s_waitcnt vmcnt(0)
v_readfirstlane_b32 s28, v3
s_add_u32 s27, s27, 1
s_cmp_ge_u32 s28, 1
s_cbranch_scc1 adaLN_cond__sliding_block_cached__swiglu_ffn__prompt_kernel_wd_10
s_cmp_ge_u32 s27, 0x40000
s_cbranch_scc1 adaLN_cond__sliding_block_cached__swiglu_ffn__prompt_kernel_wd_10
s_sleep 2
s_branch adaLN_cond__sliding_block_cached__swiglu_ffn__prompt_kernel_wt_9
adaLN_cond__sliding_block_cached__swiglu_ffn__prompt_kernel_wd_10:
s_mov_b64 exec, -1
adaLN_cond__sliding_block_cached__swiglu_ffn__prompt_kernel_ws_11:
s_barrier
s_mov_b32 s8, s90
s_mov_b32 s9, s91
s_mov_b32 s10, 0x10000
s_mov_b32 s11, 0x20000
s_mov_b32 s27, 0
buffer_load_dwordx4 v[96:99], v7, s[8:11], s27 offen sc1
s_mov_b32 s27, 8192
buffer_load_dwordx4 v[100:103], v7, s[8:11], s27 offen sc1
s_mov_b32 s27, 16384
buffer_load_dwordx4 v[104:107], v7, s[8:11], s27 offen sc1
s_mov_b32 s27, 24576
buffer_load_dwordx4 v[108:111], v7, s[8:11], s27 offen sc1
s_mov_b32 s27, 4096
buffer_load_dwordx4 v[112:115], v7, s[8:11], s27 offen sc1
s_mov_b32 s27, 12288
buffer_load_dwordx4 v[116:119], v7, s[8:11], s27 offen sc1
s_mov_b32 s27, 20480
buffer_load_dwordx4 v[120:123], v7, s[8:11], s27 offen sc1
s_mov_b32 s27, 28672
buffer_load_dwordx4 v[124:127], v7, s[8:11], s27 offen sc1
s_waitcnt vmcnt(0)
v_add_f32 v96, v96, v100
v_add_f32 v97, v97, v101
v_add_f32 v98, v98, v102
v_add_f32 v99, v99, v103
v_add_f32 v96, v96, v104
v_add_f32 v97, v97, v105
v_add_f32 v98, v98, v106
v_add_f32 v99, v99, v107
v_add_f32 v96, v96, v108
v_add_f32 v97, v97, v109
v_add_f32 v98, v98, v110
v_add_f32 v99, v99, v111
v_cvt_pk_bf16_f32 v100, v96, v97
v_cvt_pk_bf16_f32 v101, v98, v99
v_lshlrev_b32 v96, 16, v100
v_and_b32 v97, 0xffff0000, v100
v_lshlrev_b32 v98, 16, v101
v_and_b32 v99, 0xffff0000, v101
v_mul_f32 v96, 0x3e0293ee, v96
v_mul_f32 v97, 0x3e0293ee, v97
v_mul_f32 v98, 0x3e0293ee, v98
v_mul_f32 v99, 0x3e0293ee, v99
ds_write_b128 v11, v[96:99] offset:0
v_add_f32 v112, v112, v116
v_add_f32 v113, v113, v117
v_add_f32 v114, v114, v118
v_add_f32 v115, v115, v119
v_add_f32 v112, v112, v120
v_add_f32 v113, v113, v121
v_add_f32 v114, v114, v122
v_add_f32 v115, v115, v123
v_add_f32 v112, v112, v124
v_add_f32 v113, v113, v125
v_add_f32 v114, v114, v126
v_add_f32 v115, v115, v127
v_cvt_pk_bf16_f32 v116, v112, v113
v_cvt_pk_bf16_f32 v117, v114, v115
v_lshlrev_b32 v112, 16, v116
v_and_b32 v113, 0xffff0000, v116
v_lshlrev_b32 v114, 16, v117
v_and_b32 v115, 0xffff0000, v117
v_add_f32 v112, 1.0, v112
v_add_f32 v113, 1.0, v113
v_add_f32 v114, 1.0, v114
v_add_f32 v115, 1.0, v115
v_cvt_pk_bf16_f32 v116, v112, v113
v_cvt_pk_bf16_f32 v117, v114, v115
v_lshlrev_b32 v112, 16, v116
v_and_b32 v113, 0xffff0000, v116
v_lshlrev_b32 v114, 16, v117
v_and_b32 v115, 0xffff0000, v117
v_mul_f32 v112, 0x3e0293ee, v112
v_mul_f32 v113, 0x3e0293ee, v113
v_mul_f32 v114, 0x3e0293ee, v114
v_mul_f32 v115, 0x3e0293ee, v115
ds_write_b128 v11, v[112:115] offset:4096
s_waitcnt lgkmcnt(0)
s_barrier
ds_read_b128 v[144:147], v8 offset:4096
ds_read_b128 v[148:151], v8 offset:4112
ds_read_b128 v[152:155], v8 offset:4352
ds_read_b128 v[156:159], v8 offset:4368
ds_read_b128 v[160:163], v8 offset:4608
ds_read_b128 v[164:167], v8 offset:4624
ds_read_b128 v[168:171], v8 offset:4864
ds_read_b128 v[172:175], v8 offset:4880
s_waitcnt lgkmcnt(0)
ds_read_b128 v[176:179], v8 offset:0
ds_read_b128 v[180:183], v8 offset:16
ds_read_b128 v[184:187], v8 offset:256
ds_read_b128 v[188:191], v8 offset:272
ds_read_b128 v[192:195], v8 offset:512
ds_read_b128 v[196:199], v8 offset:528
ds_read_b128 v[200:203], v8 offset:768
ds_read_b128 v[204:207], v8 offset:784
s_waitcnt lgkmcnt(0)
s_add_u32 s16, s90, 0x100000
s_addc_u32 s17, s91, 0
s_mov_b32 s18, 0x400000
s_mov_b32 s19, 0x20000
v_pk_mul_f32 v[144:145], v[144:145], v[28:29] op_sel_hi:[1,0]
v_pk_mul_f32 v[146:147], v[146:147], v[28:29] op_sel_hi:[1,0]
v_pk_mul_f32 v[148:149], v[148:149], v[28:29] op_sel_hi:[1,0]
v_pk_mul_f32 v[150:151], v[150:151], v[28:29] op_sel_hi:[1,0]
v_pk_fma_f32 v[176:177], v[144:145], v[30:31], v[176:177] op_sel_hi:[1,0,1]
v_pk_fma_f32 v[178:179], v[146:147], v[30:31], v[178:179] op_sel_hi:[1,0,1]
v_pk_fma_f32 v[180:181], v[148:149], v[30:31], v[180:181] op_sel_hi:[1,0,1]
v_pk_fma_f32 v[182:183], v[150:151], v[30:31], v[182:183] op_sel_hi:[1,0,1]
v_pk_fma_f32 v[32:33], v[32:33], v[144:145], v[176:177] op_sel_hi:[1,1,1]
v_pk_fma_f32 v[34:35], v[34:35], v[146:147], v[178:179] op_sel_hi:[1,1,1]
v_pk_fma_f32 v[36:37], v[36:37], v[148:149], v[180:181] op_sel_hi:[1,1,1]
v_pk_fma_f32 v[38:39], v[38:39], v[150:151], v[182:183] op_sel_hi:[1,1,1]
v_cvt_pk_bf16_f32 v104, v32, v33
v_cvt_pk_bf16_f32 v105, v34, v35
v_cvt_pk_bf16_f32 v106, v36, v37
v_cvt_pk_bf16_f32 v107, v38, v39
buffer_store_dwordx4 v[104:107], v5, s[16:19], s40 offen sc1
v_pk_mul_f32 v[152:153], v[152:153], v[28:29] op_sel_hi:[1,0]
v_pk_mul_f32 v[154:155], v[154:155], v[28:29] op_sel_hi:[1,0]
v_pk_mul_f32 v[156:157], v[156:157], v[28:29] op_sel_hi:[1,0]
v_pk_mul_f32 v[158:159], v[158:159], v[28:29] op_sel_hi:[1,0]
v_pk_fma_f32 v[184:185], v[152:153], v[30:31], v[184:185] op_sel_hi:[1,0,1]
v_pk_fma_f32 v[186:187], v[154:155], v[30:31], v[186:187] op_sel_hi:[1,0,1]
v_pk_fma_f32 v[188:189], v[156:157], v[30:31], v[188:189] op_sel_hi:[1,0,1]
v_pk_fma_f32 v[190:191], v[158:159], v[30:31], v[190:191] op_sel_hi:[1,0,1]
v_pk_fma_f32 v[40:41], v[40:41], v[152:153], v[184:185] op_sel_hi:[1,1,1]
v_pk_fma_f32 v[42:43], v[42:43], v[154:155], v[186:187] op_sel_hi:[1,1,1]
v_pk_fma_f32 v[44:45], v[44:45], v[156:157], v[188:189] op_sel_hi:[1,1,1]
v_pk_fma_f32 v[46:47], v[46:47], v[158:159], v[190:191] op_sel_hi:[1,1,1]
v_cvt_pk_bf16_f32 v108, v40, v41
v_cvt_pk_bf16_f32 v109, v42, v43
v_cvt_pk_bf16_f32 v110, v44, v45
v_cvt_pk_bf16_f32 v111, v46, v47
buffer_store_dwordx4 v[108:111], v5, s[16:19], s41 offen sc1
v_pk_mul_f32 v[160:161], v[160:161], v[28:29] op_sel_hi:[1,0]
v_pk_mul_f32 v[162:163], v[162:163], v[28:29] op_sel_hi:[1,0]
v_pk_mul_f32 v[164:165], v[164:165], v[28:29] op_sel_hi:[1,0]
v_pk_mul_f32 v[166:167], v[166:167], v[28:29] op_sel_hi:[1,0]
v_pk_fma_f32 v[192:193], v[160:161], v[30:31], v[192:193] op_sel_hi:[1,0,1]
v_pk_fma_f32 v[194:195], v[162:163], v[30:31], v[194:195] op_sel_hi:[1,0,1]
v_pk_fma_f32 v[196:197], v[164:165], v[30:31], v[196:197] op_sel_hi:[1,0,1]
v_pk_fma_f32 v[198:199], v[166:167], v[30:31], v[198:199] op_sel_hi:[1,0,1]
v_pk_fma_f32 v[48:49], v[48:49], v[160:161], v[192:193] op_sel_hi:[1,1,1]
v_pk_fma_f32 v[50:51], v[50:51], v[162:163], v[194:195] op_sel_hi:[1,1,1]
v_pk_fma_f32 v[52:53], v[52:53], v[164:165], v[196:197] op_sel_hi:[1,1,1]
v_pk_fma_f32 v[54:55], v[54:55], v[166:167], v[198:199] op_sel_hi:[1,1,1]
v_cvt_pk_bf16_f32 v112, v48, v49
v_cvt_pk_bf16_f32 v113, v50, v51
v_cvt_pk_bf16_f32 v114, v52, v53
v_cvt_pk_bf16_f32 v115, v54, v55
buffer_store_dwordx4 v[112:115], v5, s[16:19], s42 offen sc1
v_pk_mul_f32 v[168:169], v[168:169], v[28:29] op_sel_hi:[1,0]
v_pk_mul_f32 v[170:171], v[170:171], v[28:29] op_sel_hi:[1,0]
v_pk_mul_f32 v[172:173], v[172:173], v[28:29] op_sel_hi:[1,0]
v_pk_mul_f32 v[174:175], v[174:175], v[28:29] op_sel_hi:[1,0]
v_pk_fma_f32 v[200:201], v[168:169], v[30:31], v[200:201] op_sel_hi:[1,0,1]
v_pk_fma_f32 v[202:203], v[170:171], v[30:31], v[202:203] op_sel_hi:[1,0,1]
v_pk_fma_f32 v[204:205], v[172:173], v[30:31], v[204:205] op_sel_hi:[1,0,1]
v_pk_fma_f32 v[206:207], v[174:175], v[30:31], v[206:207] op_sel_hi:[1,0,1]
v_pk_fma_f32 v[56:57], v[56:57], v[168:169], v[200:201] op_sel_hi:[1,1,1]
v_pk_fma_f32 v[58:59], v[58:59], v[170:171], v[202:203] op_sel_hi:[1,1,1]
v_pk_fma_f32 v[60:61], v[60:61], v[172:173], v[204:205] op_sel_hi:[1,1,1]
v_pk_fma_f32 v[62:63], v[62:63], v[174:175], v[206:207] op_sel_hi:[1,1,1]
v_cvt_pk_bf16_f32 v116, v56, v57
v_cvt_pk_bf16_f32 v117, v58, v59
v_cvt_pk_bf16_f32 v118, v60, v61
v_cvt_pk_bf16_f32 v119, v62, v63
buffer_store_dwordx4 v[116:119], v5, s[16:19], s43 offen sc1
s_waitcnt vmcnt(0)
s_barrier
s_cmp_lg_u32 s26, 0
s_cbranch_scc1 adaLN_cond__sliding_block_cached__swiglu_ffn__prompt_kernel_arr_12
s_add_u32 s27, s63, 0
s_lshl_b32 s6, s27, 8
s_add_u32 s6, s6, 0x20000
s_add_u32 s6, s6, s90
s_addc_u32 s7, s91, 0
v_mov_b32 v2, 0
v_mov_b32 v3, 1
s_mov_b64 exec, 1
global_atomic_add v2, v3, s[6:7] sc1
s_mov_b64 exec, -1
adaLN_cond__sliding_block_cached__swiglu_ffn__prompt_kernel_arr_12:
s_lshl_b32 s35, s22, 3
s_add_u32 s35, s35, s25
s_mov_b32 s62, s35
v_lshrrev_b32 v40, 5, v1
v_lshlrev_b32 v40, 11, v40
v_bfe_u32 v41, v1, 2, 2
v_lshl_add_u32 v40, v41, 8, v40
v_bfe_u32 v42, v1, 4, 1
v_lshl_add_u32 v40, v42, 5, v40
v_and_b32 v42, 1, v1
v_lshl_add_u32 v40, v42, 4, v40
v_bfe_u32 v42, v1, 1, 1
v_lshl_add_u32 v40, v42, 3, v40
v_xor_b32 v42, 0, v41
v_lshl_add_u32 v4, v42, 6, v40
v_xor_b32 v42, 1, v41
v_lshl_add_u32 v5, v42, 6, v40
v_xor_b32 v42, 2, v41
v_lshl_add_u32 v6, v42, 6, v40
v_xor_b32 v42, 3, v41
v_lshl_add_u32 v7, v42, 6, v40
v_lshlrev_b32 v8, 4, v1
v_add_u32 v9, 0x10000, v8
s_lshl_b32 s28, s62, 8
v_lshrrev_b32 v40, 4, v1
v_bfe_u32 v41, v1, 2, 2
v_xor_b32 v41, v41, v40
v_and_b32 v42, 3, v1
v_lshlrev_b32 v42, 4, v42
v_lshl_add_u32 v42, v41, 6, v42
s_lshl_b32 s27, s26, 4
v_add_u32 v40, s27, v40
v_mul_u32_u24 v40, 8192, v40
v_add3_u32 v10, v40, v42, s28
v_add_u32 v11, 0x7c00, v10
v_add_u32 v12, 0xf800, v10
v_add_u32 v13, 0x17400, v10
s_add_u32 s8, s90, 0x100000
s_addc_u32 s9, s91, 0
s_mov_b32 s10, 0x400000
s_mov_b32 s11, 0x20000
s_mov_b32 s12, s70
s_mov_b32 s13, s71
s_mov_b32 s14, 0x800000
s_mov_b32 s15, 0x20000
s_lshl_b32 s27, s24, 3
s_lshl_b32 s28, s26, 1
s_add_u32 s34, s27, s28
s_lshl_b32 s30, s34, 16
s_sub_u32 s30, s30, 4096
s_mov_b32 s31, 0xfff80000
s_lshl_b32 s32, s26, 12
s_add_u32 s31, s31, 0x80000
s_add_u32 m0, s32, 0x0
s_nop 0
buffer_load_dwordx4 v10, s[12:15], s31 offen offset:0 lds
buffer_load_dwordx4 v11, s[12:15], s31 offen offset:1024 lds
buffer_load_dwordx4 v12, s[12:15], s31 offen offset:2048 lds
buffer_load_dwordx4 v13, s[12:15], s31 offen offset:3072 lds
s_add_u32 s31, s31, 0x80000
s_add_u32 m0, s32, 0x4000
s_nop 0
buffer_load_dwordx4 v10, s[12:15], s31 offen offset:0 lds
buffer_load_dwordx4 v11, s[12:15], s31 offen offset:1024 lds
buffer_load_dwordx4 v12, s[12:15], s31 offen offset:2048 lds
buffer_load_dwordx4 v13, s[12:15], s31 offen offset:3072 lds
s_add_u32 s31, s31, 0x80000
s_add_u32 m0, s32, 0x8000
s_nop 0
buffer_load_dwordx4 v10, s[12:15], s31 offen offset:0 lds
s_lshl_b32 s27, s26, 12
v_add_u32 v28, s27, v8
v_add_u32 v16, 65536, v8
v_add_u32 v17, 114688, v8
v_lshlrev_b32 v18, 7, v1
s_lshl_b32 s27, s26, 13
v_add_u32 v18, s27, v18
s_lshl_b32 s27, s22, 17
s_add_u32 s28, s27, 0x5b00000
s_add_u32 s44, s90, s28
s_addc_u32 s45, s91, 0
s_mov_b32 s46, 0x20000
s_mov_b32 s47, 0x20000
s_add_u32 s28, s27, 0x5b80000
s_add_u32 s48, s90, s28
s_addc_u32 s49, s91, 0
s_mov_b32 s50, 0x20000
s_mov_b32 s51, 0x20000
v_mov_b32 v37, 0xff800000
v_mov_b32 v38, 0xff800000
s_mov_b32 s59, 0
s_cmp_lg_u32 s26, 0
s_cbranch_scc1 adaLN_cond__sliding_block_cached__swiglu_ffn__prompt_kernel_ws_15
s_mov_b32 s6, s88
s_mov_b32 s7, s89
v_mov_b32 v2, 0
s_mov_b32 s27, 0
s_mov_b64 exec, 1
adaLN_cond__sliding_block_cached__swiglu_ffn__prompt_kernel_wt_13:
global_load_dword v3, v2, s[6:7] offset:4 sc1
s_waitcnt vmcnt(0)
v_readfirstlane_b32 s28, v3
s_add_u32 s27, s27, 1
s_cmp_ge_u32 s28, 128
s_cbranch_scc1 adaLN_cond__sliding_block_cached__swiglu_ffn__prompt_kernel_wd_14
s_cmp_ge_u32 s27, 0x40000
s_cbranch_scc1 adaLN_cond__sliding_block_cached__swiglu_ffn__prompt_kernel_wd_14
s_sleep 2
s_branch adaLN_cond__sliding_block_cached__swiglu_ffn__prompt_kernel_wt_13
adaLN_cond__sliding_block_cached__swiglu_ffn__prompt_kernel_wd_14:
s_mov_b64 exec, -1
adaLN_cond__sliding_block_cached__swiglu_ffn__prompt_kernel_ws_15:
s_barrier
s_cmp_lg_u32 s26, 0
s_cbranch_scc1 adaLN_cond__sliding_block_cached__swiglu_ffn__prompt_kernel_ws_18
s_add_u32 s27, s24, 0
s_lshl_b32 s6, s27, 8
s_add_u32 s6, s6, 0x20000
s_add_u32 s6, s6, s90
s_addc_u32 s7, s91, 0
v_mov_b32 v2, 0
s_mov_b32 s27, 0
s_mov_b64 exec, 1
adaLN_cond__sliding_block_cached__swiglu_ffn__prompt_kernel_wt_16:
global_load_dword v3, v2, s[6:7] offset:0 sc1
s_waitcnt vmcnt(0)
v_readfirstlane_b32 s28, v3
s_add_u32 s27, s27, 1
s_cmp_ge_u32 s28, 32
s_cbranch_scc1 adaLN_cond__sliding_block_cached__swiglu_ffn__prompt_kernel_wd_17
s_cmp_ge_u32 s27, 0x40000
s_cbranch_scc1 adaLN_cond__sliding_block_cached__swiglu_ffn__prompt_kernel_wd_17
s_sleep 2
s_branch adaLN_cond__sliding_block_cached__swiglu_ffn__prompt_kernel_wt_16
adaLN_cond__sliding_block_cached__swiglu_ffn__prompt_kernel_wd_17:
s_mov_b64 exec, -1
adaLN_cond__sliding_block_cached__swiglu_ffn__prompt_kernel_ws_18:
s_barrier
s_add_u32 s30, s30, 4096
buffer_load_dwordx4 a[0:3], v8, s[8:11], s30 offen offset:0 sc1
buffer_load_dwordx4 a[16:19], v9, s[8:11], s30 offen offset:0 sc1
buffer_load_dwordx4 a[4:7], v8, s[8:11], s30 offen offset:1024 sc1
buffer_load_dwordx4 a[20:23], v9, s[8:11], s30 offen offset:1024 sc1
buffer_load_dwordx4 a[8:11], v8, s[8:11], s30 offen offset:2048 sc1
buffer_load_dwordx4 a[24:27], v9, s[8:11], s30 offen offset:2048 sc1
buffer_load_dwordx4 a[12:15], v8, s[8:11], s30 offen offset:3072 sc1
buffer_load_dwordx4 a[28:31], v9, s[8:11], s30 offen offset:3072 sc1
s_add_u32 s30, s30, 4096
buffer_load_dwordx4 a[32:35], v8, s[8:11], s30 offen offset:0 sc1
buffer_load_dwordx4 a[48:51], v9, s[8:11], s30 offen offset:0 sc1
buffer_load_dwordx4 a[36:39], v8, s[8:11], s30 offen offset:1024 sc1
buffer_load_dwordx4 a[52:55], v9, s[8:11], s30 offen offset:1024 sc1
buffer_load_dwordx4 a[40:43], v8, s[8:11], s30 offen offset:2048 sc1
buffer_load_dwordx4 a[56:59], v9, s[8:11], s30 offen offset:2048 sc1
buffer_load_dwordx4 a[44:47], v8, s[8:11], s30 offen offset:3072 sc1
buffer_load_dwordx4 a[60:63], v9, s[8:11], s30 offen offset:3072 sc1
s_waitcnt vmcnt(10)
s_barrier
ds_read_b64_tr_b16 a[128:129], v4 offset:0
ds_read_b64_tr_b16 a[130:131], v4 offset:1024
ds_read_b64_tr_b16 a[132:133], v5 offset:0
ds_read_b64_tr_b16 a[134:135], v5 offset:1024
ds_read_b64_tr_b16 a[136:137], v6 offset:0
ds_read_b64_tr_b16 a[138:139], v6 offset:1024
ds_read_b64_tr_b16 a[140:141], v7 offset:0
ds_read_b64_tr_b16 a[142:143], v7 offset:1024
s_waitcnt lgkmcnt(0)
v_mfma_f32_32x32x16_bf16 v[128:143], a[128:131], a[0:3], 0
ds_read_b64_tr_b16 a[144:145], v4 offset:4096
ds_read_b64_tr_b16 a[146:147], v4 offset:5120
v_mfma_f32_32x32x16_bf16 v[144:159], a[128:131], a[16:19], 0
ds_read_b64_tr_b16 a[148:149], v5 offset:4096
ds_read_b64_tr_b16 a[150:151], v5 offset:5120
v_mfma_f32_32x32x16_bf16 v[160:175], a[132:135], a[0:3], 0
ds_read_b64_tr_b16 a[152:153], v6 offset:4096
ds_read_b64_tr_b16 a[154:155], v6 offset:5120
v_mfma_f32_32x32x16_bf16 v[176:191], a[132:135], a[16:19], 0
ds_read_b64_tr_b16 a[156:157], v7 offset:4096
ds_read_b64_tr_b16 a[158:159], v7 offset:5120
v_mfma_f32_32x32x16_bf16 v[192:207], a[136:139], a[0:3], 0
s_add_u32 s30, s30, 4096
buffer_load_dwordx4 a[64:67], v8, s[8:11], s30 offen offset:0 sc1
v_mfma_f32_32x32x16_bf16 v[208:223], a[136:139], a[16:19], 0
buffer_load_dwordx4 v11, s[12:15], s31 offen offset:1024 lds
v_mfma_f32_32x32x16_bf16 v[224:239], a[140:143], a[0:3], 0
buffer_load_dwordx4 a[80:83], v9, s[8:11], s30 offen offset:0 sc1
v_mfma_f32_32x32x16_bf16 v[240:255], a[140:143], a[16:19], 0
buffer_load_dwordx4 a[68:71], v8, s[8:11], s30 offen offset:1024 sc1
s_waitcnt lgkmcnt(0)
v_mfma_f32_32x32x16_bf16 v[128:143], a[144:147], a[4:7], v[128:143]
ds_read_b64_tr_b16 a[128:129], v4 offset:8192
ds_read_b64_tr_b16 a[130:131], v4 offset:9216
v_mfma_f32_32x32x16_bf16 v[144:159], a[144:147], a[20:23], v[144:159]
ds_read_b64_tr_b16 a[132:133], v5 offset:8192
ds_read_b64_tr_b16 a[134:135], v5 offset:9216
v_mfma_f32_32x32x16_bf16 v[160:175], a[148:151], a[4:7], v[160:175]
ds_read_b64_tr_b16 a[136:137], v6 offset:8192
ds_read_b64_tr_b16 a[138:139], v6 offset:9216
v_mfma_f32_32x32x16_bf16 v[176:191], a[148:151], a[20:23], v[176:191]
ds_read_b64_tr_b16 a[140:141], v7 offset:8192
ds_read_b64_tr_b16 a[142:143], v7 offset:9216
v_mfma_f32_32x32x16_bf16 v[192:207], a[152:155], a[4:7], v[192:207]
buffer_load_dwordx4 v12, s[12:15], s31 offen offset:2048 lds
v_mfma_f32_32x32x16_bf16 v[208:223], a[152:155], a[20:23], v[208:223]
buffer_load_dwordx4 a[84:87], v9, s[8:11], s30 offen offset:1024 sc1
v_mfma_f32_32x32x16_bf16 v[224:239], a[156:159], a[4:7], v[224:239]
buffer_load_dwordx4 a[72:75], v8, s[8:11], s30 offen offset:2048 sc1
v_mfma_f32_32x32x16_bf16 v[240:255], a[156:159], a[20:23], v[240:255]
buffer_load_dwordx4 v13, s[12:15], s31 offen offset:3072 lds
s_waitcnt lgkmcnt(0)
v_mfma_f32_32x32x16_bf16 v[128:143], a[128:131], a[8:11], v[128:143]
ds_read_b64_tr_b16 a[144:145], v4 offset:12288
ds_read_b64_tr_b16 a[146:147], v4 offset:13312
v_mfma_f32_32x32x16_bf16 v[144:159], a[128:131], a[24:27], v[144:159]
ds_read_b64_tr_b16 a[148:149], v5 offset:12288
ds_read_b64_tr_b16 a[150:151], v5 offset:13312
v_mfma_f32_32x32x16_bf16 v[160:175], a[132:135], a[8:11], v[160:175]
ds_read_b64_tr_b16 a[152:153], v6 offset:12288
ds_read_b64_tr_b16 a[154:155], v6 offset:13312
v_mfma_f32_32x32x16_bf16 v[176:191], a[132:135], a[24:27], v[176:191]
ds_read_b64_tr_b16 a[156:157], v7 offset:12288
ds_read_b64_tr_b16 a[158:159], v7 offset:13312
v_mfma_f32_32x32x16_bf16 v[192:207], a[136:139], a[8:11], v[192:207]
buffer_load_dwordx4 a[88:91], v9, s[8:11], s30 offen offset:2048 sc1
v_mfma_f32_32x32x16_bf16 v[208:223], a[136:139], a[24:27], v[208:223]
buffer_load_dwordx4 a[76:79], v8, s[8:11], s30 offen offset:3072 sc1
v_mfma_f32_32x32x16_bf16 v[224:239], a[140:143], a[8:11], v[224:239]
s_add_u32 s31, s31, 0x80000
s_add_u32 m0, s32, 0xc000
s_nop 0
buffer_load_dwordx4 v10, s[12:15], s31 offen offset:0 lds
v_mfma_f32_32x32x16_bf16 v[240:255], a[140:143], a[24:27], v[240:255]
buffer_load_dwordx4 a[92:95], v9, s[8:11], s30 offen offset:3072 sc1
s_waitcnt vmcnt(14) lgkmcnt(0)
s_barrier
v_mfma_f32_32x32x16_bf16 v[128:143], a[144:147], a[12:15], v[128:143]
ds_read_b64_tr_b16 a[128:129], v4 offset:16384
ds_read_b64_tr_b16 a[130:131], v4 offset:17408
v_mfma_f32_32x32x16_bf16 v[144:159], a[144:147], a[28:31], v[144:159]
ds_read_b64_tr_b16 a[132:133], v5 offset:16384
ds_read_b64_tr_b16 a[134:135], v5 offset:17408
v_mfma_f32_32x32x16_bf16 v[160:175], a[148:151], a[12:15], v[160:175]
ds_read_b64_tr_b16 a[136:137], v6 offset:16384
ds_read_b64_tr_b16 a[138:139], v6 offset:17408
v_mfma_f32_32x32x16_bf16 v[176:191], a[148:151], a[28:31], v[176:191]
ds_read_b64_tr_b16 a[140:141], v7 offset:16384
ds_read_b64_tr_b16 a[142:143], v7 offset:17408
v_mfma_f32_32x32x16_bf16 v[192:207], a[152:155], a[12:15], v[192:207]
s_add_u32 s30, s30, 4096
buffer_load_dwordx4 a[96:99], v8, s[8:11], s30 offen offset:0 sc1
v_mfma_f32_32x32x16_bf16 v[208:223], a[152:155], a[28:31], v[208:223]
buffer_load_dwordx4 v11, s[12:15], s31 offen offset:1024 lds
v_mfma_f32_32x32x16_bf16 v[224:239], a[156:159], a[12:15], v[224:239]
buffer_load_dwordx4 a[112:115], v9, s[8:11], s30 offen offset:0 sc1
v_mfma_f32_32x32x16_bf16 v[240:255], a[156:159], a[28:31], v[240:255]
buffer_load_dwordx4 a[100:103], v8, s[8:11], s30 offen offset:1024 sc1
s_waitcnt lgkmcnt(0)
v_mfma_f32_32x32x16_bf16 v[128:143], a[128:131], a[32:35], v[128:143]
ds_read_b64_tr_b16 a[144:145], v4 offset:20480
ds_read_b64_tr_b16 a[146:147], v4 offset:21504
v_mfma_f32_32x32x16_bf16 v[144:159], a[128:131], a[48:51], v[144:159]
ds_read_b64_tr_b16 a[148:149], v5 offset:20480
ds_read_b64_tr_b16 a[150:151], v5 offset:21504
v_mfma_f32_32x32x16_bf16 v[160:175], a[132:135], a[32:35], v[160:175]
ds_read_b64_tr_b16 a[152:153], v6 offset:20480
ds_read_b64_tr_b16 a[154:155], v6 offset:21504
v_mfma_f32_32x32x16_bf16 v[176:191], a[132:135], a[48:51], v[176:191]
ds_read_b64_tr_b16 a[156:157], v7 offset:20480
ds_read_b64_tr_b16 a[158:159], v7 offset:21504
v_mfma_f32_32x32x16_bf16 v[192:207], a[136:139], a[32:35], v[192:207]
buffer_load_dwordx4 v12, s[12:15], s31 offen offset:2048 lds
v_mfma_f32_32x32x16_bf16 v[208:223], a[136:139], a[48:51], v[208:223]
buffer_load_dwordx4 a[116:119], v9, s[8:11], s30 offen offset:1024 sc1
v_mfma_f32_32x32x16_bf16 v[224:239], a[140:143], a[32:35], v[224:239]
buffer_load_dwordx4 a[104:107], v8, s[8:11], s30 offen offset:2048 sc1
v_mfma_f32_32x32x16_bf16 v[240:255], a[140:143], a[48:51], v[240:255]
buffer_load_dwordx4 v13, s[12:15], s31 offen offset:3072 lds
s_waitcnt lgkmcnt(0)
v_mfma_f32_32x32x16_bf16 v[128:143], a[144:147], a[36:39], v[128:143]
ds_read_b64_tr_b16 a[128:129], v4 offset:24576
ds_read_b64_tr_b16 a[130:131], v4 offset:25600
v_mfma_f32_32x32x16_bf16 v[144:159], a[144:147], a[52:55], v[144:159]
ds_read_b64_tr_b16 a[132:133], v5 offset:24576
ds_read_b64_tr_b16 a[134:135], v5 offset:25600
v_mfma_f32_32x32x16_bf16 v[160:175], a[148:151], a[36:39], v[160:175]
ds_read_b64_tr_b16 a[136:137], v6 offset:24576
ds_read_b64_tr_b16 a[138:139], v6 offset:25600
v_mfma_f32_32x32x16_bf16 v[176:191], a[148:151], a[52:55], v[176:191]
ds_read_b64_tr_b16 a[140:141], v7 offset:24576
ds_read_b64_tr_b16 a[142:143], v7 offset:25600
v_mfma_f32_32x32x16_bf16 v[192:207], a[152:155], a[36:39], v[192:207]
buffer_load_dwordx4 a[120:123], v9, s[8:11], s30 offen offset:2048 sc1
v_mfma_f32_32x32x16_bf16 v[208:223], a[152:155], a[52:55], v[208:223]
buffer_load_dwordx4 a[108:111], v8, s[8:11], s30 offen offset:3072 sc1
v_mfma_f32_32x32x16_bf16 v[224:239], a[156:159], a[36:39], v[224:239]
s_add_u32 s31, s31, 0x80000
s_add_u32 m0, s32, 0x0
s_nop 0
buffer_load_dwordx4 v10, s[12:15], s31 offen offset:0 lds
v_mfma_f32_32x32x16_bf16 v[240:255], a[156:159], a[52:55], v[240:255]
buffer_load_dwordx4 a[124:127], v9, s[8:11], s30 offen offset:3072 sc1
s_waitcnt lgkmcnt(0)
v_mfma_f32_32x32x16_bf16 v[128:143], a[128:131], a[40:43], v[128:143]
ds_read_b64_tr_b16 a[144:145], v4 offset:28672
ds_read_b64_tr_b16 a[146:147], v4 offset:29696
v_mfma_f32_32x32x16_bf16 v[144:159], a[128:131], a[56:59], v[144:159]
ds_read_b64_tr_b16 a[148:149], v5 offset:28672
ds_read_b64_tr_b16 a[150:151], v5 offset:29696
v_mfma_f32_32x32x16_bf16 v[160:175], a[132:135], a[40:43], v[160:175]
ds_read_b64_tr_b16 a[152:153], v6 offset:28672
ds_read_b64_tr_b16 a[154:155], v6 offset:29696
v_mfma_f32_32x32x16_bf16 v[176:191], a[132:135], a[56:59], v[176:191]
ds_read_b64_tr_b16 a[156:157], v7 offset:28672
ds_read_b64_tr_b16 a[158:159], v7 offset:29696
v_mfma_f32_32x32x16_bf16 v[192:207], a[136:139], a[40:43], v[192:207]
s_add_u32 s30, s30, 4096
buffer_load_dwordx4 a[0:3], v8, s[8:11], s30 offen offset:0 sc1
v_mfma_f32_32x32x16_bf16 v[208:223], a[136:139], a[56:59], v[208:223]
buffer_load_dwordx4 v11, s[12:15], s31 offen offset:1024 lds
v_mfma_f32_32x32x16_bf16 v[224:239], a[140:143], a[40:43], v[224:239]
buffer_load_dwordx4 a[16:19], v9, s[8:11], s30 offen offset:0 sc1
v_mfma_f32_32x32x16_bf16 v[240:255], a[140:143], a[56:59], v[240:255]
buffer_load_dwordx4 a[4:7], v8, s[8:11], s30 offen offset:1024 sc1
s_waitcnt vmcnt(19) lgkmcnt(0)
s_barrier
v_mfma_f32_32x32x16_bf16 v[128:143], a[144:147], a[44:47], v[128:143]
ds_read_b64_tr_b16 a[128:129], v4 offset:32768
ds_read_b64_tr_b16 a[130:131], v4 offset:33792
v_mfma_f32_32x32x16_bf16 v[144:159], a[144:147], a[60:63], v[144:159]
ds_read_b64_tr_b16 a[132:133], v5 offset:32768
ds_read_b64_tr_b16 a[134:135], v5 offset:33792
v_mfma_f32_32x32x16_bf16 v[160:175], a[148:151], a[44:47], v[160:175]
ds_read_b64_tr_b16 a[136:137], v6 offset:32768
ds_read_b64_tr_b16 a[138:139], v6 offset:33792
v_mfma_f32_32x32x16_bf16 v[176:191], a[148:151], a[60:63], v[176:191]
ds_read_b64_tr_b16 a[140:141], v7 offset:32768
ds_read_b64_tr_b16 a[142:143], v7 offset:33792
v_mfma_f32_32x32x16_bf16 v[192:207], a[152:155], a[44:47], v[192:207]
buffer_load_dwordx4 v12, s[12:15], s31 offen offset:2048 lds
v_mfma_f32_32x32x16_bf16 v[208:223], a[152:155], a[60:63], v[208:223]
buffer_load_dwordx4 a[20:23], v9, s[8:11], s30 offen offset:1024 sc1
v_mfma_f32_32x32x16_bf16 v[224:239], a[156:159], a[44:47], v[224:239]
buffer_load_dwordx4 a[8:11], v8, s[8:11], s30 offen offset:2048 sc1
v_mfma_f32_32x32x16_bf16 v[240:255], a[156:159], a[60:63], v[240:255]
buffer_load_dwordx4 v13, s[12:15], s31 offen offset:3072 lds
s_waitcnt lgkmcnt(0)
v_mfma_f32_32x32x16_bf16 v[128:143], a[128:131], a[64:67], v[128:143]
ds_read_b64_tr_b16 a[144:145], v4 offset:36864
ds_read_b64_tr_b16 a[146:147], v4 offset:37888
v_mfma_f32_32x32x16_bf16 v[144:159], a[128:131], a[80:83], v[144:159]
ds_read_b64_tr_b16 a[148:149], v5 offset:36864
ds_read_b64_tr_b16 a[150:151], v5 offset:37888
v_mfma_f32_32x32x16_bf16 v[160:175], a[132:135], a[64:67], v[160:175]
ds_read_b64_tr_b16 a[152:153], v6 offset:36864
ds_read_b64_tr_b16 a[154:155], v6 offset:37888
v_mfma_f32_32x32x16_bf16 v[176:191], a[132:135], a[80:83], v[176:191]
ds_read_b64_tr_b16 a[156:157], v7 offset:36864
ds_read_b64_tr_b16 a[158:159], v7 offset:37888
v_mfma_f32_32x32x16_bf16 v[192:207], a[136:139], a[64:67], v[192:207]
buffer_load_dwordx4 a[24:27], v9, s[8:11], s30 offen offset:2048 sc1
v_mfma_f32_32x32x16_bf16 v[208:223], a[136:139], a[80:83], v[208:223]
buffer_load_dwordx4 a[12:15], v8, s[8:11], s30 offen offset:3072 sc1
v_mfma_f32_32x32x16_bf16 v[224:239], a[140:143], a[64:67], v[224:239]
s_add_u32 s31, s31, 0x80000
s_add_u32 m0, s32, 0x4000
s_nop 0
buffer_load_dwordx4 v10, s[12:15], s31 offen offset:0 lds
v_mfma_f32_32x32x16_bf16 v[240:255], a[140:143], a[80:83], v[240:255]
buffer_load_dwordx4 a[28:31], v9, s[8:11], s30 offen offset:3072 sc1
s_waitcnt lgkmcnt(0)
v_mfma_f32_32x32x16_bf16 v[128:143], a[144:147], a[68:71], v[128:143]
ds_read_b64_tr_b16 a[128:129], v4 offset:40960
ds_read_b64_tr_b16 a[130:131], v4 offset:41984
v_mfma_f32_32x32x16_bf16 v[144:159], a[144:147], a[84:87], v[144:159]
ds_read_b64_tr_b16 a[132:133], v5 offset:40960
ds_read_b64_tr_b16 a[134:135], v5 offset:41984
v_mfma_f32_32x32x16_bf16 v[160:175], a[148:151], a[68:71], v[160:175]
ds_read_b64_tr_b16 a[136:137], v6 offset:40960
ds_read_b64_tr_b16 a[138:139], v6 offset:41984
v_mfma_f32_32x32x16_bf16 v[176:191], a[148:151], a[84:87], v[176:191]
ds_read_b64_tr_b16 a[140:141], v7 offset:40960
ds_read_b64_tr_b16 a[142:143], v7 offset:41984
v_mfma_f32_32x32x16_bf16 v[192:207], a[152:155], a[68:71], v[192:207]
s_add_u32 s30, s30, 4096
buffer_load_dwordx4 a[32:35], v8, s[8:11], s30 offen offset:0 sc1
v_mfma_f32_32x32x16_bf16 v[208:223], a[152:155], a[84:87], v[208:223]
buffer_load_dwordx4 v11, s[12:15], s31 offen offset:1024 lds
v_mfma_f32_32x32x16_bf16 v[224:239], a[156:159], a[68:71], v[224:239]
buffer_load_dwordx4 a[48:51], v9, s[8:11], s30 offen offset:0 sc1
v_mfma_f32_32x32x16_bf16 v[240:255], a[156:159], a[84:87], v[240:255]
buffer_load_dwordx4 a[36:39], v8, s[8:11], s30 offen offset:1024 sc1
s_waitcnt lgkmcnt(0)
v_mfma_f32_32x32x16_bf16 v[128:143], a[128:131], a[72:75], v[128:143]
ds_read_b64_tr_b16 a[144:145], v4 offset:45056
ds_read_b64_tr_b16 a[146:147], v4 offset:46080
v_mfma_f32_32x32x16_bf16 v[144:159], a[128:131], a[88:91], v[144:159]
ds_read_b64_tr_b16 a[148:149], v5 offset:45056
ds_read_b64_tr_b16 a[150:151], v5 offset:46080
v_mfma_f32_32x32x16_bf16 v[160:175], a[132:135], a[72:75], v[160:175]
ds_read_b64_tr_b16 a[152:153], v6 offset:45056
ds_read_b64_tr_b16 a[154:155], v6 offset:46080
v_mfma_f32_32x32x16_bf16 v[176:191], a[132:135], a[88:91], v[176:191]
ds_read_b64_tr_b16 a[156:157], v7 offset:45056
ds_read_b64_tr_b16 a[158:159], v7 offset:46080
v_mfma_f32_32x32x16_bf16 v[192:207], a[136:139], a[72:75], v[192:207]
buffer_load_dwordx4 v12, s[12:15], s31 offen offset:2048 lds
v_mfma_f32_32x32x16_bf16 v[208:223], a[136:139], a[88:91], v[208:223]
buffer_load_dwordx4 a[52:55], v9, s[8:11], s30 offen offset:1024 sc1
v_mfma_f32_32x32x16_bf16 v[224:239], a[140:143], a[72:75], v[224:239]
buffer_load_dwordx4 a[40:43], v8, s[8:11], s30 offen offset:2048 sc1
v_mfma_f32_32x32x16_bf16 v[240:255], a[140:143], a[88:91], v[240:255]
buffer_load_dwordx4 v13, s[12:15], s31 offen offset:3072 lds
s_waitcnt vmcnt(23) lgkmcnt(0)
s_barrier
v_mfma_f32_32x32x16_bf16 v[128:143], a[144:147], a[76:79], v[128:143]
ds_read_b64_tr_b16 a[128:129], v4 offset:49152
ds_read_b64_tr_b16 a[130:131], v4 offset:50176
v_mfma_f32_32x32x16_bf16 v[144:159], a[144:147], a[92:95], v[144:159]
ds_read_b64_tr_b16 a[132:133], v5 offset:49152
ds_read_b64_tr_b16 a[134:135], v5 offset:50176
v_mfma_f32_32x32x16_bf16 v[160:175], a[148:151], a[76:79], v[160:175]
ds_read_b64_tr_b16 a[136:137], v6 offset:49152
ds_read_b64_tr_b16 a[138:139], v6 offset:50176
v_mfma_f32_32x32x16_bf16 v[176:191], a[148:151], a[92:95], v[176:191]
ds_read_b64_tr_b16 a[140:141], v7 offset:49152
ds_read_b64_tr_b16 a[142:143], v7 offset:50176
v_mfma_f32_32x32x16_bf16 v[192:207], a[152:155], a[76:79], v[192:207]
buffer_load_dwordx4 a[56:59], v9, s[8:11], s30 offen offset:2048 sc1
v_mfma_f32_32x32x16_bf16 v[208:223], a[152:155], a[92:95], v[208:223]
buffer_load_dwordx4 a[44:47], v8, s[8:11], s30 offen offset:3072 sc1
v_mfma_f32_32x32x16_bf16 v[224:239], a[156:159], a[76:79], v[224:239]
s_add_u32 s31, s31, 0x80000
s_add_u32 m0, s32, 0x8000
s_nop 0
buffer_load_dwordx4 v10, s[12:15], s31 offen offset:0 lds
v_mfma_f32_32x32x16_bf16 v[240:255], a[156:159], a[92:95], v[240:255]
buffer_load_dwordx4 a[60:63], v9, s[8:11], s30 offen offset:3072 sc1
s_waitcnt lgkmcnt(0)
v_mfma_f32_32x32x16_bf16 v[128:143], a[128:131], a[96:99], v[128:143]
ds_read_b64_tr_b16 a[144:145], v4 offset:53248
ds_read_b64_tr_b16 a[146:147], v4 offset:54272
v_mfma_f32_32x32x16_bf16 v[144:159], a[128:131], a[112:115], v[144:159]
ds_read_b64_tr_b16 a[148:149], v5 offset:53248
ds_read_b64_tr_b16 a[150:151], v5 offset:54272
v_mfma_f32_32x32x16_bf16 v[160:175], a[132:135], a[96:99], v[160:175]
ds_read_b64_tr_b16 a[152:153], v6 offset:53248
ds_read_b64_tr_b16 a[154:155], v6 offset:54272
v_mfma_f32_32x32x16_bf16 v[176:191], a[132:135], a[112:115], v[176:191]
ds_read_b64_tr_b16 a[156:157], v7 offset:53248
ds_read_b64_tr_b16 a[158:159], v7 offset:54272
v_mfma_f32_32x32x16_bf16 v[192:207], a[136:139], a[96:99], v[192:207]
s_add_u32 s30, s30, 4096
buffer_load_dwordx4 a[64:67], v8, s[8:11], s30 offen offset:0 sc1
v_mfma_f32_32x32x16_bf16 v[208:223], a[136:139], a[112:115], v[208:223]
buffer_load_dwordx4 v11, s[12:15], s31 offen offset:1024 lds
v_mfma_f32_32x32x16_bf16 v[224:239], a[140:143], a[96:99], v[224:239]
buffer_load_dwordx4 a[80:83], v9, s[8:11], s30 offen offset:0 sc1
v_mfma_f32_32x32x16_bf16 v[240:255], a[140:143], a[112:115], v[240:255]
s_waitcnt lgkmcnt(0)
v_mfma_f32_32x32x16_bf16 v[128:143], a[144:147], a[100:103], v[128:143]
ds_read_b64_tr_b16 a[128:129], v4 offset:57344
ds_read_b64_tr_b16 a[130:131], v4 offset:58368
v_mfma_f32_32x32x16_bf16 v[144:159], a[144:147], a[116:119], v[144:159]
ds_read_b64_tr_b16 a[132:133], v5 offset:57344
ds_read_b64_tr_b16 a[134:135], v5 offset:58368
v_mfma_f32_32x32x16_bf16 v[160:175], a[148:151], a[100:103], v[160:175]
ds_read_b64_tr_b16 a[136:137], v6 offset:57344
ds_read_b64_tr_b16 a[138:139], v6 offset:58368
v_mfma_f32_32x32x16_bf16 v[176:191], a[148:151], a[116:119], v[176:191]
ds_read_b64_tr_b16 a[140:141], v7 offset:57344
ds_read_b64_tr_b16 a[142:143], v7 offset:58368
v_mfma_f32_32x32x16_bf16 v[192:207], a[152:155], a[100:103], v[192:207]
buffer_load_dwordx4 a[68:71], v8, s[8:11], s30 offen offset:1024 sc1
v_mfma_f32_32x32x16_bf16 v[208:223], a[152:155], a[116:119], v[208:223]
buffer_load_dwordx4 v12, s[12:15], s31 offen offset:2048 lds
v_mfma_f32_32x32x16_bf16 v[224:239], a[156:159], a[100:103], v[224:239]
buffer_load_dwordx4 a[84:87], v9, s[8:11], s30 offen offset:1024 sc1
v_mfma_f32_32x32x16_bf16 v[240:255], a[156:159], a[116:119], v[240:255]
s_waitcnt lgkmcnt(0)
v_mfma_f32_32x32x16_bf16 v[128:143], a[128:131], a[104:107], v[128:143]
ds_read_b64_tr_b16 a[144:145], v4 offset:61440
ds_read_b64_tr_b16 a[146:147], v4 offset:62464
v_mfma_f32_32x32x16_bf16 v[144:159], a[128:131], a[120:123], v[144:159]
ds_read_b64_tr_b16 a[148:149], v5 offset:61440
ds_read_b64_tr_b16 a[150:151], v5 offset:62464
v_mfma_f32_32x32x16_bf16 v[160:175], a[132:135], a[104:107], v[160:175]
ds_read_b64_tr_b16 a[152:153], v6 offset:61440
ds_read_b64_tr_b16 a[154:155], v6 offset:62464
v_mfma_f32_32x32x16_bf16 v[176:191], a[132:135], a[120:123], v[176:191]
ds_read_b64_tr_b16 a[156:157], v7 offset:61440
ds_read_b64_tr_b16 a[158:159], v7 offset:62464
v_mfma_f32_32x32x16_bf16 v[192:207], a[136:139], a[104:107], v[192:207]
buffer_load_dwordx4 a[72:75], v8, s[8:11], s30 offen offset:2048 sc1
v_mfma_f32_32x32x16_bf16 v[208:223], a[136:139], a[120:123], v[208:223]
buffer_load_dwordx4 v13, s[12:15], s31 offen offset:3072 lds
v_mfma_f32_32x32x16_bf16 v[224:239], a[140:143], a[104:107], v[224:239]
buffer_load_dwordx4 a[88:91], v9, s[8:11], s30 offen offset:2048 sc1
v_mfma_f32_32x32x16_bf16 v[240:255], a[140:143], a[120:123], v[240:255]
s_waitcnt vmcnt(24) lgkmcnt(0)
s_barrier
v_mfma_f32_32x32x16_bf16 v[128:143], a[144:147], a[108:111], v[128:143]
ds_read_b64_tr_b16 a[128:129], v4 offset:0
ds_read_b64_tr_b16 a[130:131], v4 offset:1024
v_mfma_f32_32x32x16_bf16 v[144:159], a[144:147], a[124:127], v[144:159]
ds_read_b64_tr_b16 a[132:133], v5 offset:0
ds_read_b64_tr_b16 a[134:135], v5 offset:1024
v_mfma_f32_32x32x16_bf16 v[160:175], a[148:151], a[108:111], v[160:175]
ds_read_b64_tr_b16 a[136:137], v6 offset:0
ds_read_b64_tr_b16 a[138:139], v6 offset:1024
v_mfma_f32_32x32x16_bf16 v[176:191], a[148:151], a[124:127], v[176:191]
ds_read_b64_tr_b16 a[140:141], v7 offset:0
ds_read_b64_tr_b16 a[142:143], v7 offset:1024
v_mfma_f32_32x32x16_bf16 v[192:207], a[152:155], a[108:111], v[192:207]
buffer_load_dwordx4 a[76:79], v8, s[8:11], s30 offen offset:3072 sc1
v_mfma_f32_32x32x16_bf16 v[208:223], a[152:155], a[124:127], v[208:223]
s_add_u32 s31, s31, 0x80000
s_add_u32 m0, s32, 0xc000
s_nop 0
buffer_load_dwordx4 v10, s[12:15], s31 offen offset:0 lds
v_mfma_f32_32x32x16_bf16 v[224:239], a[156:159], a[108:111], v[224:239]
buffer_load_dwordx4 a[92:95], v9, s[8:11], s30 offen offset:3072 sc1
v_mfma_f32_32x32x16_bf16 v[240:255], a[156:159], a[124:127], v[240:255]
s_mov_b32 s33, 2
adaLN_cond__sliding_block_cached__swiglu_ffn__prompt_kernel_loop_19:
s_waitcnt lgkmcnt(0)
v_mfma_f32_32x32x16_bf16 v[128:143], a[128:131], a[0:3], v[128:143]
ds_read_b64_tr_b16 a[144:145], v4 offset:4096
ds_read_b64_tr_b16 a[146:147], v4 offset:5120
v_mfma_f32_32x32x16_bf16 v[144:159], a[128:131], a[16:19], v[144:159]
ds_read_b64_tr_b16 a[148:149], v5 offset:4096
ds_read_b64_tr_b16 a[150:151], v5 offset:5120
v_mfma_f32_32x32x16_bf16 v[160:175], a[132:135], a[0:3], v[160:175]
ds_read_b64_tr_b16 a[152:153], v6 offset:4096
ds_read_b64_tr_b16 a[154:155], v6 offset:5120
v_mfma_f32_32x32x16_bf16 v[176:191], a[132:135], a[16:19], v[176:191]
ds_read_b64_tr_b16 a[156:157], v7 offset:4096
ds_read_b64_tr_b16 a[158:159], v7 offset:5120
v_mfma_f32_32x32x16_bf16 v[192:207], a[136:139], a[0:3], v[192:207]
s_add_u32 s30, s30, 4096
buffer_load_dwordx4 a[96:99], v8, s[8:11], s30 offen offset:0 sc1
v_mfma_f32_32x32x16_bf16 v[208:223], a[136:139], a[16:19], v[208:223]
buffer_load_dwordx4 v11, s[12:15], s31 offen offset:1024 lds
v_mfma_f32_32x32x16_bf16 v[224:239], a[140:143], a[0:3], v[224:239]
buffer_load_dwordx4 a[112:115], v9, s[8:11], s30 offen offset:0 sc1
v_mfma_f32_32x32x16_bf16 v[240:255], a[140:143], a[16:19], v[240:255]
s_waitcnt lgkmcnt(0)
v_mfma_f32_32x32x16_bf16 v[128:143], a[144:147], a[4:7], v[128:143]
ds_read_b64_tr_b16 a[128:129], v4 offset:8192
ds_read_b64_tr_b16 a[130:131], v4 offset:9216
v_mfma_f32_32x32x16_bf16 v[144:159], a[144:147], a[20:23], v[144:159]
ds_read_b64_tr_b16 a[132:133], v5 offset:8192
ds_read_b64_tr_b16 a[134:135], v5 offset:9216
v_mfma_f32_32x32x16_bf16 v[160:175], a[148:151], a[4:7], v[160:175]
ds_read_b64_tr_b16 a[136:137], v6 offset:8192
ds_read_b64_tr_b16 a[138:139], v6 offset:9216
v_mfma_f32_32x32x16_bf16 v[176:191], a[148:151], a[20:23], v[176:191]
ds_read_b64_tr_b16 a[140:141], v7 offset:8192
ds_read_b64_tr_b16 a[142:143], v7 offset:9216
v_mfma_f32_32x32x16_bf16 v[192:207], a[152:155], a[4:7], v[192:207]
buffer_load_dwordx4 a[100:103], v8, s[8:11], s30 offen offset:1024 sc1
v_mfma_f32_32x32x16_bf16 v[208:223], a[152:155], a[20:23], v[208:223]
buffer_load_dwordx4 v12, s[12:15], s31 offen offset:2048 lds
v_mfma_f32_32x32x16_bf16 v[224:239], a[156:159], a[4:7], v[224:239]
buffer_load_dwordx4 a[116:119], v9, s[8:11], s30 offen offset:1024 sc1
v_mfma_f32_32x32x16_bf16 v[240:255], a[156:159], a[20:23], v[240:255]
s_waitcnt lgkmcnt(0)
v_mfma_f32_32x32x16_bf16 v[128:143], a[128:131], a[8:11], v[128:143]
ds_read_b64_tr_b16 a[144:145], v4 offset:12288
ds_read_b64_tr_b16 a[146:147], v4 offset:13312
v_mfma_f32_32x32x16_bf16 v[144:159], a[128:131], a[24:27], v[144:159]
ds_read_b64_tr_b16 a[148:149], v5 offset:12288
ds_read_b64_tr_b16 a[150:151], v5 offset:13312
v_mfma_f32_32x32x16_bf16 v[160:175], a[132:135], a[8:11], v[160:175]
ds_read_b64_tr_b16 a[152:153], v6 offset:12288
ds_read_b64_tr_b16 a[154:155], v6 offset:13312
v_mfma_f32_32x32x16_bf16 v[176:191], a[132:135], a[24:27], v[176:191]
ds_read_b64_tr_b16 a[156:157], v7 offset:12288
ds_read_b64_tr_b16 a[158:159], v7 offset:13312
v_mfma_f32_32x32x16_bf16 v[192:207], a[136:139], a[8:11], v[192:207]
buffer_load_dwordx4 a[104:107], v8, s[8:11], s30 offen offset:2048 sc1
v_mfma_f32_32x32x16_bf16 v[208:223], a[136:139], a[24:27], v[208:223]
buffer_load_dwordx4 v13, s[12:15], s31 offen offset:3072 lds
v_mfma_f32_32x32x16_bf16 v[224:239], a[140:143], a[8:11], v[224:239]
buffer_load_dwordx4 a[120:123], v9, s[8:11], s30 offen offset:2048 sc1
v_mfma_f32_32x32x16_bf16 v[240:255], a[140:143], a[24:27], v[240:255]
s_waitcnt vmcnt(24) lgkmcnt(0)
s_barrier
v_mfma_f32_32x32x16_bf16 v[128:143], a[144:147], a[12:15], v[128:143]
ds_read_b64_tr_b16 a[128:129], v4 offset:16384
ds_read_b64_tr_b16 a[130:131], v4 offset:17408
v_mfma_f32_32x32x16_bf16 v[144:159], a[144:147], a[28:31], v[144:159]
ds_read_b64_tr_b16 a[132:133], v5 offset:16384
ds_read_b64_tr_b16 a[134:135], v5 offset:17408
v_mfma_f32_32x32x16_bf16 v[160:175], a[148:151], a[12:15], v[160:175]
ds_read_b64_tr_b16 a[136:137], v6 offset:16384
ds_read_b64_tr_b16 a[138:139], v6 offset:17408
v_mfma_f32_32x32x16_bf16 v[176:191], a[148:151], a[28:31], v[176:191]
ds_read_b64_tr_b16 a[140:141], v7 offset:16384
ds_read_b64_tr_b16 a[142:143], v7 offset:17408
v_mfma_f32_32x32x16_bf16 v[192:207], a[152:155], a[12:15], v[192:207]
buffer_load_dwordx4 a[108:111], v8, s[8:11], s30 offen offset:3072 sc1
v_mfma_f32_32x32x16_bf16 v[208:223], a[152:155], a[28:31], v[208:223]
s_add_u32 s31, s31, 0x80000
s_add_u32 m0, s32, 0x0
s_nop 0
buffer_load_dwordx4 v10, s[12:15], s31 offen offset:0 lds
v_mfma_f32_32x32x16_bf16 v[224:239], a[156:159], a[12:15], v[224:239]
buffer_load_dwordx4 a[124:127], v9, s[8:11], s30 offen offset:3072 sc1
v_mfma_f32_32x32x16_bf16 v[240:255], a[156:159], a[28:31], v[240:255]
s_waitcnt lgkmcnt(0)
v_mfma_f32_32x32x16_bf16 v[128:143], a[128:131], a[32:35], v[128:143]
ds_read_b64_tr_b16 a[144:145], v4 offset:20480
ds_read_b64_tr_b16 a[146:147], v4 offset:21504
v_mfma_f32_32x32x16_bf16 v[144:159], a[128:131], a[48:51], v[144:159]
ds_read_b64_tr_b16 a[148:149], v5 offset:20480
ds_read_b64_tr_b16 a[150:151], v5 offset:21504
v_mfma_f32_32x32x16_bf16 v[160:175], a[132:135], a[32:35], v[160:175]
ds_read_b64_tr_b16 a[152:153], v6 offset:20480
ds_read_b64_tr_b16 a[154:155], v6 offset:21504
v_mfma_f32_32x32x16_bf16 v[176:191], a[132:135], a[48:51], v[176:191]
ds_read_b64_tr_b16 a[156:157], v7 offset:20480
ds_read_b64_tr_b16 a[158:159], v7 offset:21504
v_mfma_f32_32x32x16_bf16 v[192:207], a[136:139], a[32:35], v[192:207]
s_add_u32 s30, s30, 4096
buffer_load_dwordx4 a[0:3], v8, s[8:11], s30 offen offset:0 sc1
v_mfma_f32_32x32x16_bf16 v[208:223], a[136:139], a[48:51], v[208:223]
buffer_load_dwordx4 v11, s[12:15], s31 offen offset:1024 lds
v_mfma_f32_32x32x16_bf16 v[224:239], a[140:143], a[32:35], v[224:239]
buffer_load_dwordx4 a[16:19], v9, s[8:11], s30 offen offset:0 sc1
v_mfma_f32_32x32x16_bf16 v[240:255], a[140:143], a[48:51], v[240:255]
s_waitcnt lgkmcnt(0)
v_mfma_f32_32x32x16_bf16 v[128:143], a[144:147], a[36:39], v[128:143]
ds_read_b64_tr_b16 a[128:129], v4 offset:24576
ds_read_b64_tr_b16 a[130:131], v4 offset:25600
v_mfma_f32_32x32x16_bf16 v[144:159], a[144:147], a[52:55], v[144:159]
ds_read_b64_tr_b16 a[132:133], v5 offset:24576
ds_read_b64_tr_b16 a[134:135], v5 offset:25600
v_mfma_f32_32x32x16_bf16 v[160:175], a[148:151], a[36:39], v[160:175]
ds_read_b64_tr_b16 a[136:137], v6 offset:24576
ds_read_b64_tr_b16 a[138:139], v6 offset:25600
v_mfma_f32_32x32x16_bf16 v[176:191], a[148:151], a[52:55], v[176:191]
ds_read_b64_tr_b16 a[140:141], v7 offset:24576
ds_read_b64_tr_b16 a[142:143], v7 offset:25600
v_mfma_f32_32x32x16_bf16 v[192:207], a[152:155], a[36:39], v[192:207]
buffer_load_dwordx4 a[4:7], v8, s[8:11], s30 offen offset:1024 sc1
v_mfma_f32_32x32x16_bf16 v[208:223], a[152:155], a[52:55], v[208:223]
buffer_load_dwordx4 v12, s[12:15], s31 offen offset:2048 lds
v_mfma_f32_32x32x16_bf16 v[224:239], a[156:159], a[36:39], v[224:239]
buffer_load_dwordx4 a[20:23], v9, s[8:11], s30 offen offset:1024 sc1
v_mfma_f32_32x32x16_bf16 v[240:255], a[156:159], a[52:55], v[240:255]
s_waitcnt lgkmcnt(0)
v_mfma_f32_32x32x16_bf16 v[128:143], a[128:131], a[40:43], v[128:143]
ds_read_b64_tr_b16 a[144:145], v4 offset:28672
ds_read_b64_tr_b16 a[146:147], v4 offset:29696
v_mfma_f32_32x32x16_bf16 v[144:159], a[128:131], a[56:59], v[144:159]
ds_read_b64_tr_b16 a[148:149], v5 offset:28672
ds_read_b64_tr_b16 a[150:151], v5 offset:29696
v_mfma_f32_32x32x16_bf16 v[160:175], a[132:135], a[40:43], v[160:175]
ds_read_b64_tr_b16 a[152:153], v6 offset:28672
ds_read_b64_tr_b16 a[154:155], v6 offset:29696
v_mfma_f32_32x32x16_bf16 v[176:191], a[132:135], a[56:59], v[176:191]
ds_read_b64_tr_b16 a[156:157], v7 offset:28672
ds_read_b64_tr_b16 a[158:159], v7 offset:29696
v_mfma_f32_32x32x16_bf16 v[192:207], a[136:139], a[40:43], v[192:207]
buffer_load_dwordx4 a[8:11], v8, s[8:11], s30 offen offset:2048 sc1
v_mfma_f32_32x32x16_bf16 v[208:223], a[136:139], a[56:59], v[208:223]
buffer_load_dwordx4 v13, s[12:15], s31 offen offset:3072 lds
v_mfma_f32_32x32x16_bf16 v[224:239], a[140:143], a[40:43], v[224:239]
buffer_load_dwordx4 a[24:27], v9, s[8:11], s30 offen offset:2048 sc1
v_mfma_f32_32x32x16_bf16 v[240:255], a[140:143], a[56:59], v[240:255]
s_waitcnt vmcnt(24) lgkmcnt(0)
s_barrier
v_mfma_f32_32x32x16_bf16 v[128:143], a[144:147], a[44:47], v[128:143]
ds_read_b64_tr_b16 a[128:129], v4 offset:32768
ds_read_b64_tr_b16 a[130:131], v4 offset:33792
v_mfma_f32_32x32x16_bf16 v[144:159], a[144:147], a[60:63], v[144:159]
ds_read_b64_tr_b16 a[132:133], v5 offset:32768
ds_read_b64_tr_b16 a[134:135], v5 offset:33792
v_mfma_f32_32x32x16_bf16 v[160:175], a[148:151], a[44:47], v[160:175]
ds_read_b64_tr_b16 a[136:137], v6 offset:32768
ds_read_b64_tr_b16 a[138:139], v6 offset:33792
v_mfma_f32_32x32x16_bf16 v[176:191], a[148:151], a[60:63], v[176:191]
ds_read_b64_tr_b16 a[140:141], v7 offset:32768
ds_read_b64_tr_b16 a[142:143], v7 offset:33792
v_mfma_f32_32x32x16_bf16 v[192:207], a[152:155], a[44:47], v[192:207]
buffer_load_dwordx4 a[12:15], v8, s[8:11], s30 offen offset:3072 sc1
v_mfma_f32_32x32x16_bf16 v[208:223], a[152:155], a[60:63], v[208:223]
s_add_u32 s31, s31, 0x80000
s_add_u32 m0, s32, 0x4000
s_nop 0
buffer_load_dwordx4 v10, s[12:15], s31 offen offset:0 lds
v_mfma_f32_32x32x16_bf16 v[224:239], a[156:159], a[44:47], v[224:239]
buffer_load_dwordx4 a[28:31], v9, s[8:11], s30 offen offset:3072 sc1
v_mfma_f32_32x32x16_bf16 v[240:255], a[156:159], a[60:63], v[240:255]
s_waitcnt lgkmcnt(0)
v_mfma_f32_32x32x16_bf16 v[128:143], a[128:131], a[64:67], v[128:143]
ds_read_b64_tr_b16 a[144:145], v4 offset:36864
ds_read_b64_tr_b16 a[146:147], v4 offset:37888
v_mfma_f32_32x32x16_bf16 v[144:159], a[128:131], a[80:83], v[144:159]
ds_read_b64_tr_b16 a[148:149], v5 offset:36864
ds_read_b64_tr_b16 a[150:151], v5 offset:37888
v_mfma_f32_32x32x16_bf16 v[160:175], a[132:135], a[64:67], v[160:175]
ds_read_b64_tr_b16 a[152:153], v6 offset:36864
ds_read_b64_tr_b16 a[154:155], v6 offset:37888
v_mfma_f32_32x32x16_bf16 v[176:191], a[132:135], a[80:83], v[176:191]
ds_read_b64_tr_b16 a[156:157], v7 offset:36864
ds_read_b64_tr_b16 a[158:159], v7 offset:37888
v_mfma_f32_32x32x16_bf16 v[192:207], a[136:139], a[64:67], v[192:207]
s_add_u32 s30, s30, 4096
buffer_load_dwordx4 a[32:35], v8, s[8:11], s30 offen offset:0 sc1
v_mfma_f32_32x32x16_bf16 v[208:223], a[136:139], a[80:83], v[208:223]
buffer_load_dwordx4 v11, s[12:15], s31 offen offset:1024 lds
v_mfma_f32_32x32x16_bf16 v[224:239], a[140:143], a[64:67], v[224:239]
buffer_load_dwordx4 a[48:51], v9, s[8:11], s30 offen offset:0 sc1
v_mfma_f32_32x32x16_bf16 v[240:255], a[140:143], a[80:83], v[240:255]
s_waitcnt lgkmcnt(0)
v_mfma_f32_32x32x16_bf16 v[128:143], a[144:147], a[68:71], v[128:143]
ds_read_b64_tr_b16 a[128:129], v4 offset:40960
ds_read_b64_tr_b16 a[130:131], v4 offset:41984
v_mfma_f32_32x32x16_bf16 v[144:159], a[144:147], a[84:87], v[144:159]
ds_read_b64_tr_b16 a[132:133], v5 offset:40960
ds_read_b64_tr_b16 a[134:135], v5 offset:41984
v_mfma_f32_32x32x16_bf16 v[160:175], a[148:151], a[68:71], v[160:175]
ds_read_b64_tr_b16 a[136:137], v6 offset:40960
ds_read_b64_tr_b16 a[138:139], v6 offset:41984
v_mfma_f32_32x32x16_bf16 v[176:191], a[148:151], a[84:87], v[176:191]
ds_read_b64_tr_b16 a[140:141], v7 offset:40960
ds_read_b64_tr_b16 a[142:143], v7 offset:41984
v_mfma_f32_32x32x16_bf16 v[192:207], a[152:155], a[68:71], v[192:207]
buffer_load_dwordx4 a[36:39], v8, s[8:11], s30 offen offset:1024 sc1
v_mfma_f32_32x32x16_bf16 v[208:223], a[152:155], a[84:87], v[208:223]
buffer_load_dwordx4 v12, s[12:15], s31 offen offset:2048 lds
v_mfma_f32_32x32x16_bf16 v[224:239], a[156:159], a[68:71], v[224:239]
buffer_load_dwordx4 a[52:55], v9, s[8:11], s30 offen offset:1024 sc1
v_mfma_f32_32x32x16_bf16 v[240:255], a[156:159], a[84:87], v[240:255]
s_waitcnt lgkmcnt(0)
v_mfma_f32_32x32x16_bf16 v[128:143], a[128:131], a[72:75], v[128:143]
ds_read_b64_tr_b16 a[144:145], v4 offset:45056
ds_read_b64_tr_b16 a[146:147], v4 offset:46080
v_mfma_f32_32x32x16_bf16 v[144:159], a[128:131], a[88:91], v[144:159]
ds_read_b64_tr_b16 a[148:149], v5 offset:45056
ds_read_b64_tr_b16 a[150:151], v5 offset:46080
v_mfma_f32_32x32x16_bf16 v[160:175], a[132:135], a[72:75], v[160:175]
ds_read_b64_tr_b16 a[152:153], v6 offset:45056
ds_read_b64_tr_b16 a[154:155], v6 offset:46080
v_mfma_f32_32x32x16_bf16 v[176:191], a[132:135], a[88:91], v[176:191]
ds_read_b64_tr_b16 a[156:157], v7 offset:45056
ds_read_b64_tr_b16 a[158:159], v7 offset:46080
v_mfma_f32_32x32x16_bf16 v[192:207], a[136:139], a[72:75], v[192:207]
buffer_load_dwordx4 a[40:43], v8, s[8:11], s30 offen offset:2048 sc1
v_mfma_f32_32x32x16_bf16 v[208:223], a[136:139], a[88:91], v[208:223]
buffer_load_dwordx4 v13, s[12:15], s31 offen offset:3072 lds
v_mfma_f32_32x32x16_bf16 v[224:239], a[140:143], a[72:75], v[224:239]
buffer_load_dwordx4 a[56:59], v9, s[8:11], s30 offen offset:2048 sc1
v_mfma_f32_32x32x16_bf16 v[240:255], a[140:143], a[88:91], v[240:255]
s_waitcnt vmcnt(24) lgkmcnt(0)
s_barrier
v_mfma_f32_32x32x16_bf16 v[128:143], a[144:147], a[76:79], v[128:143]
ds_read_b64_tr_b16 a[128:129], v4 offset:49152
ds_read_b64_tr_b16 a[130:131], v4 offset:50176
v_mfma_f32_32x32x16_bf16 v[144:159], a[144:147], a[92:95], v[144:159]
ds_read_b64_tr_b16 a[132:133], v5 offset:49152
ds_read_b64_tr_b16 a[134:135], v5 offset:50176
v_mfma_f32_32x32x16_bf16 v[160:175], a[148:151], a[76:79], v[160:175]
ds_read_b64_tr_b16 a[136:137], v6 offset:49152
ds_read_b64_tr_b16 a[138:139], v6 offset:50176
v_mfma_f32_32x32x16_bf16 v[176:191], a[148:151], a[92:95], v[176:191]
ds_read_b64_tr_b16 a[140:141], v7 offset:49152
ds_read_b64_tr_b16 a[142:143], v7 offset:50176
v_mfma_f32_32x32x16_bf16 v[192:207], a[152:155], a[76:79], v[192:207]
buffer_load_dwordx4 a[44:47], v8, s[8:11], s30 offen offset:3072 sc1
v_mfma_f32_32x32x16_bf16 v[208:223], a[152:155], a[92:95], v[208:223]
s_add_u32 s31, s31, 0x80000
s_add_u32 m0, s32, 0x8000
s_nop 0
buffer_load_dwordx4 v10, s[12:15], s31 offen offset:0 lds
v_mfma_f32_32x32x16_bf16 v[224:239], a[156:159], a[76:79], v[224:239]
buffer_load_dwordx4 a[60:63], v9, s[8:11], s30 offen offset:3072 sc1
v_mfma_f32_32x32x16_bf16 v[240:255], a[156:159], a[92:95], v[240:255]
s_waitcnt lgkmcnt(0)
v_mfma_f32_32x32x16_bf16 v[128:143], a[128:131], a[96:99], v[128:143]
ds_read_b64_tr_b16 a[144:145], v4 offset:53248
ds_read_b64_tr_b16 a[146:147], v4 offset:54272
v_mfma_f32_32x32x16_bf16 v[144:159], a[128:131], a[112:115], v[144:159]
ds_read_b64_tr_b16 a[148:149], v5 offset:53248
ds_read_b64_tr_b16 a[150:151], v5 offset:54272
v_mfma_f32_32x32x16_bf16 v[160:175], a[132:135], a[96:99], v[160:175]
ds_read_b64_tr_b16 a[152:153], v6 offset:53248
ds_read_b64_tr_b16 a[154:155], v6 offset:54272
v_mfma_f32_32x32x16_bf16 v[176:191], a[132:135], a[112:115], v[176:191]
ds_read_b64_tr_b16 a[156:157], v7 offset:53248
ds_read_b64_tr_b16 a[158:159], v7 offset:54272
v_mfma_f32_32x32x16_bf16 v[192:207], a[136:139], a[96:99], v[192:207]
s_add_u32 s30, s30, 4096
buffer_load_dwordx4 a[64:67], v8, s[8:11], s30 offen offset:0 sc1
v_mfma_f32_32x32x16_bf16 v[208:223], a[136:139], a[112:115], v[208:223]
buffer_load_dwordx4 v11, s[12:15], s31 offen offset:1024 lds
v_mfma_f32_32x32x16_bf16 v[224:239], a[140:143], a[96:99], v[224:239]
buffer_load_dwordx4 a[80:83], v9, s[8:11], s30 offen offset:0 sc1
v_mfma_f32_32x32x16_bf16 v[240:255], a[140:143], a[112:115], v[240:255]
s_waitcnt lgkmcnt(0)
v_mfma_f32_32x32x16_bf16 v[128:143], a[144:147], a[100:103], v[128:143]
ds_read_b64_tr_b16 a[128:129], v4 offset:57344
ds_read_b64_tr_b16 a[130:131], v4 offset:58368
v_mfma_f32_32x32x16_bf16 v[144:159], a[144:147], a[116:119], v[144:159]
ds_read_b64_tr_b16 a[132:133], v5 offset:57344
ds_read_b64_tr_b16 a[134:135], v5 offset:58368
v_mfma_f32_32x32x16_bf16 v[160:175], a[148:151], a[100:103], v[160:175]
ds_read_b64_tr_b16 a[136:137], v6 offset:57344
ds_read_b64_tr_b16 a[138:139], v6 offset:58368
v_mfma_f32_32x32x16_bf16 v[176:191], a[148:151], a[116:119], v[176:191]
ds_read_b64_tr_b16 a[140:141], v7 offset:57344
ds_read_b64_tr_b16 a[142:143], v7 offset:58368
v_mfma_f32_32x32x16_bf16 v[192:207], a[152:155], a[100:103], v[192:207]
buffer_load_dwordx4 a[68:71], v8, s[8:11], s30 offen offset:1024 sc1
v_mfma_f32_32x32x16_bf16 v[208:223], a[152:155], a[116:119], v[208:223]
buffer_load_dwordx4 v12, s[12:15], s31 offen offset:2048 lds
v_mfma_f32_32x32x16_bf16 v[224:239], a[156:159], a[100:103], v[224:239]
buffer_load_dwordx4 a[84:87], v9, s[8:11], s30 offen offset:1024 sc1
v_mfma_f32_32x32x16_bf16 v[240:255], a[156:159], a[116:119], v[240:255]
s_waitcnt lgkmcnt(0)
v_mfma_f32_32x32x16_bf16 v[128:143], a[128:131], a[104:107], v[128:143]
ds_read_b64_tr_b16 a[144:145], v4 offset:61440
ds_read_b64_tr_b16 a[146:147], v4 offset:62464
v_mfma_f32_32x32x16_bf16 v[144:159], a[128:131], a[120:123], v[144:159]
ds_read_b64_tr_b16 a[148:149], v5 offset:61440
ds_read_b64_tr_b16 a[150:151], v5 offset:62464
v_mfma_f32_32x32x16_bf16 v[160:175], a[132:135], a[104:107], v[160:175]
ds_read_b64_tr_b16 a[152:153], v6 offset:61440
ds_read_b64_tr_b16 a[154:155], v6 offset:62464
v_mfma_f32_32x32x16_bf16 v[176:191], a[132:135], a[120:123], v[176:191]
ds_read_b64_tr_b16 a[156:157], v7 offset:61440
ds_read_b64_tr_b16 a[158:159], v7 offset:62464
v_mfma_f32_32x32x16_bf16 v[192:207], a[136:139], a[104:107], v[192:207]
buffer_load_dwordx4 a[72:75], v8, s[8:11], s30 offen offset:2048 sc1
v_mfma_f32_32x32x16_bf16 v[208:223], a[136:139], a[120:123], v[208:223]
buffer_load_dwordx4 v13, s[12:15], s31 offen offset:3072 lds
v_mfma_f32_32x32x16_bf16 v[224:239], a[140:143], a[104:107], v[224:239]
buffer_load_dwordx4 a[88:91], v9, s[8:11], s30 offen offset:2048 sc1
v_mfma_f32_32x32x16_bf16 v[240:255], a[140:143], a[120:123], v[240:255]
s_waitcnt vmcnt(24) lgkmcnt(0)
s_barrier
v_mfma_f32_32x32x16_bf16 v[128:143], a[144:147], a[108:111], v[128:143]
ds_read_b64_tr_b16 a[128:129], v4 offset:0
ds_read_b64_tr_b16 a[130:131], v4 offset:1024
v_mfma_f32_32x32x16_bf16 v[144:159], a[144:147], a[124:127], v[144:159]
ds_read_b64_tr_b16 a[132:133], v5 offset:0
ds_read_b64_tr_b16 a[134:135], v5 offset:1024
v_mfma_f32_32x32x16_bf16 v[160:175], a[148:151], a[108:111], v[160:175]
ds_read_b64_tr_b16 a[136:137], v6 offset:0
ds_read_b64_tr_b16 a[138:139], v6 offset:1024
v_mfma_f32_32x32x16_bf16 v[176:191], a[148:151], a[124:127], v[176:191]
ds_read_b64_tr_b16 a[140:141], v7 offset:0
ds_read_b64_tr_b16 a[142:143], v7 offset:1024
v_mfma_f32_32x32x16_bf16 v[192:207], a[152:155], a[108:111], v[192:207]
buffer_load_dwordx4 a[76:79], v8, s[8:11], s30 offen offset:3072 sc1
v_mfma_f32_32x32x16_bf16 v[208:223], a[152:155], a[124:127], v[208:223]
s_add_u32 s31, s31, 0x80000
s_add_u32 m0, s32, 0xc000
s_nop 0
buffer_load_dwordx4 v10, s[12:15], s31 offen offset:0 lds
v_mfma_f32_32x32x16_bf16 v[224:239], a[156:159], a[108:111], v[224:239]
buffer_load_dwordx4 a[92:95], v9, s[8:11], s30 offen offset:3072 sc1
v_mfma_f32_32x32x16_bf16 v[240:255], a[156:159], a[124:127], v[240:255]
s_sub_u32 s33, s33, 1
s_cmp_lg_u32 s33, 0
s_cbranch_scc1 adaLN_cond__sliding_block_cached__swiglu_ffn__prompt_kernel_loop_19
s_waitcnt lgkmcnt(0)
v_mfma_f32_32x32x16_bf16 v[128:143], a[128:131], a[0:3], v[128:143]
ds_read_b64_tr_b16 a[144:145], v4 offset:4096
ds_read_b64_tr_b16 a[146:147], v4 offset:5120
v_accvgpr_write_b32 a192, 0
v_mfma_f32_32x32x16_bf16 v[144:159], a[128:131], a[16:19], v[144:159]
ds_read_b64_tr_b16 a[148:149], v5 offset:4096
ds_read_b64_tr_b16 a[150:151], v5 offset:5120
v_accvgpr_write_b32 a193, 0
v_mfma_f32_32x32x16_bf16 v[160:175], a[132:135], a[0:3], v[160:175]
ds_read_b64_tr_b16 a[152:153], v6 offset:4096
ds_read_b64_tr_b16 a[154:155], v6 offset:5120
v_accvgpr_write_b32 a194, 0
v_mfma_f32_32x32x16_bf16 v[176:191], a[132:135], a[16:19], v[176:191]
ds_read_b64_tr_b16 a[156:157], v7 offset:4096
ds_read_b64_tr_b16 a[158:159], v7 offset:5120
v_accvgpr_write_b32 a195, 0
v_mfma_f32_32x32x16_bf16 v[192:207], a[136:139], a[0:3], v[192:207]
s_add_u32 s30, s30, 4096
buffer_load_dwordx4 a[96:99], v8, s[8:11], s30 offen offset:0 sc1
v_accvgpr_write_b32 a196, 0
v_mfma_f32_32x32x16_bf16 v[208:223], a[136:139], a[16:19], v[208:223]
buffer_load_dwordx4 v11, s[12:15], s31 offen offset:1024 lds
v_accvgpr_write_b32 a197, 0
v_mfma_f32_32x32x16_bf16 v[224:239], a[140:143], a[0:3], v[224:239]
buffer_load_dwordx4 a[112:115], v9, s[8:11], s30 offen offset:0 sc1
v_accvgpr_write_b32 a198, 0
v_mfma_f32_32x32x16_bf16 v[240:255], a[140:143], a[16:19], v[240:255]
v_accvgpr_write_b32 a199, 0
s_waitcnt lgkmcnt(0)
v_mfma_f32_32x32x16_bf16 v[128:143], a[144:147], a[4:7], v[128:143]
ds_read_b64_tr_b16 a[128:129], v4 offset:8192
ds_read_b64_tr_b16 a[130:131], v4 offset:9216
v_accvgpr_write_b32 a200, 0
v_mfma_f32_32x32x16_bf16 v[144:159], a[144:147], a[20:23], v[144:159]
ds_read_b64_tr_b16 a[132:133], v5 offset:8192
ds_read_b64_tr_b16 a[134:135], v5 offset:9216
v_accvgpr_write_b32 a201, 0
v_mfma_f32_32x32x16_bf16 v[160:175], a[148:151], a[4:7], v[160:175]
ds_read_b64_tr_b16 a[136:137], v6 offset:8192
ds_read_b64_tr_b16 a[138:139], v6 offset:9216
v_accvgpr_write_b32 a202, 0
v_mfma_f32_32x32x16_bf16 v[176:191], a[148:151], a[20:23], v[176:191]
ds_read_b64_tr_b16 a[140:141], v7 offset:8192
ds_read_b64_tr_b16 a[142:143], v7 offset:9216
v_accvgpr_write_b32 a203, 0
v_mfma_f32_32x32x16_bf16 v[192:207], a[152:155], a[4:7], v[192:207]
buffer_load_dwordx4 a[100:103], v8, s[8:11], s30 offen offset:1024 sc1
v_accvgpr_write_b32 a204, 0
v_mfma_f32_32x32x16_bf16 v[208:223], a[152:155], a[20:23], v[208:223]
buffer_load_dwordx4 v12, s[12:15], s31 offen offset:2048 lds
v_accvgpr_write_b32 a205, 0
v_mfma_f32_32x32x16_bf16 v[224:239], a[156:159], a[4:7], v[224:239]
buffer_load_dwordx4 a[116:119], v9, s[8:11], s30 offen offset:1024 sc1
v_accvgpr_write_b32 a206, 0
v_mfma_f32_32x32x16_bf16 v[240:255], a[156:159], a[20:23], v[240:255]
v_accvgpr_write_b32 a207, 0
s_waitcnt lgkmcnt(0)
v_mfma_f32_32x32x16_bf16 v[128:143], a[128:131], a[8:11], v[128:143]
ds_read_b64_tr_b16 a[144:145], v4 offset:12288
ds_read_b64_tr_b16 a[146:147], v4 offset:13312
v_accvgpr_write_b32 a208, 0
v_mfma_f32_32x32x16_bf16 v[144:159], a[128:131], a[24:27], v[144:159]
ds_read_b64_tr_b16 a[148:149], v5 offset:12288
ds_read_b64_tr_b16 a[150:151], v5 offset:13312
v_accvgpr_write_b32 a209, 0
v_mfma_f32_32x32x16_bf16 v[160:175], a[132:135], a[8:11], v[160:175]
ds_read_b64_tr_b16 a[152:153], v6 offset:12288
ds_read_b64_tr_b16 a[154:155], v6 offset:13312
v_accvgpr_write_b32 a210, 0
v_mfma_f32_32x32x16_bf16 v[176:191], a[132:135], a[24:27], v[176:191]
ds_read_b64_tr_b16 a[156:157], v7 offset:12288
ds_read_b64_tr_b16 a[158:159], v7 offset:13312
v_accvgpr_write_b32 a211, 0
v_mfma_f32_32x32x16_bf16 v[192:207], a[136:139], a[8:11], v[192:207]
buffer_load_dwordx4 a[104:107], v8, s[8:11], s30 offen offset:2048 sc1
v_accvgpr_write_b32 a212, 0
v_mfma_f32_32x32x16_bf16 v[208:223], a[136:139], a[24:27], v[208:223]
buffer_load_dwordx4 v13, s[12:15], s31 offen offset:3072 lds
v_accvgpr_write_b32 a213, 0
v_mfma_f32_32x32x16_bf16 v[224:239], a[140:143], a[8:11], v[224:239]
buffer_load_dwordx4 a[120:123], v9, s[8:11], s30 offen offset:2048 sc1
v_accvgpr_write_b32 a214, 0
v_mfma_f32_32x32x16_bf16 v[240:255], a[140:143], a[24:27], v[240:255]
v_accvgpr_write_b32 a215, 0
s_waitcnt vmcnt(24) lgkmcnt(0)
s_barrier
v_mfma_f32_32x32x16_bf16 v[128:143], a[144:147], a[12:15], v[128:143]
ds_read_b64_tr_b16 a[128:129], v4 offset:16384
ds_read_b64_tr_b16 a[130:131], v4 offset:17408
v_accvgpr_write_b32 a216, 0
v_mfma_f32_32x32x16_bf16 v[144:159], a[144:147], a[28:31], v[144:159]
ds_read_b64_tr_b16 a[132:133], v5 offset:16384
ds_read_b64_tr_b16 a[134:135], v5 offset:17408
v_accvgpr_write_b32 a217, 0
v_mfma_f32_32x32x16_bf16 v[160:175], a[148:151], a[12:15], v[160:175]
ds_read_b64_tr_b16 a[136:137], v6 offset:16384
ds_read_b64_tr_b16 a[138:139], v6 offset:17408
v_accvgpr_write_b32 a218, 0
v_mfma_f32_32x32x16_bf16 v[176:191], a[148:151], a[28:31], v[176:191]
ds_read_b64_tr_b16 a[140:141], v7 offset:16384
ds_read_b64_tr_b16 a[142:143], v7 offset:17408
v_accvgpr_write_b32 a219, 0
v_mfma_f32_32x32x16_bf16 v[192:207], a[152:155], a[12:15], v[192:207]
buffer_load_dwordx4 a[108:111], v8, s[8:11], s30 offen offset:3072 sc1
v_accvgpr_write_b32 a220, 0
v_mfma_f32_32x32x16_bf16 v[208:223], a[152:155], a[28:31], v[208:223]
buffer_load_dwordx4 a[124:127], v9, s[8:11], s30 offen offset:3072 sc1
v_accvgpr_write_b32 a221, 0
v_mfma_f32_32x32x16_bf16 v[224:239], a[156:159], a[12:15], v[224:239]
s_mov_b32 s52, 0
s_add_u32 m0, s32, 65536
s_nop 0
buffer_load_dwordx4 v28, s[44:47], s52 offen offset:0 sc1 lds
v_accvgpr_write_b32 a222, 0
v_mfma_f32_32x32x16_bf16 v[240:255], a[156:159], a[28:31], v[240:255]
v_accvgpr_write_b32 a223, 0
s_waitcnt lgkmcnt(0)
v_mfma_f32_32x32x16_bf16 v[128:143], a[128:131], a[32:35], v[128:143]
ds_read_b64_tr_b16 a[144:145], v4 offset:20480
ds_read_b64_tr_b16 a[146:147], v4 offset:21504
v_accvgpr_write_b32 a0, 0
v_mfma_f32_32x32x16_bf16 v[144:159], a[128:131], a[48:51], v[144:159]
ds_read_b64_tr_b16 a[148:149], v5 offset:20480
ds_read_b64_tr_b16 a[150:151], v5 offset:21504
v_accvgpr_write_b32 a1, 0
v_mfma_f32_32x32x16_bf16 v[160:175], a[132:135], a[32:35], v[160:175]
ds_read_b64_tr_b16 a[152:153], v6 offset:20480
ds_read_b64_tr_b16 a[154:155], v6 offset:21504
v_accvgpr_write_b32 a2, 0
v_mfma_f32_32x32x16_bf16 v[176:191], a[132:135], a[48:51], v[176:191]
ds_read_b64_tr_b16 a[156:157], v7 offset:20480
ds_read_b64_tr_b16 a[158:159], v7 offset:21504
v_accvgpr_write_b32 a3, 0
v_mfma_f32_32x32x16_bf16 v[192:207], a[136:139], a[32:35], v[192:207]
buffer_load_dwordx4 v28, s[44:47], s52 offen offset:1024 sc1 lds
v_accvgpr_write_b32 a4, 0
v_mfma_f32_32x32x16_bf16 v[208:223], a[136:139], a[48:51], v[208:223]
v_accvgpr_write_b32 a5, 0
v_mfma_f32_32x32x16_bf16 v[224:239], a[140:143], a[32:35], v[224:239]
buffer_load_dwordx4 v28, s[44:47], s52 offen offset:2048 sc1 lds
v_accvgpr_write_b32 a6, 0
v_mfma_f32_32x32x16_bf16 v[240:255], a[140:143], a[48:51], v[240:255]
v_accvgpr_write_b32 a7, 0
s_waitcnt lgkmcnt(0)
v_mfma_f32_32x32x16_bf16 v[128:143], a[144:147], a[36:39], v[128:143]
ds_read_b64_tr_b16 a[128:129], v4 offset:24576
ds_read_b64_tr_b16 a[130:131], v4 offset:25600
v_accvgpr_write_b32 a8, 0
v_mfma_f32_32x32x16_bf16 v[144:159], a[144:147], a[52:55], v[144:159]
ds_read_b64_tr_b16 a[132:133], v5 offset:24576
ds_read_b64_tr_b16 a[134:135], v5 offset:25600
v_accvgpr_write_b32 a9, 0
v_mfma_f32_32x32x16_bf16 v[160:175], a[148:151], a[36:39], v[160:175]
ds_read_b64_tr_b16 a[136:137], v6 offset:24576
ds_read_b64_tr_b16 a[138:139], v6 offset:25600
v_accvgpr_write_b32 a10, 0
v_mfma_f32_32x32x16_bf16 v[176:191], a[148:151], a[52:55], v[176:191]
ds_read_b64_tr_b16 a[140:141], v7 offset:24576
ds_read_b64_tr_b16 a[142:143], v7 offset:25600
v_accvgpr_write_b32 a11, 0
v_mfma_f32_32x32x16_bf16 v[192:207], a[152:155], a[36:39], v[192:207]
buffer_load_dwordx4 v28, s[44:47], s52 offen offset:3072 sc1 lds
v_accvgpr_write_b32 a12, 0
v_mfma_f32_32x32x16_bf16 v[208:223], a[152:155], a[52:55], v[208:223]
v_accvgpr_write_b32 a13, 0
v_mfma_f32_32x32x16_bf16 v[224:239], a[156:159], a[36:39], v[224:239]
s_mov_b32 s53, 0
s_add_u32 m0, s32, 114688
s_nop 0
buffer_load_dwordx4 v28, s[48:51], s53 offen offset:0 sc1 lds
v_accvgpr_write_b32 a14, 0
v_mfma_f32_32x32x16_bf16 v[240:255], a[156:159], a[52:55], v[240:255]
v_accvgpr_write_b32 a15, 0
s_waitcnt lgkmcnt(0)
v_mfma_f32_32x32x16_bf16 v[128:143], a[128:131], a[40:43], v[128:143]
ds_read_b64_tr_b16 a[144:145], v4 offset:28672
ds_read_b64_tr_b16 a[146:147], v4 offset:29696
v_accvgpr_write_b32 a16, 0
v_mfma_f32_32x32x16_bf16 v[144:159], a[128:131], a[56:59], v[144:159]
ds_read_b64_tr_b16 a[148:149], v5 offset:28672
ds_read_b64_tr_b16 a[150:151], v5 offset:29696
v_accvgpr_write_b32 a17, 0
v_mfma_f32_32x32x16_bf16 v[160:175], a[132:135], a[40:43], v[160:175]
ds_read_b64_tr_b16 a[152:153], v6 offset:28672
ds_read_b64_tr_b16 a[154:155], v6 offset:29696
v_accvgpr_write_b32 a18, 0
v_mfma_f32_32x32x16_bf16 v[176:191], a[132:135], a[56:59], v[176:191]
ds_read_b64_tr_b16 a[156:157], v7 offset:28672
ds_read_b64_tr_b16 a[158:159], v7 offset:29696
v_accvgpr_write_b32 a19, 0
v_mfma_f32_32x32x16_bf16 v[192:207], a[136:139], a[40:43], v[192:207]
buffer_load_dwordx4 v28, s[48:51], s53 offen offset:1024 sc1 lds
v_accvgpr_write_b32 a20, 0
v_mfma_f32_32x32x16_bf16 v[208:223], a[136:139], a[56:59], v[208:223]
v_accvgpr_write_b32 a21, 0
v_mfma_f32_32x32x16_bf16 v[224:239], a[140:143], a[40:43], v[224:239]
buffer_load_dwordx4 v28, s[48:51], s53 offen offset:2048 sc1 lds
v_accvgpr_write_b32 a22, 0
v_mfma_f32_32x32x16_bf16 v[240:255], a[140:143], a[56:59], v[240:255]
v_accvgpr_write_b32 a23, 0
s_waitcnt vmcnt(21) lgkmcnt(0)
s_barrier
v_mfma_f32_32x32x16_bf16 v[128:143], a[144:147], a[44:47], v[128:143]
ds_read_b64_tr_b16 a[128:129], v4 offset:32768
ds_read_b64_tr_b16 a[130:131], v4 offset:33792
v_accvgpr_write_b32 a24, 0
v_mfma_f32_32x32x16_bf16 v[144:159], a[144:147], a[60:63], v[144:159]
ds_read_b64_tr_b16 a[132:133], v5 offset:32768
ds_read_b64_tr_b16 a[134:135], v5 offset:33792
v_accvgpr_write_b32 a25, 0
v_mfma_f32_32x32x16_bf16 v[160:175], a[148:151], a[44:47], v[160:175]
ds_read_b64_tr_b16 a[136:137], v6 offset:32768
ds_read_b64_tr_b16 a[138:139], v6 offset:33792
v_accvgpr_write_b32 a26, 0
v_mfma_f32_32x32x16_bf16 v[176:191], a[148:151], a[60:63], v[176:191]
ds_read_b64_tr_b16 a[140:141], v7 offset:32768
ds_read_b64_tr_b16 a[142:143], v7 offset:33792
v_accvgpr_write_b32 a27, 0
v_mfma_f32_32x32x16_bf16 v[192:207], a[152:155], a[44:47], v[192:207]
buffer_load_dwordx4 v28, s[48:51], s53 offen offset:3072 sc1 lds
v_accvgpr_write_b32 a28, 0
v_mfma_f32_32x32x16_bf16 v[208:223], a[152:155], a[60:63], v[208:223]
v_accvgpr_write_b32 a29, 0
v_mfma_f32_32x32x16_bf16 v[224:239], a[156:159], a[44:47], v[224:239]
s_mov_b32 s52, 16384
s_add_u32 m0, s32, 81920
s_nop 0
buffer_load_dwordx4 v28, s[44:47], s52 offen offset:0 sc1 lds
v_accvgpr_write_b32 a30, 0
v_mfma_f32_32x32x16_bf16 v[240:255], a[156:159], a[60:63], v[240:255]
v_accvgpr_write_b32 a31, 0
s_waitcnt lgkmcnt(0)
v_mfma_f32_32x32x16_bf16 v[128:143], a[128:131], a[64:67], v[128:143]
ds_read_b64_tr_b16 a[144:145], v4 offset:36864
ds_read_b64_tr_b16 a[146:147], v4 offset:37888
v_accvgpr_write_b32 a32, 0
v_mfma_f32_32x32x16_bf16 v[144:159], a[128:131], a[80:83], v[144:159]
ds_read_b64_tr_b16 a[148:149], v5 offset:36864
ds_read_b64_tr_b16 a[150:151], v5 offset:37888
v_accvgpr_write_b32 a33, 0
v_mfma_f32_32x32x16_bf16 v[160:175], a[132:135], a[64:67], v[160:175]
ds_read_b64_tr_b16 a[152:153], v6 offset:36864
ds_read_b64_tr_b16 a[154:155], v6 offset:37888
v_accvgpr_write_b32 a34, 0
v_mfma_f32_32x32x16_bf16 v[176:191], a[132:135], a[80:83], v[176:191]
ds_read_b64_tr_b16 a[156:157], v7 offset:36864
ds_read_b64_tr_b16 a[158:159], v7 offset:37888
v_accvgpr_write_b32 a35, 0
v_mfma_f32_32x32x16_bf16 v[192:207], a[136:139], a[64:67], v[192:207]
buffer_load_dwordx4 v28, s[44:47], s52 offen offset:1024 sc1 lds
v_accvgpr_write_b32 a36, 0
v_mfma_f32_32x32x16_bf16 v[208:223], a[136:139], a[80:83], v[208:223]
v_accvgpr_write_b32 a37, 0
v_mfma_f32_32x32x16_bf16 v[224:239], a[140:143], a[64:67], v[224:239]
buffer_load_dwordx4 v28, s[44:47], s52 offen offset:2048 sc1 lds
v_accvgpr_write_b32 a38, 0
v_mfma_f32_32x32x16_bf16 v[240:255], a[140:143], a[80:83], v[240:255]
v_accvgpr_write_b32 a39, 0
s_waitcnt lgkmcnt(0)
v_mfma_f32_32x32x16_bf16 v[128:143], a[144:147], a[68:71], v[128:143]
ds_read_b64_tr_b16 a[128:129], v4 offset:40960
ds_read_b64_tr_b16 a[130:131], v4 offset:41984
v_accvgpr_write_b32 a40, 0
v_mfma_f32_32x32x16_bf16 v[144:159], a[144:147], a[84:87], v[144:159]
ds_read_b64_tr_b16 a[132:133], v5 offset:40960
ds_read_b64_tr_b16 a[134:135], v5 offset:41984
v_accvgpr_write_b32 a41, 0
v_mfma_f32_32x32x16_bf16 v[160:175], a[148:151], a[68:71], v[160:175]
ds_read_b64_tr_b16 a[136:137], v6 offset:40960
ds_read_b64_tr_b16 a[138:139], v6 offset:41984
v_accvgpr_write_b32 a42, 0
v_mfma_f32_32x32x16_bf16 v[176:191], a[148:151], a[84:87], v[176:191]
ds_read_b64_tr_b16 a[140:141], v7 offset:40960
ds_read_b64_tr_b16 a[142:143], v7 offset:41984
v_accvgpr_write_b32 a43, 0
v_mfma_f32_32x32x16_bf16 v[192:207], a[152:155], a[68:71], v[192:207]
buffer_load_dwordx4 v28, s[44:47], s52 offen offset:3072 sc1 lds
v_accvgpr_write_b32 a44, 0
v_mfma_f32_32x32x16_bf16 v[208:223], a[152:155], a[84:87], v[208:223]
v_accvgpr_write_b32 a45, 0
v_mfma_f32_32x32x16_bf16 v[224:239], a[156:159], a[68:71], v[224:239]
v_accvgpr_write_b32 a46, 0
v_mfma_f32_32x32x16_bf16 v[240:255], a[156:159], a[84:87], v[240:255]
v_accvgpr_write_b32 a47, 0
s_waitcnt lgkmcnt(0)
v_mfma_f32_32x32x16_bf16 v[128:143], a[128:131], a[72:75], v[128:143]
ds_read_b64_tr_b16 a[144:145], v4 offset:45056
ds_read_b64_tr_b16 a[146:147], v4 offset:46080
v_accvgpr_write_b32 a48, 0
v_mfma_f32_32x32x16_bf16 v[144:159], a[128:131], a[88:91], v[144:159]
ds_read_b64_tr_b16 a[148:149], v5 offset:45056
ds_read_b64_tr_b16 a[150:151], v5 offset:46080
v_accvgpr_write_b32 a49, 0
v_mfma_f32_32x32x16_bf16 v[160:175], a[132:135], a[72:75], v[160:175]
ds_read_b64_tr_b16 a[152:153], v6 offset:45056
ds_read_b64_tr_b16 a[154:155], v6 offset:46080
v_accvgpr_write_b32 a50, 0
v_mfma_f32_32x32x16_bf16 v[176:191], a[132:135], a[88:91], v[176:191]
ds_read_b64_tr_b16 a[156:157], v7 offset:45056
ds_read_b64_tr_b16 a[158:159], v7 offset:46080
v_accvgpr_write_b32 a51, 0
v_mfma_f32_32x32x16_bf16 v[192:207], a[136:139], a[72:75], v[192:207]
s_mov_b32 s53, 16384
s_add_u32 m0, s32, 131072
s_nop 0
buffer_load_dwordx4 v28, s[48:51], s53 offen offset:0 sc1 lds
v_accvgpr_write_b32 a52, 0
v_mfma_f32_32x32x16_bf16 v[208:223], a[136:139], a[88:91], v[208:223]
v_accvgpr_write_b32 a53, 0
v_mfma_f32_32x32x16_bf16 v[224:239], a[140:143], a[72:75], v[224:239]
buffer_load_dwordx4 v28, s[48:51], s53 offen offset:1024 sc1 lds
v_accvgpr_write_b32 a54, 0
v_mfma_f32_32x32x16_bf16 v[240:255], a[140:143], a[88:91], v[240:255]
v_accvgpr_write_b32 a55, 0
s_waitcnt vmcnt(14) lgkmcnt(0)
s_barrier
v_mfma_f32_32x32x16_bf16 v[128:143], a[144:147], a[76:79], v[128:143]
ds_read_b64_tr_b16 a[128:129], v4 offset:49152
ds_read_b64_tr_b16 a[130:131], v4 offset:50176
v_accvgpr_write_b32 a56, 0
v_mfma_f32_32x32x16_bf16 v[144:159], a[144:147], a[92:95], v[144:159]
ds_read_b64_tr_b16 a[132:133], v4 offset:53248
ds_read_b64_tr_b16 a[134:135], v4 offset:54272
v_accvgpr_write_b32 a57, 0
v_mfma_f32_32x32x16_bf16 v[160:175], a[148:151], a[76:79], v[160:175]
ds_read_b64_tr_b16 a[136:137], v4 offset:57344
ds_read_b64_tr_b16 a[138:139], v4 offset:58368
v_accvgpr_write_b32 a58, 0
v_mfma_f32_32x32x16_bf16 v[176:191], a[148:151], a[92:95], v[176:191]
ds_read_b64_tr_b16 a[140:141], v4 offset:61440
ds_read_b64_tr_b16 a[142:143], v4 offset:62464
v_accvgpr_write_b32 a59, 0
v_mfma_f32_32x32x16_bf16 v[192:207], a[152:155], a[76:79], v[192:207]
buffer_load_dwordx4 v28, s[48:51], s53 offen offset:2048 sc1 lds
v_accvgpr_write_b32 a60, 0
v_mfma_f32_32x32x16_bf16 v[208:223], a[152:155], a[92:95], v[208:223]
v_accvgpr_write_b32 a61, 0
v_mfma_f32_32x32x16_bf16 v[224:239], a[156:159], a[76:79], v[224:239]
buffer_load_dwordx4 v28, s[48:51], s53 offen offset:3072 sc1 lds
v_accvgpr_write_b32 a62, 0
v_mfma_f32_32x32x16_bf16 v[240:255], a[156:159], a[92:95], v[240:255]
v_accvgpr_write_b32 a63, 0
s_waitcnt lgkmcnt(6)
v_mfma_f32_32x32x16_bf16 v[128:143], a[128:131], a[96:99], v[128:143]
ds_read_b64_tr_b16 a[144:145], v5 offset:49152
s_mov_b32 s52, 32768
s_add_u32 m0, s32, 98304
s_nop 0
buffer_load_dwordx4 v28, s[44:47], s52 offen offset:0 sc1 lds
buffer_load_dwordx4 v28, s[44:47], s52 offen offset:1024 sc1 lds
v_accvgpr_write_b32 a64, 0
v_accvgpr_write_b32 a65, 0
v_accvgpr_write_b32 a66, 0
v_mfma_f32_32x32x16_bf16 v[144:159], a[128:131], a[112:115], v[144:159]
ds_read_b64_tr_b16 a[146:147], v5 offset:50176
v_accvgpr_write_b32 a67, 0
v_accvgpr_write_b32 a68, 0
v_accvgpr_write_b32 a69, 0
v_accvgpr_write_b32 a70, 0
v_accvgpr_write_b32 a71, 0
s_waitcnt lgkmcnt(6)
v_mfma_f32_32x32x16_bf16 v[128:143], a[132:135], a[100:103], v[128:143]
ds_read_b64_tr_b16 a[148:149], v5 offset:53248
buffer_load_dwordx4 v28, s[44:47], s52 offen offset:2048 sc1 lds
buffer_load_dwordx4 v28, s[44:47], s52 offen offset:3072 sc1 lds
v_accvgpr_write_b32 a72, 0
v_accvgpr_write_b32 a73, 0
v_accvgpr_write_b32 a74, 0
v_mfma_f32_32x32x16_bf16 v[144:159], a[132:135], a[116:119], v[144:159]
ds_read_b64_tr_b16 a[150:151], v5 offset:54272
v_accvgpr_write_b32 a75, 0
v_accvgpr_write_b32 a76, 0
v_accvgpr_write_b32 a77, 0
v_accvgpr_write_b32 a78, 0
v_accvgpr_write_b32 a79, 0
s_waitcnt lgkmcnt(6)
v_mfma_f32_32x32x16_bf16 v[128:143], a[136:139], a[104:107], v[128:143]
ds_read_b64_tr_b16 a[152:153], v5 offset:57344
s_mov_b32 s53, 32768
s_add_u32 m0, s32, 147456
s_nop 0
buffer_load_dwordx4 v28, s[48:51], s53 offen offset:0 sc1 lds
buffer_load_dwordx4 v28, s[48:51], s53 offen offset:1024 sc1 lds
v_accvgpr_write_b32 a80, 0
v_accvgpr_write_b32 a81, 0
v_accvgpr_write_b32 a82, 0
v_mfma_f32_32x32x16_bf16 v[144:159], a[136:139], a[120:123], v[144:159]
ds_read_b64_tr_b16 a[154:155], v5 offset:58368
v_accvgpr_write_b32 a83, 0
v_accvgpr_write_b32 a84, 0
v_accvgpr_write_b32 a85, 0
v_accvgpr_write_b32 a86, 0
v_accvgpr_write_b32 a87, 0
s_waitcnt lgkmcnt(6)
v_mfma_f32_32x32x16_bf16 v[128:143], a[140:143], a[108:111], v[128:143]
ds_read_b64_tr_b16 a[156:157], v5 offset:61440
buffer_load_dwordx4 v28, s[48:51], s53 offen offset:2048 sc1 lds
buffer_load_dwordx4 v28, s[48:51], s53 offen offset:3072 sc1 lds
v_accvgpr_write_b32 a88, 0
v_accvgpr_write_b32 a89, 0
v_accvgpr_write_b32 a90, 0
v_mfma_f32_32x32x16_bf16 v[144:159], a[140:143], a[124:127], v[144:159]
ds_read_b64_tr_b16 a[158:159], v5 offset:62464
v_accvgpr_write_b32 a91, 0
v_accvgpr_write_b32 a92, 0
v_accvgpr_write_b32 a93, 0
v_accvgpr_write_b32 a94, 0
v_accvgpr_write_b32 a95, 0
s_waitcnt lgkmcnt(6)
v_mfma_f32_32x32x16_bf16 v[160:175], a[144:147], a[96:99], v[160:175]
ds_read_b64_tr_b16 a[128:129], v6 offset:49152
v_mfma_f32_32x32x16_bf16 v[176:191], a[144:147], a[112:115], v[176:191]
ds_read_b64_tr_b16 a[130:131], v6 offset:50176
s_waitcnt lgkmcnt(6)
v_mfma_f32_32x32x16_bf16 v[160:175], a[148:151], a[100:103], v[160:175]
ds_read_b64_tr_b16 a[132:133], v6 offset:53248
v_mfma_f32_32x32x16_bf16 v[176:191], a[148:151], a[116:119], v[176:191]
ds_read_b64_tr_b16 a[134:135], v6 offset:54272
s_waitcnt lgkmcnt(6)
v_mfma_f32_32x32x16_bf16 v[160:175], a[152:155], a[104:107], v[160:175]
ds_read_b64_tr_b16 a[136:137], v6 offset:57344
v_cvt_pk_bf16_f32 v64, v128, v129
v_cvt_pk_bf16_f32 v65, v130, v131
v_cvt_pk_bf16_f32 v66, v132, v133
v_cvt_pk_bf16_f32 v67, v134, v135
v_mfma_f32_32x32x16_bf16 v[176:191], a[152:155], a[120:123], v[176:191]
ds_read_b64_tr_b16 a[138:139], v6 offset:58368
v_cvt_pk_bf16_f32 v68, v136, v137
v_cvt_pk_bf16_f32 v69, v138, v139
v_cvt_pk_bf16_f32 v70, v140, v141
v_cvt_pk_bf16_f32 v71, v142, v143
s_waitcnt lgkmcnt(6)
v_mfma_f32_32x32x16_bf16 v[160:175], a[156:159], a[108:111], v[160:175]
ds_read_b64_tr_b16 a[140:141], v6 offset:61440
v_cvt_pk_bf16_f32 v96, v144, v145
v_cvt_pk_bf16_f32 v97, v146, v147
v_cvt_pk_bf16_f32 v98, v148, v149
v_cvt_pk_bf16_f32 v99, v150, v151
v_mfma_f32_32x32x16_bf16 v[176:191], a[156:159], a[124:127], v[176:191]
ds_read_b64_tr_b16 a[142:143], v6 offset:62464
v_cvt_pk_bf16_f32 v100, v152, v153
v_cvt_pk_bf16_f32 v101, v154, v155
v_cvt_pk_bf16_f32 v102, v156, v157
v_cvt_pk_bf16_f32 v103, v158, v159
s_waitcnt lgkmcnt(6)
v_mfma_f32_32x32x16_bf16 v[192:207], a[128:131], a[96:99], v[192:207]
ds_read_b64_tr_b16 a[144:145], v7 offset:49152
v_mfma_f32_32x32x16_bf16 v[208:223], a[128:131], a[112:115], v[208:223]
ds_read_b64_tr_b16 a[146:147], v7 offset:50176
s_waitcnt lgkmcnt(6)
v_mfma_f32_32x32x16_bf16 v[192:207], a[132:135], a[100:103], v[192:207]
ds_read_b64_tr_b16 a[148:149], v7 offset:53248
v_mfma_f32_32x32x16_bf16 v[208:223], a[132:135], a[116:119], v[208:223]
ds_read_b64_tr_b16 a[150:151], v7 offset:54272
s_waitcnt lgkmcnt(6)
v_mfma_f32_32x32x16_bf16 v[192:207], a[136:139], a[104:107], v[192:207]
ds_read_b64_tr_b16 a[152:153], v7 offset:57344
v_cvt_pk_bf16_f32 v72, v160, v161
v_cvt_pk_bf16_f32 v73, v162, v163
v_cvt_pk_bf16_f32 v74, v164, v165
v_cvt_pk_bf16_f32 v75, v166, v167
v_mfma_f32_32x32x16_bf16 v[208:223], a[136:139], a[120:123], v[208:223]
ds_read_b64_tr_b16 a[154:155], v7 offset:58368
v_cvt_pk_bf16_f32 v76, v168, v169
v_cvt_pk_bf16_f32 v77, v170, v171
v_cvt_pk_bf16_f32 v78, v172, v173
v_cvt_pk_bf16_f32 v79, v174, v175
s_waitcnt lgkmcnt(6)
v_mfma_f32_32x32x16_bf16 v[192:207], a[140:143], a[108:111], v[192:207]
ds_read_b64_tr_b16 a[156:157], v7 offset:61440
v_cvt_pk_bf16_f32 v104, v176, v177
v_cvt_pk_bf16_f32 v105, v178, v179
v_cvt_pk_bf16_f32 v106, v180, v181
v_cvt_pk_bf16_f32 v107, v182, v183
v_mfma_f32_32x32x16_bf16 v[208:223], a[140:143], a[124:127], v[208:223]
ds_read_b64_tr_b16 a[158:159], v7 offset:62464
v_cvt_pk_bf16_f32 v108, v184, v185
v_cvt_pk_bf16_f32 v109, v186, v187
v_cvt_pk_bf16_f32 v110, v188, v189
v_cvt_pk_bf16_f32 v111, v190, v191
s_waitcnt lgkmcnt(6)
v_mfma_f32_32x32x16_bf16 v[224:239], a[144:147], a[96:99], v[224:239]
v_mfma_f32_32x32x16_bf16 v[240:255], a[144:147], a[112:115], v[240:255]
s_waitcnt lgkmcnt(4)
v_mfma_f32_32x32x16_bf16 v[224:239], a[148:151], a[100:103], v[224:239]
v_mfma_f32_32x32x16_bf16 v[240:255], a[148:151], a[116:119], v[240:255]
s_waitcnt lgkmcnt(2)
v_mfma_f32_32x32x16_bf16 v[224:239], a[152:155], a[104:107], v[224:239]
v_cvt_pk_bf16_f32 v80, v192, v193
v_cvt_pk_bf16_f32 v81, v194, v195
v_cvt_pk_bf16_f32 v82, v196, v197
v_cvt_pk_bf16_f32 v83, v198, v199
v_mfma_f32_32x32x16_bf16 v[240:255], a[152:155], a[120:123], v[240:255]
v_cvt_pk_bf16_f32 v84, v200, v201
v_cvt_pk_bf16_f32 v85, v202, v203
v_cvt_pk_bf16_f32 v86, v204, v205
v_cvt_pk_bf16_f32 v87, v206, v207
s_waitcnt lgkmcnt(0)
v_mfma_f32_32x32x16_bf16 v[224:239], a[156:159], a[108:111], v[224:239]
v_cvt_pk_bf16_f32 v112, v208, v209
v_cvt_pk_bf16_f32 v113, v210, v211
v_cvt_pk_bf16_f32 v114, v212, v213
v_cvt_pk_bf16_f32 v115, v214, v215
v_mfma_f32_32x32x16_bf16 v[240:255], a[156:159], a[124:127], v[240:255]
v_cvt_pk_bf16_f32 v116, v216, v217
v_cvt_pk_bf16_f32 v117, v218, v219
v_cvt_pk_bf16_f32 v118, v220, v221
v_cvt_pk_bf16_f32 v119, v222, v223
s_nop 7
s_nop 3
v_cvt_pk_bf16_f32 v88, v224, v225
v_cvt_pk_bf16_f32 v89, v226, v227
v_cvt_pk_bf16_f32 v90, v228, v229
v_cvt_pk_bf16_f32 v91, v230, v231
v_cvt_pk_bf16_f32 v92, v232, v233
v_cvt_pk_bf16_f32 v93, v234, v235
v_cvt_pk_bf16_f32 v94, v236, v237
v_cvt_pk_bf16_f32 v95, v238, v239
v_cvt_pk_bf16_f32 v120, v240, v241
v_cvt_pk_bf16_f32 v121, v242, v243
v_cvt_pk_bf16_f32 v122, v244, v245
v_cvt_pk_bf16_f32 v123, v246, v247
v_cvt_pk_bf16_f32 v124, v248, v249
v_cvt_pk_bf16_f32 v125, v250, v251
v_cvt_pk_bf16_f32 v126, v252, v253
v_cvt_pk_bf16_f32 v127, v254, v255
s_mul_i32 s27, s2, 28672
s_add_u32 s28, s27, 0
s_add_u32 s8, s76, s28
s_addc_u32 s9, s77, 0
s_sub_u32 s10, 0x700000, s28
s_add_u32 s28, s27, 4096
s_add_u32 s12, s76, s28
s_addc_u32 s13, s77, 0
s_sub_u32 s14, 0x700000, s28
s_add_u32 s28, s27, 0
s_add_u32 s54, s78, s28
s_addc_u32 s55, s79, 0
s_sub_u32 s56, 0x700000, s28
s_add_u32 s28, s27, 4096
s_add_u32 s57, s78, s28
s_addc_u32 s61, s79, 0
s_sub_u32 s63, 0x700000, s28
s_waitcnt vmcnt(16)
adaLN_cond__sliding_block_cached__swiglu_ffn__prompt_kernel_pro:
s_barrier
s_mov_b32 s36, 65536
s_mov_b32 s41, 114688
s_mov_b32 s37, 81920
s_mov_b32 s42, 131072
s_mov_b32 s38, 98304
s_mov_b32 s43, 147456
s_mov_b32 s39, 0
s_mov_b32 s29, 32768
s_mov_b32 s40, 16384
s_mov_b32 s35, 49152
ds_read_b128 a[128:131], v16 offset:0
ds_read_b128 a[132:135], v16 offset:1024
ds_read_b128 a[136:139], v16 offset:2048
ds_read_b128 a[140:143], v16 offset:3072
ds_read_b128 a[144:147], v16 offset:4096
ds_read_b128 a[148:151], v16 offset:5120
ds_read_b128 a[152:155], v16 offset:6144
ds_read_b128 a[156:159], v16 offset:7168
v_mov_b32 v33, 0
v_mov_b32 v34, 0
v_mov_b32 v35, 0
v_mov_b32 v36, 0
s_waitcnt lgkmcnt(0)
v_mfma_f32_32x32x16_bf16 v[128:143], a[128:131], v[64:67], 0
v_mfma_f32_32x32x16_bf16 v[128:143], a[132:135], v[68:71], v[128:143]
v_mfma_f32_32x32x16_bf16 v[128:143], a[136:139], v[72:75], v[128:143]
v_mfma_f32_32x32x16_bf16 v[128:143], a[140:143], v[76:79], v[128:143]
v_mfma_f32_32x32x16_bf16 v[128:143], a[144:147], v[80:83], v[128:143]
v_mfma_f32_32x32x16_bf16 v[128:143], a[148:151], v[84:87], v[128:143]
v_mfma_f32_32x32x16_bf16 v[128:143], a[152:155], v[88:91], v[128:143]
v_mfma_f32_32x32x16_bf16 v[128:143], a[156:159], v[92:95], v[128:143]
v_mfma_f32_32x32x16_bf16 v[144:159], a[128:131], v[96:99], 0
v_mfma_f32_32x32x16_bf16 v[144:159], a[132:135], v[100:103], v[144:159]
v_mfma_f32_32x32x16_bf16 v[144:159], a[136:139], v[104:107], v[144:159]
v_mfma_f32_32x32x16_bf16 v[144:159], a[140:143], v[108:111], v[144:159]
v_mfma_f32_32x32x16_bf16 v[144:159], a[144:147], v[112:115], v[144:159]
v_mfma_f32_32x32x16_bf16 v[144:159], a[148:151], v[116:119], v[144:159]
v_mfma_f32_32x32x16_bf16 v[144:159], a[152:155], v[120:123], v[144:159]
v_mfma_f32_32x32x16_bf16 v[144:159], a[156:159], v[124:127], v[144:159]
s_nop 3
s_nop 7
v_max3_f32 v40, v128, v129, v37
v_max3_f32 v40, v40, v130, v131
v_max3_f32 v40, v40, v132, v133
v_max3_f32 v40, v40, v134, v135
v_max3_f32 v40, v40, v136, v137
v_max3_f32 v40, v40, v138, v139
v_max3_f32 v40, v40, v140, v141
v_max3_f32 v40, v40, v142, v143
v_max3_f32 v41, v144, v145, v38
v_max3_f32 v41, v41, v146, v147
v_max3_f32 v41, v41, v148, v149
v_max3_f32 v41, v41, v150, v151
v_max3_f32 v41, v41, v152, v153
v_max3_f32 v41, v41, v154, v155
v_max3_f32 v41, v41, v156, v157
v_max3_f32 v41, v41, v158, v159
v_mov_b32 v42, v40
v_mov_b32 v43, v41
s_nop 1
v_permlane32_swap_b32 v40, v42
v_permlane32_swap_b32 v41, v43
s_nop 1
v_max_f32 v40, v40, v42
v_max_f32 v41, v41, v43
v_sub_f32 v224, 0, v40
v_sub_f32 v225, 0, v40
v_sub_f32 v226, 0, v40
v_sub_f32 v227, 0, v40
v_sub_f32 v228, 0, v40
v_sub_f32 v229, 0, v40
v_sub_f32 v230, 0, v40
v_sub_f32 v231, 0, v40
v_sub_f32 v232, 0, v40
v_sub_f32 v233, 0, v40
v_sub_f32 v234, 0, v40
v_sub_f32 v235, 0, v40
v_sub_f32 v236, 0, v40
v_sub_f32 v237, 0, v40
v_sub_f32 v238, 0, v40
v_sub_f32 v239, 0, v40
v_sub_f32 v128, v128, v40
v_sub_f32 v129, v129, v40
v_sub_f32 v130, v130, v40
v_sub_f32 v131, v131, v40
v_sub_f32 v132, v132, v40
v_sub_f32 v133, v133, v40
v_sub_f32 v134, v134, v40
v_sub_f32 v135, v135, v40
v_sub_f32 v136, v136, v40
v_sub_f32 v137, v137, v40
v_sub_f32 v138, v138, v40
v_sub_f32 v139, v139, v40
v_sub_f32 v140, v140, v40
v_sub_f32 v141, v141, v40
v_sub_f32 v142, v142, v40
v_sub_f32 v143, v143, v40
v_sub_f32 v240, 0, v41
v_sub_f32 v241, 0, v41
v_sub_f32 v242, 0, v41
v_sub_f32 v243, 0, v41
v_sub_f32 v244, 0, v41
v_sub_f32 v245, 0, v41
v_sub_f32 v246, 0, v41
v_sub_f32 v247, 0, v41
v_sub_f32 v248, 0, v41
v_sub_f32 v249, 0, v41
v_sub_f32 v250, 0, v41
v_sub_f32 v251, 0, v41
v_sub_f32 v252, 0, v41
v_sub_f32 v253, 0, v41
v_sub_f32 v254, 0, v41
v_sub_f32 v255, 0, v41
v_sub_f32 v144, v144, v41
v_sub_f32 v145, v145, v41
v_sub_f32 v146, v146, v41
v_sub_f32 v147, v147, v41
v_sub_f32 v148, v148, v41
v_sub_f32 v149, v149, v41
v_sub_f32 v150, v150, v41
v_sub_f32 v151, v151, v41
v_sub_f32 v152, v152, v41
v_sub_f32 v153, v153, v41
v_sub_f32 v154, v154, v41
v_sub_f32 v155, v155, v41
v_sub_f32 v156, v156, v41
v_sub_f32 v157, v157, v41
v_sub_f32 v158, v158, v41
v_sub_f32 v159, v159, v41
v_exp_f32 v128, v128
v_exp_f32 v129, v129
ds_read_b128 a[128:131], v16 offset:8192
s_mov_b32 s52, 49152
s_add_u32 m0, s32, 0
s_nop 0
buffer_load_dwordx4 v28, s[44:47], s52 offen offset:0 sc1 lds
v_exp_f32 v130, v130
v_exp_f32 v131, v131
v_cvt_pk_bf16_f32 v192, v128, v129
buffer_load_dwordx4 v28, s[44:47], s52 offen offset:1024 sc1 lds
v_add_f32 v33, v33, v128
v_add_f32 v34, v34, v129
ds_read_b128 a[132:135], v16 offset:9216
buffer_load_dwordx4 v28, s[44:47], s52 offen offset:2048 sc1 lds
v_exp_f32 v132, v132
v_exp_f32 v133, v133
v_cvt_pk_bf16_f32 v193, v130, v131
buffer_load_dwordx4 v28, s[44:47], s52 offen offset:3072 sc1 lds
v_add_f32 v33, v33, v130
v_add_f32 v34, v34, v131
ds_read_b128 a[136:139], v16 offset:10240
s_mov_b32 s53, 49152
s_add_u32 m0, s32, 32768
s_nop 0
buffer_load_dwordx4 v28, s[48:51], s53 offen offset:0 sc1 lds
v_exp_f32 v134, v134
v_exp_f32 v135, v135
v_cvt_pk_bf16_f32 v194, v132, v133
buffer_load_dwordx4 v28, s[48:51], s53 offen offset:1024 sc1 lds
v_add_f32 v33, v33, v132
v_add_f32 v34, v34, v133
ds_read_b128 a[140:143], v16 offset:11264
buffer_load_dwordx4 v28, s[48:51], s53 offen offset:2048 sc1 lds
v_exp_f32 v136, v136
v_exp_f32 v137, v137
v_cvt_pk_bf16_f32 v195, v134, v135
buffer_load_dwordx4 v28, s[48:51], s53 offen offset:3072 sc1 lds
v_add_f32 v33, v33, v134
v_add_f32 v34, v34, v135
ds_read_b128 a[144:147], v16 offset:12288
s_mov_b32 s52, 65536
s_add_u32 m0, s32, 16384
s_nop 0
buffer_load_dwordx4 v28, s[44:47], s52 offen offset:0 sc1 lds
v_exp_f32 v138, v138
v_exp_f32 v139, v139
v_cvt_pk_bf16_f32 v196, v136, v137
buffer_load_dwordx4 v28, s[44:47], s52 offen offset:1024 sc1 lds
v_add_f32 v33, v33, v136
v_add_f32 v34, v34, v137
ds_read_b128 a[148:151], v16 offset:13312
buffer_load_dwordx4 v28, s[44:47], s52 offen offset:2048 sc1 lds
v_exp_f32 v140, v140
v_exp_f32 v141, v141
v_cvt_pk_bf16_f32 v197, v138, v139
buffer_load_dwordx4 v28, s[44:47], s52 offen offset:3072 sc1 lds
v_add_f32 v33, v33, v138
v_add_f32 v34, v34, v139
ds_read_b128 a[152:155], v16 offset:14336
v_exp_f32 v142, v142
v_exp_f32 v143, v143
v_cvt_pk_bf16_f32 v198, v140, v141
v_add_f32 v33, v33, v140
v_add_f32 v34, v34, v141
ds_read_b128 a[156:159], v16 offset:15360
s_waitcnt lgkmcnt(2)
v_mfma_f32_32x32x16_bf16 v[160:175], a[128:131], v[64:67], v[224:239]
v_exp_f32 v144, v144
v_exp_f32 v145, v145
v_cvt_pk_bf16_f32 v199, v142, v143
v_mfma_f32_32x32x16_bf16 v[160:175], a[132:135], v[68:71], v[160:175]
v_add_f32 v33, v33, v142
v_add_f32 v34, v34, v143
ds_read_b128 a[160:163], v17 offset:0
v_mfma_f32_32x32x16_bf16 v[160:175], a[136:139], v[72:75], v[160:175]
v_exp_f32 v146, v146
v_exp_f32 v147, v147
v_cvt_pk_bf16_f32 v200, v144, v145
v_mfma_f32_32x32x16_bf16 v[160:175], a[140:143], v[76:79], v[160:175]
v_add_f32 v35, v35, v144
v_add_f32 v36, v36, v145
ds_read_b128 a[164:167], v17 offset:1024
v_mfma_f32_32x32x16_bf16 v[160:175], a[144:147], v[80:83], v[160:175]
v_exp_f32 v148, v148
v_exp_f32 v149, v149
v_cvt_pk_bf16_f32 v201, v146, v147
s_mov_b32 s52, 81920
s_mov_b32 s53, 65536
v_mfma_f32_32x32x16_bf16 v[160:175], a[148:151], v[84:87], v[160:175]
v_add_f32 v35, v35, v146
v_add_f32 v36, v36, v147
ds_read_b128 a[168:171], v17 offset:2048
s_waitcnt lgkmcnt(3)
v_mfma_f32_32x32x16_bf16 v[160:175], a[152:155], v[88:91], v[160:175]
v_exp_f32 v150, v150
v_exp_f32 v151, v151
v_cvt_pk_bf16_f32 v202, v148, v149
v_mfma_f32_32x32x16_bf16 v[160:175], a[156:159], v[92:95], v[160:175]
v_add_f32 v35, v35, v148
v_add_f32 v36, v36, v149
ds_read_b128 a[172:175], v17 offset:3072
v_mfma_f32_32x32x16_bf16 v[176:191], a[128:131], v[96:99], v[240:255]
v_exp_f32 v152, v152
v_exp_f32 v153, v153
v_cvt_pk_bf16_f32 v203, v150, v151
v_mfma_f32_32x32x16_bf16 v[176:191], a[132:135], v[100:103], v[176:191]
v_add_f32 v35, v35, v150
v_add_f32 v36, v36, v151
ds_read_b128 a[176:179], v17 offset:4096
v_mfma_f32_32x32x16_bf16 v[176:191], a[136:139], v[104:107], v[176:191]
v_exp_f32 v154, v154
v_exp_f32 v155, v155
v_cvt_pk_bf16_f32 v204, v152, v153
v_mfma_f32_32x32x16_bf16 v[176:191], a[140:143], v[108:111], v[176:191]
v_add_f32 v35, v35, v152
v_add_f32 v36, v36, v153
ds_read_b128 a[180:183], v17 offset:5120
v_mfma_f32_32x32x16_bf16 v[176:191], a[144:147], v[112:115], v[176:191]
v_exp_f32 v156, v156
v_exp_f32 v157, v157
v_cvt_pk_bf16_f32 v205, v154, v155
v_mfma_f32_32x32x16_bf16 v[176:191], a[148:151], v[116:119], v[176:191]
v_add_f32 v35, v35, v154
v_add_f32 v36, v36, v155
ds_read_b128 a[184:187], v17 offset:6144
v_mfma_f32_32x32x16_bf16 v[176:191], a[152:155], v[120:123], v[176:191]
v_exp_f32 v158, v158
v_exp_f32 v159, v159
v_cvt_pk_bf16_f32 v206, v156, v157
v_mfma_f32_32x32x16_bf16 v[176:191], a[156:159], v[124:127], v[176:191]
v_add_f32 v35, v35, v156
v_add_f32 v36, v36, v157
ds_read_b128 a[188:191], v17 offset:7168
s_mov_b32 s60, 4
adaLN_cond__sliding_block_cached__swiglu_ffn__prompt_kernel_aloop_20:
s_waitcnt lgkmcnt(2)
v_mfma_f32_32x32x16_bf16 a[0:15], a[160:163], v[192:195], a[0:15]
v_exp_f32 v160, v160
v_exp_f32 v161, v161
v_cvt_pk_bf16_f32 v207, v158, v159
v_add_u32 v16, s37, v8
s_waitcnt vmcnt(20)
s_barrier
v_mfma_f32_32x32x16_bf16 a[16:31], a[160:163], v[200:203], a[16:31]
v_add_f32 v35, v35, v158
v_add_f32 v36, v36, v159
ds_read_b128 a[128:131], v16 offset:0
v_mfma_f32_32x32x16_bf16 a[32:47], a[164:167], v[192:195], a[32:47]
v_exp_f32 v162, v162
v_exp_f32 v163, v163
v_cvt_pk_bf16_f32 v208, v160, v161
s_add_u32 m0, s32, s35
s_nop 0
buffer_load_dwordx4 v28, s[48:51], s53 offen offset:0 sc1 lds
v_mfma_f32_32x32x16_bf16 a[48:63], a[164:167], v[200:203], a[48:63]
v_add_f32 v33, v33, v160
v_add_f32 v34, v34, v161
ds_read_b128 a[132:135], v16 offset:1024
v_mfma_f32_32x32x16_bf16 a[64:79], a[168:171], v[192:195], a[64:79]
v_exp_f32 v164, v164
v_exp_f32 v165, v165
v_cvt_pk_bf16_f32 v209, v162, v163
buffer_load_dwordx4 v28, s[48:51], s53 offen offset:1024 sc1 lds
v_mfma_f32_32x32x16_bf16 a[80:95], a[168:171], v[200:203], a[80:95]
v_add_f32 v33, v33, v162
v_add_f32 v34, v34, v163
ds_read_b128 a[136:139], v16 offset:2048
v_mfma_f32_32x32x16_bf16 a[192:207], a[172:175], v[192:195], a[192:207]
v_exp_f32 v166, v166
v_exp_f32 v167, v167
v_cvt_pk_bf16_f32 v210, v164, v165
buffer_load_dwordx4 v28, s[48:51], s53 offen offset:2048 sc1 lds
v_mfma_f32_32x32x16_bf16 a[208:223], a[172:175], v[200:203], a[208:223]
v_add_f32 v33, v33, v164
v_add_f32 v34, v34, v165
ds_read_b128 a[140:143], v16 offset:3072
v_mfma_f32_32x32x16_bf16 a[0:15], a[176:179], v[196:199], a[0:15]
v_exp_f32 v168, v168
v_exp_f32 v169, v169
v_cvt_pk_bf16_f32 v211, v166, v167
buffer_load_dwordx4 v28, s[48:51], s53 offen offset:3072 sc1 lds
v_mfma_f32_32x32x16_bf16 a[16:31], a[176:179], v[204:207], a[16:31]
v_add_f32 v33, v33, v166
v_add_f32 v34, v34, v167
ds_read_b128 a[144:147], v16 offset:4096
v_mfma_f32_32x32x16_bf16 a[32:47], a[180:183], v[196:199], a[32:47]
v_exp_f32 v170, v170
v_exp_f32 v171, v171
v_cvt_pk_bf16_f32 v212, v168, v169
s_add_u32 m0, s32, s36
s_nop 0
buffer_load_dwordx4 v28, s[44:47], s52 offen offset:0 sc1 lds
v_mfma_f32_32x32x16_bf16 a[48:63], a[180:183], v[204:207], a[48:63]
v_add_f32 v33, v33, v168
v_add_f32 v34, v34, v169
ds_read_b128 a[148:151], v16 offset:5120
s_waitcnt lgkmcnt(6)
v_mfma_f32_32x32x16_bf16 a[64:79], a[184:187], v[196:199], a[64:79]
v_exp_f32 v172, v172
v_exp_f32 v173, v173
v_cvt_pk_bf16_f32 v213, v170, v171
buffer_load_dwordx4 v28, s[44:47], s52 offen offset:1024 sc1 lds
v_mfma_f32_32x32x16_bf16 a[80:95], a[184:187], v[204:207], a[80:95]
v_add_f32 v33, v33, v170
v_add_f32 v34, v34, v171
ds_read_b128 a[152:155], v16 offset:6144
v_mfma_f32_32x32x16_bf16 a[192:207], a[188:191], v[196:199], a[192:207]
v_exp_f32 v174, v174
v_exp_f32 v175, v175
v_cvt_pk_bf16_f32 v214, v172, v173
buffer_load_dwordx4 v28, s[44:47], s52 offen offset:2048 sc1 lds
v_mfma_f32_32x32x16_bf16 a[208:223], a[188:191], v[204:207], a[208:223]
v_add_f32 v33, v33, v172
v_add_f32 v34, v34, v173
ds_read_b128 a[156:159], v16 offset:7168
s_waitcnt lgkmcnt(2)
v_mfma_f32_32x32x16_bf16 v[128:143], a[128:131], v[64:67], v[224:239]
v_exp_f32 v176, v176
v_exp_f32 v177, v177
v_cvt_pk_bf16_f32 v215, v174, v175
buffer_load_dwordx4 v28, s[44:47], s52 offen offset:3072 sc1 lds
v_mfma_f32_32x32x16_bf16 v[128:143], a[132:135], v[68:71], v[128:143]
v_add_f32 v33, v33, v174
v_add_f32 v34, v34, v175
ds_read_b128 a[160:163], v17 offset:8192
v_mfma_f32_32x32x16_bf16 v[128:143], a[136:139], v[72:75], v[128:143]
v_exp_f32 v178, v178
v_exp_f32 v179, v179
v_cvt_pk_bf16_f32 v216, v176, v177
v_mfma_f32_32x32x16_bf16 v[128:143], a[140:143], v[76:79], v[128:143]
v_add_f32 v35, v35, v176
v_add_f32 v36, v36, v177
ds_read_b128 a[164:167], v17 offset:9216
s_mov_b32 s16, s8
s_mov_b32 s17, s9
s_mov_b32 s18, s10
s_mov_b32 s19, 0x20000
s_mov_b32 exec_hi, 0
buffer_load_dword v19, v18, s[16:19], 0 offen
s_mov_b32 exec_hi, -1
v_mfma_f32_32x32x16_bf16 v[128:143], a[144:147], v[80:83], v[128:143]
v_exp_f32 v180, v180
v_exp_f32 v181, v181
v_cvt_pk_bf16_f32 v217, v178, v179
v_mfma_f32_32x32x16_bf16 v[128:143], a[148:151], v[84:87], v[128:143]
v_add_f32 v35, v35, v178
v_add_f32 v36, v36, v179
ds_read_b128 a[168:171], v17 offset:10240
s_mov_b32 s8, s12
s_mov_b32 s9, s13
s_mov_b32 s10, s14
s_mov_b32 s12, s54
s_mov_b32 s13, s55
s_waitcnt lgkmcnt(3)
v_mfma_f32_32x32x16_bf16 v[128:143], a[152:155], v[88:91], v[128:143]
v_exp_f32 v182, v182
v_exp_f32 v183, v183
v_cvt_pk_bf16_f32 v218, v180, v181
v_mfma_f32_32x32x16_bf16 v[128:143], a[156:159], v[92:95], v[128:143]
v_add_f32 v35, v35, v180
v_add_f32 v36, v36, v181
ds_read_b128 a[172:175], v17 offset:11264
s_mov_b32 s14, s56
s_mov_b32 s54, s57
s_mov_b32 s55, s61
s_mov_b32 s56, s63
v_mfma_f32_32x32x16_bf16 v[144:159], a[128:131], v[96:99], v[240:255]
v_exp_f32 v184, v184
v_exp_f32 v185, v185
v_cvt_pk_bf16_f32 v219, v182, v183
v_mfma_f32_32x32x16_bf16 v[144:159], a[132:135], v[100:103], v[144:159]
v_add_f32 v35, v35, v182
v_add_f32 v36, v36, v183
ds_read_b128 a[176:179], v17 offset:12288
v_mfma_f32_32x32x16_bf16 v[144:159], a[136:139], v[104:107], v[144:159]
v_exp_f32 v186, v186
v_exp_f32 v187, v187
v_cvt_pk_bf16_f32 v220, v184, v185
v_mfma_f32_32x32x16_bf16 v[144:159], a[140:143], v[108:111], v[144:159]
v_add_f32 v35, v35, v184
v_add_f32 v36, v36, v185
ds_read_b128 a[180:183], v17 offset:13312
s_add_u32 s52, s52, 16384
s_add_u32 s53, s53, 16384
v_mfma_f32_32x32x16_bf16 v[144:159], a[144:147], v[112:115], v[144:159]
v_exp_f32 v188, v188
v_exp_f32 v189, v189
v_cvt_pk_bf16_f32 v221, v186, v187
v_mfma_f32_32x32x16_bf16 v[144:159], a[148:151], v[116:119], v[144:159]
v_add_f32 v35, v35, v186
v_add_f32 v36, v36, v187
ds_read_b128 a[184:187], v17 offset:14336
s_mov_b32 s58, s36
s_mov_b32 s36, s37
s_mov_b32 s37, s38
s_mov_b32 s38, s39
s_mov_b32 s39, s40
s_mov_b32 s40, s58
v_mfma_f32_32x32x16_bf16 v[144:159], a[152:155], v[120:123], v[144:159]
v_exp_f32 v190, v190
v_exp_f32 v191, v191
v_cvt_pk_bf16_f32 v222, v188, v189
v_mfma_f32_32x32x16_bf16 v[144:159], a[156:159], v[124:127], v[144:159]
v_add_f32 v35, v35, v188
v_add_f32 v36, v36, v189
ds_read_b128 a[188:191], v17 offset:15360
s_waitcnt lgkmcnt(2)
v_mfma_f32_32x32x16_bf16 a[0:15], a[160:163], v[208:211], a[0:15]
v_exp_f32 v128, v128
v_exp_f32 v129, v129
v_cvt_pk_bf16_f32 v223, v190, v191
v_mfma_f32_32x32x16_bf16 a[16:31], a[160:163], v[216:219], a[16:31]
v_add_f32 v35, v35, v190
v_add_f32 v36, v36, v191
ds_read_b128 a[128:131], v16 offset:8192
v_mfma_f32_32x32x16_bf16 a[32:47], a[164:167], v[208:211], a[32:47]
v_exp_f32 v130, v130
v_exp_f32 v131, v131
v_cvt_pk_bf16_f32 v192, v128, v129
v_add_u32 v17, s42, v8
v_mfma_f32_32x32x16_bf16 a[48:63], a[164:167], v[216:219], a[48:63]
v_add_f32 v33, v33, v128
v_add_f32 v34, v34, v129
ds_read_b128 a[132:135], v16 offset:9216
v_mfma_f32_32x32x16_bf16 a[64:79], a[168:171], v[208:211], a[64:79]
v_exp_f32 v132, v132
v_exp_f32 v133, v133
v_cvt_pk_bf16_f32 v193, v130, v131
s_mov_b32 s58, s41
s_mov_b32 s41, s42
s_mov_b32 s42, s43
s_mov_b32 s43, s29
s_mov_b32 s29, s35
s_mov_b32 s35, s58
v_mfma_f32_32x32x16_bf16 a[80:95], a[168:171], v[216:219], a[80:95]
v_add_f32 v33, v33, v130
v_add_f32 v34, v34, v131
ds_read_b128 a[136:139], v16 offset:10240
v_mfma_f32_32x32x16_bf16 a[192:207], a[172:175], v[208:211], a[192:207]
v_exp_f32 v134, v134
v_exp_f32 v135, v135
v_cvt_pk_bf16_f32 v194, v132, v133
v_mfma_f32_32x32x16_bf16 a[208:223], a[172:175], v[216:219], a[208:223]
v_add_f32 v33, v33, v132
v_add_f32 v34, v34, v133
ds_read_b128 a[140:143], v16 offset:11264
v_mfma_f32_32x32x16_bf16 a[0:15], a[176:179], v[212:215], a[0:15]
v_exp_f32 v136, v136
v_exp_f32 v137, v137
v_cvt_pk_bf16_f32 v195, v134, v135
v_mfma_f32_32x32x16_bf16 a[16:31], a[176:179], v[220:223], a[16:31]
v_add_f32 v33, v33, v134
v_add_f32 v34, v34, v135
ds_read_b128 a[144:147], v16 offset:12288
v_mfma_f32_32x32x16_bf16 a[32:47], a[180:183], v[212:215], a[32:47]
v_exp_f32 v138, v138
v_exp_f32 v139, v139
v_cvt_pk_bf16_f32 v196, v136, v137
v_mfma_f32_32x32x16_bf16 a[48:63], a[180:183], v[220:223], a[48:63]
v_add_f32 v33, v33, v136
v_add_f32 v34, v34, v137
ds_read_b128 a[148:151], v16 offset:13312
s_waitcnt lgkmcnt(6)
v_mfma_f32_32x32x16_bf16 a[64:79], a[184:187], v[212:215], a[64:79]
v_exp_f32 v140, v140
v_exp_f32 v141, v141
v_cvt_pk_bf16_f32 v197, v138, v139
v_mfma_f32_32x32x16_bf16 a[80:95], a[184:187], v[220:223], a[80:95]
v_add_f32 v33, v33, v138
v_add_f32 v34, v34, v139
ds_read_b128 a[152:155], v16 offset:14336
v_mfma_f32_32x32x16_bf16 a[192:207], a[188:191], v[212:215], a[192:207]
v_exp_f32 v142, v142
v_exp_f32 v143, v143
v_cvt_pk_bf16_f32 v198, v140, v141
v_mfma_f32_32x32x16_bf16 a[208:223], a[188:191], v[220:223], a[208:223]
v_add_f32 v33, v33, v140
v_add_f32 v34, v34, v141
ds_read_b128 a[156:159], v16 offset:15360
s_waitcnt lgkmcnt(2)
v_mfma_f32_32x32x16_bf16 v[160:175], a[128:131], v[64:67], v[224:239]
v_exp_f32 v144, v144
v_exp_f32 v145, v145
v_cvt_pk_bf16_f32 v199, v142, v143
v_mfma_f32_32x32x16_bf16 v[160:175], a[132:135], v[68:71], v[160:175]
v_add_f32 v33, v33, v142
v_add_f32 v34, v34, v143
ds_read_b128 a[160:163], v17 offset:0
v_mfma_f32_32x32x16_bf16 v[160:175], a[136:139], v[72:75], v[160:175]
v_exp_f32 v146, v146
v_exp_f32 v147, v147
v_cvt_pk_bf16_f32 v200, v144, v145
v_mfma_f32_32x32x16_bf16 v[160:175], a[140:143], v[76:79], v[160:175]
v_add_f32 v35, v35, v144
v_add_f32 v36, v36, v145
ds_read_b128 a[164:167], v17 offset:1024
v_mfma_f32_32x32x16_bf16 v[160:175], a[144:147], v[80:83], v[160:175]
v_exp_f32 v148, v148
v_exp_f32 v149, v149
v_cvt_pk_bf16_f32 v201, v146, v147
v_mfma_f32_32x32x16_bf16 v[160:175], a[148:151], v[84:87], v[160:175]
v_add_f32 v35, v35, v146
v_add_f32 v36, v36, v147
ds_read_b128 a[168:171], v17 offset:2048
s_waitcnt lgkmcnt(3)
v_mfma_f32_32x32x16_bf16 v[160:175], a[152:155], v[88:91], v[160:175]
v_exp_f32 v150, v150
v_exp_f32 v151, v151
v_cvt_pk_bf16_f32 v202, v148, v149
v_mfma_f32_32x32x16_bf16 v[160:175], a[156:159], v[92:95], v[160:175]
v_add_f32 v35, v35, v148
v_add_f32 v36, v36, v149
ds_read_b128 a[172:175], v17 offset:3072
v_mfma_f32_32x32x16_bf16 v[176:191], a[128:131], v[96:99], v[240:255]
v_exp_f32 v152, v152
v_exp_f32 v153, v153
v_cvt_pk_bf16_f32 v203, v150, v151
v_mfma_f32_32x32x16_bf16 v[176:191], a[132:135], v[100:103], v[176:191]
v_add_f32 v35, v35, v150
v_add_f32 v36, v36, v151
ds_read_b128 a[176:179], v17 offset:4096
v_mfma_f32_32x32x16_bf16 v[176:191], a[136:139], v[104:107], v[176:191]
v_exp_f32 v154, v154
v_exp_f32 v155, v155
v_cvt_pk_bf16_f32 v204, v152, v153
v_mfma_f32_32x32x16_bf16 v[176:191], a[140:143], v[108:111], v[176:191]
v_add_f32 v35, v35, v152
v_add_f32 v36, v36, v153
ds_read_b128 a[180:183], v17 offset:5120
v_mfma_f32_32x32x16_bf16 v[176:191], a[144:147], v[112:115], v[176:191]
v_exp_f32 v156, v156
v_exp_f32 v157, v157
v_cvt_pk_bf16_f32 v205, v154, v155
v_mfma_f32_32x32x16_bf16 v[176:191], a[148:151], v[116:119], v[176:191]
v_add_f32 v35, v35, v154
v_add_f32 v36, v36, v155
ds_read_b128 a[184:187], v17 offset:6144
v_mfma_f32_32x32x16_bf16 v[176:191], a[152:155], v[120:123], v[176:191]
v_exp_f32 v158, v158
v_exp_f32 v159, v159
v_cvt_pk_bf16_f32 v206, v156, v157
v_mfma_f32_32x32x16_bf16 v[176:191], a[156:159], v[124:127], v[176:191]
v_add_f32 v35, v35, v156
v_add_f32 v36, v36, v157
ds_read_b128 a[188:191], v17 offset:7168
s_sub_u32 s60, s60, 1
s_cmp_lg_u32 s60, 0
s_cbranch_scc1 adaLN_cond__sliding_block_cached__swiglu_ffn__prompt_kernel_aloop_20
s_mul_i32 s27, s2, 28672
s_add_u32 s8, s80, s27
s_addc_u32 s9, s81, 0
s_sub_u32 s10, 0x700000, s27
s_lshl_b32 s27, s20, 20
s_lshl_b32 s28, s21, 15
s_add_u32 s27, s27, s28
s_add_u32 s12, s72, s27
s_addc_u32 s13, s73, 0
s_mov_b32 s14, 0x8000
s_mov_b32 s54, s90
s_mov_b32 s55, s91
s_mov_b32 s56, 0
s_mov_b32 s57, s90
s_mov_b32 s61, s91
s_mov_b32 s63, 0
s_waitcnt vmcnt(1)
s_barrier
s_cmp_lg_u32 s26, 0
s_cbranch_scc1 adaLN_cond__sliding_block_cached__swiglu_ffn__prompt_kernel_ct_22
s_getpc_b64 s[6:7]
adaLN_cond__sliding_block_cached__swiglu_ffn__prompt_kernel_pc_21:
s_add_u32 s6, s6, adaLN_cond__sliding_block_cached__swiglu_ffn__prompt_kernel_L_oproj-adaLN_cond__sliding_block_cached__swiglu_ffn__prompt_kernel_pc_21
s_addc_u32 s7, s7, 0
v_lshlrev_b32 v30, 5, v1
v_add_u32 v30, s21, v30
v_lshlrev_b32 v30, 7, v30
v_cmp_gt_u32 vcc, adaLN_cond__sliding_block_cached__swiglu_ffn__prompt_kernel_L_gateup-adaLN_cond__sliding_block_cached__swiglu_ffn__prompt_kernel_L_oproj, v30
s_and_saveexec_b64 s[4:5], vcc
s_cbranch_execz adaLN_cond__sliding_block_cached__swiglu_ffn__prompt_kernel_ct_22_r
global_load_dword v31, v30, s[6:7]
adaLN_cond__sliding_block_cached__swiglu_ffn__prompt_kernel_ct_22_r:
s_mov_b64 exec, s[4:5]
adaLN_cond__sliding_block_cached__swiglu_ffn__prompt_kernel_ct_22:
s_mov_b32 s60, 3
adaLN_cond__sliding_block_cached__swiglu_ffn__prompt_kernel_bloop_23:
s_waitcnt lgkmcnt(2)
v_mfma_f32_32x32x16_bf16 a[0:15], a[160:163], v[192:195], a[0:15]
v_exp_f32 v160, v160
v_exp_f32 v161, v161
v_cvt_pk_bf16_f32 v207, v158, v159
v_add_u32 v16, s37, v8
v_mfma_f32_32x32x16_bf16 a[16:31], a[160:163], v[200:203], a[16:31]
v_add_f32 v35, v35, v158
v_add_f32 v36, v36, v159
ds_read_b128 a[128:131], v16 offset:0
v_mfma_f32_32x32x16_bf16 a[32:47], a[164:167], v[192:195], a[32:47]
v_exp_f32 v162, v162
v_exp_f32 v163, v163
v_cvt_pk_bf16_f32 v208, v160, v161
s_mov_b32 s16, s8
s_mov_b32 s17, s9
s_mov_b32 s18, s10
s_mov_b32 s19, 0x20000
buffer_load_dword v19, v18, s[16:19], 0 offen
v_mfma_f32_32x32x16_bf16 a[48:63], a[164:167], v[200:203], a[48:63]
v_add_f32 v33, v33, v160
v_add_f32 v34, v34, v161
ds_read_b128 a[132:135], v16 offset:1024
v_mfma_f32_32x32x16_bf16 a[64:79], a[168:171], v[192:195], a[64:79]
v_exp_f32 v164, v164
v_exp_f32 v165, v165
v_cvt_pk_bf16_f32 v209, v162, v163
v_mfma_f32_32x32x16_bf16 a[80:95], a[168:171], v[200:203], a[80:95]
v_add_f32 v33, v33, v162
v_add_f32 v34, v34, v163
ds_read_b128 a[136:139], v16 offset:2048
s_mov_b32 s8, s12
s_mov_b32 s9, s13
s_mov_b32 s10, s14
s_mov_b32 s12, s54
s_mov_b32 s13, s55
v_mfma_f32_32x32x16_bf16 a[192:207], a[172:175], v[192:195], a[192:207]
v_exp_f32 v166, v166
v_exp_f32 v167, v167
v_cvt_pk_bf16_f32 v210, v164, v165
v_mfma_f32_32x32x16_bf16 a[208:223], a[172:175], v[200:203], a[208:223]
v_add_f32 v33, v33, v164
v_add_f32 v34, v34, v165
ds_read_b128 a[140:143], v16 offset:3072
s_mov_b32 s14, s56
s_mov_b32 s54, s57
s_mov_b32 s55, s61
s_mov_b32 s56, s63
v_mfma_f32_32x32x16_bf16 a[0:15], a[176:179], v[196:199], a[0:15]
v_exp_f32 v168, v168
v_exp_f32 v169, v169
v_cvt_pk_bf16_f32 v211, v166, v167
v_mfma_f32_32x32x16_bf16 a[16:31], a[176:179], v[204:207], a[16:31]
v_add_f32 v33, v33, v166
v_add_f32 v34, v34, v167
ds_read_b128 a[144:147], v16 offset:4096
v_mfma_f32_32x32x16_bf16 a[32:47], a[180:183], v[196:199], a[32:47]
v_exp_f32 v170, v170
v_exp_f32 v171, v171
v_cvt_pk_bf16_f32 v212, v168, v169
v_mfma_f32_32x32x16_bf16 a[48:63], a[180:183], v[204:207], a[48:63]
v_add_f32 v33, v33, v168
v_add_f32 v34, v34, v169
ds_read_b128 a[148:151], v16 offset:5120
s_waitcnt lgkmcnt(6)
v_mfma_f32_32x32x16_bf16 a[64:79], a[184:187], v[196:199], a[64:79]
v_exp_f32 v172, v172
v_exp_f32 v173, v173
v_cvt_pk_bf16_f32 v213, v170, v171
v_mfma_f32_32x32x16_bf16 a[80:95], a[184:187], v[204:207], a[80:95]
v_add_f32 v33, v33, v170
v_add_f32 v34, v34, v171
ds_read_b128 a[152:155], v16 offset:6144
v_mfma_f32_32x32x16_bf16 a[192:207], a[188:191], v[196:199], a[192:207]
v_exp_f32 v174, v174
v_exp_f32 v175, v175
v_cvt_pk_bf16_f32 v214, v172, v173
v_mfma_f32_32x32x16_bf16 a[208:223], a[188:191], v[204:207], a[208:223]
v_add_f32 v33, v33, v172
v_add_f32 v34, v34, v173
ds_read_b128 a[156:159], v16 offset:7168
s_waitcnt lgkmcnt(2)
v_mfma_f32_32x32x16_bf16 v[128:143], a[128:131], v[64:67], v[224:239]
v_exp_f32 v176, v176
v_exp_f32 v177, v177
v_cvt_pk_bf16_f32 v215, v174, v175
v_mfma_f32_32x32x16_bf16 v[128:143], a[132:135], v[68:71], v[128:143]
v_add_f32 v33, v33, v174
v_add_f32 v34, v34, v175
ds_read_b128 a[160:163], v17 offset:8192
v_mfma_f32_32x32x16_bf16 v[128:143], a[136:139], v[72:75], v[128:143]
v_exp_f32 v178, v178
v_exp_f32 v179, v179
v_cvt_pk_bf16_f32 v216, v176, v177
v_mfma_f32_32x32x16_bf16 v[128:143], a[140:143], v[76:79], v[128:143]
v_add_f32 v35, v35, v176
v_add_f32 v36, v36, v177
ds_read_b128 a[164:167], v17 offset:9216
v_mfma_f32_32x32x16_bf16 v[128:143], a[144:147], v[80:83], v[128:143]
v_exp_f32 v180, v180
v_exp_f32 v181, v181
v_cvt_pk_bf16_f32 v217, v178, v179
v_mfma_f32_32x32x16_bf16 v[128:143], a[148:151], v[84:87], v[128:143]
v_add_f32 v35, v35, v178
v_add_f32 v36, v36, v179
ds_read_b128 a[168:171], v17 offset:10240
s_waitcnt lgkmcnt(3)
v_mfma_f32_32x32x16_bf16 v[128:143], a[152:155], v[88:91], v[128:143]
v_exp_f32 v182, v182
v_exp_f32 v183, v183
v_cvt_pk_bf16_f32 v218, v180, v181
v_mfma_f32_32x32x16_bf16 v[128:143], a[156:159], v[92:95], v[128:143]
v_add_f32 v35, v35, v180
v_add_f32 v36, v36, v181
ds_read_b128 a[172:175], v17 offset:11264
v_mfma_f32_32x32x16_bf16 v[144:159], a[128:131], v[96:99], v[240:255]
v_exp_f32 v184, v184
v_exp_f32 v185, v185
v_cvt_pk_bf16_f32 v219, v182, v183
v_mfma_f32_32x32x16_bf16 v[144:159], a[132:135], v[100:103], v[144:159]
v_add_f32 v35, v35, v182
v_add_f32 v36, v36, v183
ds_read_b128 a[176:179], v17 offset:12288
v_mfma_f32_32x32x16_bf16 v[144:159], a[136:139], v[104:107], v[144:159]
v_exp_f32 v186, v186
v_exp_f32 v187, v187
v_cvt_pk_bf16_f32 v220, v184, v185
v_mfma_f32_32x32x16_bf16 v[144:159], a[140:143], v[108:111], v[144:159]
v_add_f32 v35, v35, v184
v_add_f32 v36, v36, v185
ds_read_b128 a[180:183], v17 offset:13312
v_mfma_f32_32x32x16_bf16 v[144:159], a[144:147], v[112:115], v[144:159]
v_exp_f32 v188, v188
v_exp_f32 v189, v189
v_cvt_pk_bf16_f32 v221, v186, v187
v_mfma_f32_32x32x16_bf16 v[144:159], a[148:151], v[116:119], v[144:159]
v_add_f32 v35, v35, v186
v_add_f32 v36, v36, v187
ds_read_b128 a[184:187], v17 offset:14336
s_mov_b32 s58, s36
s_mov_b32 s36, s37
s_mov_b32 s37, s38
s_mov_b32 s38, s39
s_mov_b32 s39, s40
s_mov_b32 s40, s58
v_mfma_f32_32x32x16_bf16 v[144:159], a[152:155], v[120:123], v[144:159]
v_exp_f32 v190, v190
v_exp_f32 v191, v191
v_cvt_pk_bf16_f32 v222, v188, v189
v_mfma_f32_32x32x16_bf16 v[144:159], a[156:159], v[124:127], v[144:159]
v_add_f32 v35, v35, v188
v_add_f32 v36, v36, v189
ds_read_b128 a[188:191], v17 offset:15360
s_waitcnt lgkmcnt(2)
v_mfma_f32_32x32x16_bf16 a[0:15], a[160:163], v[208:211], a[0:15]
v_exp_f32 v128, v128
v_exp_f32 v129, v129
v_cvt_pk_bf16_f32 v223, v190, v191
v_mfma_f32_32x32x16_bf16 a[16:31], a[160:163], v[216:219], a[16:31]
v_add_f32 v35, v35, v190
v_add_f32 v36, v36, v191
ds_read_b128 a[128:131], v16 offset:8192
v_mfma_f32_32x32x16_bf16 a[32:47], a[164:167], v[208:211], a[32:47]
v_exp_f32 v130, v130
v_exp_f32 v131, v131
v_cvt_pk_bf16_f32 v192, v128, v129
v_add_u32 v17, s42, v8
v_mfma_f32_32x32x16_bf16 a[48:63], a[164:167], v[216:219], a[48:63]
v_add_f32 v33, v33, v128
v_add_f32 v34, v34, v129
ds_read_b128 a[132:135], v16 offset:9216
v_mfma_f32_32x32x16_bf16 a[64:79], a[168:171], v[208:211], a[64:79]
v_exp_f32 v132, v132
v_exp_f32 v133, v133
v_cvt_pk_bf16_f32 v193, v130, v131
s_mov_b32 s58, s41
s_mov_b32 s41, s42
s_mov_b32 s42, s43
s_mov_b32 s43, s29
s_mov_b32 s29, s35
s_mov_b32 s35, s58
v_mfma_f32_32x32x16_bf16 a[80:95], a[168:171], v[216:219], a[80:95]
v_add_f32 v33, v33, v130
v_add_f32 v34, v34, v131
ds_read_b128 a[136:139], v16 offset:10240
v_mfma_f32_32x32x16_bf16 a[192:207], a[172:175], v[208:211], a[192:207]
v_exp_f32 v134, v134
v_exp_f32 v135, v135
v_cvt_pk_bf16_f32 v194, v132, v133
v_mfma_f32_32x32x16_bf16 a[208:223], a[172:175], v[216:219], a[208:223]
v_add_f32 v33, v33, v132
v_add_f32 v34, v34, v133
ds_read_b128 a[140:143], v16 offset:11264
v_mfma_f32_32x32x16_bf16 a[0:15], a[176:179], v[212:215], a[0:15]
v_exp_f32 v136, v136
v_exp_f32 v137, v137
v_cvt_pk_bf16_f32 v195, v134, v135
v_mfma_f32_32x32x16_bf16 a[16:31], a[176:179], v[220:223], a[16:31]
v_add_f32 v33, v33, v134
v_add_f32 v34, v34, v135
ds_read_b128 a[144:147], v16 offset:12288
v_mfma_f32_32x32x16_bf16 a[32:47], a[180:183], v[212:215], a[32:47]
v_exp_f32 v138, v138
v_exp_f32 v139, v139
v_cvt_pk_bf16_f32 v196, v136, v137
v_mfma_f32_32x32x16_bf16 a[48:63], a[180:183], v[220:223], a[48:63]
v_add_f32 v33, v33, v136
v_add_f32 v34, v34, v137
ds_read_b128 a[148:151], v16 offset:13312
s_waitcnt lgkmcnt(6)
v_mfma_f32_32x32x16_bf16 a[64:79], a[184:187], v[212:215], a[64:79]
v_exp_f32 v140, v140
v_exp_f32 v141, v141
v_cvt_pk_bf16_f32 v197, v138, v139
v_mfma_f32_32x32x16_bf16 a[80:95], a[184:187], v[220:223], a[80:95]
v_add_f32 v33, v33, v138
v_add_f32 v34, v34, v139
ds_read_b128 a[152:155], v16 offset:14336
v_mfma_f32_32x32x16_bf16 a[192:207], a[188:191], v[212:215], a[192:207]
v_exp_f32 v142, v142
v_exp_f32 v143, v143
v_cvt_pk_bf16_f32 v198, v140, v141
v_mfma_f32_32x32x16_bf16 a[208:223], a[188:191], v[220:223], a[208:223]
v_add_f32 v33, v33, v140
v_add_f32 v34, v34, v141
ds_read_b128 a[156:159], v16 offset:15360
s_waitcnt lgkmcnt(2)
v_mfma_f32_32x32x16_bf16 v[160:175], a[128:131], v[64:67], v[224:239]
v_exp_f32 v144, v144
v_exp_f32 v145, v145
v_cvt_pk_bf16_f32 v199, v142, v143
v_mfma_f32_32x32x16_bf16 v[160:175], a[132:135], v[68:71], v[160:175]
v_add_f32 v33, v33, v142
v_add_f32 v34, v34, v143
ds_read_b128 a[160:163], v17 offset:0
v_mfma_f32_32x32x16_bf16 v[160:175], a[136:139], v[72:75], v[160:175]
v_exp_f32 v146, v146
v_exp_f32 v147, v147
v_cvt_pk_bf16_f32 v200, v144, v145
v_mfma_f32_32x32x16_bf16 v[160:175], a[140:143], v[76:79], v[160:175]
v_add_f32 v35, v35, v144
v_add_f32 v36, v36, v145
ds_read_b128 a[164:167], v17 offset:1024
v_mfma_f32_32x32x16_bf16 v[160:175], a[144:147], v[80:83], v[160:175]
v_exp_f32 v148, v148
v_exp_f32 v149, v149
v_cvt_pk_bf16_f32 v201, v146, v147
v_mfma_f32_32x32x16_bf16 v[160:175], a[148:151], v[84:87], v[160:175]
v_add_f32 v35, v35, v146
v_add_f32 v36, v36, v147
ds_read_b128 a[168:171], v17 offset:2048
s_waitcnt lgkmcnt(3)
v_mfma_f32_32x32x16_bf16 v[160:175], a[152:155], v[88:91], v[160:175]
v_exp_f32 v150, v150
v_exp_f32 v151, v151
v_cvt_pk_bf16_f32 v202, v148, v149
v_mfma_f32_32x32x16_bf16 v[160:175], a[156:159], v[92:95], v[160:175]
v_add_f32 v35, v35, v148
v_add_f32 v36, v36, v149
ds_read_b128 a[172:175], v17 offset:3072
v_mfma_f32_32x32x16_bf16 v[176:191], a[128:131], v[96:99], v[240:255]
v_exp_f32 v152, v152
v_exp_f32 v153, v153
v_cvt_pk_bf16_f32 v203, v150, v151
v_mfma_f32_32x32x16_bf16 v[176:191], a[132:135], v[100:103], v[176:191]
v_add_f32 v35, v35, v150
v_add_f32 v36, v36, v151
ds_read_b128 a[176:179], v17 offset:4096
v_mfma_f32_32x32x16_bf16 v[176:191], a[136:139], v[104:107], v[176:191]
v_exp_f32 v154, v154
v_exp_f32 v155, v155
v_cvt_pk_bf16_f32 v204, v152, v153
v_mfma_f32_32x32x16_bf16 v[176:191], a[140:143], v[108:111], v[176:191]
v_add_f32 v35, v35, v152
v_add_f32 v36, v36, v153
ds_read_b128 a[180:183], v17 offset:5120
v_mfma_f32_32x32x16_bf16 v[176:191], a[144:147], v[112:115], v[176:191]
v_exp_f32 v156, v156
v_exp_f32 v157, v157
v_cvt_pk_bf16_f32 v205, v154, v155
v_mfma_f32_32x32x16_bf16 v[176:191], a[148:151], v[116:119], v[176:191]
v_add_f32 v35, v35, v154
v_add_f32 v36, v36, v155
ds_read_b128 a[184:187], v17 offset:6144
v_mfma_f32_32x32x16_bf16 v[176:191], a[152:155], v[120:123], v[176:191]
v_exp_f32 v158, v158
v_exp_f32 v159, v159
v_cvt_pk_bf16_f32 v206, v156, v157
v_mfma_f32_32x32x16_bf16 v[176:191], a[156:159], v[124:127], v[176:191]
v_add_f32 v35, v35, v156
v_add_f32 v36, v36, v157
ds_read_b128 a[188:191], v17 offset:7168
s_sub_u32 s60, s60, 1
s_cmp_lg_u32 s60, 0
s_cbranch_scc1 adaLN_cond__sliding_block_cached__swiglu_ffn__prompt_kernel_bloop_23
s_waitcnt lgkmcnt(2)
v_mfma_f32_32x32x16_bf16 a[0:15], a[160:163], v[192:195], a[0:15]
v_exp_f32 v160, v160
v_exp_f32 v161, v161
v_cvt_pk_bf16_f32 v207, v158, v159
v_mfma_f32_32x32x16_bf16 a[16:31], a[160:163], v[200:203], a[16:31]
v_add_f32 v35, v35, v158
v_add_f32 v36, v36, v159
v_mfma_f32_32x32x16_bf16 a[32:47], a[164:167], v[192:195], a[32:47]
v_exp_f32 v162, v162
v_exp_f32 v163, v163
v_cvt_pk_bf16_f32 v208, v160, v161
s_mov_b32 s8, s84
s_mov_b32 s9, s85
v_mfma_f32_32x32x16_bf16 a[48:63], a[164:167], v[200:203], a[48:63]
v_add_f32 v33, v33, v160
v_add_f32 v34, v34, v161
s_mov_b32 s10, 0xc00000
s_mov_b32 s11, 0x20000
v_mfma_f32_32x32x16_bf16 a[64:79], a[168:171], v[192:195], a[64:79]
v_exp_f32 v164, v164
v_exp_f32 v165, v165
v_cvt_pk_bf16_f32 v209, v162, v163
s_mov_b32 s12, s82
v_mfma_f32_32x32x16_bf16 a[80:95], a[168:171], v[200:203], a[80:95]
v_add_f32 v33, v33, v162
v_add_f32 v34, v34, v163
s_mov_b32 s13, s83
s_mov_b32 s14, 2048
v_mfma_f32_32x32x16_bf16 a[192:207], a[172:175], v[192:195], a[192:207]
v_exp_f32 v166, v166
v_exp_f32 v167, v167
v_cvt_pk_bf16_f32 v210, v164, v165
s_mov_b32 s15, 0x20000
s_lshr_b32 s52, s2, 6
v_mfma_f32_32x32x16_bf16 a[208:223], a[172:175], v[200:203], a[208:223]
v_add_f32 v33, v33, v164
v_add_f32 v34, v34, v165
s_and_b32 s53, s2, 63
v_mfma_f32_32x32x16_bf16 a[0:15], a[176:179], v[196:199], a[0:15]
v_exp_f32 v168, v168
v_exp_f32 v169, v169
v_cvt_pk_bf16_f32 v211, v166, v167
s_lshl_b32 s54, s52, 14
s_lshl_b32 s55, s53, 8
v_mfma_f32_32x32x16_bf16 a[16:31], a[176:179], v[204:207], a[16:31]
v_add_f32 v33, v33, v166
v_add_f32 v34, v34, v167
s_add_u32 s54, s54, s55
s_lshl_b32 s52, s52, 8
v_mfma_f32_32x32x16_bf16 a[32:47], a[180:183], v[196:199], a[32:47]
v_exp_f32 v170, v170
v_exp_f32 v171, v171
v_cvt_pk_bf16_f32 v212, v168, v169
s_lshl_b32 s53, s53, 7
v_mfma_f32_32x32x16_bf16 a[48:63], a[180:183], v[204:207], a[48:63]
v_add_f32 v33, v33, v168
v_add_f32 v34, v34, v169
s_add_u32 s53, s53, 4096
v_and_b32 v48, 7, v0
s_waitcnt lgkmcnt(0)
v_mfma_f32_32x32x16_bf16 a[64:79], a[184:187], v[196:199], a[64:79]
v_exp_f32 v172, v172
v_exp_f32 v173, v173
v_cvt_pk_bf16_f32 v213, v170, v171
v_lshrrev_b32 v49, 3, v0
v_mul_u32_u24 v50, 98304, v49
v_mfma_f32_32x32x16_bf16 a[80:95], a[184:187], v[204:207], a[80:95]
v_add_f32 v33, v33, v170
v_add_f32 v34, v34, v171
v_lshl_add_u32 v50, v48, 4, v50
v_mfma_f32_32x32x16_bf16 a[192:207], a[188:191], v[196:199], a[192:207]
v_exp_f32 v174, v174
v_exp_f32 v175, v175
v_cvt_pk_bf16_f32 v214, v172, v173
v_mul_u32_u24 v51, 16, v49
s_mul_i32 s36, s52, 12288
v_mfma_f32_32x32x16_bf16 a[208:223], a[188:191], v[204:207], a[208:223]
v_add_f32 v33, v33, v172
v_add_f32 v34, v34, v173
s_add_u32 s36, s36, s53
s_lshl_b32 s37, s52, 1
v_exp_f32 v176, v176
v_exp_f32 v177, v177
v_cvt_pk_bf16_f32 v215, v174, v175
buffer_load_dwordx4 v[52:55], v51, s[12:15], s37 offen offset:0
v_add_f32 v33, v33, v174
v_add_f32 v34, v34, v175
ds_read_b128 a[160:163], v17 offset:8192
buffer_load_dwordx4 v[128:131], v50, s[8:11], s36 offen
s_add_u32 s36, s36, 12288
v_exp_f32 v178, v178
v_exp_f32 v179, v179
v_cvt_pk_bf16_f32 v216, v176, v177
buffer_load_dwordx4 v[132:135], v50, s[8:11], s36 offen
s_add_u32 s36, s36, 12288
v_add_f32 v35, v35, v176
v_add_f32 v36, v36, v177
ds_read_b128 a[164:167], v17 offset:9216
buffer_load_dwordx4 v[136:139], v50, s[8:11], s36 offen
v_exp_f32 v180, v180
v_exp_f32 v181, v181
v_cvt_pk_bf16_f32 v217, v178, v179
s_add_u32 s36, s36, 12288
buffer_load_dwordx4 v[140:143], v50, s[8:11], s36 offen
v_add_f32 v35, v35, v178
v_add_f32 v36, v36, v179
ds_read_b128 a[168:171], v17 offset:10240
s_add_u32 s36, s36, 12288
buffer_load_dwordx4 v[144:147], v50, s[8:11], s36 offen
v_exp_f32 v182, v182
v_exp_f32 v183, v183
v_cvt_pk_bf16_f32 v218, v180, v181
s_add_u32 s36, s36, 12288
v_add_f32 v35, v35, v180
v_add_f32 v36, v36, v181
ds_read_b128 a[172:175], v17 offset:11264
buffer_load_dwordx4 v[148:151], v50, s[8:11], s36 offen
s_add_u32 s36, s36, 12288
v_exp_f32 v184, v184
v_exp_f32 v185, v185
v_cvt_pk_bf16_f32 v219, v182, v183
buffer_load_dwordx4 v[152:155], v50, s[8:11], s36 offen
s_add_u32 s36, s36, 12288
v_add_f32 v35, v35, v182
v_add_f32 v36, v36, v183
ds_read_b128 a[176:179], v17 offset:12288
buffer_load_dwordx4 v[156:159], v50, s[8:11], s36 offen
v_exp_f32 v186, v186
v_exp_f32 v187, v187
v_cvt_pk_bf16_f32 v220, v184, v185
v_add_f32 v35, v35, v184
v_add_f32 v36, v36, v185
ds_read_b128 a[180:183], v17 offset:13312
v_exp_f32 v188, v188
v_exp_f32 v189, v189
v_cvt_pk_bf16_f32 v221, v186, v187
v_add_f32 v35, v35, v186
v_add_f32 v36, v36, v187
ds_read_b128 a[184:187], v17 offset:14336
v_exp_f32 v190, v190
v_exp_f32 v191, v191
v_cvt_pk_bf16_f32 v222, v188, v189
v_add_f32 v35, v35, v188
v_add_f32 v36, v36, v189
ds_read_b128 a[188:191], v17 offset:15360
v_add_f32 v35, v35, v190
v_add_f32 v36, v36, v191
v_cvt_pk_bf16_f32 v223, v190, v191
v_add_f32 v40, v33, v34
v_add_f32 v41, v35, v36
v_mov_b32 v42, v40
v_mov_b32 v43, v41
s_nop 1
v_permlane32_swap_b32 v40, v42
v_permlane32_swap_b32 v41, v43
s_nop 1
v_add_f32 v40, v40, v42
v_add_f32 v41, v41, v43
v_mov_b32 v43, 0x71800000
v_cmp_nlt_f32 vcc, v40, v43
v_cmp_nlt_f32 s[6:7], v41, v43
v_rcp_f32 v40, v40
v_rcp_f32 v41, v41
s_or_b64 vcc, vcc, s[6:7]
s_cmp_lg_u64 vcc, 0
s_cselect_b32 s58, 1, 0
v_mov_b32 v43, s58
s_lshl_b32 s58, s26, 2
s_add_u32 s58, s58, 33792
v_mov_b32 v44, s58
ds_write_b32 v44, v43
s_add_u32 s16, s90, 0x500000
s_addc_u32 s17, s91, 0
s_mov_b32 s18, 0x1000000
s_mov_b32 s19, 0x20000
s_lshl_b32 s27, s34, 8
s_lshl_b32 s28, s62, 3
s_add_u32 s27, s27, s28
s_lshl_b32 s60, s27, 10
s_add_u32 s61, s60, 0x40000
v_add_u32 v20, 4096, v8
s_waitcnt lgkmcnt(0)
v_mfma_f32_32x32x16_bf16 a[0:15], a[160:163], v[208:211], a[0:15]
v_mfma_f32_32x32x16_bf16 a[0:15], a[176:179], v[212:215], a[0:15]
v_mfma_f32_32x32x16_bf16 a[16:31], a[160:163], v[216:219], a[16:31]
v_mfma_f32_32x32x16_bf16 a[16:31], a[176:179], v[220:223], a[16:31]
v_mfma_f32_32x32x16_bf16 a[32:47], a[164:167], v[208:211], a[32:47]
v_mfma_f32_32x32x16_bf16 a[32:47], a[180:183], v[212:215], a[32:47]
s_nop 7
v_accvgpr_read_b32 v224, a0
v_accvgpr_read_b32 v225, a1
v_accvgpr_read_b32 v226, a2
v_accvgpr_read_b32 v227, a3
v_accvgpr_read_b32 v228, a4
v_accvgpr_read_b32 v229, a5
v_accvgpr_read_b32 v230, a6
v_accvgpr_read_b32 v231, a7
v_mul_f32 v224, v224, v40
v_mul_f32 v225, v225, v40
v_mul_f32 v226, v226, v40
v_mul_f32 v227, v227, v40
v_mul_f32 v228, v228, v40
v_mul_f32 v229, v229, v40
v_mul_f32 v230, v230, v40
v_mul_f32 v231, v231, v40
v_cvt_pk_bf16_f32 v232, v224, v225
v_cvt_pk_bf16_f32 v233, v226, v227
v_cvt_pk_bf16_f32 v234, v228, v229
v_cvt_pk_bf16_f32 v235, v230, v231
buffer_store_dwordx4 v[232:235], v8, s[16:19], s60 offen offset:0 sc1
v_accvgpr_read_b32 v240, a8
v_accvgpr_read_b32 v241, a9
v_accvgpr_read_b32 v242, a10
v_accvgpr_read_b32 v243, a11
v_accvgpr_read_b32 v244, a12
v_accvgpr_read_b32 v245, a13
v_accvgpr_read_b32 v246, a14
v_accvgpr_read_b32 v247, a15
v_mul_f32 v240, v240, v40
v_mul_f32 v241, v241, v40
v_mul_f32 v242, v242, v40
v_mul_f32 v243, v243, v40
v_mul_f32 v244, v244, v40
v_mul_f32 v245, v245, v40
v_mul_f32 v246, v246, v40
v_mul_f32 v247, v247, v40
v_cvt_pk_bf16_f32 v248, v240, v241
v_cvt_pk_bf16_f32 v249, v242, v243
v_cvt_pk_bf16_f32 v250, v244, v245
v_cvt_pk_bf16_f32 v251, v246, v247
buffer_store_dwordx4 v[248:251], v8, s[16:19], s60 offen offset:1024 sc1
v_mfma_f32_32x32x16_bf16 a[48:63], a[164:167], v[216:219], a[48:63]
v_mfma_f32_32x32x16_bf16 a[48:63], a[180:183], v[220:223], a[48:63]
v_accvgpr_read_b32 v192, a16
v_accvgpr_read_b32 v193, a17
v_accvgpr_read_b32 v194, a18
v_accvgpr_read_b32 v195, a19
v_accvgpr_read_b32 v196, a20
v_accvgpr_read_b32 v197, a21
v_accvgpr_read_b32 v198, a22
v_accvgpr_read_b32 v199, a23
v_mul_f32 v192, v192, v41
v_mul_f32 v193, v193, v41
v_mul_f32 v194, v194, v41
v_mul_f32 v195, v195, v41
v_mul_f32 v196, v196, v41
v_mul_f32 v197, v197, v41
v_mul_f32 v198, v198, v41
v_mul_f32 v199, v199, v41
v_cvt_pk_bf16_f32 v200, v192, v193
v_cvt_pk_bf16_f32 v201, v194, v195
v_cvt_pk_bf16_f32 v202, v196, v197
v_cvt_pk_bf16_f32 v203, v198, v199
buffer_store_dwordx4 v[200:203], v8, s[16:19], s61 offen offset:0 sc1
v_accvgpr_read_b32 v224, a24
v_accvgpr_read_b32 v225, a25
v_accvgpr_read_b32 v226, a26
v_accvgpr_read_b32 v227, a27
v_accvgpr_read_b32 v228, a28
v_accvgpr_read_b32 v229, a29
v_accvgpr_read_b32 v230, a30
v_accvgpr_read_b32 v231, a31
v_mul_f32 v224, v224, v41
v_mul_f32 v225, v225, v41
v_mul_f32 v226, v226, v41
v_mul_f32 v227, v227, v41
v_mul_f32 v228, v228, v41
v_mul_f32 v229, v229, v41
v_mul_f32 v230, v230, v41
v_mul_f32 v231, v231, v41
v_cvt_pk_bf16_f32 v232, v224, v225
v_cvt_pk_bf16_f32 v233, v226, v227
v_cvt_pk_bf16_f32 v234, v228, v229
v_cvt_pk_bf16_f32 v235, v230, v231
buffer_store_dwordx4 v[232:235], v8, s[16:19], s61 offen offset:1024 sc1
v_mfma_f32_32x32x16_bf16 a[64:79], a[168:171], v[208:211], a[64:79]
v_mfma_f32_32x32x16_bf16 a[64:79], a[184:187], v[212:215], a[64:79]
v_accvgpr_read_b32 v240, a32
v_accvgpr_read_b32 v241, a33
v_accvgpr_read_b32 v242, a34
v_accvgpr_read_b32 v243, a35
v_accvgpr_read_b32 v244, a36
v_accvgpr_read_b32 v245, a37
v_accvgpr_read_b32 v246, a38
v_accvgpr_read_b32 v247, a39
v_mul_f32 v240, v240, v40
v_mul_f32 v241, v241, v40
v_mul_f32 v242, v242, v40
v_mul_f32 v243, v243, v40
v_mul_f32 v244, v244, v40
v_mul_f32 v245, v245, v40
v_mul_f32 v246, v246, v40
v_mul_f32 v247, v247, v40
v_cvt_pk_bf16_f32 v248, v240, v241
v_cvt_pk_bf16_f32 v249, v242, v243
v_cvt_pk_bf16_f32 v250, v244, v245
v_cvt_pk_bf16_f32 v251, v246, v247
buffer_store_dwordx4 v[248:251], v8, s[16:19], s60 offen offset:2048 sc1
v_accvgpr_read_b32 v192, a40
v_accvgpr_read_b32 v193, a41
v_accvgpr_read_b32 v194, a42
v_accvgpr_read_b32 v195, a43
v_accvgpr_read_b32 v196, a44
v_accvgpr_read_b32 v197, a45
v_accvgpr_read_b32 v198, a46
v_accvgpr_read_b32 v199, a47
v_mul_f32 v192, v192, v40
v_mul_f32 v193, v193, v40
v_mul_f32 v194, v194, v40
v_mul_f32 v195, v195, v40
v_mul_f32 v196, v196, v40
v_mul_f32 v197, v197, v40
v_mul_f32 v198, v198, v40
v_mul_f32 v199, v199, v40
v_cvt_pk_bf16_f32 v200, v192, v193
v_cvt_pk_bf16_f32 v201, v194, v195
v_cvt_pk_bf16_f32 v202, v196, v197
v_cvt_pk_bf16_f32 v203, v198, v199
buffer_store_dwordx4 v[200:203], v8, s[16:19], s60 offen offset:3072 sc1
v_mfma_f32_32x32x16_bf16 a[80:95], a[168:171], v[216:219], a[80:95]
v_mfma_f32_32x32x16_bf16 a[80:95], a[184:187], v[220:223], a[80:95]
v_accvgpr_read_b32 v224, a48
v_accvgpr_read_b32 v225, a49
v_accvgpr_read_b32 v226, a50
v_accvgpr_read_b32 v227, a51
v_accvgpr_read_b32 v228, a52
v_accvgpr_read_b32 v229, a53
v_accvgpr_read_b32 v230, a54
v_accvgpr_read_b32 v231, a55
v_mul_f32 v224, v224, v41
v_mul_f32 v225, v225, v41
v_mul_f32 v226, v226, v41
v_mul_f32 v227, v227, v41
v_mul_f32 v228, v228, v41
v_mul_f32 v229, v229, v41
v_mul_f32 v230, v230, v41
v_mul_f32 v231, v231, v41
v_cvt_pk_bf16_f32 v232, v224, v225
v_cvt_pk_bf16_f32 v233, v226, v227
v_cvt_pk_bf16_f32 v234, v228, v229
v_cvt_pk_bf16_f32 v235, v230, v231
buffer_store_dwordx4 v[232:235], v8, s[16:19], s61 offen offset:2048 sc1
v_accvgpr_read_b32 v240, a56
v_accvgpr_read_b32 v241, a57
v_accvgpr_read_b32 v242, a58
v_accvgpr_read_b32 v243, a59
v_accvgpr_read_b32 v244, a60
v_accvgpr_read_b32 v245, a61
v_accvgpr_read_b32 v246, a62
v_accvgpr_read_b32 v247, a63
v_mul_f32 v240, v240, v41
v_mul_f32 v241, v241, v41
v_mul_f32 v242, v242, v41
v_mul_f32 v243, v243, v41
v_mul_f32 v244, v244, v41
v_mul_f32 v245, v245, v41
v_mul_f32 v246, v246, v41
v_mul_f32 v247, v247, v41
v_cvt_pk_bf16_f32 v248, v240, v241
v_cvt_pk_bf16_f32 v249, v242, v243
v_cvt_pk_bf16_f32 v250, v244, v245
v_cvt_pk_bf16_f32 v251, v246, v247
buffer_store_dwordx4 v[248:251], v8, s[16:19], s61 offen offset:3072 sc1
v_mfma_f32_32x32x16_bf16 a[192:207], a[172:175], v[208:211], a[192:207]
v_mfma_f32_32x32x16_bf16 a[192:207], a[188:191], v[212:215], a[192:207]
v_accvgpr_read_b32 v192, a64
v_accvgpr_read_b32 v193, a65
v_accvgpr_read_b32 v194, a66
v_accvgpr_read_b32 v195, a67
v_accvgpr_read_b32 v196, a68
v_accvgpr_read_b32 v197, a69
v_accvgpr_read_b32 v198, a70
v_accvgpr_read_b32 v199, a71
v_mul_f32 v192, v192, v40
v_mul_f32 v193, v193, v40
v_mul_f32 v194, v194, v40
v_mul_f32 v195, v195, v40
v_mul_f32 v196, v196, v40
v_mul_f32 v197, v197, v40
v_mul_f32 v198, v198, v40
v_mul_f32 v199, v199, v40
v_cvt_pk_bf16_f32 v200, v192, v193
v_cvt_pk_bf16_f32 v201, v194, v195
v_cvt_pk_bf16_f32 v202, v196, v197
v_cvt_pk_bf16_f32 v203, v198, v199
buffer_store_dwordx4 v[200:203], v20, s[16:19], s60 offen offset:0 sc1
v_accvgpr_read_b32 v224, a72
v_accvgpr_read_b32 v225, a73
v_accvgpr_read_b32 v226, a74
v_accvgpr_read_b32 v227, a75
v_accvgpr_read_b32 v228, a76
v_accvgpr_read_b32 v229, a77
v_accvgpr_read_b32 v230, a78
v_accvgpr_read_b32 v231, a79
v_mul_f32 v224, v224, v40
v_mul_f32 v225, v225, v40
v_mul_f32 v226, v226, v40
v_mul_f32 v227, v227, v40
v_mul_f32 v228, v228, v40
v_mul_f32 v229, v229, v40
v_mul_f32 v230, v230, v40
v_mul_f32 v231, v231, v40
v_cvt_pk_bf16_f32 v232, v224, v225
v_cvt_pk_bf16_f32 v233, v226, v227
v_cvt_pk_bf16_f32 v234, v228, v229
v_cvt_pk_bf16_f32 v235, v230, v231
buffer_store_dwordx4 v[232:235], v20, s[16:19], s60 offen offset:1024 sc1
v_mfma_f32_32x32x16_bf16 a[208:223], a[172:175], v[216:219], a[208:223]
v_mfma_f32_32x32x16_bf16 a[208:223], a[188:191], v[220:223], a[208:223]
v_accvgpr_read_b32 v240, a80
v_accvgpr_read_b32 v241, a81
v_accvgpr_read_b32 v242, a82
v_accvgpr_read_b32 v243, a83
v_accvgpr_read_b32 v244, a84
v_accvgpr_read_b32 v245, a85
v_accvgpr_read_b32 v246, a86
v_accvgpr_read_b32 v247, a87
v_mul_f32 v240, v240, v41
v_mul_f32 v241, v241, v41
v_mul_f32 v242, v242, v41
v_mul_f32 v243, v243, v41
v_mul_f32 v244, v244, v41
v_mul_f32 v245, v245, v41
v_mul_f32 v246, v246, v41
v_mul_f32 v247, v247, v41
v_cvt_pk_bf16_f32 v248, v240, v241
v_cvt_pk_bf16_f32 v249, v242, v243
v_cvt_pk_bf16_f32 v250, v244, v245
v_cvt_pk_bf16_f32 v251, v246, v247
buffer_store_dwordx4 v[248:251], v20, s[16:19], s61 offen offset:0 sc1
v_accvgpr_read_b32 v192, a88
v_accvgpr_read_b32 v193, a89
v_accvgpr_read_b32 v194, a90
v_accvgpr_read_b32 v195, a91
v_accvgpr_read_b32 v196, a92
v_accvgpr_read_b32 v197, a93
v_accvgpr_read_b32 v198, a94
v_accvgpr_read_b32 v199, a95
v_mul_f32 v192, v192, v41
v_mul_f32 v193, v193, v41
v_mul_f32 v194, v194, v41
v_mul_f32 v195, v195, v41
v_mul_f32 v196, v196, v41
v_mul_f32 v197, v197, v41
v_mul_f32 v198, v198, v41
v_mul_f32 v199, v199, v41
v_cvt_pk_bf16_f32 v200, v192, v193
v_cvt_pk_bf16_f32 v201, v194, v195
v_cvt_pk_bf16_f32 v202, v196, v197
v_cvt_pk_bf16_f32 v203, v198, v199
buffer_store_dwordx4 v[200:203], v20, s[16:19], s61 offen offset:1024 sc1
v_accvgpr_read_b32 v224, a192
v_accvgpr_read_b32 v225, a193
v_accvgpr_read_b32 v226, a194
v_accvgpr_read_b32 v227, a195
v_accvgpr_read_b32 v228, a196
v_accvgpr_read_b32 v229, a197
v_accvgpr_read_b32 v230, a198
v_accvgpr_read_b32 v231, a199
v_mul_f32 v224, v224, v40
v_mul_f32 v225, v225, v40
v_mul_f32 v226, v226, v40
v_mul_f32 v227, v227, v40
v_mul_f32 v228, v228, v40
v_mul_f32 v229, v229, v40
v_mul_f32 v230, v230, v40
v_mul_f32 v231, v231, v40
v_cvt_pk_bf16_f32 v232, v224, v225
v_cvt_pk_bf16_f32 v233, v226, v227
v_cvt_pk_bf16_f32 v234, v228, v229
v_cvt_pk_bf16_f32 v235, v230, v231
buffer_store_dwordx4 v[232:235], v20, s[16:19], s60 offen offset:2048 sc1
v_accvgpr_read_b32 v240, a200
v_accvgpr_read_b32 v241, a201
v_accvgpr_read_b32 v242, a202
v_accvgpr_read_b32 v243, a203
v_accvgpr_read_b32 v244, a204
v_accvgpr_read_b32 v245, a205
v_accvgpr_read_b32 v246, a206
v_accvgpr_read_b32 v247, a207
v_mul_f32 v240, v240, v40
v_mul_f32 v241, v241, v40
v_mul_f32 v242, v242, v40
v_mul_f32 v243, v243, v40
v_mul_f32 v244, v244, v40
v_mul_f32 v245, v245, v40
v_mul_f32 v246, v246, v40
v_mul_f32 v247, v247, v40
v_cvt_pk_bf16_f32 v248, v240, v241
v_cvt_pk_bf16_f32 v249, v242, v243
v_cvt_pk_bf16_f32 v250, v244, v245
v_cvt_pk_bf16_f32 v251, v246, v247
buffer_store_dwordx4 v[248:251], v20, s[16:19], s60 offen offset:3072 sc1
v_accvgpr_read_b32 v192, a208
v_accvgpr_read_b32 v193, a209
v_accvgpr_read_b32 v194, a210
v_accvgpr_read_b32 v195, a211
v_accvgpr_read_b32 v196, a212
v_accvgpr_read_b32 v197, a213
v_accvgpr_read_b32 v198, a214
v_accvgpr_read_b32 v199, a215
v_mul_f32 v192, v192, v41
v_mul_f32 v193, v193, v41
v_mul_f32 v194, v194, v41
v_mul_f32 v195, v195, v41
v_mul_f32 v196, v196, v41
v_mul_f32 v197, v197, v41
v_mul_f32 v198, v198, v41
v_mul_f32 v199, v199, v41
v_cvt_pk_bf16_f32 v200, v192, v193
v_cvt_pk_bf16_f32 v201, v194, v195
v_cvt_pk_bf16_f32 v202, v196, v197
v_cvt_pk_bf16_f32 v203, v198, v199
buffer_store_dwordx4 v[200:203], v20, s[16:19], s61 offen offset:2048 sc1
v_accvgpr_read_b32 v224, a216
v_accvgpr_read_b32 v225, a217
v_accvgpr_read_b32 v226, a218
v_accvgpr_read_b32 v227, a219
v_accvgpr_read_b32 v228, a220
v_accvgpr_read_b32 v229, a221
v_accvgpr_read_b32 v230, a222
v_accvgpr_read_b32 v231, a223
v_mul_f32 v224, v224, v41
v_mul_f32 v225, v225, v41
v_mul_f32 v226, v226, v41
v_mul_f32 v227, v227, v41
v_mul_f32 v228, v228, v41
v_mul_f32 v229, v229, v41
v_mul_f32 v230, v230, v41
v_mul_f32 v231, v231, v41
v_cvt_pk_bf16_f32 v232, v224, v225
v_cvt_pk_bf16_f32 v233, v226, v227
v_cvt_pk_bf16_f32 v234, v228, v229
v_cvt_pk_bf16_f32 v235, v230, v231
buffer_store_dwordx4 v[232:235], v20, s[16:19], s61 offen offset:3072 sc1
s_barrier
v_mov_b32 v44, 33792
ds_read_b128 v[44:47], v44
s_waitcnt lgkmcnt(0)
v_or3_b32 v44, v44, v45, v46
v_or_b32 v44, v44, v47
s_nop 0
v_readfirstlane_b32 s58, v44
s_nop 3
s_cmp_lg_u32 s59, 0
s_cbranch_scc1 adaLN_cond__sliding_block_cached__swiglu_ffn__prompt_kernel_fin
s_cmp_lg_u32 s58, 0
s_cbranch_scc1 adaLN_cond__sliding_block_cached__swiglu_ffn__prompt_kernel_slow
adaLN_cond__sliding_block_cached__swiglu_ffn__prompt_kernel_fin:
s_waitcnt vmcnt(0)
s_barrier
s_cmp_lg_u32 s26, 0
s_cbranch_scc1 adaLN_cond__sliding_block_cached__swiglu_ffn__prompt_kernel_arr_24
s_lshl_b32 s27, s24, 2
s_add_u32 s27, s27, s22
s_add_u32 s27, s27, 8
s_lshl_b32 s6, s27, 8
s_add_u32 s6, s6, 0x20000
s_add_u32 s6, s6, s90
s_addc_u32 s7, s91, 0
v_mov_b32 v2, 0
v_mov_b32 v3, 1
s_mov_b64 exec, 1
global_atomic_add v2, v3, s[6:7] sc1
s_mov_b64 exec, -1
adaLN_cond__sliding_block_cached__swiglu_ffn__prompt_kernel_arr_24:
v_lshrrev_b32 v14, 5, v1
v_lshlrev_b32 v14, 11, v14
v_bfe_u32 v15, v1, 2, 2
v_lshl_add_u32 v14, v15, 8, v14
v_bfe_u32 v16, v1, 4, 1
v_lshl_add_u32 v14, v16, 5, v14
v_and_b32 v16, 1, v1
v_lshl_add_u32 v14, v16, 4, v14
v_bfe_u32 v16, v1, 1, 1
v_lshl_add_u32 v14, v16, 3, v14
v_xor_b32 v16, 0, v15
v_lshl_add_u32 v4, v16, 6, v14
v_xor_b32 v16, 1, v15
v_lshl_add_u32 v5, v16, 6, v14
v_xor_b32 v16, 2, v15
v_lshl_add_u32 v6, v16, 6, v14
v_xor_b32 v16, 3, v15
v_lshl_add_u32 v7, v16, 6, v14
v_lshlrev_b32 v8, 4, v1
v_add_u32 v9, 0x40000, v8
s_lshl_b32 s28, s25, 8
v_lshrrev_b32 v14, 4, v1
v_bfe_u32 v15, v1, 2, 2
v_xor_b32 v15, v15, v14
v_and_b32 v16, 3, v1
v_lshlrev_b32 v16, 4, v16
v_lshl_add_u32 v16, v15, 6, v16
s_lshl_b32 s27, s26, 4
v_add_u32 v14, s27, v14
v_mul_u32_u24 v14, 2048, v14
v_add3_u32 v10, v14, v16, s28
v_add_u32 v11, 0x1c00, v10
v_add_u32 v12, 0x3800, v10
v_add_u32 v13, 0x5400, v10
s_add_u32 s8, s90, 0x500000
s_addc_u32 s9, s91, 0
s_mov_b32 s10, 0x1000000
s_mov_b32 s11, 0x20000
s_mov_b32 s12, s72
s_mov_b32 s13, s73
s_mov_b32 s14, 0x800000
s_mov_b32 s15, 0x20000
s_lshl_b32 s27, s24, 3
s_lshl_b32 s28, s26, 1
s_add_u32 s34, s27, s28
s_mul_i32 s30, s34, 256
s_mul_i32 s28, s22, 64
s_add_u32 s30, s30, s28
s_lshl_b32 s30, s30, 10
s_sub_u32 s30, s30, 4096
s_add_u32 s38, s30, 65536
s_mul_i32 s31, s22, 0x200000
s_sub_u32 s31, s31, 0x20000
s_lshl_b32 s32, s26, 12
s_add_u32 s31, s31, 0x20000
s_add_u32 m0, s32, 0x0
s_nop 0
buffer_load_dwordx4 v10, s[12:15], s31 offen offset:0 lds
buffer_load_dwordx4 v11, s[12:15], s31 offen offset:1024 lds
buffer_load_dwordx4 v12, s[12:15], s31 offen offset:2048 lds
buffer_load_dwordx4 v13, s[12:15], s31 offen offset:3072 lds
s_add_u32 s31, s31, 0x20000
s_add_u32 m0, s32, 0x4000
s_nop 0
buffer_load_dwordx4 v10, s[12:15], s31 offen offset:0 lds
buffer_load_dwordx4 v11, s[12:15], s31 offen offset:1024 lds
buffer_load_dwordx4 v12, s[12:15], s31 offen offset:2048 lds
buffer_load_dwordx4 v13, s[12:15], s31 offen offset:3072 lds
s_add_u32 s31, s31, 0x20000
s_add_u32 m0, s32, 0x8000
s_nop 0
buffer_load_dwordx4 v10, s[12:15], s31 offen offset:0 lds
s_add_u32 s16, s90, 0x10000
s_addc_u32 s17, s91, 0
s_mov_b32 s18, 0x10000
s_mov_b32 s19, 0x20000
v_and_b32 v192, 7, v0
v_lshrrev_b32 v193, 3, v0
s_waitcnt vmcnt(32)
v_lshlrev_b32 v208, 16, v52
v_and_b32 v209, 0xffff0000, v52
v_lshlrev_b32 v210, 16, v53
v_and_b32 v211, 0xffff0000, v53
v_lshlrev_b32 v212, 16, v54
v_and_b32 v213, 0xffff0000, v54
v_lshlrev_b32 v214, 16, v55
v_and_b32 v215, 0xffff0000, v55
v_mul_f32 v224, 0xbfb8aa3b, v208
v_mul_f32 v225, 0xbfb8aa3b, v209
v_mul_f32 v226, 0xbfb8aa3b, v210
v_mul_f32 v227, 0xbfb8aa3b, v211
v_mul_f32 v228, 0xbfb8aa3b, v212
v_mul_f32 v229, 0xbfb8aa3b, v213
v_mul_f32 v230, 0xbfb8aa3b, v214
v_mul_f32 v231, 0xbfb8aa3b, v215
v_exp_f32 v224, v224
v_exp_f32 v225, v225
v_exp_f32 v226, v226
v_exp_f32 v227, v227
v_exp_f32 v228, v228
v_exp_f32 v229, v229
v_exp_f32 v230, v230
v_exp_f32 v231, v231
s_nop 0
v_add_f32 v224, 1.0, v224
v_add_f32 v225, 1.0, v225
v_add_f32 v226, 1.0, v226
v_add_f32 v227, 1.0, v227
v_add_f32 v228, 1.0, v228
v_add_f32 v229, 1.0, v229
v_add_f32 v230, 1.0, v230
v_add_f32 v231, 1.0, v231
v_rcp_f32 v224, v224
v_rcp_f32 v225, v225
v_rcp_f32 v226, v226
v_rcp_f32 v227, v227
v_rcp_f32 v228, v228
v_rcp_f32 v229, v229
v_rcp_f32 v230, v230
v_rcp_f32 v231, v231
s_nop 0
v_mul_f32 v208, v208, v224
v_mul_f32 v209, v209, v225
v_mul_f32 v210, v210, v226
v_mul_f32 v211, v211, v227
v_mul_f32 v212, v212, v228
v_mul_f32 v213, v213, v229
v_mul_f32 v214, v214, v230
v_mul_f32 v215, v215, v231
v_cvt_pk_bf16_f32 v224, v208, v209
v_cvt_pk_bf16_f32 v225, v210, v211
v_cvt_pk_bf16_f32 v226, v212, v213
v_cvt_pk_bf16_f32 v227, v214, v215
v_lshlrev_b32 v208, 16, v224
v_and_b32 v209, 0xffff0000, v224
v_lshlrev_b32 v210, 16, v225
v_and_b32 v211, 0xffff0000, v225
v_lshlrev_b32 v212, 16, v226
v_and_b32 v213, 0xffff0000, v226
v_lshlrev_b32 v214, 16, v227
v_and_b32 v215, 0xffff0000, v227
v_mov_b32 v240, 0
v_mov_b32 v241, 0
v_mov_b32 v242, 0
v_mov_b32 v243, 0
v_mov_b32 v244, 0
v_mov_b32 v245, 0
v_mov_b32 v246, 0
v_mov_b32 v247, 0
s_waitcnt vmcnt(31)
v_lshlrev_b32 v248, 16, v128
v_and_b32 v249, 0xffff0000, v128
v_fmac_f32 v240, v248, v208
v_fmac_f32 v241, v249, v208
v_lshlrev_b32 v250, 16, v129
v_and_b32 v251, 0xffff0000, v129
v_fmac_f32 v242, v250, v208
v_fmac_f32 v243, v251, v208
v_lshlrev_b32 v248, 16, v130
v_and_b32 v249, 0xffff0000, v130
v_fmac_f32 v244, v248, v208
v_fmac_f32 v245, v249, v208
v_lshlrev_b32 v250, 16, v131
v_and_b32 v251, 0xffff0000, v131
v_fmac_f32 v246, v250, v208
v_fmac_f32 v247, v251, v208
s_waitcnt vmcnt(30)
v_lshlrev_b32 v248, 16, v132
v_and_b32 v249, 0xffff0000, v132
v_fmac_f32 v240, v248, v209
v_fmac_f32 v241, v249, v209
v_lshlrev_b32 v250, 16, v133
v_and_b32 v251, 0xffff0000, v133
v_fmac_f32 v242, v250, v209
v_fmac_f32 v243, v251, v209
v_lshlrev_b32 v248, 16, v134
v_and_b32 v249, 0xffff0000, v134
v_fmac_f32 v244, v248, v209
v_fmac_f32 v245, v249, v209
v_lshlrev_b32 v250, 16, v135
v_and_b32 v251, 0xffff0000, v135
v_fmac_f32 v246, v250, v209
v_fmac_f32 v247, v251, v209
s_waitcnt vmcnt(29)
v_lshlrev_b32 v248, 16, v136
v_and_b32 v249, 0xffff0000, v136
v_fmac_f32 v240, v248, v210
v_fmac_f32 v241, v249, v210
v_lshlrev_b32 v250, 16, v137
v_and_b32 v251, 0xffff0000, v137
v_fmac_f32 v242, v250, v210
v_fmac_f32 v243, v251, v210
v_lshlrev_b32 v248, 16, v138
v_and_b32 v249, 0xffff0000, v138
v_fmac_f32 v244, v248, v210
v_fmac_f32 v245, v249, v210
v_lshlrev_b32 v250, 16, v139
v_and_b32 v251, 0xffff0000, v139
v_fmac_f32 v246, v250, v210
v_fmac_f32 v247, v251, v210
s_waitcnt vmcnt(28)
v_lshlrev_b32 v248, 16, v140
v_and_b32 v249, 0xffff0000, v140
v_fmac_f32 v240, v248, v211
v_fmac_f32 v241, v249, v211
v_lshlrev_b32 v250, 16, v141
v_and_b32 v251, 0xffff0000, v141
v_fmac_f32 v242, v250, v211
v_fmac_f32 v243, v251, v211
v_lshlrev_b32 v248, 16, v142
v_and_b32 v249, 0xffff0000, v142
v_fmac_f32 v244, v248, v211
v_fmac_f32 v245, v249, v211
v_lshlrev_b32 v250, 16, v143
v_and_b32 v251, 0xffff0000, v143
v_fmac_f32 v246, v250, v211
v_fmac_f32 v247, v251, v211
s_waitcnt vmcnt(27)
v_lshlrev_b32 v248, 16, v144
v_and_b32 v249, 0xffff0000, v144
v_fmac_f32 v240, v248, v212
v_fmac_f32 v241, v249, v212
v_lshlrev_b32 v250, 16, v145
v_and_b32 v251, 0xffff0000, v145
v_fmac_f32 v242, v250, v212
v_fmac_f32 v243, v251, v212
v_lshlrev_b32 v248, 16, v146
v_and_b32 v249, 0xffff0000, v146
v_fmac_f32 v244, v248, v212
v_fmac_f32 v245, v249, v212
v_lshlrev_b32 v250, 16, v147
v_and_b32 v251, 0xffff0000, v147
v_fmac_f32 v246, v250, v212
v_fmac_f32 v247, v251, v212
s_waitcnt vmcnt(26)
v_lshlrev_b32 v248, 16, v148
v_and_b32 v249, 0xffff0000, v148
v_fmac_f32 v240, v248, v213
v_fmac_f32 v241, v249, v213
v_lshlrev_b32 v250, 16, v149
v_and_b32 v251, 0xffff0000, v149
v_fmac_f32 v242, v250, v213
v_fmac_f32 v243, v251, v213
v_lshlrev_b32 v248, 16, v150
v_and_b32 v249, 0xffff0000, v150
v_fmac_f32 v244, v248, v213
v_fmac_f32 v245, v249, v213
v_lshlrev_b32 v250, 16, v151
v_and_b32 v251, 0xffff0000, v151
v_fmac_f32 v246, v250, v213
v_fmac_f32 v247, v251, v213
s_waitcnt vmcnt(25)
v_lshlrev_b32 v248, 16, v152
v_and_b32 v249, 0xffff0000, v152
v_fmac_f32 v240, v248, v214
v_fmac_f32 v241, v249, v214
v_lshlrev_b32 v250, 16, v153
v_and_b32 v251, 0xffff0000, v153
v_fmac_f32 v242, v250, v214
v_fmac_f32 v243, v251, v214
v_lshlrev_b32 v248, 16, v154
v_and_b32 v249, 0xffff0000, v154
v_fmac_f32 v244, v248, v214
v_fmac_f32 v245, v249, v214
v_lshlrev_b32 v250, 16, v155
v_and_b32 v251, 0xffff0000, v155
v_fmac_f32 v246, v250, v214
v_fmac_f32 v247, v251, v214
s_waitcnt vmcnt(24)
v_lshlrev_b32 v248, 16, v156
v_and_b32 v249, 0xffff0000, v156
v_fmac_f32 v240, v248, v215
v_fmac_f32 v241, v249, v215
v_lshlrev_b32 v250, 16, v157
v_and_b32 v251, 0xffff0000, v157
v_fmac_f32 v242, v250, v215
v_fmac_f32 v243, v251, v215
v_lshlrev_b32 v248, 16, v158
v_and_b32 v249, 0xffff0000, v158
v_fmac_f32 v244, v248, v215
v_fmac_f32 v245, v249, v215
v_lshlrev_b32 v250, 16, v159
v_and_b32 v251, 0xffff0000, v159
v_fmac_f32 v246, v250, v215
v_fmac_f32 v247, v251, v215
v_lshlrev_b32 v196, 8, v193
v_lshl_add_u32 v196, v192, 5, v196
v_add_u32 v196, 65536, v196
ds_write_b128 v196, v[240:243]
ds_write_b128 v196, v[244:247] offset:16
s_waitcnt lgkmcnt(0)
s_barrier
s_cmp_lg_u32 s26, 0
s_cbranch_scc1 adaLN_cond__sliding_block_cached__swiglu_ffn__prompt_kernel_skip_25
v_lshlrev_b32 v198, 2, v1
v_add_u32 v196, 65536, v198
ds_read_b32 v128, v196 offset:0
ds_read_b32 v129, v196 offset:256
ds_read_b32 v130, v196 offset:512
ds_read_b32 v131, v196 offset:768
ds_read_b32 v132, v196 offset:1024
ds_read_b32 v133, v196 offset:1280
ds_read_b32 v134, v196 offset:1536
ds_read_b32 v135, v196 offset:1792
ds_read_b32 v136, v196 offset:2048
ds_read_b32 v137, v196 offset:2304
ds_read_b32 v138, v196 offset:2560
ds_read_b32 v139, v196 offset:2816
ds_read_b32 v140, v196 offset:3072
ds_read_b32 v141, v196 offset:3328
ds_read_b32 v142, v196 offset:3584
ds_read_b32 v143, v196 offset:3840
s_waitcnt lgkmcnt(7)
ds_read_b32 v144, v196 offset:4096
ds_read_b32 v145, v196 offset:4352
ds_read_b32 v146, v196 offset:4608
ds_read_b32 v147, v196 offset:4864
ds_read_b32 v148, v196 offset:5120
ds_read_b32 v149, v196 offset:5376
ds_read_b32 v150, v196 offset:5632
ds_read_b32 v151, v196 offset:5888
s_waitcnt lgkmcnt(7)
ds_read_b32 v152, v196 offset:6144
ds_read_b32 v153, v196 offset:6400
ds_read_b32 v154, v196 offset:6656
ds_read_b32 v155, v196 offset:6912
ds_read_b32 v156, v196 offset:7168
ds_read_b32 v157, v196 offset:7424
ds_read_b32 v158, v196 offset:7680
ds_read_b32 v159, v196 offset:7936
s_waitcnt lgkmcnt(0)
v_add_f32 v128, v128, v144
v_add_f32 v129, v129, v145
v_add_f32 v130, v130, v146
v_add_f32 v131, v131, v147
v_add_f32 v132, v132, v148
v_add_f32 v133, v133, v149
v_add_f32 v134, v134, v150
v_add_f32 v135, v135, v151
v_add_f32 v136, v136, v152
v_add_f32 v137, v137, v153
v_add_f32 v138, v138, v154
v_add_f32 v139, v139, v155
v_add_f32 v140, v140, v156
v_add_f32 v141, v141, v157
v_add_f32 v142, v142, v158
v_add_f32 v143, v143, v159
v_add_f32 v128, v128, v136
v_add_f32 v129, v129, v137
v_add_f32 v130, v130, v138
v_add_f32 v131, v131, v139
v_add_f32 v132, v132, v140
v_add_f32 v133, v133, v141
v_add_f32 v134, v134, v142
v_add_f32 v135, v135, v143
v_add_f32 v128, v128, v132
v_add_f32 v129, v129, v133
v_add_f32 v130, v130, v134
v_add_f32 v131, v131, v135
v_add_f32 v128, v128, v130
v_add_f32 v129, v129, v131
v_add_f32 v128, v128, v129
buffer_store_dword v128, v198, s[16:19], s54 offen sc1
adaLN_cond__sliding_block_cached__swiglu_ffn__prompt_kernel_skip_25:
s_cmp_lg_u32 s26, 0
s_cbranch_scc1 adaLN_cond__sliding_block_cached__swiglu_ffn__prompt_kernel_mb_26
s_waitcnt vmcnt(0)
v_mov_b32 v2, 8
v_mov_b32 v3, 1
s_mov_b64 exec, 1
global_atomic_add v2, v3, s[88:89] sc1
s_mov_b64 exec, -1
adaLN_cond__sliding_block_cached__swiglu_ffn__prompt_kernel_mb_26:
adaLN_cond__sliding_block_cached__swiglu_ffn__prompt_kernel_L_oproj:
s_cmp_lg_u32 s26, 0
s_cbranch_scc1 adaLN_cond__sliding_block_cached__swiglu_ffn__prompt_kernel_ws_29
s_lshl_b32 s27, s24, 2
s_add_u32 s27, s27, s22
s_add_u32 s27, s27, 8
s_lshl_b32 s6, s27, 8
s_add_u32 s6, s6, 0x20000
s_add_u32 s6, s6, s90
s_addc_u32 s7, s91, 0
v_mov_b32 v2, 0
s_mov_b32 s27, 0
s_mov_b64 exec, 1
adaLN_cond__sliding_block_cached__swiglu_ffn__prompt_kernel_wt_27:
global_load_dword v3, v2, s[6:7] offset:0 sc1
s_waitcnt vmcnt(0)
v_readfirstlane_b32 s28, v3
s_add_u32 s27, s27, 1
s_cmp_ge_u32 s28, 8
s_cbranch_scc1 adaLN_cond__sliding_block_cached__swiglu_ffn__prompt_kernel_wd_28
s_cmp_ge_u32 s27, 0x40000
s_cbranch_scc1 adaLN_cond__sliding_block_cached__swiglu_ffn__prompt_kernel_wd_28
s_sleep 2
s_branch adaLN_cond__sliding_block_cached__swiglu_ffn__prompt_kernel_wt_27
adaLN_cond__sliding_block_cached__swiglu_ffn__prompt_kernel_wd_28:
s_mov_b64 exec, -1
adaLN_cond__sliding_block_cached__swiglu_ffn__prompt_kernel_ws_29:
s_barrier
s_add_u32 m0, s32, 0x8000
s_add_u32 s30, s30, 4096
buffer_load_dwordx4 a[0:3], v8, s[8:11], s30 offen offset:0 sc1
buffer_load_dwordx4 a[16:19], v9, s[8:11], s30 offen offset:0 sc1
buffer_load_dwordx4 a[4:7], v8, s[8:11], s30 offen offset:1024 sc1
buffer_load_dwordx4 a[20:23], v9, s[8:11], s30 offen offset:1024 sc1
buffer_load_dwordx4 a[8:11], v8, s[8:11], s30 offen offset:2048 sc1
buffer_load_dwordx4 a[24:27], v9, s[8:11], s30 offen offset:2048 sc1
buffer_load_dwordx4 a[12:15], v8, s[8:11], s30 offen offset:3072 sc1
buffer_load_dwordx4 a[28:31], v9, s[8:11], s30 offen offset:3072 sc1
s_add_u32 s30, s30, 4096
buffer_load_dwordx4 a[32:35], v8, s[8:11], s30 offen offset:0 sc1
buffer_load_dwordx4 a[48:51], v9, s[8:11], s30 offen offset:0 sc1
buffer_load_dwordx4 a[36:39], v8, s[8:11], s30 offen offset:1024 sc1
buffer_load_dwordx4 a[52:55], v9, s[8:11], s30 offen offset:1024 sc1
buffer_load_dwordx4 a[40:43], v8, s[8:11], s30 offen offset:2048 sc1
buffer_load_dwordx4 a[56:59], v9, s[8:11], s30 offen offset:2048 sc1
buffer_load_dwordx4 a[44:47], v8, s[8:11], s30 offen offset:3072 sc1
buffer_load_dwordx4 a[60:63], v9, s[8:11], s30 offen offset:3072 sc1
s_lshl_b32 s27, s22, 22
s_add_u32 s27, s27, 0x1500000
s_add_u32 s16, s90, s27
s_addc_u32 s17, s91, 0
s_mov_b32 s18, 0x400000
s_mov_b32 s19, 0x20000
s_lshl_b32 s27, s34, 6
s_lshl_b32 s28, s25, 3
s_add_u32 s27, s27, s28
s_lshl_b32 s36, s27, 10
s_add_u32 s37, s36, 0x10000
v_add_u32 v14, 4096, v8
s_waitcnt vmcnt(10)
s_barrier
ds_read_b64_tr_b16 a[128:129], v4 offset:0
ds_read_b64_tr_b16 a[130:131], v4 offset:1024
ds_read_b64_tr_b16 a[132:133], v5 offset:0
ds_read_b64_tr_b16 a[134:135], v5 offset:1024
ds_read_b64_tr_b16 a[136:137], v6 offset:0
ds_read_b64_tr_b16 a[138:139], v6 offset:1024
ds_read_b64_tr_b16 a[140:141], v7 offset:0
ds_read_b64_tr_b16 a[142:143], v7 offset:1024
s_waitcnt lgkmcnt(0)
v_mfma_f32_32x32x16_bf16 v[128:143], a[128:131], a[0:3], 0
ds_read_b64_tr_b16 a[144:145], v4 offset:4096
ds_read_b64_tr_b16 a[146:147], v4 offset:5120
v_mfma_f32_32x32x16_bf16 v[144:159], a[128:131], a[16:19], 0
ds_read_b64_tr_b16 a[148:149], v5 offset:4096
ds_read_b64_tr_b16 a[150:151], v5 offset:5120
v_mfma_f32_32x32x16_bf16 v[160:175], a[132:135], a[0:3], 0
ds_read_b64_tr_b16 a[152:153], v6 offset:4096
ds_read_b64_tr_b16 a[154:155], v6 offset:5120
v_mfma_f32_32x32x16_bf16 v[176:191], a[132:135], a[16:19], 0
ds_read_b64_tr_b16 a[156:157], v7 offset:4096
ds_read_b64_tr_b16 a[158:159], v7 offset:5120
v_mfma_f32_32x32x16_bf16 v[192:207], a[136:139], a[0:3], 0
s_add_u32 s30, s30, 4096
buffer_load_dwordx4 a[64:67], v8, s[8:11], s30 offen offset:0 sc1
v_mfma_f32_32x32x16_bf16 v[208:223], a[136:139], a[16:19], 0
buffer_load_dwordx4 v11, s[12:15], s31 offen offset:1024 lds
v_mfma_f32_32x32x16_bf16 v[224:239], a[140:143], a[0:3], 0
buffer_load_dwordx4 a[80:83], v9, s[8:11], s30 offen offset:0 sc1
v_mfma_f32_32x32x16_bf16 v[240:255], a[140:143], a[16:19], 0
buffer_load_dwordx4 a[68:71], v8, s[8:11], s30 offen offset:1024 sc1
s_waitcnt lgkmcnt(0)
v_mfma_f32_32x32x16_bf16 v[128:143], a[144:147], a[4:7], v[128:143]
ds_read_b64_tr_b16 a[128:129], v4 offset:8192
ds_read_b64_tr_b16 a[130:131], v4 offset:9216
v_mfma_f32_32x32x16_bf16 v[144:159], a[144:147], a[20:23], v[144:159]
ds_read_b64_tr_b16 a[132:133], v5 offset:8192
ds_read_b64_tr_b16 a[134:135], v5 offset:9216
v_mfma_f32_32x32x16_bf16 v[160:175], a[148:151], a[4:7], v[160:175]
ds_read_b64_tr_b16 a[136:137], v6 offset:8192
ds_read_b64_tr_b16 a[138:139], v6 offset:9216
v_mfma_f32_32x32x16_bf16 v[176:191], a[148:151], a[20:23], v[176:191]
ds_read_b64_tr_b16 a[140:141], v7 offset:8192
ds_read_b64_tr_b16 a[142:143], v7 offset:9216
v_mfma_f32_32x32x16_bf16 v[192:207], a[152:155], a[4:7], v[192:207]
buffer_load_dwordx4 v12, s[12:15], s31 offen offset:2048 lds
v_mfma_f32_32x32x16_bf16 v[208:223], a[152:155], a[20:23], v[208:223]
buffer_load_dwordx4 a[84:87], v9, s[8:11], s30 offen offset:1024 sc1
v_mfma_f32_32x32x16_bf16 v[224:239], a[156:159], a[4:7], v[224:239]
buffer_load_dwordx4 a[72:75], v8, s[8:11], s30 offen offset:2048 sc1
v_mfma_f32_32x32x16_bf16 v[240:255], a[156:159], a[20:23], v[240:255]
buffer_load_dwordx4 v13, s[12:15], s31 offen offset:3072 lds
s_waitcnt lgkmcnt(0)
v_mfma_f32_32x32x16_bf16 v[128:143], a[128:131], a[8:11], v[128:143]
ds_read_b64_tr_b16 a[144:145], v4 offset:12288
ds_read_b64_tr_b16 a[146:147], v4 offset:13312
v_mfma_f32_32x32x16_bf16 v[144:159], a[128:131], a[24:27], v[144:159]
ds_read_b64_tr_b16 a[148:149], v5 offset:12288
ds_read_b64_tr_b16 a[150:151], v5 offset:13312
v_mfma_f32_32x32x16_bf16 v[160:175], a[132:135], a[8:11], v[160:175]
ds_read_b64_tr_b16 a[152:153], v6 offset:12288
ds_read_b64_tr_b16 a[154:155], v6 offset:13312
v_mfma_f32_32x32x16_bf16 v[176:191], a[132:135], a[24:27], v[176:191]
ds_read_b64_tr_b16 a[156:157], v7 offset:12288
ds_read_b64_tr_b16 a[158:159], v7 offset:13312
v_mfma_f32_32x32x16_bf16 v[192:207], a[136:139], a[8:11], v[192:207]
buffer_load_dwordx4 a[88:91], v9, s[8:11], s30 offen offset:2048 sc1
v_mfma_f32_32x32x16_bf16 v[208:223], a[136:139], a[24:27], v[208:223]
buffer_load_dwordx4 a[76:79], v8, s[8:11], s30 offen offset:3072 sc1
v_mfma_f32_32x32x16_bf16 v[224:239], a[140:143], a[8:11], v[224:239]
s_add_u32 s31, s31, 0x20000
s_add_u32 m0, s32, 0xc000
s_nop 0
buffer_load_dwordx4 v10, s[12:15], s31 offen offset:0 lds
v_mfma_f32_32x32x16_bf16 v[240:255], a[140:143], a[24:27], v[240:255]
buffer_load_dwordx4 a[92:95], v9, s[8:11], s30 offen offset:3072 sc1
s_waitcnt vmcnt(14) lgkmcnt(0)
s_barrier
v_mfma_f32_32x32x16_bf16 v[128:143], a[144:147], a[12:15], v[128:143]
ds_read_b64_tr_b16 a[128:129], v4 offset:16384
ds_read_b64_tr_b16 a[130:131], v4 offset:17408
v_mfma_f32_32x32x16_bf16 v[144:159], a[144:147], a[28:31], v[144:159]
ds_read_b64_tr_b16 a[132:133], v5 offset:16384
ds_read_b64_tr_b16 a[134:135], v5 offset:17408
v_mfma_f32_32x32x16_bf16 v[160:175], a[148:151], a[12:15], v[160:175]
ds_read_b64_tr_b16 a[136:137], v6 offset:16384
ds_read_b64_tr_b16 a[138:139], v6 offset:17408
v_mfma_f32_32x32x16_bf16 v[176:191], a[148:151], a[28:31], v[176:191]
ds_read_b64_tr_b16 a[140:141], v7 offset:16384
ds_read_b64_tr_b16 a[142:143], v7 offset:17408
v_mfma_f32_32x32x16_bf16 v[192:207], a[152:155], a[12:15], v[192:207]
s_add_u32 s30, s30, 4096
buffer_load_dwordx4 a[96:99], v8, s[8:11], s30 offen offset:0 sc1
v_mfma_f32_32x32x16_bf16 v[208:223], a[152:155], a[28:31], v[208:223]
buffer_load_dwordx4 v11, s[12:15], s31 offen offset:1024 lds
v_mfma_f32_32x32x16_bf16 v[224:239], a[156:159], a[12:15], v[224:239]
buffer_load_dwordx4 a[112:115], v9, s[8:11], s30 offen offset:0 sc1
v_mfma_f32_32x32x16_bf16 v[240:255], a[156:159], a[28:31], v[240:255]
buffer_load_dwordx4 a[100:103], v8, s[8:11], s30 offen offset:1024 sc1
s_waitcnt lgkmcnt(0)
v_mfma_f32_32x32x16_bf16 v[128:143], a[128:131], a[32:35], v[128:143]
ds_read_b64_tr_b16 a[144:145], v4 offset:20480
ds_read_b64_tr_b16 a[146:147], v4 offset:21504
v_mfma_f32_32x32x16_bf16 v[144:159], a[128:131], a[48:51], v[144:159]
ds_read_b64_tr_b16 a[148:149], v5 offset:20480
ds_read_b64_tr_b16 a[150:151], v5 offset:21504
v_mfma_f32_32x32x16_bf16 v[160:175], a[132:135], a[32:35], v[160:175]
ds_read_b64_tr_b16 a[152:153], v6 offset:20480
ds_read_b64_tr_b16 a[154:155], v6 offset:21504
v_mfma_f32_32x32x16_bf16 v[176:191], a[132:135], a[48:51], v[176:191]
ds_read_b64_tr_b16 a[156:157], v7 offset:20480
ds_read_b64_tr_b16 a[158:159], v7 offset:21504
v_mfma_f32_32x32x16_bf16 v[192:207], a[136:139], a[32:35], v[192:207]
buffer_load_dwordx4 v12, s[12:15], s31 offen offset:2048 lds
v_mfma_f32_32x32x16_bf16 v[208:223], a[136:139], a[48:51], v[208:223]
buffer_load_dwordx4 a[116:119], v9, s[8:11], s30 offen offset:1024 sc1
v_mfma_f32_32x32x16_bf16 v[224:239], a[140:143], a[32:35], v[224:239]
buffer_load_dwordx4 a[104:107], v8, s[8:11], s30 offen offset:2048 sc1
v_mfma_f32_32x32x16_bf16 v[240:255], a[140:143], a[48:51], v[240:255]
buffer_load_dwordx4 v13, s[12:15], s31 offen offset:3072 lds
s_waitcnt lgkmcnt(0)
v_mfma_f32_32x32x16_bf16 v[128:143], a[144:147], a[36:39], v[128:143]
ds_read_b64_tr_b16 a[128:129], v4 offset:24576
ds_read_b64_tr_b16 a[130:131], v4 offset:25600
v_mfma_f32_32x32x16_bf16 v[144:159], a[144:147], a[52:55], v[144:159]
ds_read_b64_tr_b16 a[132:133], v5 offset:24576
ds_read_b64_tr_b16 a[134:135], v5 offset:25600
v_mfma_f32_32x32x16_bf16 v[160:175], a[148:151], a[36:39], v[160:175]
ds_read_b64_tr_b16 a[136:137], v6 offset:24576
ds_read_b64_tr_b16 a[138:139], v6 offset:25600
v_mfma_f32_32x32x16_bf16 v[176:191], a[148:151], a[52:55], v[176:191]
ds_read_b64_tr_b16 a[140:141], v7 offset:24576
ds_read_b64_tr_b16 a[142:143], v7 offset:25600
v_mfma_f32_32x32x16_bf16 v[192:207], a[152:155], a[36:39], v[192:207]
buffer_load_dwordx4 a[120:123], v9, s[8:11], s30 offen offset:2048 sc1
v_mfma_f32_32x32x16_bf16 v[208:223], a[152:155], a[52:55], v[208:223]
buffer_load_dwordx4 a[108:111], v8, s[8:11], s30 offen offset:3072 sc1
v_mfma_f32_32x32x16_bf16 v[224:239], a[156:159], a[36:39], v[224:239]
s_add_u32 s31, s31, 0x20000
s_add_u32 m0, s32, 0x0
s_nop 0
buffer_load_dwordx4 v10, s[12:15], s31 offen offset:0 lds
v_mfma_f32_32x32x16_bf16 v[240:255], a[156:159], a[52:55], v[240:255]
buffer_load_dwordx4 a[124:127], v9, s[8:11], s30 offen offset:3072 sc1
s_waitcnt lgkmcnt(0)
v_mfma_f32_32x32x16_bf16 v[128:143], a[128:131], a[40:43], v[128:143]
ds_read_b64_tr_b16 a[144:145], v4 offset:28672
ds_read_b64_tr_b16 a[146:147], v4 offset:29696
v_mfma_f32_32x32x16_bf16 v[144:159], a[128:131], a[56:59], v[144:159]
ds_read_b64_tr_b16 a[148:149], v5 offset:28672
ds_read_b64_tr_b16 a[150:151], v5 offset:29696
v_mfma_f32_32x32x16_bf16 v[160:175], a[132:135], a[40:43], v[160:175]
ds_read_b64_tr_b16 a[152:153], v6 offset:28672
ds_read_b64_tr_b16 a[154:155], v6 offset:29696
v_mfma_f32_32x32x16_bf16 v[176:191], a[132:135], a[56:59], v[176:191]
ds_read_b64_tr_b16 a[156:157], v7 offset:28672
ds_read_b64_tr_b16 a[158:159], v7 offset:29696
v_mfma_f32_32x32x16_bf16 v[192:207], a[136:139], a[40:43], v[192:207]
s_add_u32 s30, s30, 4096
buffer_load_dwordx4 a[0:3], v8, s[8:11], s30 offen offset:0 sc1
v_mfma_f32_32x32x16_bf16 v[208:223], a[136:139], a[56:59], v[208:223]
buffer_load_dwordx4 v11, s[12:15], s31 offen offset:1024 lds
v_mfma_f32_32x32x16_bf16 v[224:239], a[140:143], a[40:43], v[224:239]
buffer_load_dwordx4 a[16:19], v9, s[8:11], s30 offen offset:0 sc1
v_mfma_f32_32x32x16_bf16 v[240:255], a[140:143], a[56:59], v[240:255]
buffer_load_dwordx4 a[4:7], v8, s[8:11], s30 offen offset:1024 sc1
s_waitcnt vmcnt(19) lgkmcnt(0)
s_barrier
v_mfma_f32_32x32x16_bf16 v[128:143], a[144:147], a[44:47], v[128:143]
ds_read_b64_tr_b16 a[128:129], v4 offset:32768
ds_read_b64_tr_b16 a[130:131], v4 offset:33792
v_mfma_f32_32x32x16_bf16 v[144:159], a[144:147], a[60:63], v[144:159]
ds_read_b64_tr_b16 a[132:133], v5 offset:32768
ds_read_b64_tr_b16 a[134:135], v5 offset:33792
v_mfma_f32_32x32x16_bf16 v[160:175], a[148:151], a[44:47], v[160:175]
ds_read_b64_tr_b16 a[136:137], v6 offset:32768
ds_read_b64_tr_b16 a[138:139], v6 offset:33792
v_mfma_f32_32x32x16_bf16 v[176:191], a[148:151], a[60:63], v[176:191]
ds_read_b64_tr_b16 a[140:141], v7 offset:32768
ds_read_b64_tr_b16 a[142:143], v7 offset:33792
v_mfma_f32_32x32x16_bf16 v[192:207], a[152:155], a[44:47], v[192:207]
buffer_load_dwordx4 v12, s[12:15], s31 offen offset:2048 lds
v_mfma_f32_32x32x16_bf16 v[208:223], a[152:155], a[60:63], v[208:223]
buffer_load_dwordx4 a[20:23], v9, s[8:11], s30 offen offset:1024 sc1
v_mfma_f32_32x32x16_bf16 v[224:239], a[156:159], a[44:47], v[224:239]
buffer_load_dwordx4 a[8:11], v8, s[8:11], s30 offen offset:2048 sc1
v_mfma_f32_32x32x16_bf16 v[240:255], a[156:159], a[60:63], v[240:255]
buffer_load_dwordx4 v13, s[12:15], s31 offen offset:3072 lds
s_waitcnt lgkmcnt(0)
v_mfma_f32_32x32x16_bf16 v[128:143], a[128:131], a[64:67], v[128:143]
ds_read_b64_tr_b16 a[144:145], v4 offset:36864
ds_read_b64_tr_b16 a[146:147], v4 offset:37888
v_mfma_f32_32x32x16_bf16 v[144:159], a[128:131], a[80:83], v[144:159]
ds_read_b64_tr_b16 a[148:149], v5 offset:36864
ds_read_b64_tr_b16 a[150:151], v5 offset:37888
v_mfma_f32_32x32x16_bf16 v[160:175], a[132:135], a[64:67], v[160:175]
ds_read_b64_tr_b16 a[152:153], v6 offset:36864
ds_read_b64_tr_b16 a[154:155], v6 offset:37888
v_mfma_f32_32x32x16_bf16 v[176:191], a[132:135], a[80:83], v[176:191]
ds_read_b64_tr_b16 a[156:157], v7 offset:36864
ds_read_b64_tr_b16 a[158:159], v7 offset:37888
v_mfma_f32_32x32x16_bf16 v[192:207], a[136:139], a[64:67], v[192:207]
buffer_load_dwordx4 a[24:27], v9, s[8:11], s30 offen offset:2048 sc1
v_mfma_f32_32x32x16_bf16 v[208:223], a[136:139], a[80:83], v[208:223]
buffer_load_dwordx4 a[12:15], v8, s[8:11], s30 offen offset:3072 sc1
v_mfma_f32_32x32x16_bf16 v[224:239], a[140:143], a[64:67], v[224:239]
s_add_u32 s31, s31, 0x20000
s_add_u32 m0, s32, 0x4000
s_nop 0
buffer_load_dwordx4 v10, s[12:15], s31 offen offset:0 lds
v_mfma_f32_32x32x16_bf16 v[240:255], a[140:143], a[80:83], v[240:255]
buffer_load_dwordx4 a[28:31], v9, s[8:11], s30 offen offset:3072 sc1
s_waitcnt lgkmcnt(0)
v_mfma_f32_32x32x16_bf16 v[128:143], a[144:147], a[68:71], v[128:143]
ds_read_b64_tr_b16 a[128:129], v4 offset:40960
ds_read_b64_tr_b16 a[130:131], v4 offset:41984
v_mfma_f32_32x32x16_bf16 v[144:159], a[144:147], a[84:87], v[144:159]
ds_read_b64_tr_b16 a[132:133], v5 offset:40960
ds_read_b64_tr_b16 a[134:135], v5 offset:41984
v_mfma_f32_32x32x16_bf16 v[160:175], a[148:151], a[68:71], v[160:175]
ds_read_b64_tr_b16 a[136:137], v6 offset:40960
ds_read_b64_tr_b16 a[138:139], v6 offset:41984
v_mfma_f32_32x32x16_bf16 v[176:191], a[148:151], a[84:87], v[176:191]
ds_read_b64_tr_b16 a[140:141], v7 offset:40960
ds_read_b64_tr_b16 a[142:143], v7 offset:41984
v_mfma_f32_32x32x16_bf16 v[192:207], a[152:155], a[68:71], v[192:207]
s_add_u32 s30, s30, 4096
buffer_load_dwordx4 a[32:35], v8, s[8:11], s30 offen offset:0 sc1
v_mfma_f32_32x32x16_bf16 v[208:223], a[152:155], a[84:87], v[208:223]
buffer_load_dwordx4 v11, s[12:15], s31 offen offset:1024 lds
v_mfma_f32_32x32x16_bf16 v[224:239], a[156:159], a[68:71], v[224:239]
buffer_load_dwordx4 a[48:51], v9, s[8:11], s30 offen offset:0 sc1
v_mfma_f32_32x32x16_bf16 v[240:255], a[156:159], a[84:87], v[240:255]
buffer_load_dwordx4 a[36:39], v8, s[8:11], s30 offen offset:1024 sc1
s_waitcnt lgkmcnt(0)
v_mfma_f32_32x32x16_bf16 v[128:143], a[128:131], a[72:75], v[128:143]
ds_read_b64_tr_b16 a[144:145], v4 offset:45056
ds_read_b64_tr_b16 a[146:147], v4 offset:46080
v_mfma_f32_32x32x16_bf16 v[144:159], a[128:131], a[88:91], v[144:159]
ds_read_b64_tr_b16 a[148:149], v5 offset:45056
ds_read_b64_tr_b16 a[150:151], v5 offset:46080
v_mfma_f32_32x32x16_bf16 v[160:175], a[132:135], a[72:75], v[160:175]
ds_read_b64_tr_b16 a[152:153], v6 offset:45056
ds_read_b64_tr_b16 a[154:155], v6 offset:46080
v_mfma_f32_32x32x16_bf16 v[176:191], a[132:135], a[88:91], v[176:191]
ds_read_b64_tr_b16 a[156:157], v7 offset:45056
ds_read_b64_tr_b16 a[158:159], v7 offset:46080
v_mfma_f32_32x32x16_bf16 v[192:207], a[136:139], a[72:75], v[192:207]
buffer_load_dwordx4 v12, s[12:15], s31 offen offset:2048 lds
v_mfma_f32_32x32x16_bf16 v[208:223], a[136:139], a[88:91], v[208:223]
buffer_load_dwordx4 a[52:55], v9, s[8:11], s30 offen offset:1024 sc1
v_mfma_f32_32x32x16_bf16 v[224:239], a[140:143], a[72:75], v[224:239]
buffer_load_dwordx4 a[40:43], v8, s[8:11], s30 offen offset:2048 sc1
v_mfma_f32_32x32x16_bf16 v[240:255], a[140:143], a[88:91], v[240:255]
buffer_load_dwordx4 v13, s[12:15], s31 offen offset:3072 lds
s_waitcnt vmcnt(23) lgkmcnt(0)
s_barrier
v_mfma_f32_32x32x16_bf16 v[128:143], a[144:147], a[76:79], v[128:143]
ds_read_b64_tr_b16 a[128:129], v4 offset:49152
ds_read_b64_tr_b16 a[130:131], v4 offset:50176
v_mfma_f32_32x32x16_bf16 v[144:159], a[144:147], a[92:95], v[144:159]
ds_read_b64_tr_b16 a[132:133], v5 offset:49152
ds_read_b64_tr_b16 a[134:135], v5 offset:50176
v_mfma_f32_32x32x16_bf16 v[160:175], a[148:151], a[76:79], v[160:175]
ds_read_b64_tr_b16 a[136:137], v6 offset:49152
ds_read_b64_tr_b16 a[138:139], v6 offset:50176
v_mfma_f32_32x32x16_bf16 v[176:191], a[148:151], a[92:95], v[176:191]
ds_read_b64_tr_b16 a[140:141], v7 offset:49152
ds_read_b64_tr_b16 a[142:143], v7 offset:50176
v_mfma_f32_32x32x16_bf16 v[192:207], a[152:155], a[76:79], v[192:207]
buffer_load_dwordx4 a[56:59], v9, s[8:11], s30 offen offset:2048 sc1
v_mfma_f32_32x32x16_bf16 v[208:223], a[152:155], a[92:95], v[208:223]
buffer_load_dwordx4 a[44:47], v8, s[8:11], s30 offen offset:3072 sc1
v_mfma_f32_32x32x16_bf16 v[224:239], a[156:159], a[76:79], v[224:239]
s_add_u32 s31, s31, 0x20000
s_add_u32 m0, s32, 0x8000
s_nop 0
buffer_load_dwordx4 v10, s[12:15], s31 offen offset:0 lds
v_mfma_f32_32x32x16_bf16 v[240:255], a[156:159], a[92:95], v[240:255]
buffer_load_dwordx4 a[60:63], v9, s[8:11], s30 offen offset:3072 sc1
s_waitcnt lgkmcnt(0)
v_mfma_f32_32x32x16_bf16 v[128:143], a[128:131], a[96:99], v[128:143]
ds_read_b64_tr_b16 a[144:145], v4 offset:53248
ds_read_b64_tr_b16 a[146:147], v4 offset:54272
v_mfma_f32_32x32x16_bf16 v[144:159], a[128:131], a[112:115], v[144:159]
ds_read_b64_tr_b16 a[148:149], v5 offset:53248
ds_read_b64_tr_b16 a[150:151], v5 offset:54272
v_mfma_f32_32x32x16_bf16 v[160:175], a[132:135], a[96:99], v[160:175]
ds_read_b64_tr_b16 a[152:153], v6 offset:53248
ds_read_b64_tr_b16 a[154:155], v6 offset:54272
v_mfma_f32_32x32x16_bf16 v[176:191], a[132:135], a[112:115], v[176:191]
ds_read_b64_tr_b16 a[156:157], v7 offset:53248
ds_read_b64_tr_b16 a[158:159], v7 offset:54272
v_mfma_f32_32x32x16_bf16 v[192:207], a[136:139], a[96:99], v[192:207]
s_add_u32 s30, s30, 4096
buffer_load_dwordx4 a[64:67], v8, s[8:11], s30 offen offset:0 sc1
v_mfma_f32_32x32x16_bf16 v[208:223], a[136:139], a[112:115], v[208:223]
buffer_load_dwordx4 v11, s[12:15], s31 offen offset:1024 lds
v_mfma_f32_32x32x16_bf16 v[224:239], a[140:143], a[96:99], v[224:239]
buffer_load_dwordx4 a[80:83], v9, s[8:11], s30 offen offset:0 sc1
v_mfma_f32_32x32x16_bf16 v[240:255], a[140:143], a[112:115], v[240:255]
s_waitcnt lgkmcnt(0)
v_mfma_f32_32x32x16_bf16 v[128:143], a[144:147], a[100:103], v[128:143]
ds_read_b64_tr_b16 a[128:129], v4 offset:57344
ds_read_b64_tr_b16 a[130:131], v4 offset:58368
v_mfma_f32_32x32x16_bf16 v[144:159], a[144:147], a[116:119], v[144:159]
ds_read_b64_tr_b16 a[132:133], v5 offset:57344
ds_read_b64_tr_b16 a[134:135], v5 offset:58368
v_mfma_f32_32x32x16_bf16 v[160:175], a[148:151], a[100:103], v[160:175]
ds_read_b64_tr_b16 a[136:137], v6 offset:57344
ds_read_b64_tr_b16 a[138:139], v6 offset:58368
v_mfma_f32_32x32x16_bf16 v[176:191], a[148:151], a[116:119], v[176:191]
ds_read_b64_tr_b16 a[140:141], v7 offset:57344
ds_read_b64_tr_b16 a[142:143], v7 offset:58368
v_mfma_f32_32x32x16_bf16 v[192:207], a[152:155], a[100:103], v[192:207]
buffer_load_dwordx4 a[68:71], v8, s[8:11], s30 offen offset:1024 sc1
v_mfma_f32_32x32x16_bf16 v[208:223], a[152:155], a[116:119], v[208:223]
buffer_load_dwordx4 v12, s[12:15], s31 offen offset:2048 lds
v_mfma_f32_32x32x16_bf16 v[224:239], a[156:159], a[100:103], v[224:239]
buffer_load_dwordx4 a[84:87], v9, s[8:11], s30 offen offset:1024 sc1
v_mfma_f32_32x32x16_bf16 v[240:255], a[156:159], a[116:119], v[240:255]
s_waitcnt lgkmcnt(0)
v_mfma_f32_32x32x16_bf16 v[128:143], a[128:131], a[104:107], v[128:143]
ds_read_b64_tr_b16 a[144:145], v4 offset:61440
ds_read_b64_tr_b16 a[146:147], v4 offset:62464
v_mfma_f32_32x32x16_bf16 v[144:159], a[128:131], a[120:123], v[144:159]
ds_read_b64_tr_b16 a[148:149], v5 offset:61440
ds_read_b64_tr_b16 a[150:151], v5 offset:62464
v_mfma_f32_32x32x16_bf16 v[160:175], a[132:135], a[104:107], v[160:175]
ds_read_b64_tr_b16 a[152:153], v6 offset:61440
ds_read_b64_tr_b16 a[154:155], v6 offset:62464
v_mfma_f32_32x32x16_bf16 v[176:191], a[132:135], a[120:123], v[176:191]
ds_read_b64_tr_b16 a[156:157], v7 offset:61440
ds_read_b64_tr_b16 a[158:159], v7 offset:62464
v_mfma_f32_32x32x16_bf16 v[192:207], a[136:139], a[104:107], v[192:207]
buffer_load_dwordx4 a[72:75], v8, s[8:11], s30 offen offset:2048 sc1
v_mfma_f32_32x32x16_bf16 v[208:223], a[136:139], a[120:123], v[208:223]
buffer_load_dwordx4 v13, s[12:15], s31 offen offset:3072 lds
v_mfma_f32_32x32x16_bf16 v[224:239], a[140:143], a[104:107], v[224:239]
buffer_load_dwordx4 a[88:91], v9, s[8:11], s30 offen offset:2048 sc1
v_mfma_f32_32x32x16_bf16 v[240:255], a[140:143], a[120:123], v[240:255]
s_waitcnt vmcnt(24) lgkmcnt(0)
s_barrier
v_mfma_f32_32x32x16_bf16 v[128:143], a[144:147], a[108:111], v[128:143]
ds_read_b64_tr_b16 a[128:129], v4 offset:0
ds_read_b64_tr_b16 a[130:131], v4 offset:1024
v_mfma_f32_32x32x16_bf16 v[144:159], a[144:147], a[124:127], v[144:159]
ds_read_b64_tr_b16 a[132:133], v5 offset:0
ds_read_b64_tr_b16 a[134:135], v5 offset:1024
v_mfma_f32_32x32x16_bf16 v[160:175], a[148:151], a[108:111], v[160:175]
ds_read_b64_tr_b16 a[136:137], v6 offset:0
ds_read_b64_tr_b16 a[138:139], v6 offset:1024
v_mfma_f32_32x32x16_bf16 v[176:191], a[148:151], a[124:127], v[176:191]
ds_read_b64_tr_b16 a[140:141], v7 offset:0
ds_read_b64_tr_b16 a[142:143], v7 offset:1024
v_mfma_f32_32x32x16_bf16 v[192:207], a[152:155], a[108:111], v[192:207]
buffer_load_dwordx4 a[76:79], v8, s[8:11], s30 offen offset:3072 sc1
v_mfma_f32_32x32x16_bf16 v[208:223], a[152:155], a[124:127], v[208:223]
s_add_u32 s31, s31, 0x20000
s_add_u32 m0, s32, 0xc000
s_nop 0
buffer_load_dwordx4 v10, s[12:15], s31 offen offset:0 lds
v_mfma_f32_32x32x16_bf16 v[224:239], a[156:159], a[108:111], v[224:239]
buffer_load_dwordx4 a[92:95], v9, s[8:11], s30 offen offset:3072 sc1
v_mfma_f32_32x32x16_bf16 v[240:255], a[156:159], a[124:127], v[240:255]
s_mov_b32 s33, 2
adaLN_cond__sliding_block_cached__swiglu_ffn__prompt_kernel_loop_30:
s_waitcnt lgkmcnt(0)
v_mfma_f32_32x32x16_bf16 v[128:143], a[128:131], a[0:3], v[128:143]
ds_read_b64_tr_b16 a[144:145], v4 offset:4096
ds_read_b64_tr_b16 a[146:147], v4 offset:5120
v_mfma_f32_32x32x16_bf16 v[144:159], a[128:131], a[16:19], v[144:159]
ds_read_b64_tr_b16 a[148:149], v5 offset:4096
ds_read_b64_tr_b16 a[150:151], v5 offset:5120
v_mfma_f32_32x32x16_bf16 v[160:175], a[132:135], a[0:3], v[160:175]
ds_read_b64_tr_b16 a[152:153], v6 offset:4096
ds_read_b64_tr_b16 a[154:155], v6 offset:5120
v_mfma_f32_32x32x16_bf16 v[176:191], a[132:135], a[16:19], v[176:191]
ds_read_b64_tr_b16 a[156:157], v7 offset:4096
ds_read_b64_tr_b16 a[158:159], v7 offset:5120
v_mfma_f32_32x32x16_bf16 v[192:207], a[136:139], a[0:3], v[192:207]
s_add_u32 s30, s30, 4096
buffer_load_dwordx4 a[96:99], v8, s[8:11], s30 offen offset:0 sc1
v_mfma_f32_32x32x16_bf16 v[208:223], a[136:139], a[16:19], v[208:223]
buffer_load_dwordx4 v11, s[12:15], s31 offen offset:1024 lds
v_mfma_f32_32x32x16_bf16 v[224:239], a[140:143], a[0:3], v[224:239]
buffer_load_dwordx4 a[112:115], v9, s[8:11], s30 offen offset:0 sc1
v_mfma_f32_32x32x16_bf16 v[240:255], a[140:143], a[16:19], v[240:255]
s_waitcnt lgkmcnt(0)
v_mfma_f32_32x32x16_bf16 v[128:143], a[144:147], a[4:7], v[128:143]
ds_read_b64_tr_b16 a[128:129], v4 offset:8192
ds_read_b64_tr_b16 a[130:131], v4 offset:9216
v_mfma_f32_32x32x16_bf16 v[144:159], a[144:147], a[20:23], v[144:159]
ds_read_b64_tr_b16 a[132:133], v5 offset:8192
ds_read_b64_tr_b16 a[134:135], v5 offset:9216
v_mfma_f32_32x32x16_bf16 v[160:175], a[148:151], a[4:7], v[160:175]
ds_read_b64_tr_b16 a[136:137], v6 offset:8192
ds_read_b64_tr_b16 a[138:139], v6 offset:9216
v_mfma_f32_32x32x16_bf16 v[176:191], a[148:151], a[20:23], v[176:191]
ds_read_b64_tr_b16 a[140:141], v7 offset:8192
ds_read_b64_tr_b16 a[142:143], v7 offset:9216
v_mfma_f32_32x32x16_bf16 v[192:207], a[152:155], a[4:7], v[192:207]
buffer_load_dwordx4 a[100:103], v8, s[8:11], s30 offen offset:1024 sc1
v_mfma_f32_32x32x16_bf16 v[208:223], a[152:155], a[20:23], v[208:223]
buffer_load_dwordx4 v12, s[12:15], s31 offen offset:2048 lds
v_mfma_f32_32x32x16_bf16 v[224:239], a[156:159], a[4:7], v[224:239]
buffer_load_dwordx4 a[116:119], v9, s[8:11], s30 offen offset:1024 sc1
v_mfma_f32_32x32x16_bf16 v[240:255], a[156:159], a[20:23], v[240:255]
s_waitcnt lgkmcnt(0)
v_mfma_f32_32x32x16_bf16 v[128:143], a[128:131], a[8:11], v[128:143]
ds_read_b64_tr_b16 a[144:145], v4 offset:12288
ds_read_b64_tr_b16 a[146:147], v4 offset:13312
v_mfma_f32_32x32x16_bf16 v[144:159], a[128:131], a[24:27], v[144:159]
ds_read_b64_tr_b16 a[148:149], v5 offset:12288
ds_read_b64_tr_b16 a[150:151], v5 offset:13312
v_mfma_f32_32x32x16_bf16 v[160:175], a[132:135], a[8:11], v[160:175]
ds_read_b64_tr_b16 a[152:153], v6 offset:12288
ds_read_b64_tr_b16 a[154:155], v6 offset:13312
v_mfma_f32_32x32x16_bf16 v[176:191], a[132:135], a[24:27], v[176:191]
ds_read_b64_tr_b16 a[156:157], v7 offset:12288
ds_read_b64_tr_b16 a[158:159], v7 offset:13312
v_mfma_f32_32x32x16_bf16 v[192:207], a[136:139], a[8:11], v[192:207]
buffer_load_dwordx4 a[104:107], v8, s[8:11], s30 offen offset:2048 sc1
v_mfma_f32_32x32x16_bf16 v[208:223], a[136:139], a[24:27], v[208:223]
buffer_load_dwordx4 v13, s[12:15], s31 offen offset:3072 lds
v_mfma_f32_32x32x16_bf16 v[224:239], a[140:143], a[8:11], v[224:239]
buffer_load_dwordx4 a[120:123], v9, s[8:11], s30 offen offset:2048 sc1
v_mfma_f32_32x32x16_bf16 v[240:255], a[140:143], a[24:27], v[240:255]
s_waitcnt vmcnt(24) lgkmcnt(0)
s_barrier
v_mfma_f32_32x32x16_bf16 v[128:143], a[144:147], a[12:15], v[128:143]
ds_read_b64_tr_b16 a[128:129], v4 offset:16384
ds_read_b64_tr_b16 a[130:131], v4 offset:17408
v_mfma_f32_32x32x16_bf16 v[144:159], a[144:147], a[28:31], v[144:159]
ds_read_b64_tr_b16 a[132:133], v5 offset:16384
ds_read_b64_tr_b16 a[134:135], v5 offset:17408
v_mfma_f32_32x32x16_bf16 v[160:175], a[148:151], a[12:15], v[160:175]
ds_read_b64_tr_b16 a[136:137], v6 offset:16384
ds_read_b64_tr_b16 a[138:139], v6 offset:17408
v_mfma_f32_32x32x16_bf16 v[176:191], a[148:151], a[28:31], v[176:191]
ds_read_b64_tr_b16 a[140:141], v7 offset:16384
ds_read_b64_tr_b16 a[142:143], v7 offset:17408
v_mfma_f32_32x32x16_bf16 v[192:207], a[152:155], a[12:15], v[192:207]
buffer_load_dwordx4 a[108:111], v8, s[8:11], s30 offen offset:3072 sc1
v_mfma_f32_32x32x16_bf16 v[208:223], a[152:155], a[28:31], v[208:223]
s_add_u32 s31, s31, 0x20000
s_add_u32 m0, s32, 0x0
s_nop 0
buffer_load_dwordx4 v10, s[12:15], s31 offen offset:0 lds
v_mfma_f32_32x32x16_bf16 v[224:239], a[156:159], a[12:15], v[224:239]
buffer_load_dwordx4 a[124:127], v9, s[8:11], s30 offen offset:3072 sc1
v_mfma_f32_32x32x16_bf16 v[240:255], a[156:159], a[28:31], v[240:255]
s_waitcnt lgkmcnt(0)
v_mfma_f32_32x32x16_bf16 v[128:143], a[128:131], a[32:35], v[128:143]
ds_read_b64_tr_b16 a[144:145], v4 offset:20480
ds_read_b64_tr_b16 a[146:147], v4 offset:21504
v_mfma_f32_32x32x16_bf16 v[144:159], a[128:131], a[48:51], v[144:159]
ds_read_b64_tr_b16 a[148:149], v5 offset:20480
ds_read_b64_tr_b16 a[150:151], v5 offset:21504
v_mfma_f32_32x32x16_bf16 v[160:175], a[132:135], a[32:35], v[160:175]
ds_read_b64_tr_b16 a[152:153], v6 offset:20480
ds_read_b64_tr_b16 a[154:155], v6 offset:21504
v_mfma_f32_32x32x16_bf16 v[176:191], a[132:135], a[48:51], v[176:191]
ds_read_b64_tr_b16 a[156:157], v7 offset:20480
ds_read_b64_tr_b16 a[158:159], v7 offset:21504
v_mfma_f32_32x32x16_bf16 v[192:207], a[136:139], a[32:35], v[192:207]
s_add_u32 s30, s30, 4096
buffer_load_dwordx4 a[0:3], v8, s[8:11], s30 offen offset:0 sc1
v_mfma_f32_32x32x16_bf16 v[208:223], a[136:139], a[48:51], v[208:223]
buffer_load_dwordx4 v11, s[12:15], s31 offen offset:1024 lds
v_mfma_f32_32x32x16_bf16 v[224:239], a[140:143], a[32:35], v[224:239]
buffer_load_dwordx4 a[16:19], v9, s[8:11], s30 offen offset:0 sc1
v_mfma_f32_32x32x16_bf16 v[240:255], a[140:143], a[48:51], v[240:255]
s_waitcnt lgkmcnt(0)
v_mfma_f32_32x32x16_bf16 v[128:143], a[144:147], a[36:39], v[128:143]
ds_read_b64_tr_b16 a[128:129], v4 offset:24576
ds_read_b64_tr_b16 a[130:131], v4 offset:25600
v_mfma_f32_32x32x16_bf16 v[144:159], a[144:147], a[52:55], v[144:159]
ds_read_b64_tr_b16 a[132:133], v5 offset:24576
ds_read_b64_tr_b16 a[134:135], v5 offset:25600
v_mfma_f32_32x32x16_bf16 v[160:175], a[148:151], a[36:39], v[160:175]
ds_read_b64_tr_b16 a[136:137], v6 offset:24576
ds_read_b64_tr_b16 a[138:139], v6 offset:25600
v_mfma_f32_32x32x16_bf16 v[176:191], a[148:151], a[52:55], v[176:191]
ds_read_b64_tr_b16 a[140:141], v7 offset:24576
ds_read_b64_tr_b16 a[142:143], v7 offset:25600
v_mfma_f32_32x32x16_bf16 v[192:207], a[152:155], a[36:39], v[192:207]
buffer_load_dwordx4 a[4:7], v8, s[8:11], s30 offen offset:1024 sc1
v_mfma_f32_32x32x16_bf16 v[208:223], a[152:155], a[52:55], v[208:223]
buffer_load_dwordx4 v12, s[12:15], s31 offen offset:2048 lds
v_mfma_f32_32x32x16_bf16 v[224:239], a[156:159], a[36:39], v[224:239]
buffer_load_dwordx4 a[20:23], v9, s[8:11], s30 offen offset:1024 sc1
v_mfma_f32_32x32x16_bf16 v[240:255], a[156:159], a[52:55], v[240:255]
s_waitcnt lgkmcnt(0)
v_mfma_f32_32x32x16_bf16 v[128:143], a[128:131], a[40:43], v[128:143]
ds_read_b64_tr_b16 a[144:145], v4 offset:28672
ds_read_b64_tr_b16 a[146:147], v4 offset:29696
v_mfma_f32_32x32x16_bf16 v[144:159], a[128:131], a[56:59], v[144:159]
ds_read_b64_tr_b16 a[148:149], v5 offset:28672
ds_read_b64_tr_b16 a[150:151], v5 offset:29696
v_mfma_f32_32x32x16_bf16 v[160:175], a[132:135], a[40:43], v[160:175]
ds_read_b64_tr_b16 a[152:153], v6 offset:28672
ds_read_b64_tr_b16 a[154:155], v6 offset:29696
v_mfma_f32_32x32x16_bf16 v[176:191], a[132:135], a[56:59], v[176:191]
ds_read_b64_tr_b16 a[156:157], v7 offset:28672
ds_read_b64_tr_b16 a[158:159], v7 offset:29696
v_mfma_f32_32x32x16_bf16 v[192:207], a[136:139], a[40:43], v[192:207]
buffer_load_dwordx4 a[8:11], v8, s[8:11], s30 offen offset:2048 sc1
v_mfma_f32_32x32x16_bf16 v[208:223], a[136:139], a[56:59], v[208:223]
buffer_load_dwordx4 v13, s[12:15], s31 offen offset:3072 lds
v_mfma_f32_32x32x16_bf16 v[224:239], a[140:143], a[40:43], v[224:239]
buffer_load_dwordx4 a[24:27], v9, s[8:11], s30 offen offset:2048 sc1
v_mfma_f32_32x32x16_bf16 v[240:255], a[140:143], a[56:59], v[240:255]
s_waitcnt vmcnt(24) lgkmcnt(0)
s_barrier
v_mfma_f32_32x32x16_bf16 v[128:143], a[144:147], a[44:47], v[128:143]
ds_read_b64_tr_b16 a[128:129], v4 offset:32768
ds_read_b64_tr_b16 a[130:131], v4 offset:33792
v_mfma_f32_32x32x16_bf16 v[144:159], a[144:147], a[60:63], v[144:159]
ds_read_b64_tr_b16 a[132:133], v5 offset:32768
ds_read_b64_tr_b16 a[134:135], v5 offset:33792
v_mfma_f32_32x32x16_bf16 v[160:175], a[148:151], a[44:47], v[160:175]
ds_read_b64_tr_b16 a[136:137], v6 offset:32768
ds_read_b64_tr_b16 a[138:139], v6 offset:33792
v_mfma_f32_32x32x16_bf16 v[176:191], a[148:151], a[60:63], v[176:191]
ds_read_b64_tr_b16 a[140:141], v7 offset:32768
ds_read_b64_tr_b16 a[142:143], v7 offset:33792
v_mfma_f32_32x32x16_bf16 v[192:207], a[152:155], a[44:47], v[192:207]
buffer_load_dwordx4 a[12:15], v8, s[8:11], s30 offen offset:3072 sc1
v_mfma_f32_32x32x16_bf16 v[208:223], a[152:155], a[60:63], v[208:223]
s_add_u32 s31, s31, 0x20000
s_add_u32 m0, s32, 0x4000
s_nop 0
buffer_load_dwordx4 v10, s[12:15], s31 offen offset:0 lds
v_mfma_f32_32x32x16_bf16 v[224:239], a[156:159], a[44:47], v[224:239]
buffer_load_dwordx4 a[28:31], v9, s[8:11], s30 offen offset:3072 sc1
v_mfma_f32_32x32x16_bf16 v[240:255], a[156:159], a[60:63], v[240:255]
s_waitcnt lgkmcnt(0)
v_mfma_f32_32x32x16_bf16 v[128:143], a[128:131], a[64:67], v[128:143]
ds_read_b64_tr_b16 a[144:145], v4 offset:36864
ds_read_b64_tr_b16 a[146:147], v4 offset:37888
v_mfma_f32_32x32x16_bf16 v[144:159], a[128:131], a[80:83], v[144:159]
ds_read_b64_tr_b16 a[148:149], v5 offset:36864
ds_read_b64_tr_b16 a[150:151], v5 offset:37888
v_mfma_f32_32x32x16_bf16 v[160:175], a[132:135], a[64:67], v[160:175]
ds_read_b64_tr_b16 a[152:153], v6 offset:36864
ds_read_b64_tr_b16 a[154:155], v6 offset:37888
v_mfma_f32_32x32x16_bf16 v[176:191], a[132:135], a[80:83], v[176:191]
ds_read_b64_tr_b16 a[156:157], v7 offset:36864
ds_read_b64_tr_b16 a[158:159], v7 offset:37888
v_mfma_f32_32x32x16_bf16 v[192:207], a[136:139], a[64:67], v[192:207]
s_add_u32 s30, s30, 4096
buffer_load_dwordx4 a[32:35], v8, s[8:11], s30 offen offset:0 sc1
v_mfma_f32_32x32x16_bf16 v[208:223], a[136:139], a[80:83], v[208:223]
buffer_load_dwordx4 v11, s[12:15], s31 offen offset:1024 lds
v_mfma_f32_32x32x16_bf16 v[224:239], a[140:143], a[64:67], v[224:239]
buffer_load_dwordx4 a[48:51], v9, s[8:11], s30 offen offset:0 sc1
v_mfma_f32_32x32x16_bf16 v[240:255], a[140:143], a[80:83], v[240:255]
s_waitcnt lgkmcnt(0)
v_mfma_f32_32x32x16_bf16 v[128:143], a[144:147], a[68:71], v[128:143]
ds_read_b64_tr_b16 a[128:129], v4 offset:40960
ds_read_b64_tr_b16 a[130:131], v4 offset:41984
v_mfma_f32_32x32x16_bf16 v[144:159], a[144:147], a[84:87], v[144:159]
ds_read_b64_tr_b16 a[132:133], v5 offset:40960
ds_read_b64_tr_b16 a[134:135], v5 offset:41984
v_mfma_f32_32x32x16_bf16 v[160:175], a[148:151], a[68:71], v[160:175]
ds_read_b64_tr_b16 a[136:137], v6 offset:40960
ds_read_b64_tr_b16 a[138:139], v6 offset:41984
v_mfma_f32_32x32x16_bf16 v[176:191], a[148:151], a[84:87], v[176:191]
ds_read_b64_tr_b16 a[140:141], v7 offset:40960
ds_read_b64_tr_b16 a[142:143], v7 offset:41984
v_mfma_f32_32x32x16_bf16 v[192:207], a[152:155], a[68:71], v[192:207]
buffer_load_dwordx4 a[36:39], v8, s[8:11], s30 offen offset:1024 sc1
v_mfma_f32_32x32x16_bf16 v[208:223], a[152:155], a[84:87], v[208:223]
buffer_load_dwordx4 v12, s[12:15], s31 offen offset:2048 lds
v_mfma_f32_32x32x16_bf16 v[224:239], a[156:159], a[68:71], v[224:239]
buffer_load_dwordx4 a[52:55], v9, s[8:11], s30 offen offset:1024 sc1
v_mfma_f32_32x32x16_bf16 v[240:255], a[156:159], a[84:87], v[240:255]
s_waitcnt lgkmcnt(0)
v_mfma_f32_32x32x16_bf16 v[128:143], a[128:131], a[72:75], v[128:143]
ds_read_b64_tr_b16 a[144:145], v4 offset:45056
ds_read_b64_tr_b16 a[146:147], v4 offset:46080
v_mfma_f32_32x32x16_bf16 v[144:159], a[128:131], a[88:91], v[144:159]
ds_read_b64_tr_b16 a[148:149], v5 offset:45056
ds_read_b64_tr_b16 a[150:151], v5 offset:46080
v_mfma_f32_32x32x16_bf16 v[160:175], a[132:135], a[72:75], v[160:175]
ds_read_b64_tr_b16 a[152:153], v6 offset:45056
ds_read_b64_tr_b16 a[154:155], v6 offset:46080
v_mfma_f32_32x32x16_bf16 v[176:191], a[132:135], a[88:91], v[176:191]
ds_read_b64_tr_b16 a[156:157], v7 offset:45056
ds_read_b64_tr_b16 a[158:159], v7 offset:46080
v_mfma_f32_32x32x16_bf16 v[192:207], a[136:139], a[72:75], v[192:207]
buffer_load_dwordx4 a[40:43], v8, s[8:11], s30 offen offset:2048 sc1
v_mfma_f32_32x32x16_bf16 v[208:223], a[136:139], a[88:91], v[208:223]
buffer_load_dwordx4 v13, s[12:15], s31 offen offset:3072 lds
v_mfma_f32_32x32x16_bf16 v[224:239], a[140:143], a[72:75], v[224:239]
buffer_load_dwordx4 a[56:59], v9, s[8:11], s30 offen offset:2048 sc1
v_mfma_f32_32x32x16_bf16 v[240:255], a[140:143], a[88:91], v[240:255]
s_waitcnt vmcnt(24) lgkmcnt(0)
s_barrier
v_mfma_f32_32x32x16_bf16 v[128:143], a[144:147], a[76:79], v[128:143]
ds_read_b64_tr_b16 a[128:129], v4 offset:49152
ds_read_b64_tr_b16 a[130:131], v4 offset:50176
v_mfma_f32_32x32x16_bf16 v[144:159], a[144:147], a[92:95], v[144:159]
ds_read_b64_tr_b16 a[132:133], v5 offset:49152
ds_read_b64_tr_b16 a[134:135], v5 offset:50176
v_mfma_f32_32x32x16_bf16 v[160:175], a[148:151], a[76:79], v[160:175]
ds_read_b64_tr_b16 a[136:137], v6 offset:49152
ds_read_b64_tr_b16 a[138:139], v6 offset:50176
v_mfma_f32_32x32x16_bf16 v[176:191], a[148:151], a[92:95], v[176:191]
ds_read_b64_tr_b16 a[140:141], v7 offset:49152
ds_read_b64_tr_b16 a[142:143], v7 offset:50176
v_mfma_f32_32x32x16_bf16 v[192:207], a[152:155], a[76:79], v[192:207]
buffer_load_dwordx4 a[44:47], v8, s[8:11], s30 offen offset:3072 sc1
v_mfma_f32_32x32x16_bf16 v[208:223], a[152:155], a[92:95], v[208:223]
s_add_u32 s31, s31, 0x20000
s_add_u32 m0, s32, 0x8000
s_nop 0
buffer_load_dwordx4 v10, s[12:15], s31 offen offset:0 lds
v_mfma_f32_32x32x16_bf16 v[224:239], a[156:159], a[76:79], v[224:239]
buffer_load_dwordx4 a[60:63], v9, s[8:11], s30 offen offset:3072 sc1
v_mfma_f32_32x32x16_bf16 v[240:255], a[156:159], a[92:95], v[240:255]
s_waitcnt lgkmcnt(0)
v_mfma_f32_32x32x16_bf16 v[128:143], a[128:131], a[96:99], v[128:143]
ds_read_b64_tr_b16 a[144:145], v4 offset:53248
ds_read_b64_tr_b16 a[146:147], v4 offset:54272
v_mfma_f32_32x32x16_bf16 v[144:159], a[128:131], a[112:115], v[144:159]
ds_read_b64_tr_b16 a[148:149], v5 offset:53248
ds_read_b64_tr_b16 a[150:151], v5 offset:54272
v_mfma_f32_32x32x16_bf16 v[160:175], a[132:135], a[96:99], v[160:175]
ds_read_b64_tr_b16 a[152:153], v6 offset:53248
ds_read_b64_tr_b16 a[154:155], v6 offset:54272
v_mfma_f32_32x32x16_bf16 v[176:191], a[132:135], a[112:115], v[176:191]
ds_read_b64_tr_b16 a[156:157], v7 offset:53248
ds_read_b64_tr_b16 a[158:159], v7 offset:54272
v_mfma_f32_32x32x16_bf16 v[192:207], a[136:139], a[96:99], v[192:207]
s_add_u32 s30, s30, 4096
buffer_load_dwordx4 a[64:67], v8, s[8:11], s30 offen offset:0 sc1
v_mfma_f32_32x32x16_bf16 v[208:223], a[136:139], a[112:115], v[208:223]
buffer_load_dwordx4 v11, s[12:15], s31 offen offset:1024 lds
v_mfma_f32_32x32x16_bf16 v[224:239], a[140:143], a[96:99], v[224:239]
buffer_load_dwordx4 a[80:83], v9, s[8:11], s30 offen offset:0 sc1
v_mfma_f32_32x32x16_bf16 v[240:255], a[140:143], a[112:115], v[240:255]
s_waitcnt lgkmcnt(0)
v_mfma_f32_32x32x16_bf16 v[128:143], a[144:147], a[100:103], v[128:143]
ds_read_b64_tr_b16 a[128:129], v4 offset:57344
ds_read_b64_tr_b16 a[130:131], v4 offset:58368
v_mfma_f32_32x32x16_bf16 v[144:159], a[144:147], a[116:119], v[144:159]
ds_read_b64_tr_b16 a[132:133], v5 offset:57344
ds_read_b64_tr_b16 a[134:135], v5 offset:58368
v_mfma_f32_32x32x16_bf16 v[160:175], a[148:151], a[100:103], v[160:175]
ds_read_b64_tr_b16 a[136:137], v6 offset:57344
ds_read_b64_tr_b16 a[138:139], v6 offset:58368
v_mfma_f32_32x32x16_bf16 v[176:191], a[148:151], a[116:119], v[176:191]
ds_read_b64_tr_b16 a[140:141], v7 offset:57344
ds_read_b64_tr_b16 a[142:143], v7 offset:58368
v_mfma_f32_32x32x16_bf16 v[192:207], a[152:155], a[100:103], v[192:207]
buffer_load_dwordx4 a[68:71], v8, s[8:11], s30 offen offset:1024 sc1
v_mfma_f32_32x32x16_bf16 v[208:223], a[152:155], a[116:119], v[208:223]
buffer_load_dwordx4 v12, s[12:15], s31 offen offset:2048 lds
v_mfma_f32_32x32x16_bf16 v[224:239], a[156:159], a[100:103], v[224:239]
buffer_load_dwordx4 a[84:87], v9, s[8:11], s30 offen offset:1024 sc1
v_mfma_f32_32x32x16_bf16 v[240:255], a[156:159], a[116:119], v[240:255]
s_waitcnt lgkmcnt(0)
v_mfma_f32_32x32x16_bf16 v[128:143], a[128:131], a[104:107], v[128:143]
ds_read_b64_tr_b16 a[144:145], v4 offset:61440
ds_read_b64_tr_b16 a[146:147], v4 offset:62464
v_mfma_f32_32x32x16_bf16 v[144:159], a[128:131], a[120:123], v[144:159]
ds_read_b64_tr_b16 a[148:149], v5 offset:61440
ds_read_b64_tr_b16 a[150:151], v5 offset:62464
v_mfma_f32_32x32x16_bf16 v[160:175], a[132:135], a[104:107], v[160:175]
ds_read_b64_tr_b16 a[152:153], v6 offset:61440
ds_read_b64_tr_b16 a[154:155], v6 offset:62464
v_mfma_f32_32x32x16_bf16 v[176:191], a[132:135], a[120:123], v[176:191]
ds_read_b64_tr_b16 a[156:157], v7 offset:61440
ds_read_b64_tr_b16 a[158:159], v7 offset:62464
v_mfma_f32_32x32x16_bf16 v[192:207], a[136:139], a[104:107], v[192:207]
buffer_load_dwordx4 a[72:75], v8, s[8:11], s30 offen offset:2048 sc1
v_mfma_f32_32x32x16_bf16 v[208:223], a[136:139], a[120:123], v[208:223]
buffer_load_dwordx4 v13, s[12:15], s31 offen offset:3072 lds
v_mfma_f32_32x32x16_bf16 v[224:239], a[140:143], a[104:107], v[224:239]
buffer_load_dwordx4 a[88:91], v9, s[8:11], s30 offen offset:2048 sc1
v_mfma_f32_32x32x16_bf16 v[240:255], a[140:143], a[120:123], v[240:255]
s_waitcnt vmcnt(24) lgkmcnt(0)
s_barrier
v_mfma_f32_32x32x16_bf16 v[128:143], a[144:147], a[108:111], v[128:143]
ds_read_b64_tr_b16 a[128:129], v4 offset:0
ds_read_b64_tr_b16 a[130:131], v4 offset:1024
v_mfma_f32_32x32x16_bf16 v[144:159], a[144:147], a[124:127], v[144:159]
ds_read_b64_tr_b16 a[132:133], v5 offset:0
ds_read_b64_tr_b16 a[134:135], v5 offset:1024
v_mfma_f32_32x32x16_bf16 v[160:175], a[148:151], a[108:111], v[160:175]
ds_read_b64_tr_b16 a[136:137], v6 offset:0
ds_read_b64_tr_b16 a[138:139], v6 offset:1024
v_mfma_f32_32x32x16_bf16 v[176:191], a[148:151], a[124:127], v[176:191]
ds_read_b64_tr_b16 a[140:141], v7 offset:0
ds_read_b64_tr_b16 a[142:143], v7 offset:1024
v_mfma_f32_32x32x16_bf16 v[192:207], a[152:155], a[108:111], v[192:207]
buffer_load_dwordx4 a[76:79], v8, s[8:11], s30 offen offset:3072 sc1
v_mfma_f32_32x32x16_bf16 v[208:223], a[152:155], a[124:127], v[208:223]
s_add_u32 s31, s31, 0x20000
s_add_u32 m0, s32, 0xc000
s_nop 0
buffer_load_dwordx4 v10, s[12:15], s31 offen offset:0 lds
v_mfma_f32_32x32x16_bf16 v[224:239], a[156:159], a[108:111], v[224:239]
buffer_load_dwordx4 a[92:95], v9, s[8:11], s30 offen offset:3072 sc1
v_mfma_f32_32x32x16_bf16 v[240:255], a[156:159], a[124:127], v[240:255]
s_sub_u32 s33, s33, 1
s_cmp_lg_u32 s33, 0
s_cbranch_scc1 adaLN_cond__sliding_block_cached__swiglu_ffn__prompt_kernel_loop_30
s_waitcnt lgkmcnt(0)
v_mfma_f32_32x32x16_bf16 v[128:143], a[128:131], a[0:3], v[128:143]
ds_read_b64_tr_b16 a[144:145], v4 offset:4096
ds_read_b64_tr_b16 a[146:147], v4 offset:5120
v_mfma_f32_32x32x16_bf16 v[144:159], a[128:131], a[16:19], v[144:159]
ds_read_b64_tr_b16 a[148:149], v5 offset:4096
ds_read_b64_tr_b16 a[150:151], v5 offset:5120
v_mfma_f32_32x32x16_bf16 v[160:175], a[132:135], a[0:3], v[160:175]
ds_read_b64_tr_b16 a[152:153], v6 offset:4096
ds_read_b64_tr_b16 a[154:155], v6 offset:5120
v_mfma_f32_32x32x16_bf16 v[176:191], a[132:135], a[16:19], v[176:191]
ds_read_b64_tr_b16 a[156:157], v7 offset:4096
ds_read_b64_tr_b16 a[158:159], v7 offset:5120
v_mfma_f32_32x32x16_bf16 v[192:207], a[136:139], a[0:3], v[192:207]
s_add_u32 s30, s30, 4096
buffer_load_dwordx4 a[96:99], v8, s[8:11], s30 offen offset:0 sc1
v_mfma_f32_32x32x16_bf16 v[208:223], a[136:139], a[16:19], v[208:223]
buffer_load_dwordx4 v11, s[12:15], s31 offen offset:1024 lds
v_mfma_f32_32x32x16_bf16 v[224:239], a[140:143], a[0:3], v[224:239]
buffer_load_dwordx4 a[112:115], v9, s[8:11], s30 offen offset:0 sc1
v_mfma_f32_32x32x16_bf16 v[240:255], a[140:143], a[16:19], v[240:255]
s_waitcnt lgkmcnt(0)
v_mfma_f32_32x32x16_bf16 v[128:143], a[144:147], a[4:7], v[128:143]
ds_read_b64_tr_b16 a[128:129], v4 offset:8192
ds_read_b64_tr_b16 a[130:131], v4 offset:9216
v_mfma_f32_32x32x16_bf16 v[144:159], a[144:147], a[20:23], v[144:159]
ds_read_b64_tr_b16 a[132:133], v5 offset:8192
ds_read_b64_tr_b16 a[134:135], v5 offset:9216
v_mfma_f32_32x32x16_bf16 v[160:175], a[148:151], a[4:7], v[160:175]
ds_read_b64_tr_b16 a[136:137], v6 offset:8192
ds_read_b64_tr_b16 a[138:139], v6 offset:9216
v_mfma_f32_32x32x16_bf16 v[176:191], a[148:151], a[20:23], v[176:191]
ds_read_b64_tr_b16 a[140:141], v7 offset:8192
ds_read_b64_tr_b16 a[142:143], v7 offset:9216
v_mfma_f32_32x32x16_bf16 v[192:207], a[152:155], a[4:7], v[192:207]
buffer_load_dwordx4 a[100:103], v8, s[8:11], s30 offen offset:1024 sc1
v_mfma_f32_32x32x16_bf16 v[208:223], a[152:155], a[20:23], v[208:223]
buffer_load_dwordx4 v12, s[12:15], s31 offen offset:2048 lds
v_mfma_f32_32x32x16_bf16 v[224:239], a[156:159], a[4:7], v[224:239]
buffer_load_dwordx4 a[116:119], v9, s[8:11], s30 offen offset:1024 sc1
v_mfma_f32_32x32x16_bf16 v[240:255], a[156:159], a[20:23], v[240:255]
s_waitcnt lgkmcnt(0)
v_mfma_f32_32x32x16_bf16 v[128:143], a[128:131], a[8:11], v[128:143]
ds_read_b64_tr_b16 a[144:145], v4 offset:12288
ds_read_b64_tr_b16 a[146:147], v4 offset:13312
v_mfma_f32_32x32x16_bf16 v[144:159], a[128:131], a[24:27], v[144:159]
ds_read_b64_tr_b16 a[148:149], v5 offset:12288
ds_read_b64_tr_b16 a[150:151], v5 offset:13312
v_mfma_f32_32x32x16_bf16 v[160:175], a[132:135], a[8:11], v[160:175]
ds_read_b64_tr_b16 a[152:153], v6 offset:12288
ds_read_b64_tr_b16 a[154:155], v6 offset:13312
v_mfma_f32_32x32x16_bf16 v[176:191], a[132:135], a[24:27], v[176:191]
ds_read_b64_tr_b16 a[156:157], v7 offset:12288
ds_read_b64_tr_b16 a[158:159], v7 offset:13312
v_mfma_f32_32x32x16_bf16 v[192:207], a[136:139], a[8:11], v[192:207]
buffer_load_dwordx4 a[104:107], v8, s[8:11], s30 offen offset:2048 sc1
v_mfma_f32_32x32x16_bf16 v[208:223], a[136:139], a[24:27], v[208:223]
buffer_load_dwordx4 v13, s[12:15], s31 offen offset:3072 lds
v_mfma_f32_32x32x16_bf16 v[224:239], a[140:143], a[8:11], v[224:239]
buffer_load_dwordx4 a[120:123], v9, s[8:11], s30 offen offset:2048 sc1
v_mfma_f32_32x32x16_bf16 v[240:255], a[140:143], a[24:27], v[240:255]
s_waitcnt vmcnt(9) lgkmcnt(0)
s_barrier
v_mfma_f32_32x32x16_bf16 v[128:143], a[144:147], a[12:15], v[128:143]
ds_read_b64_tr_b16 a[128:129], v4 offset:16384
ds_read_b64_tr_b16 a[130:131], v4 offset:17408
v_mfma_f32_32x32x16_bf16 v[144:159], a[144:147], a[28:31], v[144:159]
ds_read_b64_tr_b16 a[132:133], v4 offset:20480
ds_read_b64_tr_b16 a[134:135], v4 offset:21504
v_mfma_f32_32x32x16_bf16 v[160:175], a[148:151], a[12:15], v[160:175]
ds_read_b64_tr_b16 a[136:137], v4 offset:24576
ds_read_b64_tr_b16 a[138:139], v4 offset:25600
v_mfma_f32_32x32x16_bf16 v[176:191], a[148:151], a[28:31], v[176:191]
ds_read_b64_tr_b16 a[140:141], v4 offset:28672
ds_read_b64_tr_b16 a[142:143], v4 offset:29696
v_mfma_f32_32x32x16_bf16 v[192:207], a[152:155], a[12:15], v[192:207]
buffer_load_dwordx4 a[108:111], v8, s[8:11], s30 offen offset:3072 sc1
v_mfma_f32_32x32x16_bf16 v[208:223], a[152:155], a[28:31], v[208:223]
v_mfma_f32_32x32x16_bf16 v[224:239], a[156:159], a[12:15], v[224:239]
buffer_load_dwordx4 a[124:127], v9, s[8:11], s30 offen offset:3072 sc1
v_mfma_f32_32x32x16_bf16 v[240:255], a[156:159], a[28:31], v[240:255]
s_waitcnt lgkmcnt(6)
v_mfma_f32_32x32x16_bf16 v[128:143], a[128:131], a[32:35], v[128:143]
ds_read_b64_tr_b16 a[144:145], v4 offset:32768
v_mfma_f32_32x32x16_bf16 v[144:159], a[128:131], a[48:51], v[144:159]
ds_read_b64_tr_b16 a[146:147], v4 offset:33792
s_waitcnt lgkmcnt(6)
v_mfma_f32_32x32x16_bf16 v[128:143], a[132:135], a[36:39], v[128:143]
ds_read_b64_tr_b16 a[148:149], v4 offset:36864
v_mfma_f32_32x32x16_bf16 v[144:159], a[132:135], a[52:55], v[144:159]
ds_read_b64_tr_b16 a[150:151], v4 offset:37888
s_waitcnt lgkmcnt(6)
v_mfma_f32_32x32x16_bf16 v[128:143], a[136:139], a[40:43], v[128:143]
ds_read_b64_tr_b16 a[152:153], v4 offset:40960
v_mfma_f32_32x32x16_bf16 v[144:159], a[136:139], a[56:59], v[144:159]
ds_read_b64_tr_b16 a[154:155], v4 offset:41984
s_waitcnt lgkmcnt(6)
v_mfma_f32_32x32x16_bf16 v[128:143], a[140:143], a[44:47], v[128:143]
ds_read_b64_tr_b16 a[156:157], v4 offset:45056
v_mfma_f32_32x32x16_bf16 v[144:159], a[140:143], a[60:63], v[144:159]
ds_read_b64_tr_b16 a[158:159], v4 offset:46080
s_waitcnt vmcnt(0)
s_barrier
s_waitcnt lgkmcnt(6)
v_mfma_f32_32x32x16_bf16 v[128:143], a[144:147], a[64:67], v[128:143]
ds_read_b64_tr_b16 a[128:129], v4 offset:49152
v_mfma_f32_32x32x16_bf16 v[144:159], a[144:147], a[80:83], v[144:159]
ds_read_b64_tr_b16 a[130:131], v4 offset:50176
s_waitcnt lgkmcnt(6)
v_mfma_f32_32x32x16_bf16 v[128:143], a[148:151], a[68:71], v[128:143]
ds_read_b64_tr_b16 a[132:133], v4 offset:53248
v_mfma_f32_32x32x16_bf16 v[144:159], a[148:151], a[84:87], v[144:159]
ds_read_b64_tr_b16 a[134:135], v4 offset:54272
s_waitcnt lgkmcnt(6)
v_mfma_f32_32x32x16_bf16 v[128:143], a[152:155], a[72:75], v[128:143]
ds_read_b64_tr_b16 a[136:137], v4 offset:57344
v_mfma_f32_32x32x16_bf16 v[144:159], a[152:155], a[88:91], v[144:159]
ds_read_b64_tr_b16 a[138:139], v4 offset:58368
s_waitcnt lgkmcnt(6)
v_mfma_f32_32x32x16_bf16 v[128:143], a[156:159], a[76:79], v[128:143]
ds_read_b64_tr_b16 a[140:141], v4 offset:61440
v_mfma_f32_32x32x16_bf16 v[144:159], a[156:159], a[92:95], v[144:159]
ds_read_b64_tr_b16 a[142:143], v4 offset:62464
s_waitcnt lgkmcnt(6)
v_mfma_f32_32x32x16_bf16 v[128:143], a[128:131], a[96:99], v[128:143]
ds_read_b64_tr_b16 a[144:145], v5 offset:16384
v_mfma_f32_32x32x16_bf16 v[144:159], a[128:131], a[112:115], v[144:159]
ds_read_b64_tr_b16 a[146:147], v5 offset:17408
s_waitcnt lgkmcnt(6)
v_mfma_f32_32x32x16_bf16 v[128:143], a[132:135], a[100:103], v[128:143]
ds_read_b64_tr_b16 a[148:149], v5 offset:20480
v_mfma_f32_32x32x16_bf16 v[144:159], a[132:135], a[116:119], v[144:159]
ds_read_b64_tr_b16 a[150:151], v5 offset:21504
s_waitcnt lgkmcnt(6)
v_mfma_f32_32x32x16_bf16 v[128:143], a[136:139], a[104:107], v[128:143]
ds_read_b64_tr_b16 a[152:153], v5 offset:24576
v_mfma_f32_32x32x16_bf16 v[144:159], a[136:139], a[120:123], v[144:159]
ds_read_b64_tr_b16 a[154:155], v5 offset:25600
s_waitcnt lgkmcnt(6)
v_mfma_f32_32x32x16_bf16 v[128:143], a[140:143], a[108:111], v[128:143]
ds_read_b64_tr_b16 a[156:157], v5 offset:28672
v_mfma_f32_32x32x16_bf16 v[144:159], a[140:143], a[124:127], v[144:159]
ds_read_b64_tr_b16 a[158:159], v5 offset:29696
s_waitcnt lgkmcnt(6)
v_mfma_f32_32x32x16_bf16 v[160:175], a[144:147], a[32:35], v[160:175]
ds_read_b64_tr_b16 a[128:129], v5 offset:32768
v_mfma_f32_32x32x16_bf16 v[176:191], a[144:147], a[48:51], v[176:191]
ds_read_b64_tr_b16 a[130:131], v5 offset:33792
s_waitcnt lgkmcnt(6)
v_mfma_f32_32x32x16_bf16 v[160:175], a[148:151], a[36:39], v[160:175]
ds_read_b64_tr_b16 a[132:133], v5 offset:36864
v_mfma_f32_32x32x16_bf16 v[176:191], a[148:151], a[52:55], v[176:191]
ds_read_b64_tr_b16 a[134:135], v5 offset:37888
s_waitcnt lgkmcnt(6)
v_mfma_f32_32x32x16_bf16 v[160:175], a[152:155], a[40:43], v[160:175]
ds_read_b64_tr_b16 a[136:137], v5 offset:40960
v_cvt_pk_bf16_f32 v16, v128, v129
v_mfma_f32_32x32x16_bf16 v[176:191], a[152:155], a[56:59], v[176:191]
ds_read_b64_tr_b16 a[138:139], v5 offset:41984
v_cvt_pk_bf16_f32 v17, v130, v131
s_waitcnt lgkmcnt(6)
v_mfma_f32_32x32x16_bf16 v[160:175], a[156:159], a[44:47], v[160:175]
ds_read_b64_tr_b16 a[140:141], v5 offset:45056
v_cvt_pk_bf16_f32 v18, v132, v133
v_mfma_f32_32x32x16_bf16 v[176:191], a[156:159], a[60:63], v[176:191]
ds_read_b64_tr_b16 a[142:143], v5 offset:46080
v_cvt_pk_bf16_f32 v19, v134, v135
s_waitcnt lgkmcnt(6)
v_mfma_f32_32x32x16_bf16 v[160:175], a[128:131], a[64:67], v[160:175]
ds_read_b64_tr_b16 a[144:145], v5 offset:49152
buffer_store_dwordx4 v[16:19], v8, s[16:19], s36 offen offset:0 sc1
v_mfma_f32_32x32x16_bf16 v[176:191], a[128:131], a[80:83], v[176:191]
ds_read_b64_tr_b16 a[146:147], v5 offset:50176
v_cvt_pk_bf16_f32 v20, v136, v137
s_waitcnt lgkmcnt(6)
v_mfma_f32_32x32x16_bf16 v[160:175], a[132:135], a[68:71], v[160:175]
ds_read_b64_tr_b16 a[148:149], v5 offset:53248
v_cvt_pk_bf16_f32 v21, v138, v139
v_mfma_f32_32x32x16_bf16 v[176:191], a[132:135], a[84:87], v[176:191]
ds_read_b64_tr_b16 a[150:151], v5 offset:54272
v_cvt_pk_bf16_f32 v22, v140, v141
s_waitcnt lgkmcnt(6)
v_mfma_f32_32x32x16_bf16 v[160:175], a[136:139], a[72:75], v[160:175]
ds_read_b64_tr_b16 a[152:153], v5 offset:57344
v_cvt_pk_bf16_f32 v23, v142, v143
v_mfma_f32_32x32x16_bf16 v[176:191], a[136:139], a[88:91], v[176:191]
ds_read_b64_tr_b16 a[154:155], v5 offset:58368
buffer_store_dwordx4 v[20:23], v8, s[16:19], s36 offen offset:1024 sc1
s_waitcnt lgkmcnt(6)
v_mfma_f32_32x32x16_bf16 v[160:175], a[140:143], a[76:79], v[160:175]
ds_read_b64_tr_b16 a[156:157], v5 offset:61440
v_cvt_pk_bf16_f32 v24, v144, v145
v_mfma_f32_32x32x16_bf16 v[176:191], a[140:143], a[92:95], v[176:191]
ds_read_b64_tr_b16 a[158:159], v5 offset:62464
v_cvt_pk_bf16_f32 v25, v146, v147
s_waitcnt lgkmcnt(6)
v_mfma_f32_32x32x16_bf16 v[160:175], a[144:147], a[96:99], v[160:175]
ds_read_b64_tr_b16 a[128:129], v6 offset:16384
v_cvt_pk_bf16_f32 v26, v148, v149
v_mfma_f32_32x32x16_bf16 v[176:191], a[144:147], a[112:115], v[176:191]
ds_read_b64_tr_b16 a[130:131], v6 offset:17408
v_cvt_pk_bf16_f32 v27, v150, v151
s_waitcnt lgkmcnt(6)
v_mfma_f32_32x32x16_bf16 v[160:175], a[148:151], a[100:103], v[160:175]
ds_read_b64_tr_b16 a[132:133], v6 offset:20480
buffer_store_dwordx4 v[24:27], v8, s[16:19], s37 offen offset:0 sc1
v_mfma_f32_32x32x16_bf16 v[176:191], a[148:151], a[116:119], v[176:191]
ds_read_b64_tr_b16 a[134:135], v6 offset:21504
v_cvt_pk_bf16_f32 v28, v152, v153
s_waitcnt lgkmcnt(6)
v_mfma_f32_32x32x16_bf16 v[160:175], a[152:155], a[104:107], v[160:175]
ds_read_b64_tr_b16 a[136:137], v6 offset:24576
v_cvt_pk_bf16_f32 v29, v154, v155
v_mfma_f32_32x32x16_bf16 v[176:191], a[152:155], a[120:123], v[176:191]
ds_read_b64_tr_b16 a[138:139], v6 offset:25600
v_cvt_pk_bf16_f32 v30, v156, v157
s_waitcnt lgkmcnt(6)
v_mfma_f32_32x32x16_bf16 v[160:175], a[156:159], a[108:111], v[160:175]
ds_read_b64_tr_b16 a[140:141], v6 offset:28672
v_cvt_pk_bf16_f32 v31, v158, v159
v_mfma_f32_32x32x16_bf16 v[176:191], a[156:159], a[124:127], v[176:191]
ds_read_b64_tr_b16 a[142:143], v6 offset:29696
buffer_store_dwordx4 v[28:31], v8, s[16:19], s37 offen offset:1024 sc1
s_waitcnt lgkmcnt(6)
v_mfma_f32_32x32x16_bf16 v[192:207], a[128:131], a[32:35], v[192:207]
ds_read_b64_tr_b16 a[144:145], v6 offset:32768
v_mfma_f32_32x32x16_bf16 v[208:223], a[128:131], a[48:51], v[208:223]
ds_read_b64_tr_b16 a[146:147], v6 offset:33792
s_waitcnt lgkmcnt(6)
v_mfma_f32_32x32x16_bf16 v[192:207], a[132:135], a[36:39], v[192:207]
ds_read_b64_tr_b16 a[148:149], v6 offset:36864
v_mfma_f32_32x32x16_bf16 v[208:223], a[132:135], a[52:55], v[208:223]
ds_read_b64_tr_b16 a[150:151], v6 offset:37888
s_waitcnt lgkmcnt(6)
v_mfma_f32_32x32x16_bf16 v[192:207], a[136:139], a[40:43], v[192:207]
ds_read_b64_tr_b16 a[152:153], v6 offset:40960
v_cvt_pk_bf16_f32 v32, v160, v161
v_mfma_f32_32x32x16_bf16 v[208:223], a[136:139], a[56:59], v[208:223]
ds_read_b64_tr_b16 a[154:155], v6 offset:41984
v_cvt_pk_bf16_f32 v33, v162, v163
s_waitcnt lgkmcnt(6)
v_mfma_f32_32x32x16_bf16 v[192:207], a[140:143], a[44:47], v[192:207]
ds_read_b64_tr_b16 a[156:157], v6 offset:45056
v_cvt_pk_bf16_f32 v34, v164, v165
v_mfma_f32_32x32x16_bf16 v[208:223], a[140:143], a[60:63], v[208:223]
ds_read_b64_tr_b16 a[158:159], v6 offset:46080
v_cvt_pk_bf16_f32 v35, v166, v167
s_waitcnt lgkmcnt(6)
v_mfma_f32_32x32x16_bf16 v[192:207], a[144:147], a[64:67], v[192:207]
ds_read_b64_tr_b16 a[128:129], v6 offset:49152
buffer_store_dwordx4 v[32:35], v8, s[16:19], s36 offen offset:2048 sc1
v_mfma_f32_32x32x16_bf16 v[208:223], a[144:147], a[80:83], v[208:223]
ds_read_b64_tr_b16 a[130:131], v6 offset:50176
v_cvt_pk_bf16_f32 v36, v168, v169
s_waitcnt lgkmcnt(6)
v_mfma_f32_32x32x16_bf16 v[192:207], a[148:151], a[68:71], v[192:207]
ds_read_b64_tr_b16 a[132:133], v6 offset:53248
v_cvt_pk_bf16_f32 v37, v170, v171
v_mfma_f32_32x32x16_bf16 v[208:223], a[148:151], a[84:87], v[208:223]
ds_read_b64_tr_b16 a[134:135], v6 offset:54272
v_cvt_pk_bf16_f32 v38, v172, v173
s_waitcnt lgkmcnt(6)
v_mfma_f32_32x32x16_bf16 v[192:207], a[152:155], a[72:75], v[192:207]
ds_read_b64_tr_b16 a[136:137], v6 offset:57344
v_cvt_pk_bf16_f32 v39, v174, v175
v_mfma_f32_32x32x16_bf16 v[208:223], a[152:155], a[88:91], v[208:223]
ds_read_b64_tr_b16 a[138:139], v6 offset:58368
buffer_store_dwordx4 v[36:39], v8, s[16:19], s36 offen offset:3072 sc1
s_waitcnt lgkmcnt(6)
v_mfma_f32_32x32x16_bf16 v[192:207], a[156:159], a[76:79], v[192:207]
ds_read_b64_tr_b16 a[140:141], v6 offset:61440
v_cvt_pk_bf16_f32 v40, v176, v177
v_mfma_f32_32x32x16_bf16 v[208:223], a[156:159], a[92:95], v[208:223]
ds_read_b64_tr_b16 a[142:143], v6 offset:62464
v_cvt_pk_bf16_f32 v41, v178, v179
s_waitcnt lgkmcnt(6)
v_mfma_f32_32x32x16_bf16 v[192:207], a[128:131], a[96:99], v[192:207]
ds_read_b64_tr_b16 a[144:145], v7 offset:16384
v_cvt_pk_bf16_f32 v42, v180, v181
v_mfma_f32_32x32x16_bf16 v[208:223], a[128:131], a[112:115], v[208:223]
ds_read_b64_tr_b16 a[146:147], v7 offset:17408
v_cvt_pk_bf16_f32 v43, v182, v183
s_waitcnt lgkmcnt(6)
v_mfma_f32_32x32x16_bf16 v[192:207], a[132:135], a[100:103], v[192:207]
ds_read_b64_tr_b16 a[148:149], v7 offset:20480
buffer_store_dwordx4 v[40:43], v8, s[16:19], s37 offen offset:2048 sc1
v_mfma_f32_32x32x16_bf16 v[208:223], a[132:135], a[116:119], v[208:223]
ds_read_b64_tr_b16 a[150:151], v7 offset:21504
v_cvt_pk_bf16_f32 v44, v184, v185
s_waitcnt lgkmcnt(6)
v_mfma_f32_32x32x16_bf16 v[192:207], a[136:139], a[104:107], v[192:207]
ds_read_b64_tr_b16 a[152:153], v7 offset:24576
v_cvt_pk_bf16_f32 v45, v186, v187
v_mfma_f32_32x32x16_bf16 v[208:223], a[136:139], a[120:123], v[208:223]
ds_read_b64_tr_b16 a[154:155], v7 offset:25600
v_cvt_pk_bf16_f32 v46, v188, v189
s_waitcnt lgkmcnt(6)
v_mfma_f32_32x32x16_bf16 v[192:207], a[140:143], a[108:111], v[192:207]
ds_read_b64_tr_b16 a[156:157], v7 offset:28672
v_cvt_pk_bf16_f32 v47, v190, v191
v_mfma_f32_32x32x16_bf16 v[208:223], a[140:143], a[124:127], v[208:223]
ds_read_b64_tr_b16 a[158:159], v7 offset:29696
buffer_store_dwordx4 v[44:47], v8, s[16:19], s37 offen offset:3072 sc1
s_waitcnt lgkmcnt(6)
v_mfma_f32_32x32x16_bf16 v[224:239], a[144:147], a[32:35], v[224:239]
ds_read_b64_tr_b16 a[128:129], v7 offset:32768
v_mfma_f32_32x32x16_bf16 v[240:255], a[144:147], a[48:51], v[240:255]
ds_read_b64_tr_b16 a[130:131], v7 offset:33792
s_waitcnt lgkmcnt(6)
v_mfma_f32_32x32x16_bf16 v[224:239], a[148:151], a[36:39], v[224:239]
ds_read_b64_tr_b16 a[132:133], v7 offset:36864
v_mfma_f32_32x32x16_bf16 v[240:255], a[148:151], a[52:55], v[240:255]
ds_read_b64_tr_b16 a[134:135], v7 offset:37888
s_waitcnt lgkmcnt(6)
v_mfma_f32_32x32x16_bf16 v[224:239], a[152:155], a[40:43], v[224:239]
ds_read_b64_tr_b16 a[136:137], v7 offset:40960
v_cvt_pk_bf16_f32 v16, v192, v193
v_mfma_f32_32x32x16_bf16 v[240:255], a[152:155], a[56:59], v[240:255]
ds_read_b64_tr_b16 a[138:139], v7 offset:41984
v_cvt_pk_bf16_f32 v17, v194, v195
s_waitcnt lgkmcnt(6)
v_mfma_f32_32x32x16_bf16 v[224:239], a[156:159], a[44:47], v[224:239]
ds_read_b64_tr_b16 a[140:141], v7 offset:45056
v_cvt_pk_bf16_f32 v18, v196, v197
v_mfma_f32_32x32x16_bf16 v[240:255], a[156:159], a[60:63], v[240:255]
ds_read_b64_tr_b16 a[142:143], v7 offset:46080
v_cvt_pk_bf16_f32 v19, v198, v199
s_waitcnt lgkmcnt(6)
v_mfma_f32_32x32x16_bf16 v[224:239], a[128:131], a[64:67], v[224:239]
ds_read_b64_tr_b16 a[144:145], v7 offset:49152
buffer_store_dwordx4 v[16:19], v14, s[16:19], s36 offen offset:0 sc1
v_mfma_f32_32x32x16_bf16 v[240:255], a[128:131], a[80:83], v[240:255]
ds_read_b64_tr_b16 a[146:147], v7 offset:50176
v_cvt_pk_bf16_f32 v20, v200, v201
s_waitcnt lgkmcnt(6)
v_mfma_f32_32x32x16_bf16 v[224:239], a[132:135], a[68:71], v[224:239]
ds_read_b64_tr_b16 a[148:149], v7 offset:53248
v_cvt_pk_bf16_f32 v21, v202, v203
v_mfma_f32_32x32x16_bf16 v[240:255], a[132:135], a[84:87], v[240:255]
ds_read_b64_tr_b16 a[150:151], v7 offset:54272
v_cvt_pk_bf16_f32 v22, v204, v205
s_waitcnt lgkmcnt(6)
v_mfma_f32_32x32x16_bf16 v[224:239], a[136:139], a[72:75], v[224:239]
ds_read_b64_tr_b16 a[152:153], v7 offset:57344
v_cvt_pk_bf16_f32 v23, v206, v207
v_mfma_f32_32x32x16_bf16 v[240:255], a[136:139], a[88:91], v[240:255]
ds_read_b64_tr_b16 a[154:155], v7 offset:58368
buffer_store_dwordx4 v[20:23], v14, s[16:19], s36 offen offset:1024 sc1
s_waitcnt lgkmcnt(6)
v_mfma_f32_32x32x16_bf16 v[224:239], a[140:143], a[76:79], v[224:239]
ds_read_b64_tr_b16 a[156:157], v7 offset:61440
v_cvt_pk_bf16_f32 v24, v208, v209
v_mfma_f32_32x32x16_bf16 v[240:255], a[140:143], a[92:95], v[240:255]
ds_read_b64_tr_b16 a[158:159], v7 offset:62464
v_cvt_pk_bf16_f32 v25, v210, v211
s_waitcnt lgkmcnt(6)
v_mfma_f32_32x32x16_bf16 v[224:239], a[144:147], a[96:99], v[224:239]
v_cvt_pk_bf16_f32 v26, v212, v213
v_mfma_f32_32x32x16_bf16 v[240:255], a[144:147], a[112:115], v[240:255]
v_cvt_pk_bf16_f32 v27, v214, v215
s_waitcnt lgkmcnt(4)
v_mfma_f32_32x32x16_bf16 v[224:239], a[148:151], a[100:103], v[224:239]
buffer_store_dwordx4 v[24:27], v14, s[16:19], s37 offen offset:0 sc1
v_mfma_f32_32x32x16_bf16 v[240:255], a[148:151], a[116:119], v[240:255]
v_cvt_pk_bf16_f32 v28, v216, v217
s_waitcnt lgkmcnt(2)
v_mfma_f32_32x32x16_bf16 v[224:239], a[152:155], a[104:107], v[224:239]
v_cvt_pk_bf16_f32 v29, v218, v219
v_mfma_f32_32x32x16_bf16 v[240:255], a[152:155], a[120:123], v[240:255]
v_cvt_pk_bf16_f32 v30, v220, v221
s_waitcnt lgkmcnt(0)
v_mfma_f32_32x32x16_bf16 v[224:239], a[156:159], a[108:111], v[224:239]
v_cvt_pk_bf16_f32 v31, v222, v223
v_mfma_f32_32x32x16_bf16 v[240:255], a[156:159], a[124:127], v[240:255]
buffer_store_dwordx4 v[28:31], v14, s[16:19], s37 offen offset:1024 sc1
s_nop 7
s_nop 3
v_cvt_pk_bf16_f32 v32, v224, v225
v_cvt_pk_bf16_f32 v33, v226, v227
v_cvt_pk_bf16_f32 v34, v228, v229
v_cvt_pk_bf16_f32 v35, v230, v231
buffer_store_dwordx4 v[32:35], v14, s[16:19], s36 offen offset:2048 sc1
v_cvt_pk_bf16_f32 v36, v232, v233
v_cvt_pk_bf16_f32 v37, v234, v235
v_cvt_pk_bf16_f32 v38, v236, v237
v_cvt_pk_bf16_f32 v39, v238, v239
buffer_store_dwordx4 v[36:39], v14, s[16:19], s36 offen offset:3072 sc1
v_cvt_pk_bf16_f32 v40, v240, v241
v_cvt_pk_bf16_f32 v41, v242, v243
v_cvt_pk_bf16_f32 v42, v244, v245
v_cvt_pk_bf16_f32 v43, v246, v247
buffer_store_dwordx4 v[40:43], v14, s[16:19], s37 offen offset:2048 sc1
v_cvt_pk_bf16_f32 v44, v248, v249
v_cvt_pk_bf16_f32 v45, v250, v251
v_cvt_pk_bf16_f32 v46, v252, v253
v_cvt_pk_bf16_f32 v47, v254, v255
buffer_store_dwordx4 v[44:47], v14, s[16:19], s37 offen offset:3072 sc1
s_waitcnt vmcnt(0)
s_barrier
s_cmp_lg_u32 s26, 0
s_cbranch_scc1 adaLN_cond__sliding_block_cached__swiglu_ffn__prompt_kernel_arr_31
s_add_u32 s27, s24, 40
s_lshl_b32 s6, s27, 8
s_add_u32 s6, s6, 0x20000
s_add_u32 s6, s6, s90
s_addc_u32 s7, s91, 0
v_mov_b32 v2, 0
v_mov_b32 v3, 1
s_mov_b64 exec, 1
global_atomic_add v2, v3, s[6:7] sc1
s_mov_b64 exec, -1
adaLN_cond__sliding_block_cached__swiglu_ffn__prompt_kernel_arr_31:
s_lshl_b32 s35, s22, 3
s_add_u32 s35, s35, s25
v_lshrrev_b32 v20, 5, v1
v_lshlrev_b32 v20, 3, v20
v_bfe_u32 v21, v1, 2, 2
v_add_u32 v20, v20, v21
v_mul_u32_u24 v20, 224, v20
v_bfe_u32 v21, v1, 4, 1
v_mul_u32_u24 v21, 14464, v21
v_add_u32 v20, v20, v21
v_and_b32 v21, 1, v1
v_lshl_add_u32 v20, v21, 4, v20
v_bfe_u32 v21, v1, 1, 1
v_lshl_add_u32 v4, v21, 3, v20
v_add_u32 v5, 57856, v4
v_lshlrev_b32 v8, 4, v1
v_add_u32 v9, 0x10000, v8
s_and_b32 s27, s26, 1
s_mul_i32 s28, s27, 448
s_mul_i32 s29, s35, 224
v_add_u32 v20, s28, v1
v_mul_u32_u24 v21, 4682, v20
v_lshrrev_b32 v21, 16, v21
v_mul_u32_u24 v22, 14, v21
v_sub_u32 v22, v20, v22
v_mul_u32_u24 v21, 7168, v21
v_lshl_add_u32 v21, v22, 4, v21
v_add_u32 v21, s29, v21
v_subrev_u32 v10, 0, v21
v_add_u32 v20, s28, v1
v_add_u32 v20, 64, v20
v_mul_u32_u24 v21, 4682, v20
v_lshrrev_b32 v21, 16, v21
v_mul_u32_u24 v22, 14, v21
v_sub_u32 v22, v20, v22
v_mul_u32_u24 v21, 7168, v21
v_lshl_add_u32 v21, v22, 4, v21
v_add_u32 v21, s29, v21
v_subrev_u32 v11, 1024, v21
v_add_u32 v20, s28, v1
v_add_u32 v20, 128, v20
v_mul_u32_u24 v21, 4682, v20
v_lshrrev_b32 v21, 16, v21
v_mul_u32_u24 v22, 14, v21
v_sub_u32 v22, v20, v22
v_mul_u32_u24 v21, 7168, v21
v_lshl_add_u32 v21, v22, 4, v21
v_add_u32 v21, s29, v21
v_subrev_u32 v12, 2048, v21
v_add_u32 v20, s28, v1
v_add_u32 v20, 192, v20
v_mul_u32_u24 v21, 4682, v20
v_lshrrev_b32 v21, 16, v21
v_mul_u32_u24 v22, 14, v21
v_sub_u32 v22, v20, v22
v_mul_u32_u24 v21, 7168, v21
v_lshl_add_u32 v21, v22, 4, v21
v_add_u32 v21, s29, v21
v_subrev_u32 v13, 3072, v21
v_add_u32 v20, s28, v1
v_add_u32 v20, 256, v20
v_mul_u32_u24 v21, 4682, v20
v_lshrrev_b32 v21, 16, v21
v_mul_u32_u24 v22, 14, v21
v_sub_u32 v22, v20, v22
v_mul_u32_u24 v21, 7168, v21
v_lshl_add_u32 v21, v22, 4, v21
v_add_u32 v21, s29, v21
v_subrev_u32 v14, 0, v21
v_add_u32 v20, s28, v1
v_add_u32 v20, 320, v20
v_mul_u32_u24 v21, 4682, v20
v_lshrrev_b32 v21, 16, v21
v_mul_u32_u24 v22, 14, v21
v_sub_u32 v22, v20, v22
v_mul_u32_u24 v21, 7168, v21
v_lshl_add_u32 v21, v22, 4, v21
v_add_u32 v21, s29, v21
v_subrev_u32 v15, 1024, v21
v_add_u32 v20, s28, v1
v_add_u32 v20, 384, v20
v_mul_u32_u24 v21, 4682, v20
v_lshrrev_b32 v21, 16, v21
v_mul_u32_u24 v22, 14, v21
v_sub_u32 v22, v20, v22
v_mul_u32_u24 v21, 7168, v21
v_lshl_add_u32 v21, v22, 4, v21
v_add_u32 v21, s29, v21
v_subrev_u32 v16, 2048, v21
s_add_u32 s8, s90, 0x3900000
s_addc_u32 s9, s91, 0
s_mov_b32 s10, 0x400000
s_mov_b32 s11, 0x20000
s_cmp_ge_u32 s26, 2
s_cselect_b32 s12, s78, s76
s_cselect_b32 s13, s79, s77
s_mov_b32 s14, 0x700000
s_mov_b32 s15, 0x20000
s_lshl_b32 s27, s24, 3
s_lshl_b32 s28, s26, 1
s_add_u32 s34, s27, s28
s_lshl_b32 s38, s34, 16
s_add_u32 s38, s38, 61440
s_lshl_b32 s30, s34, 16
s_sub_u32 s30, s30, 4096
s_mov_b32 s31, 0xfff90000
s_lshr_b32 s27, s26, 1
s_mul_i32 s32, s27, 14464
s_and_b32 s27, s26, 1
s_mul_i32 s27, s27, 7168
s_add_u32 s32, s32, s27
s_add_u32 s31, s31, 0x70000
s_add_u32 m0, s32, 0x0
s_nop 0
buffer_load_dwordx4 v10, s[12:15], s31 offen offset:0 lds
buffer_load_dwordx4 v11, s[12:15], s31 offen offset:1024 lds
buffer_load_dwordx4 v12, s[12:15], s31 offen offset:2048 lds
buffer_load_dwordx4 v13, s[12:15], s31 offen offset:3072 lds
s_add_u32 m0, s32, 0x1000
s_nop 0
buffer_load_dwordx4 v14, s[12:15], s31 offen offset:0 lds
buffer_load_dwordx4 v15, s[12:15], s31 offen offset:1024 lds
buffer_load_dwordx4 v16, s[12:15], s31 offen offset:2048 lds
s_add_u32 s31, s31, 0x70000
s_add_u32 m0, s32, 0x7100
s_nop 0
buffer_load_dwordx4 v10, s[12:15], s31 offen offset:0 lds
buffer_load_dwordx4 v11, s[12:15], s31 offen offset:1024 lds
buffer_load_dwordx4 v12, s[12:15], s31 offen offset:2048 lds
buffer_load_dwordx4 v13, s[12:15], s31 offen offset:3072 lds
s_add_u32 m0, s32, 0x8100
s_nop 0
buffer_load_dwordx4 v14, s[12:15], s31 offen offset:0 lds
buffer_load_dwordx4 v15, s[12:15], s31 offen offset:1024 lds
buffer_load_dwordx4 v16, s[12:15], s31 offen offset:2048 lds
s_add_u32 s31, s31, 0x70000
s_add_u32 m0, s32, 0xe200
s_nop 0
buffer_load_dwordx4 v10, s[12:15], s31 offen offset:0 lds
buffer_load_dwordx4 v11, s[12:15], s31 offen offset:1024 lds
s_cmp_lg_u32 s26, 0
s_cbranch_scc1 adaLN_cond__sliding_block_cached__swiglu_ffn__prompt_kernel_ct_33
s_getpc_b64 s[6:7]
adaLN_cond__sliding_block_cached__swiglu_ffn__prompt_kernel_pc_32:
s_add_u32 s6, s6, adaLN_cond__sliding_block_cached__swiglu_ffn__prompt_kernel_L_gateup-adaLN_cond__sliding_block_cached__swiglu_ffn__prompt_kernel_pc_32
s_addc_u32 s7, s7, 0
v_lshlrev_b32 v30, 5, v1
v_add_u32 v30, s21, v30
v_lshlrev_b32 v30, 7, v30
v_cmp_gt_u32 vcc, adaLN_cond__sliding_block_cached__swiglu_ffn__prompt_kernel_L_down-adaLN_cond__sliding_block_cached__swiglu_ffn__prompt_kernel_L_gateup, v30
s_and_saveexec_b64 s[4:5], vcc
s_cbranch_execz adaLN_cond__sliding_block_cached__swiglu_ffn__prompt_kernel_ct_33_r
global_load_dword v31, v30, s[6:7]
adaLN_cond__sliding_block_cached__swiglu_ffn__prompt_kernel_ct_33_r:
s_mov_b64 exec, s[4:5]
adaLN_cond__sliding_block_cached__swiglu_ffn__prompt_kernel_ct_33:
v_lshrrev_b32 v2, 6, v0
v_and_b32 v3, 7, v1
v_lshrrev_b32 v4, 3, v1
v_lshrrev_b32 v5, 1, v4
v_lshlrev_b32 v5, 10, v5
v_and_b32 v6, 1, v4
v_lshl_add_u32 v5, v6, 9, v5
v_lshl_add_u32 v5, v3, 4, v5
v_lshl_add_u32 v5, v2, 14, v5
v_lshlrev_b32 v6, 11, v4
v_lshl_add_u32 v6, v3, 4, v6
v_lshl_add_u32 v6, v2, 9, v6
v_lshrrev_b32 v240, 3, v1
v_mul_u32_u24 v240, 144, v240
v_and_b32 v241, 7, v1
v_lshl_add_u32 v240, v241, 4, v240
v_mul_u32_u24 v241, 144, v241
v_lshrrev_b32 v29, 3, v1
v_lshl_add_u32 v241, v29, 4, v241
s_mul_i32 s27, s26, 4608
s_add_u32 s27, s27, 126976
v_add_u32 v240, s27, v240
v_add_u32 v241, s27, v241
v_lshlrev_b32 v7, 4, v0
v_lshlrev_b32 v8, 10, v2
v_lshl_add_u32 v8, v4, 5, v8
v_add_u32 v8, 147456, v8
v_add_u32 v11, 147456, v7
v_lshlrev_b32 v9, 5, v3
v_add_u32 v9, 159744, v9
v_lshl_add_u32 v10, v2, 3, v9
s_lshl_b32 s45, s24, 5
s_lshl_b32 s46, s22, 3
s_add_u32 s45, s45, s46
s_add_u32 s45, s45, s25
s_lshr_b32 s40, s45, 2
s_lshl_b32 s40, s40, 16
s_and_b32 s46, s45, 3
s_lshl_b32 s46, s46, 7
s_add_u32 s40, s40, s46
s_add_u32 s41, s40, 4096
s_add_u32 s42, s40, 8192
s_add_u32 s43, s40, 12288
s_lshl_b32 s44, s45, 14
s_cmp_lg_u32 s26, 0
s_cbranch_scc1 adaLN_cond__sliding_block_cached__swiglu_ffn__prompt_kernel_ws_36
s_mov_b32 s6, s88
s_mov_b32 s7, s89
v_mov_b32 v2, 0
s_mov_b32 s27, 0
s_mov_b64 exec, 1
adaLN_cond__sliding_block_cached__swiglu_ffn__prompt_kernel_wt_34:
global_load_dword v3, v2, s[6:7] offset:8 sc1
s_waitcnt vmcnt(0)
v_readfirstlane_b32 s28, v3
s_add_u32 s27, s27, 1
s_cmp_ge_u32 s28, 256
s_cbranch_scc1 adaLN_cond__sliding_block_cached__swiglu_ffn__prompt_kernel_wd_35
s_cmp_ge_u32 s27, 0x40000
s_cbranch_scc1 adaLN_cond__sliding_block_cached__swiglu_ffn__prompt_kernel_wd_35
s_sleep 2
s_branch adaLN_cond__sliding_block_cached__swiglu_ffn__prompt_kernel_wt_34
adaLN_cond__sliding_block_cached__swiglu_ffn__prompt_kernel_wd_35:
s_mov_b64 exec, -1
adaLN_cond__sliding_block_cached__swiglu_ffn__prompt_kernel_ws_36:
s_barrier
s_add_u32 s8, s90, 0x10000
s_addc_u32 s9, s91, 0
s_mov_b32 s10, 0x10000
s_mov_b32 s11, 0x20000
s_mov_b32 s27, 0
buffer_load_dwordx4 v[168:171], v7, s[8:11], s27 offen sc1
s_mov_b32 s27, 16384
buffer_load_dwordx4 v[172:175], v7, s[8:11], s27 offen sc1
s_mov_b32 s27, 32768
buffer_load_dwordx4 v[176:179], v7, s[8:11], s27 offen sc1
s_mov_b32 s27, 49152
buffer_load_dwordx4 v[180:183], v7, s[8:11], s27 offen sc1
s_mov_b32 s27, 4096
buffer_load_dwordx4 v[184:187], v7, s[8:11], s27 offen sc1
s_mov_b32 s27, 20480
buffer_load_dwordx4 v[188:191], v7, s[8:11], s27 offen sc1
s_mov_b32 s27, 36864
buffer_load_dwordx4 v[192:195], v7, s[8:11], s27 offen sc1
s_mov_b32 s27, 53248
buffer_load_dwordx4 v[196:199], v7, s[8:11], s27 offen sc1
s_mov_b32 s27, 8192
buffer_load_dwordx4 v[200:203], v7, s[8:11], s27 offen sc1
s_mov_b32 s27, 24576
buffer_load_dwordx4 v[204:207], v7, s[8:11], s27 offen sc1
s_mov_b32 s27, 40960
buffer_load_dwordx4 v[208:211], v7, s[8:11], s27 offen sc1
s_mov_b32 s27, 57344
buffer_load_dwordx4 v[212:215], v7, s[8:11], s27 offen sc1
s_mov_b32 s12, s64
s_mov_b32 s13, s65
s_mov_b32 s14, 0x400000
s_mov_b32 s15, 0x20000
buffer_load_dwordx4 v[64:67], v6, s[12:15], s44 offen offset:0
buffer_load_dwordx4 v[68:71], v6, s[12:15], s44 offen offset:128
buffer_load_dwordx4 v[72:75], v6, s[12:15], s44 offen offset:256
buffer_load_dwordx4 v[76:79], v6, s[12:15], s44 offen offset:384
s_waitcnt vmcnt(4)
v_add_f32 v168, v168, v172
v_add_f32 v169, v169, v173
v_add_f32 v170, v170, v174
v_add_f32 v171, v171, v175
v_add_f32 v168, v168, v176
v_add_f32 v169, v169, v177
v_add_f32 v170, v170, v178
v_add_f32 v171, v171, v179
v_add_f32 v168, v168, v180
v_add_f32 v169, v169, v181
v_add_f32 v170, v170, v182
v_add_f32 v171, v171, v183
v_cvt_pk_bf16_f32 v172, v168, v169
v_cvt_pk_bf16_f32 v173, v170, v171
v_lshlrev_b32 v168, 16, v172
v_and_b32 v169, 0xffff0000, v172
v_lshlrev_b32 v170, 16, v173
v_and_b32 v171, 0xffff0000, v173
ds_write_b128 v11, v[168:171] offset:0
v_add_f32 v184, v184, v188
v_add_f32 v185, v185, v189
v_add_f32 v186, v186, v190
v_add_f32 v187, v187, v191
v_add_f32 v184, v184, v192
v_add_f32 v185, v185, v193
v_add_f32 v186, v186, v194
v_add_f32 v187, v187, v195
v_add_f32 v184, v184, v196
v_add_f32 v185, v185, v197
v_add_f32 v186, v186, v198
v_add_f32 v187, v187, v199
v_cvt_pk_bf16_f32 v188, v184, v185
v_cvt_pk_bf16_f32 v189, v186, v187
v_lshlrev_b32 v184, 16, v188
v_and_b32 v185, 0xffff0000, v188
v_lshlrev_b32 v186, 16, v189
v_and_b32 v187, 0xffff0000, v189
v_mul_f32 v184, 0xbfb8aa3b, v184
v_mul_f32 v185, 0xbfb8aa3b, v185
v_mul_f32 v186, 0xbfb8aa3b, v186
v_mul_f32 v187, 0xbfb8aa3b, v187
ds_write_b128 v11, v[184:187] offset:4096
v_add_f32 v200, v200, v204
v_add_f32 v201, v201, v205
v_add_f32 v202, v202, v206
v_add_f32 v203, v203, v207
v_add_f32 v200, v200, v208
v_add_f32 v201, v201, v209
v_add_f32 v202, v202, v210
v_add_f32 v203, v203, v211
v_add_f32 v200, v200, v212
v_add_f32 v201, v201, v213
v_add_f32 v202, v202, v214
v_add_f32 v203, v203, v215
v_cvt_pk_bf16_f32 v204, v200, v201
v_cvt_pk_bf16_f32 v205, v202, v203
v_lshlrev_b32 v200, 16, v204
v_and_b32 v201, 0xffff0000, v204
v_lshlrev_b32 v202, 16, v205
v_and_b32 v203, 0xffff0000, v205
v_add_f32 v200, 1.0, v200
v_add_f32 v201, 1.0, v201
v_add_f32 v202, 1.0, v202
v_add_f32 v203, 1.0, v203
v_cvt_pk_bf16_f32 v204, v200, v201
v_cvt_pk_bf16_f32 v205, v202, v203
v_lshlrev_b32 v200, 16, v204
v_and_b32 v201, 0xffff0000, v204
v_lshlrev_b32 v202, 16, v205
v_and_b32 v203, 0xffff0000, v205
v_mul_f32 v200, 0xbfb8aa3b, v200
v_mul_f32 v201, 0xbfb8aa3b, v201
v_mul_f32 v202, 0xbfb8aa3b, v202
v_mul_f32 v203, 0xbfb8aa3b, v203
ds_write_b128 v11, v[200:203] offset:8192
s_waitcnt lgkmcnt(0)
s_barrier
ds_read_b128 v[144:147], v8 offset:0
ds_read_b128 v[148:151], v8 offset:16
ds_read_b128 v[152:155], v8 offset:256
ds_read_b128 v[156:159], v8 offset:272
ds_read_b128 v[160:163], v8 offset:512
ds_read_b128 v[164:167], v8 offset:528
ds_read_b128 v[168:171], v8 offset:768
ds_read_b128 v[172:175], v8 offset:784
s_waitcnt lgkmcnt(0)
ds_read_b128 v[176:179], v8 offset:8192
ds_read_b128 v[180:183], v8 offset:8208
ds_read_b128 v[184:187], v8 offset:8448
ds_read_b128 v[188:191], v8 offset:8464
ds_read_b128 v[192:195], v8 offset:8704
ds_read_b128 v[196:199], v8 offset:8720
ds_read_b128 v[200:203], v8 offset:8960
ds_read_b128 v[204:207], v8 offset:8976
s_waitcnt lgkmcnt(0)
ds_read_b128 v[208:211], v8 offset:4096
ds_read_b128 v[212:215], v8 offset:4112
ds_read_b128 v[216:219], v8 offset:4352
ds_read_b128 v[220:223], v8 offset:4368
ds_read_b128 v[224:227], v8 offset:4608
ds_read_b128 v[228:231], v8 offset:4624
ds_read_b128 v[232:235], v8 offset:4864
ds_read_b128 v[236:239], v8 offset:4880
s_waitcnt vmcnt(0) lgkmcnt(0)
ds_write_b128 v240, v[64:67] offset:0
ds_write_b128 v240, v[68:71] offset:1152
ds_write_b128 v240, v[72:75] offset:2304
ds_write_b128 v240, v[76:79] offset:3456
s_waitcnt lgkmcnt(0)
ds_read_b128 v[64:67], v241 offset:0
ds_read_b128 v[68:71], v241 offset:1152
ds_read_b128 v[72:75], v241 offset:2304
ds_read_b128 v[76:79], v241 offset:3456
s_waitcnt lgkmcnt(0)
v_lshlrev_b32 v32, 16, v64
v_and_b32 v33, 0xffff0000, v64
v_lshlrev_b32 v34, 16, v65
v_and_b32 v35, 0xffff0000, v65
v_lshlrev_b32 v36, 16, v66
v_and_b32 v37, 0xffff0000, v66
v_lshlrev_b32 v38, 16, v67
v_and_b32 v39, 0xffff0000, v67
v_lshlrev_b32 v40, 16, v68
v_and_b32 v41, 0xffff0000, v68
v_lshlrev_b32 v42, 16, v69
v_and_b32 v43, 0xffff0000, v69
v_lshlrev_b32 v44, 16, v70
v_and_b32 v45, 0xffff0000, v70
v_lshlrev_b32 v46, 16, v71
v_and_b32 v47, 0xffff0000, v71
v_lshlrev_b32 v48, 16, v72
v_and_b32 v49, 0xffff0000, v72
v_lshlrev_b32 v50, 16, v73
v_and_b32 v51, 0xffff0000, v73
v_lshlrev_b32 v52, 16, v74
v_and_b32 v53, 0xffff0000, v74
v_lshlrev_b32 v54, 16, v75
v_and_b32 v55, 0xffff0000, v75
v_lshlrev_b32 v56, 16, v76
v_and_b32 v57, 0xffff0000, v76
v_lshlrev_b32 v58, 16, v77
v_and_b32 v59, 0xffff0000, v77
v_lshlrev_b32 v60, 16, v78
v_and_b32 v61, 0xffff0000, v78
v_lshlrev_b32 v62, 16, v79
v_and_b32 v63, 0xffff0000, v79
s_mov_b32 s46, 0x00003f80
s_mov_b32 s47, 0x3f800000
s_waitcnt lgkmcnt(0)
s_cmp_lg_u32 s26, 0
s_cbranch_scc1 adaLN_cond__sliding_block_cached__swiglu_ffn__prompt_kernel_ws_39
s_add_u32 s27, s24, 40
s_lshl_b32 s6, s27, 8
s_add_u32 s6, s6, 0x20000
s_add_u32 s6, s6, s90
s_addc_u32 s7, s91, 0
v_mov_b32 v2, 0
s_mov_b32 s27, 0
s_mov_b64 exec, 1
adaLN_cond__sliding_block_cached__swiglu_ffn__prompt_kernel_wt_37:
global_load_dword v3, v2, s[6:7] offset:0 sc1
s_waitcnt vmcnt(0)
v_readfirstlane_b32 s28, v3
s_add_u32 s27, s27, 1
s_cmp_ge_u32 s28, 32
s_cbranch_scc1 adaLN_cond__sliding_block_cached__swiglu_ffn__prompt_kernel_wd_38
s_cmp_ge_u32 s27, 0x40000
s_cbranch_scc1 adaLN_cond__sliding_block_cached__swiglu_ffn__prompt_kernel_wd_38
s_sleep 2
s_branch adaLN_cond__sliding_block_cached__swiglu_ffn__prompt_kernel_wt_37
adaLN_cond__sliding_block_cached__swiglu_ffn__prompt_kernel_wd_38:
s_mov_b64 exec, -1
adaLN_cond__sliding_block_cached__swiglu_ffn__prompt_kernel_ws_39:
s_barrier
s_add_u32 s12, s90, 0x1500000
s_addc_u32 s13, s91, 0
s_mov_b32 s14, 0x1000000
s_mov_b32 s15, 0x20000
s_add_u32 s27, s40, 0x0
buffer_load_dwordx4 v[80:83], v5, s[12:15], s27 offen sc1
s_add_u32 s27, s40, 0x400000
buffer_load_dwordx4 v[96:99], v5, s[12:15], s27 offen sc1
s_add_u32 s27, s40, 0x800000
buffer_load_dwordx4 v[112:115], v5, s[12:15], s27 offen sc1
s_add_u32 s27, s40, 0xc00000
buffer_load_dwordx4 v[128:131], v5, s[12:15], s27 offen sc1
s_add_u32 s27, s41, 0x0
buffer_load_dwordx4 v[84:87], v5, s[12:15], s27 offen sc1
s_add_u32 s27, s41, 0x400000
buffer_load_dwordx4 v[100:103], v5, s[12:15], s27 offen sc1
s_add_u32 s27, s41, 0x800000
buffer_load_dwordx4 v[116:119], v5, s[12:15], s27 offen sc1
s_add_u32 s27, s41, 0xc00000
buffer_load_dwordx4 v[132:135], v5, s[12:15], s27 offen sc1
s_add_u32 s27, s42, 0x0
buffer_load_dwordx4 v[88:91], v5, s[12:15], s27 offen sc1
s_add_u32 s27, s42, 0x400000
buffer_load_dwordx4 v[104:107], v5, s[12:15], s27 offen sc1
s_add_u32 s27, s42, 0x800000
buffer_load_dwordx4 v[120:123], v5, s[12:15], s27 offen sc1
s_add_u32 s27, s42, 0xc00000
buffer_load_dwordx4 v[136:139], v5, s[12:15], s27 offen sc1
s_add_u32 s27, s43, 0x0
buffer_load_dwordx4 v[92:95], v5, s[12:15], s27 offen sc1
s_add_u32 s27, s43, 0x400000
buffer_load_dwordx4 v[108:111], v5, s[12:15], s27 offen sc1
s_add_u32 s27, s43, 0x800000
buffer_load_dwordx4 v[124:127], v5, s[12:15], s27 offen sc1
s_add_u32 s27, s43, 0xc00000
buffer_load_dwordx4 v[140:143], v5, s[12:15], s27 offen sc1
s_waitcnt vmcnt(12)
v_dot2_f32_bf16 v20, v80, s46, 0
v_dot2_f32_bf16 v21, v80, s47, 0
v_dot2_f32_bf16 v20, v96, s46, v20
v_dot2_f32_bf16 v21, v96, s47, v21
v_dot2_f32_bf16 v20, v112, s46, v20
v_dot2_f32_bf16 v21, v112, s47, v21
v_dot2_f32_bf16 v20, v128, s46, v20
v_dot2_f32_bf16 v21, v128, s47, v21
v_dot2_f32_bf16 v22, v81, s46, 0
v_dot2_f32_bf16 v23, v81, s47, 0
v_dot2_f32_bf16 v22, v97, s46, v22
v_dot2_f32_bf16 v23, v97, s47, v23
v_dot2_f32_bf16 v22, v113, s46, v22
v_dot2_f32_bf16 v23, v113, s47, v23
v_dot2_f32_bf16 v22, v129, s46, v22
v_dot2_f32_bf16 v23, v129, s47, v23
v_fmac_f32 v32, v20, v144
v_fmac_f32 v33, v21, v145
v_dot2_f32_bf16 v20, v82, s46, 0
v_dot2_f32_bf16 v21, v82, s47, 0
v_dot2_f32_bf16 v20, v98, s46, v20
v_dot2_f32_bf16 v21, v98, s47, v21
v_dot2_f32_bf16 v20, v114, s46, v20
v_dot2_f32_bf16 v21, v114, s47, v21
v_dot2_f32_bf16 v20, v130, s46, v20
v_dot2_f32_bf16 v21, v130, s47, v21
v_fmac_f32 v34, v22, v146
v_fmac_f32 v35, v23, v147
v_dot2_f32_bf16 v22, v83, s46, 0
v_dot2_f32_bf16 v23, v83, s47, 0
v_dot2_f32_bf16 v22, v99, s46, v22
v_dot2_f32_bf16 v23, v99, s47, v23
v_dot2_f32_bf16 v22, v115, s46, v22
v_dot2_f32_bf16 v23, v115, s47, v23
v_dot2_f32_bf16 v22, v131, s46, v22
v_dot2_f32_bf16 v23, v131, s47, v23
v_fmac_f32 v36, v20, v148
v_fmac_f32 v37, v21, v149
s_nop 2
v_fmac_f32 v38, v22, v150
v_fmac_f32 v39, v23, v151
v_cvt_pk_bf16_f32 v64, v32, v33
v_cvt_pk_bf16_f32 v65, v34, v35
v_cvt_pk_bf16_f32 v66, v36, v37
v_cvt_pk_bf16_f32 v67, v38, v39
s_waitcnt vmcnt(8)
v_dot2_f32_bf16 v20, v84, s46, 0
v_dot2_f32_bf16 v21, v84, s47, 0
v_dot2_f32_bf16 v20, v100, s46, v20
v_dot2_f32_bf16 v21, v100, s47, v21
v_dot2_f32_bf16 v20, v116, s46, v20
v_dot2_f32_bf16 v21, v116, s47, v21
v_dot2_f32_bf16 v20, v132, s46, v20
v_dot2_f32_bf16 v21, v132, s47, v21
v_dot2_f32_bf16 v22, v85, s46, 0
v_dot2_f32_bf16 v23, v85, s47, 0
v_dot2_f32_bf16 v22, v101, s46, v22
v_dot2_f32_bf16 v23, v101, s47, v23
v_dot2_f32_bf16 v22, v117, s46, v22
v_dot2_f32_bf16 v23, v117, s47, v23
v_dot2_f32_bf16 v22, v133, s46, v22
v_dot2_f32_bf16 v23, v133, s47, v23
v_fmac_f32 v40, v20, v152
v_fmac_f32 v41, v21, v153
v_dot2_f32_bf16 v20, v86, s46, 0
v_dot2_f32_bf16 v21, v86, s47, 0
v_dot2_f32_bf16 v20, v102, s46, v20
v_dot2_f32_bf16 v21, v102, s47, v21
v_dot2_f32_bf16 v20, v118, s46, v20
v_dot2_f32_bf16 v21, v118, s47, v21
v_dot2_f32_bf16 v20, v134, s46, v20
v_dot2_f32_bf16 v21, v134, s47, v21
v_fmac_f32 v42, v22, v154
v_fmac_f32 v43, v23, v155
v_dot2_f32_bf16 v22, v87, s46, 0
v_dot2_f32_bf16 v23, v87, s47, 0
v_dot2_f32_bf16 v22, v103, s46, v22
v_dot2_f32_bf16 v23, v103, s47, v23
v_dot2_f32_bf16 v22, v119, s46, v22
v_dot2_f32_bf16 v23, v119, s47, v23
v_dot2_f32_bf16 v22, v135, s46, v22
v_dot2_f32_bf16 v23, v135, s47, v23
v_fmac_f32 v44, v20, v156
v_fmac_f32 v45, v21, v157
s_nop 2
v_fmac_f32 v46, v22, v158
v_fmac_f32 v47, v23, v159
v_cvt_pk_bf16_f32 v68, v40, v41
v_cvt_pk_bf16_f32 v69, v42, v43
v_cvt_pk_bf16_f32 v70, v44, v45
v_cvt_pk_bf16_f32 v71, v46, v47
s_waitcnt vmcnt(4)
v_dot2_f32_bf16 v20, v88, s46, 0
v_dot2_f32_bf16 v21, v88, s47, 0
v_dot2_f32_bf16 v20, v104, s46, v20
v_dot2_f32_bf16 v21, v104, s47, v21
v_dot2_f32_bf16 v20, v120, s46, v20
v_dot2_f32_bf16 v21, v120, s47, v21
v_dot2_f32_bf16 v20, v136, s46, v20
v_dot2_f32_bf16 v21, v136, s47, v21
v_dot2_f32_bf16 v22, v89, s46, 0
v_dot2_f32_bf16 v23, v89, s47, 0
v_dot2_f32_bf16 v22, v105, s46, v22
v_dot2_f32_bf16 v23, v105, s47, v23
v_dot2_f32_bf16 v22, v121, s46, v22
v_dot2_f32_bf16 v23, v121, s47, v23
v_dot2_f32_bf16 v22, v137, s46, v22
v_dot2_f32_bf16 v23, v137, s47, v23
v_fmac_f32 v48, v20, v160
v_fmac_f32 v49, v21, v161
v_dot2_f32_bf16 v20, v90, s46, 0
v_dot2_f32_bf16 v21, v90, s47, 0
v_dot2_f32_bf16 v20, v106, s46, v20
v_dot2_f32_bf16 v21, v106, s47, v21
v_dot2_f32_bf16 v20, v122, s46, v20
v_dot2_f32_bf16 v21, v122, s47, v21
v_dot2_f32_bf16 v20, v138, s46, v20
v_dot2_f32_bf16 v21, v138, s47, v21
v_fmac_f32 v50, v22, v162
v_fmac_f32 v51, v23, v163
v_dot2_f32_bf16 v22, v91, s46, 0
v_dot2_f32_bf16 v23, v91, s47, 0
v_dot2_f32_bf16 v22, v107, s46, v22
v_dot2_f32_bf16 v23, v107, s47, v23
v_dot2_f32_bf16 v22, v123, s46, v22
v_dot2_f32_bf16 v23, v123, s47, v23
v_dot2_f32_bf16 v22, v139, s46, v22
v_dot2_f32_bf16 v23, v139, s47, v23
v_fmac_f32 v52, v20, v164
v_fmac_f32 v53, v21, v165
s_nop 2
v_fmac_f32 v54, v22, v166
v_fmac_f32 v55, v23, v167
v_cvt_pk_bf16_f32 v72, v48, v49
v_cvt_pk_bf16_f32 v73, v50, v51
v_cvt_pk_bf16_f32 v74, v52, v53
v_cvt_pk_bf16_f32 v75, v54, v55
s_waitcnt vmcnt(0)
v_dot2_f32_bf16 v20, v92, s46, 0
v_dot2_f32_bf16 v21, v92, s47, 0
v_dot2_f32_bf16 v20, v108, s46, v20
v_dot2_f32_bf16 v21, v108, s47, v21
v_dot2_f32_bf16 v20, v124, s46, v20
v_dot2_f32_bf16 v21, v124, s47, v21
v_dot2_f32_bf16 v20, v140, s46, v20
v_dot2_f32_bf16 v21, v140, s47, v21
v_dot2_f32_bf16 v22, v93, s46, 0
v_dot2_f32_bf16 v23, v93, s47, 0
v_dot2_f32_bf16 v22, v109, s46, v22
v_dot2_f32_bf16 v23, v109, s47, v23
v_dot2_f32_bf16 v22, v125, s46, v22
v_dot2_f32_bf16 v23, v125, s47, v23
v_dot2_f32_bf16 v22, v141, s46, v22
v_dot2_f32_bf16 v23, v141, s47, v23
v_fmac_f32 v56, v20, v168
v_fmac_f32 v57, v21, v169
v_dot2_f32_bf16 v20, v94, s46, 0
v_dot2_f32_bf16 v21, v94, s47, 0
v_dot2_f32_bf16 v20, v110, s46, v20
v_dot2_f32_bf16 v21, v110, s47, v21
v_dot2_f32_bf16 v20, v126, s46, v20
v_dot2_f32_bf16 v21, v126, s47, v21
v_dot2_f32_bf16 v20, v142, s46, v20
v_dot2_f32_bf16 v21, v142, s47, v21
v_fmac_f32 v58, v22, v170
v_fmac_f32 v59, v23, v171
v_dot2_f32_bf16 v22, v95, s46, 0
v_dot2_f32_bf16 v23, v95, s47, 0
v_dot2_f32_bf16 v22, v111, s46, v22
v_dot2_f32_bf16 v23, v111, s47, v23
v_dot2_f32_bf16 v22, v127, s46, v22
v_dot2_f32_bf16 v23, v127, s47, v23
v_dot2_f32_bf16 v22, v143, s46, v22
v_dot2_f32_bf16 v23, v143, s47, v23
v_fmac_f32 v60, v20, v172
v_fmac_f32 v61, v21, v173
s_nop 2
v_fmac_f32 v62, v22, v174
v_fmac_f32 v63, v23, v175
v_cvt_pk_bf16_f32 v76, v56, v57
v_cvt_pk_bf16_f32 v77, v58, v59
v_cvt_pk_bf16_f32 v78, v60, v61
v_cvt_pk_bf16_f32 v79, v62, v63
v_pk_add_f32 v[16:17], v[32:33], v[34:35] op_sel_hi:[1,1]
v_pk_add_f32 v[18:19], v[36:37], v[38:39] op_sel_hi:[1,1]
v_pk_add_f32 v[20:21], v[40:41], v[42:43] op_sel_hi:[1,1]
v_pk_add_f32 v[22:23], v[44:45], v[46:47] op_sel_hi:[1,1]
v_pk_add_f32 v[16:17], v[16:17], v[48:49] op_sel_hi:[1,1]
v_pk_add_f32 v[18:19], v[18:19], v[52:53] op_sel_hi:[1,1]
v_pk_add_f32 v[20:21], v[20:21], v[56:57] op_sel_hi:[1,1]
v_pk_add_f32 v[22:23], v[22:23], v[60:61] op_sel_hi:[1,1]
v_pk_add_f32 v[16:17], v[16:17], v[50:51] op_sel_hi:[1,1]
v_pk_add_f32 v[18:19], v[18:19], v[54:55] op_sel_hi:[1,1]
v_pk_add_f32 v[20:21], v[20:21], v[58:59] op_sel_hi:[1,1]
v_pk_add_f32 v[22:23], v[22:23], v[62:63] op_sel_hi:[1,1]
v_pk_add_f32 v[16:17], v[16:17], v[18:19] op_sel_hi:[1,1]
v_pk_add_f32 v[20:21], v[20:21], v[22:23] op_sel_hi:[1,1]
v_pk_add_f32 v[16:17], v[16:17], v[20:21] op_sel_hi:[1,1]
v_add_f32 v16, v16, v17
v_mul_f32 v24, 0xbd000000, v16
v_pk_add_f32 v[32:33], v[32:33], v[24:25] op_sel_hi:[1,0]
v_pk_add_f32 v[34:35], v[34:35], v[24:25] op_sel_hi:[1,0]
v_pk_add_f32 v[36:37], v[36:37], v[24:25] op_sel_hi:[1,0]
v_pk_add_f32 v[38:39], v[38:39], v[24:25] op_sel_hi:[1,0]
v_pk_add_f32 v[40:41], v[40:41], v[24:25] op_sel_hi:[1,0]
v_pk_add_f32 v[42:43], v[42:43], v[24:25] op_sel_hi:[1,0]
v_pk_add_f32 v[44:45], v[44:45], v[24:25] op_sel_hi:[1,0]
v_pk_add_f32 v[46:47], v[46:47], v[24:25] op_sel_hi:[1,0]
v_pk_add_f32 v[48:49], v[48:49], v[24:25] op_sel_hi:[1,0]
v_pk_add_f32 v[50:51], v[50:51], v[24:25] op_sel_hi:[1,0]
v_pk_add_f32 v[52:53], v[52:53], v[24:25] op_sel_hi:[1,0]
v_pk_add_f32 v[54:55], v[54:55], v[24:25] op_sel_hi:[1,0]
v_pk_add_f32 v[56:57], v[56:57], v[24:25] op_sel_hi:[1,0]
v_pk_add_f32 v[58:59], v[58:59], v[24:25] op_sel_hi:[1,0]
v_pk_add_f32 v[60:61], v[60:61], v[24:25] op_sel_hi:[1,0]
v_pk_add_f32 v[62:63], v[62:63], v[24:25] op_sel_hi:[1,0]
v_pk_mul_f32 v[16:17], v[32:33], v[32:33] op_sel_hi:[1,1]
v_pk_mul_f32 v[18:19], v[34:35], v[34:35] op_sel_hi:[1,1]
v_pk_fma_f32 v[16:17], v[36:37], v[36:37], v[16:17] op_sel_hi:[1,1,1]
v_pk_fma_f32 v[18:19], v[38:39], v[38:39], v[18:19] op_sel_hi:[1,1,1]
v_pk_fma_f32 v[16:17], v[40:41], v[40:41], v[16:17] op_sel_hi:[1,1,1]
v_pk_fma_f32 v[18:19], v[42:43], v[42:43], v[18:19] op_sel_hi:[1,1,1]
v_pk_fma_f32 v[16:17], v[44:45], v[44:45], v[16:17] op_sel_hi:[1,1,1]
v_pk_fma_f32 v[18:19], v[46:47], v[46:47], v[18:19] op_sel_hi:[1,1,1]
v_pk_fma_f32 v[16:17], v[48:49], v[48:49], v[16:17] op_sel_hi:[1,1,1]
v_pk_fma_f32 v[18:19], v[50:51], v[50:51], v[18:19] op_sel_hi:[1,1,1]
v_pk_fma_f32 v[16:17], v[52:53], v[52:53], v[16:17] op_sel_hi:[1,1,1]
v_pk_fma_f32 v[18:19], v[54:55], v[54:55], v[18:19] op_sel_hi:[1,1,1]
v_pk_fma_f32 v[16:17], v[56:57], v[56:57], v[16:17] op_sel_hi:[1,1,1]
v_pk_fma_f32 v[18:19], v[58:59], v[58:59], v[18:19] op_sel_hi:[1,1,1]
v_pk_fma_f32 v[16:17], v[60:61], v[60:61], v[16:17] op_sel_hi:[1,1,1]
v_pk_fma_f32 v[18:19], v[62:63], v[62:63], v[18:19] op_sel_hi:[1,1,1]
v_pk_add_f32 v[16:17], v[16:17], v[18:19] op_sel_hi:[1,1]
v_add_f32 v27, v16, v17
v_sub_f32 v26, 0, v24
v_mov_b32 v30, v26
s_nop 1
v_mov_b32_dpp v20, v26 row_ror:8 row_mask:0xf bank_mask:0xf
v_mov_b32_dpp v21, v27 row_ror:8 row_mask:0xf bank_mask:0xf
v_sub_f32 v22, v26, v20
v_add_f32 v26, v26, v20
v_add_f32 v27, v27, v21
v_mul_f32 v22, v22, v22
v_mul_f32 v26, 0.5, v26
v_fmac_f32 v27, 0x41800000, v22
v_mov_b32 v20, v26
v_mov_b32 v21, v27
s_nop 1
v_permlane16_swap_b32 v26, v20
v_permlane16_swap_b32 v27, v21
s_nop 1
v_sub_f32 v22, v26, v20
v_add_f32 v26, v26, v20
v_add_f32 v27, v27, v21
v_mul_f32 v22, v22, v22
v_mul_f32 v26, 0.5, v26
v_fmac_f32 v27, 0x42000000, v22
v_mov_b32 v20, v26
v_mov_b32 v21, v27
s_nop 1
v_permlane32_swap_b32 v26, v20
v_permlane32_swap_b32 v27, v21
s_nop 1
v_sub_f32 v22, v26, v20
v_add_f32 v26, v26, v20
v_add_f32 v27, v27, v21
v_mul_f32 v22, v22, v22
v_mul_f32 v26, 0.5, v26
v_fmac_f32 v27, 0x42800000, v22
ds_write_b64 v10, v[26:27]
s_waitcnt lgkmcnt(0)
s_barrier
ds_read_b128 v[16:19], v9
ds_read_b128 v[20:23], v9 offset:16
s_waitcnt lgkmcnt(0)
v_add_f32 v24, v16, v18
v_add_f32 v25, v20, v22
v_add_f32 v24, v24, v25
v_mul_f32 v24, 0.25, v24
v_add_f32 v25, v17, v19
v_add_f32 v26, v21, v23
v_add_f32 v25, v25, v26
v_sub_f32 v16, v16, v24
v_sub_f32 v18, v18, v24
v_sub_f32 v20, v20, v24
v_sub_f32 v22, v22, v24
v_mul_f32 v26, v16, v16
v_fmac_f32 v26, v18, v18
v_fmac_f32 v26, v20, v20
v_fmac_f32 v26, v22, v22
v_fmac_f32 v25, 0x43800000, v26
v_mov_b32 v26, 0x3727c5ac
v_fmac_f32 v26, 0x3a800000, v25
v_rsq_f32 v28, v26
v_sub_f32 v30, v30, v24
s_add_u32 s16, s90, 0x3900000
s_addc_u32 s17, s91, 0
s_mov_b32 s18, 0x400000
s_mov_b32 s19, 0x20000
v_pk_mul_f32 v[176:177], v[176:177], v[28:29] op_sel_hi:[1,0]
v_pk_mul_f32 v[178:179], v[178:179], v[28:29] op_sel_hi:[1,0]
v_pk_mul_f32 v[180:181], v[180:181], v[28:29] op_sel_hi:[1,0]
v_pk_mul_f32 v[182:183], v[182:183], v[28:29] op_sel_hi:[1,0]
v_pk_fma_f32 v[208:209], v[176:177], v[30:31], v[208:209] op_sel_hi:[1,0,1]
v_pk_fma_f32 v[210:211], v[178:179], v[30:31], v[210:211] op_sel_hi:[1,0,1]
v_pk_fma_f32 v[212:213], v[180:181], v[30:31], v[212:213] op_sel_hi:[1,0,1]
v_pk_fma_f32 v[214:215], v[182:183], v[30:31], v[214:215] op_sel_hi:[1,0,1]
v_pk_fma_f32 v[32:33], v[32:33], v[176:177], v[208:209] op_sel_hi:[1,1,1]
v_pk_fma_f32 v[34:35], v[34:35], v[178:179], v[210:211] op_sel_hi:[1,1,1]
v_pk_fma_f32 v[36:37], v[36:37], v[180:181], v[212:213] op_sel_hi:[1,1,1]
v_pk_fma_f32 v[38:39], v[38:39], v[182:183], v[214:215] op_sel_hi:[1,1,1]
v_cvt_pk_bf16_f32 v104, v32, v33
v_cvt_pk_bf16_f32 v105, v34, v35
v_cvt_pk_bf16_f32 v106, v36, v37
v_cvt_pk_bf16_f32 v107, v38, v39
buffer_store_dwordx4 v[104:107], v5, s[16:19], s40 offen sc1
v_pk_mul_f32 v[184:185], v[184:185], v[28:29] op_sel_hi:[1,0]
v_pk_mul_f32 v[186:187], v[186:187], v[28:29] op_sel_hi:[1,0]
v_pk_mul_f32 v[188:189], v[188:189], v[28:29] op_sel_hi:[1,0]
v_pk_mul_f32 v[190:191], v[190:191], v[28:29] op_sel_hi:[1,0]
v_pk_fma_f32 v[216:217], v[184:185], v[30:31], v[216:217] op_sel_hi:[1,0,1]
v_pk_fma_f32 v[218:219], v[186:187], v[30:31], v[218:219] op_sel_hi:[1,0,1]
v_pk_fma_f32 v[220:221], v[188:189], v[30:31], v[220:221] op_sel_hi:[1,0,1]
v_pk_fma_f32 v[222:223], v[190:191], v[30:31], v[222:223] op_sel_hi:[1,0,1]
v_pk_fma_f32 v[40:41], v[40:41], v[184:185], v[216:217] op_sel_hi:[1,1,1]
v_pk_fma_f32 v[42:43], v[42:43], v[186:187], v[218:219] op_sel_hi:[1,1,1]
v_pk_fma_f32 v[44:45], v[44:45], v[188:189], v[220:221] op_sel_hi:[1,1,1]
v_pk_fma_f32 v[46:47], v[46:47], v[190:191], v[222:223] op_sel_hi:[1,1,1]
v_cvt_pk_bf16_f32 v108, v40, v41
v_cvt_pk_bf16_f32 v109, v42, v43
v_cvt_pk_bf16_f32 v110, v44, v45
v_cvt_pk_bf16_f32 v111, v46, v47
buffer_store_dwordx4 v[108:111], v5, s[16:19], s41 offen sc1
v_pk_mul_f32 v[192:193], v[192:193], v[28:29] op_sel_hi:[1,0]
v_pk_mul_f32 v[194:195], v[194:195], v[28:29] op_sel_hi:[1,0]
v_pk_mul_f32 v[196:197], v[196:197], v[28:29] op_sel_hi:[1,0]
v_pk_mul_f32 v[198:199], v[198:199], v[28:29] op_sel_hi:[1,0]
v_pk_fma_f32 v[224:225], v[192:193], v[30:31], v[224:225] op_sel_hi:[1,0,1]
v_pk_fma_f32 v[226:227], v[194:195], v[30:31], v[226:227] op_sel_hi:[1,0,1]
v_pk_fma_f32 v[228:229], v[196:197], v[30:31], v[228:229] op_sel_hi:[1,0,1]
v_pk_fma_f32 v[230:231], v[198:199], v[30:31], v[230:231] op_sel_hi:[1,0,1]
v_pk_fma_f32 v[48:49], v[48:49], v[192:193], v[224:225] op_sel_hi:[1,1,1]
v_pk_fma_f32 v[50:51], v[50:51], v[194:195], v[226:227] op_sel_hi:[1,1,1]
v_pk_fma_f32 v[52:53], v[52:53], v[196:197], v[228:229] op_sel_hi:[1,1,1]
v_pk_fma_f32 v[54:55], v[54:55], v[198:199], v[230:231] op_sel_hi:[1,1,1]
v_cvt_pk_bf16_f32 v112, v48, v49
v_cvt_pk_bf16_f32 v113, v50, v51
v_cvt_pk_bf16_f32 v114, v52, v53
v_cvt_pk_bf16_f32 v115, v54, v55
buffer_store_dwordx4 v[112:115], v5, s[16:19], s42 offen sc1
v_pk_mul_f32 v[200:201], v[200:201], v[28:29] op_sel_hi:[1,0]
v_pk_mul_f32 v[202:203], v[202:203], v[28:29] op_sel_hi:[1,0]
v_pk_mul_f32 v[204:205], v[204:205], v[28:29] op_sel_hi:[1,0]
v_pk_mul_f32 v[206:207], v[206:207], v[28:29] op_sel_hi:[1,0]
v_pk_fma_f32 v[232:233], v[200:201], v[30:31], v[232:233] op_sel_hi:[1,0,1]
v_pk_fma_f32 v[234:235], v[202:203], v[30:31], v[234:235] op_sel_hi:[1,0,1]
v_pk_fma_f32 v[236:237], v[204:205], v[30:31], v[236:237] op_sel_hi:[1,0,1]
v_pk_fma_f32 v[238:239], v[206:207], v[30:31], v[238:239] op_sel_hi:[1,0,1]
v_pk_fma_f32 v[56:57], v[56:57], v[200:201], v[232:233] op_sel_hi:[1,1,1]
v_pk_fma_f32 v[58:59], v[58:59], v[202:203], v[234:235] op_sel_hi:[1,1,1]
v_pk_fma_f32 v[60:61], v[60:61], v[204:205], v[236:237] op_sel_hi:[1,1,1]
v_pk_fma_f32 v[62:63], v[62:63], v[206:207], v[238:239] op_sel_hi:[1,1,1]
v_cvt_pk_bf16_f32 v116, v56, v57
v_cvt_pk_bf16_f32 v117, v58, v59
v_cvt_pk_bf16_f32 v118, v60, v61
v_cvt_pk_bf16_f32 v119, v62, v63
buffer_store_dwordx4 v[116:119], v5, s[16:19], s43 offen sc1
s_waitcnt vmcnt(0)
s_barrier
s_cmp_lg_u32 s26, 0
s_cbranch_scc1 adaLN_cond__sliding_block_cached__swiglu_ffn__prompt_kernel_arr_40
s_add_u32 s27, s24, 48
s_lshl_b32 s6, s27, 8
s_add_u32 s6, s6, 0x20000
s_add_u32 s6, s6, s90
s_addc_u32 s7, s91, 0
v_mov_b32 v2, 0
v_mov_b32 v3, 1
s_mov_b64 exec, 1
global_atomic_add v2, v3, s[6:7] sc1
s_mov_b64 exec, -1
adaLN_cond__sliding_block_cached__swiglu_ffn__prompt_kernel_arr_40:
s_add_u32 s16, s90, 0x3500000
s_addc_u32 s17, s91, 0
s_mov_b32 s18, 0x400000
s_mov_b32 s19, 0x20000
buffer_store_dwordx4 v[64:67], v5, s[16:19], s40 offen sc1
buffer_store_dwordx4 v[68:71], v5, s[16:19], s41 offen sc1
buffer_store_dwordx4 v[72:75], v5, s[16:19], s42 offen sc1
buffer_store_dwordx4 v[76:79], v5, s[16:19], s43 offen sc1
adaLN_cond__sliding_block_cached__swiglu_ffn__prompt_kernel_L_gateup:
s_lshl_b32 s35, s22, 3
s_add_u32 s35, s35, s25
v_lshrrev_b32 v20, 5, v1
v_lshlrev_b32 v20, 3, v20
v_bfe_u32 v21, v1, 2, 2
v_add_u32 v20, v20, v21
v_mul_u32_u24 v20, 224, v20
v_bfe_u32 v21, v1, 4, 1
v_mul_u32_u24 v21, 14464, v21
v_add_u32 v20, v20, v21
v_and_b32 v21, 1, v1
v_lshl_add_u32 v20, v21, 4, v20
v_bfe_u32 v21, v1, 1, 1
v_lshl_add_u32 v4, v21, 3, v20
v_add_u32 v5, 57856, v4
v_lshlrev_b32 v8, 4, v1
v_add_u32 v9, 0x10000, v8
s_and_b32 s27, s26, 1
s_mul_i32 s28, s27, 448
s_mul_i32 s29, s35, 224
v_add_u32 v20, s28, v1
v_mul_u32_u24 v21, 4682, v20
v_lshrrev_b32 v21, 16, v21
v_mul_u32_u24 v22, 14, v21
v_sub_u32 v22, v20, v22
v_mul_u32_u24 v21, 7168, v21
v_lshl_add_u32 v21, v22, 4, v21
v_add_u32 v21, s29, v21
v_subrev_u32 v10, 0, v21
v_add_u32 v20, s28, v1
v_add_u32 v20, 64, v20
v_mul_u32_u24 v21, 4682, v20
v_lshrrev_b32 v21, 16, v21
v_mul_u32_u24 v22, 14, v21
v_sub_u32 v22, v20, v22
v_mul_u32_u24 v21, 7168, v21
v_lshl_add_u32 v21, v22, 4, v21
v_add_u32 v21, s29, v21
v_subrev_u32 v11, 1024, v21
v_add_u32 v20, s28, v1
v_add_u32 v20, 128, v20
v_mul_u32_u24 v21, 4682, v20
v_lshrrev_b32 v21, 16, v21
v_mul_u32_u24 v22, 14, v21
v_sub_u32 v22, v20, v22
v_mul_u32_u24 v21, 7168, v21
v_lshl_add_u32 v21, v22, 4, v21
v_add_u32 v21, s29, v21
v_subrev_u32 v12, 2048, v21
v_add_u32 v20, s28, v1
v_add_u32 v20, 192, v20
v_mul_u32_u24 v21, 4682, v20
v_lshrrev_b32 v21, 16, v21
v_mul_u32_u24 v22, 14, v21
v_sub_u32 v22, v20, v22
v_mul_u32_u24 v21, 7168, v21
v_lshl_add_u32 v21, v22, 4, v21
v_add_u32 v21, s29, v21
v_subrev_u32 v13, 3072, v21
v_add_u32 v20, s28, v1
v_add_u32 v20, 256, v20
v_mul_u32_u24 v21, 4682, v20
v_lshrrev_b32 v21, 16, v21
v_mul_u32_u24 v22, 14, v21
v_sub_u32 v22, v20, v22
v_mul_u32_u24 v21, 7168, v21
v_lshl_add_u32 v21, v22, 4, v21
v_add_u32 v21, s29, v21
v_subrev_u32 v14, 0, v21
v_add_u32 v20, s28, v1
v_add_u32 v20, 320, v20
v_mul_u32_u24 v21, 4682, v20
v_lshrrev_b32 v21, 16, v21
v_mul_u32_u24 v22, 14, v21
v_sub_u32 v22, v20, v22
v_mul_u32_u24 v21, 7168, v21
v_lshl_add_u32 v21, v22, 4, v21
v_add_u32 v21, s29, v21
v_subrev_u32 v15, 1024, v21
v_add_u32 v20, s28, v1
v_add_u32 v20, 384, v20
v_mul_u32_u24 v21, 4682, v20
v_lshrrev_b32 v21, 16, v21
v_mul_u32_u24 v22, 14, v21
v_sub_u32 v22, v20, v22
v_mul_u32_u24 v21, 7168, v21
v_lshl_add_u32 v21, v22, 4, v21
v_add_u32 v21, s29, v21
v_subrev_u32 v16, 2048, v21
s_add_u32 s8, s90, 0x3900000
s_addc_u32 s9, s91, 0
s_mov_b32 s10, 0x400000
s_mov_b32 s11, 0x20000
s_cmp_ge_u32 s26, 2
s_cselect_b32 s12, s78, s76
s_cselect_b32 s13, s79, s77
s_mov_b32 s14, 0x700000
s_mov_b32 s15, 0x20000
s_lshl_b32 s27, s24, 3
s_lshl_b32 s28, s26, 1
s_add_u32 s34, s27, s28
s_lshl_b32 s38, s34, 16
s_add_u32 s38, s38, 61440
s_lshr_b32 s27, s26, 1
s_mul_i32 s32, s27, 14464
s_and_b32 s27, s26, 1
s_mul_i32 s27, s27, 7168
s_add_u32 s32, s32, s27
s_cmp_lg_u32 s26, 0
s_cbranch_scc1 adaLN_cond__sliding_block_cached__swiglu_ffn__prompt_kernel_ws_43
s_add_u32 s27, s24, 48
s_lshl_b32 s6, s27, 8
s_add_u32 s6, s6, 0x20000
s_add_u32 s6, s6, s90
s_addc_u32 s7, s91, 0
v_mov_b32 v2, 0
s_mov_b32 s27, 0
s_mov_b64 exec, 1
adaLN_cond__sliding_block_cached__swiglu_ffn__prompt_kernel_wt_41:
global_load_dword v3, v2, s[6:7] offset:0 sc1
s_waitcnt vmcnt(0)
v_readfirstlane_b32 s28, v3
s_add_u32 s27, s27, 1
s_cmp_ge_u32 s28, 32
s_cbranch_scc1 adaLN_cond__sliding_block_cached__swiglu_ffn__prompt_kernel_wd_42
s_cmp_ge_u32 s27, 0x40000
s_cbranch_scc1 adaLN_cond__sliding_block_cached__swiglu_ffn__prompt_kernel_wd_42
s_sleep 2
s_branch adaLN_cond__sliding_block_cached__swiglu_ffn__prompt_kernel_wt_41
adaLN_cond__sliding_block_cached__swiglu_ffn__prompt_kernel_wd_42:
s_mov_b64 exec, -1
adaLN_cond__sliding_block_cached__swiglu_ffn__prompt_kernel_ws_43:
s_barrier
s_add_u32 m0, s32, 0xe200
s_add_u32 s30, s30, 4096
buffer_load_dwordx4 a[0:3], v8, s[8:11], s30 offen offset:0 sc1
buffer_load_dwordx4 a[16:19], v9, s[8:11], s30 offen offset:0 sc1
buffer_load_dwordx4 a[4:7], v8, s[8:11], s30 offen offset:1024 sc1
buffer_load_dwordx4 a[20:23], v9, s[8:11], s30 offen offset:1024 sc1
buffer_load_dwordx4 a[8:11], v8, s[8:11], s30 offen offset:2048 sc1
buffer_load_dwordx4 a[24:27], v9, s[8:11], s30 offen offset:2048 sc1
buffer_load_dwordx4 a[12:15], v8, s[8:11], s30 offen offset:3072 sc1
buffer_load_dwordx4 a[28:31], v9, s[8:11], s30 offen offset:3072 sc1
s_add_u32 s30, s30, 4096
buffer_load_dwordx4 a[32:35], v8, s[8:11], s30 offen offset:0 sc1
buffer_load_dwordx4 a[48:51], v9, s[8:11], s30 offen offset:0 sc1
buffer_load_dwordx4 a[36:39], v8, s[8:11], s30 offen offset:1024 sc1
buffer_load_dwordx4 a[52:55], v9, s[8:11], s30 offen offset:1024 sc1
buffer_load_dwordx4 a[40:43], v8, s[8:11], s30 offen offset:2048 sc1
buffer_load_dwordx4 a[56:59], v9, s[8:11], s30 offen offset:2048 sc1
buffer_load_dwordx4 a[44:47], v8, s[8:11], s30 offen offset:3072 sc1
buffer_load_dwordx4 a[60:63], v9, s[8:11], s30 offen offset:3072 sc1
s_add_u32 s16, s90, 0x3d00000
s_addc_u32 s17, s91, 0
s_mov_b32 s18, 0xe00000
s_mov_b32 s19, 0x20000
s_mul_i32 s27, s34, 224
s_mul_i32 s28, s35, 7
s_add_u32 s27, s27, s28
s_lshl_b32 s36, s27, 10
s_add_u32 s37, s36, 229376
s_mov_b32 s40, 0xbfb8aa3b
s_mov_b32 s41, 0xbfb8aa3b
v_add_u32 v31, 4096, v8
v_mov_b32 v30, v8
v_mov_b32 v29, 0xbfb8aa3b
s_waitcnt vmcnt(10)
s_barrier
ds_read_b64_tr_b16 a[128:129], v4 offset:0
ds_read_b64_tr_b16 a[130:131], v4 offset:896
ds_read_b64_tr_b16 a[132:133], v4 offset:32
ds_read_b64_tr_b16 a[134:135], v4 offset:928
ds_read_b64_tr_b16 a[136:137], v4 offset:64
ds_read_b64_tr_b16 a[138:139], v4 offset:960
ds_read_b64_tr_b16 a[140:141], v4 offset:96
ds_read_b64_tr_b16 a[142:143], v4 offset:992
ds_read_b64_tr_b16 a[144:145], v4 offset:128
ds_read_b64_tr_b16 a[146:147], v4 offset:1024
ds_read_b64_tr_b16 a[148:149], v4 offset:160
ds_read_b64_tr_b16 a[150:151], v4 offset:1056
ds_read_b64_tr_b16 a[152:153], v4 offset:192
ds_read_b64_tr_b16 a[154:155], v4 offset:1088
s_waitcnt lgkmcnt(0)
v_mfma_f32_32x32x16_bf16 v[32:47], a[128:131], a[0:3], 0
ds_read_b64_tr_b16 a[156:157], v4 offset:3584
ds_read_b64_tr_b16 a[158:159], v4 offset:4480
v_mfma_f32_32x32x16_bf16 v[48:63], a[128:131], a[16:19], 0
ds_read_b64_tr_b16 a[160:161], v4 offset:3616
ds_read_b64_tr_b16 a[162:163], v4 offset:4512
v_mfma_f32_32x32x16_bf16 v[64:79], a[132:135], a[0:3], 0
ds_read_b64_tr_b16 a[164:165], v4 offset:3648
ds_read_b64_tr_b16 a[166:167], v4 offset:4544
v_mfma_f32_32x32x16_bf16 v[80:95], a[132:135], a[16:19], 0
ds_read_b64_tr_b16 a[168:169], v4 offset:3680
ds_read_b64_tr_b16 a[170:171], v4 offset:4576
v_mfma_f32_32x32x16_bf16 v[96:111], a[136:139], a[0:3], 0
ds_read_b64_tr_b16 a[172:173], v4 offset:3712
ds_read_b64_tr_b16 a[174:175], v4 offset:4608
v_mfma_f32_32x32x16_bf16 v[112:127], a[136:139], a[16:19], 0
ds_read_b64_tr_b16 a[176:177], v4 offset:3744
ds_read_b64_tr_b16 a[178:179], v4 offset:4640
v_mfma_f32_32x32x16_bf16 v[128:143], a[140:143], a[0:3], 0
ds_read_b64_tr_b16 a[180:181], v4 offset:3776
ds_read_b64_tr_b16 a[182:183], v4 offset:4672
v_mfma_f32_32x32x16_bf16 v[144:159], a[140:143], a[16:19], 0
s_add_u32 s30, s30, 4096
buffer_load_dwordx4 a[64:67], v8, s[8:11], s30 offen offset:0 sc1
v_mfma_f32_32x32x16_bf16 v[160:175], a[144:147], a[0:3], 0
buffer_load_dwordx4 v12, s[12:15], s31 offen offset:2048 lds
v_mfma_f32_32x32x16_bf16 v[176:191], a[144:147], a[16:19], 0
buffer_load_dwordx4 v13, s[12:15], s31 offen offset:3072 lds
v_mfma_f32_32x32x16_bf16 v[192:207], a[148:151], a[0:3], 0
v_mfma_f32_32x32x16_bf16 v[208:223], a[148:151], a[16:19], 0
buffer_load_dwordx4 a[80:83], v9, s[8:11], s30 offen offset:0 sc1
v_mfma_f32_32x32x16_bf16 v[224:239], a[152:155], a[0:3], 0
buffer_load_dwordx4 a[68:71], v8, s[8:11], s30 offen offset:1024 sc1
v_mfma_f32_32x32x16_bf16 v[240:255], a[152:155], a[16:19], 0
s_waitcnt lgkmcnt(0)
v_mfma_f32_32x32x16_bf16 v[32:47], a[156:159], a[4:7], v[32:47]
ds_read_b64_tr_b16 a[128:129], v4 offset:7168
ds_read_b64_tr_b16 a[130:131], v4 offset:8064
v_mfma_f32_32x32x16_bf16 v[48:63], a[156:159], a[20:23], v[48:63]
ds_read_b64_tr_b16 a[132:133], v4 offset:7200
ds_read_b64_tr_b16 a[134:135], v4 offset:8096
v_mfma_f32_32x32x16_bf16 v[64:79], a[160:163], a[4:7], v[64:79]
ds_read_b64_tr_b16 a[136:137], v4 offset:7232
ds_read_b64_tr_b16 a[138:139], v4 offset:8128
v_mfma_f32_32x32x16_bf16 v[80:95], a[160:163], a[20:23], v[80:95]
ds_read_b64_tr_b16 a[140:141], v4 offset:7264
ds_read_b64_tr_b16 a[142:143], v4 offset:8160
v_mfma_f32_32x32x16_bf16 v[96:111], a[164:167], a[4:7], v[96:111]
ds_read_b64_tr_b16 a[144:145], v4 offset:7296
ds_read_b64_tr_b16 a[146:147], v4 offset:8192
v_mfma_f32_32x32x16_bf16 v[112:127], a[164:167], a[20:23], v[112:127]
ds_read_b64_tr_b16 a[148:149], v4 offset:7328
ds_read_b64_tr_b16 a[150:151], v4 offset:8224
v_mfma_f32_32x32x16_bf16 v[128:143], a[168:171], a[4:7], v[128:143]
ds_read_b64_tr_b16 a[152:153], v4 offset:7360
ds_read_b64_tr_b16 a[154:155], v4 offset:8256
v_mfma_f32_32x32x16_bf16 v[144:159], a[168:171], a[20:23], v[144:159]
s_add_u32 m0, s32, 0xf200
s_nop 0
buffer_load_dwordx4 v14, s[12:15], s31 offen offset:0 lds
v_mfma_f32_32x32x16_bf16 v[160:175], a[172:175], a[4:7], v[160:175]
buffer_load_dwordx4 v15, s[12:15], s31 offen offset:1024 lds
v_mfma_f32_32x32x16_bf16 v[176:191], a[172:175], a[20:23], v[176:191]
buffer_load_dwordx4 a[84:87], v9, s[8:11], s30 offen offset:1024 sc1
v_mfma_f32_32x32x16_bf16 v[192:207], a[176:179], a[4:7], v[192:207]
v_mfma_f32_32x32x16_bf16 v[208:223], a[176:179], a[20:23], v[208:223]
buffer_load_dwordx4 a[72:75], v8, s[8:11], s30 offen offset:2048 sc1
v_mfma_f32_32x32x16_bf16 v[224:239], a[180:183], a[4:7], v[224:239]
buffer_load_dwordx4 v16, s[12:15], s31 offen offset:2048 lds
v_mfma_f32_32x32x16_bf16 v[240:255], a[180:183], a[20:23], v[240:255]
s_waitcnt lgkmcnt(0)
v_mfma_f32_32x32x16_bf16 v[32:47], a[128:131], a[8:11], v[32:47]
ds_read_b64_tr_b16 a[156:157], v4 offset:10752
ds_read_b64_tr_b16 a[158:159], v4 offset:11648
v_mfma_f32_32x32x16_bf16 v[48:63], a[128:131], a[24:27], v[48:63]
ds_read_b64_tr_b16 a[160:161], v4 offset:10784
ds_read_b64_tr_b16 a[162:163], v4 offset:11680
v_mfma_f32_32x32x16_bf16 v[64:79], a[132:135], a[8:11], v[64:79]
ds_read_b64_tr_b16 a[164:165], v4 offset:10816
ds_read_b64_tr_b16 a[166:167], v4 offset:11712
v_mfma_f32_32x32x16_bf16 v[80:95], a[132:135], a[24:27], v[80:95]
ds_read_b64_tr_b16 a[168:169], v4 offset:10848
ds_read_b64_tr_b16 a[170:171], v4 offset:11744
v_mfma_f32_32x32x16_bf16 v[96:111], a[136:139], a[8:11], v[96:111]
ds_read_b64_tr_b16 a[172:173], v4 offset:10880
ds_read_b64_tr_b16 a[174:175], v4 offset:11776
v_mfma_f32_32x32x16_bf16 v[112:127], a[136:139], a[24:27], v[112:127]
ds_read_b64_tr_b16 a[176:177], v4 offset:10912
ds_read_b64_tr_b16 a[178:179], v4 offset:11808
v_mfma_f32_32x32x16_bf16 v[128:143], a[140:143], a[8:11], v[128:143]
ds_read_b64_tr_b16 a[180:181], v4 offset:10944
ds_read_b64_tr_b16 a[182:183], v4 offset:11840
v_mfma_f32_32x32x16_bf16 v[144:159], a[140:143], a[24:27], v[144:159]
buffer_load_dwordx4 a[88:91], v9, s[8:11], s30 offen offset:2048 sc1
v_mfma_f32_32x32x16_bf16 v[160:175], a[144:147], a[8:11], v[160:175]
buffer_load_dwordx4 a[76:79], v8, s[8:11], s30 offen offset:3072 sc1
v_mfma_f32_32x32x16_bf16 v[176:191], a[144:147], a[24:27], v[176:191]
v_mfma_f32_32x32x16_bf16 v[192:207], a[148:151], a[8:11], v[192:207]
s_add_u32 s31, s31, 0x70000
s_add_u32 m0, s32, 0x15300
s_nop 0
buffer_load_dwordx4 v10, s[12:15], s31 offen offset:0 lds
v_mfma_f32_32x32x16_bf16 v[208:223], a[148:151], a[24:27], v[208:223]
v_mfma_f32_32x32x16_bf16 v[224:239], a[152:155], a[8:11], v[224:239]
buffer_load_dwordx4 v11, s[12:15], s31 offen offset:1024 lds
v_mfma_f32_32x32x16_bf16 v[240:255], a[152:155], a[24:27], v[240:255]
s_waitcnt vmcnt(16) lgkmcnt(0)
s_barrier
v_mfma_f32_32x32x16_bf16 v[32:47], a[156:159], a[12:15], v[32:47]
ds_read_b64_tr_b16 a[128:129], v4 offset:28928
ds_read_b64_tr_b16 a[130:131], v4 offset:29824
v_mfma_f32_32x32x16_bf16 v[48:63], a[156:159], a[28:31], v[48:63]
ds_read_b64_tr_b16 a[132:133], v4 offset:28960
ds_read_b64_tr_b16 a[134:135], v4 offset:29856
v_mfma_f32_32x32x16_bf16 v[64:79], a[160:163], a[12:15], v[64:79]
ds_read_b64_tr_b16 a[136:137], v4 offset:28992
ds_read_b64_tr_b16 a[138:139], v4 offset:29888
v_mfma_f32_32x32x16_bf16 v[80:95], a[160:163], a[28:31], v[80:95]
ds_read_b64_tr_b16 a[140:141], v4 offset:29024
ds_read_b64_tr_b16 a[142:143], v4 offset:29920
v_mfma_f32_32x32x16_bf16 v[96:111], a[164:167], a[12:15], v[96:111]
ds_read_b64_tr_b16 a[144:145], v4 offset:29056
ds_read_b64_tr_b16 a[146:147], v4 offset:29952
v_mfma_f32_32x32x16_bf16 v[112:127], a[164:167], a[28:31], v[112:127]
ds_read_b64_tr_b16 a[148:149], v4 offset:29088
ds_read_b64_tr_b16 a[150:151], v4 offset:29984
v_mfma_f32_32x32x16_bf16 v[128:143], a[168:171], a[12:15], v[128:143]
ds_read_b64_tr_b16 a[152:153], v4 offset:29120
ds_read_b64_tr_b16 a[154:155], v4 offset:30016
v_mfma_f32_32x32x16_bf16 v[144:159], a[168:171], a[28:31], v[144:159]
buffer_load_dwordx4 a[92:95], v9, s[8:11], s30 offen offset:3072 sc1
v_mfma_f32_32x32x16_bf16 v[160:175], a[172:175], a[12:15], v[160:175]
s_add_u32 s30, s30, 4096
buffer_load_dwordx4 a[96:99], v8, s[8:11], s30 offen offset:0 sc1
v_mfma_f32_32x32x16_bf16 v[176:191], a[172:175], a[28:31], v[176:191]
buffer_load_dwordx4 v12, s[12:15], s31 offen offset:2048 lds
v_mfma_f32_32x32x16_bf16 v[192:207], a[176:179], a[12:15], v[192:207]
v_mfma_f32_32x32x16_bf16 v[208:223], a[176:179], a[28:31], v[208:223]
buffer_load_dwordx4 v13, s[12:15], s31 offen offset:3072 lds
v_mfma_f32_32x32x16_bf16 v[224:239], a[180:183], a[12:15], v[224:239]
buffer_load_dwordx4 a[112:115], v9, s[8:11], s30 offen offset:0 sc1
v_mfma_f32_32x32x16_bf16 v[240:255], a[180:183], a[28:31], v[240:255]
s_waitcnt lgkmcnt(0)
v_mfma_f32_32x32x16_bf16 v[32:47], a[128:131], a[32:35], v[32:47]
ds_read_b64_tr_b16 a[156:157], v4 offset:32512
ds_read_b64_tr_b16 a[158:159], v4 offset:33408
v_mfma_f32_32x32x16_bf16 v[48:63], a[128:131], a[48:51], v[48:63]
ds_read_b64_tr_b16 a[160:161], v4 offset:32544
ds_read_b64_tr_b16 a[162:163], v4 offset:33440
v_mfma_f32_32x32x16_bf16 v[64:79], a[132:135], a[32:35], v[64:79]
ds_read_b64_tr_b16 a[164:165], v4 offset:32576
ds_read_b64_tr_b16 a[166:167], v4 offset:33472
v_mfma_f32_32x32x16_bf16 v[80:95], a[132:135], a[48:51], v[80:95]
ds_read_b64_tr_b16 a[168:169], v4 offset:32608
ds_read_b64_tr_b16 a[170:171], v4 offset:33504
v_mfma_f32_32x32x16_bf16 v[96:111], a[136:139], a[32:35], v[96:111]
ds_read_b64_tr_b16 a[172:173], v4 offset:32640
ds_read_b64_tr_b16 a[174:175], v4 offset:33536
v_mfma_f32_32x32x16_bf16 v[112:127], a[136:139], a[48:51], v[112:127]
ds_read_b64_tr_b16 a[176:177], v4 offset:32672
ds_read_b64_tr_b16 a[178:179], v4 offset:33568
v_mfma_f32_32x32x16_bf16 v[128:143], a[140:143], a[32:35], v[128:143]
ds_read_b64_tr_b16 a[180:181], v4 offset:32704
ds_read_b64_tr_b16 a[182:183], v4 offset:33600
v_mfma_f32_32x32x16_bf16 v[144:159], a[140:143], a[48:51], v[144:159]
buffer_load_dwordx4 a[100:103], v8, s[8:11], s30 offen offset:1024 sc1
v_mfma_f32_32x32x16_bf16 v[160:175], a[144:147], a[32:35], v[160:175]
s_add_u32 m0, s32, 0x16300
s_nop 0
buffer_load_dwordx4 v14, s[12:15], s31 offen offset:0 lds
v_mfma_f32_32x32x16_bf16 v[176:191], a[144:147], a[48:51], v[176:191]
buffer_load_dwordx4 v15, s[12:15], s31 offen offset:1024 lds
v_mfma_f32_32x32x16_bf16 v[192:207], a[148:151], a[32:35], v[192:207]
v_mfma_f32_32x32x16_bf16 v[208:223], a[148:151], a[48:51], v[208:223]
buffer_load_dwordx4 a[116:119], v9, s[8:11], s30 offen offset:1024 sc1
v_mfma_f32_32x32x16_bf16 v[224:239], a[152:155], a[32:35], v[224:239]
buffer_load_dwordx4 a[104:107], v8, s[8:11], s30 offen offset:2048 sc1
v_mfma_f32_32x32x16_bf16 v[240:255], a[152:155], a[48:51], v[240:255]
s_waitcnt lgkmcnt(0)
v_mfma_f32_32x32x16_bf16 v[32:47], a[156:159], a[36:39], v[32:47]
ds_read_b64_tr_b16 a[128:129], v4 offset:36096
ds_read_b64_tr_b16 a[130:131], v4 offset:36992
v_mfma_f32_32x32x16_bf16 v[48:63], a[156:159], a[52:55], v[48:63]
ds_read_b64_tr_b16 a[132:133], v4 offset:36128
ds_read_b64_tr_b16 a[134:135], v4 offset:37024
v_mfma_f32_32x32x16_bf16 v[64:79], a[160:163], a[36:39], v[64:79]
ds_read_b64_tr_b16 a[136:137], v4 offset:36160
ds_read_b64_tr_b16 a[138:139], v4 offset:37056
v_mfma_f32_32x32x16_bf16 v[80:95], a[160:163], a[52:55], v[80:95]
ds_read_b64_tr_b16 a[140:141], v4 offset:36192
ds_read_b64_tr_b16 a[142:143], v4 offset:37088
v_mfma_f32_32x32x16_bf16 v[96:111], a[164:167], a[36:39], v[96:111]
ds_read_b64_tr_b16 a[144:145], v4 offset:36224
ds_read_b64_tr_b16 a[146:147], v4 offset:37120
v_mfma_f32_32x32x16_bf16 v[112:127], a[164:167], a[52:55], v[112:127]
ds_read_b64_tr_b16 a[148:149], v4 offset:36256
ds_read_b64_tr_b16 a[150:151], v4 offset:37152
v_mfma_f32_32x32x16_bf16 v[128:143], a[168:171], a[36:39], v[128:143]
ds_read_b64_tr_b16 a[152:153], v4 offset:36288
ds_read_b64_tr_b16 a[154:155], v4 offset:37184
v_mfma_f32_32x32x16_bf16 v[144:159], a[168:171], a[52:55], v[144:159]
buffer_load_dwordx4 v16, s[12:15], s31 offen offset:2048 lds
v_mfma_f32_32x32x16_bf16 v[160:175], a[172:175], a[36:39], v[160:175]
buffer_load_dwordx4 a[120:123], v9, s[8:11], s30 offen offset:2048 sc1
v_mfma_f32_32x32x16_bf16 v[176:191], a[172:175], a[52:55], v[176:191]
buffer_load_dwordx4 a[108:111], v8, s[8:11], s30 offen offset:3072 sc1
v_mfma_f32_32x32x16_bf16 v[192:207], a[176:179], a[36:39], v[192:207]
v_mfma_f32_32x32x16_bf16 v[208:223], a[176:179], a[52:55], v[208:223]
s_add_u32 s31, s31, 0x70000
s_add_u32 m0, s32, 0x0
s_nop 0
buffer_load_dwordx4 v10, s[12:15], s31 offen offset:0 lds
v_mfma_f32_32x32x16_bf16 v[224:239], a[180:183], a[36:39], v[224:239]
buffer_load_dwordx4 v11, s[12:15], s31 offen offset:1024 lds
v_mfma_f32_32x32x16_bf16 v[240:255], a[180:183], a[52:55], v[240:255]
s_waitcnt lgkmcnt(0)
v_mfma_f32_32x32x16_bf16 v[32:47], a[128:131], a[40:43], v[32:47]
ds_read_b64_tr_b16 a[156:157], v4 offset:39680
ds_read_b64_tr_b16 a[158:159], v4 offset:40576
v_mfma_f32_32x32x16_bf16 v[48:63], a[128:131], a[56:59], v[48:63]
ds_read_b64_tr_b16 a[160:161], v4 offset:39712
ds_read_b64_tr_b16 a[162:163], v4 offset:40608
v_mfma_f32_32x32x16_bf16 v[64:79], a[132:135], a[40:43], v[64:79]
ds_read_b64_tr_b16 a[164:165], v4 offset:39744
ds_read_b64_tr_b16 a[166:167], v4 offset:40640
v_mfma_f32_32x32x16_bf16 v[80:95], a[132:135], a[56:59], v[80:95]
ds_read_b64_tr_b16 a[168:169], v4 offset:39776
ds_read_b64_tr_b16 a[170:171], v4 offset:40672
v_mfma_f32_32x32x16_bf16 v[96:111], a[136:139], a[40:43], v[96:111]
ds_read_b64_tr_b16 a[172:173], v4 offset:39808
ds_read_b64_tr_b16 a[174:175], v4 offset:40704
v_mfma_f32_32x32x16_bf16 v[112:127], a[136:139], a[56:59], v[112:127]
ds_read_b64_tr_b16 a[176:177], v4 offset:39840
ds_read_b64_tr_b16 a[178:179], v4 offset:40736
v_mfma_f32_32x32x16_bf16 v[128:143], a[140:143], a[40:43], v[128:143]
ds_read_b64_tr_b16 a[180:181], v4 offset:39872
ds_read_b64_tr_b16 a[182:183], v4 offset:40768
v_mfma_f32_32x32x16_bf16 v[144:159], a[140:143], a[56:59], v[144:159]
buffer_load_dwordx4 a[124:127], v9, s[8:11], s30 offen offset:3072 sc1
v_mfma_f32_32x32x16_bf16 v[160:175], a[144:147], a[40:43], v[160:175]
s_add_u32 s30, s30, 4096
buffer_load_dwordx4 a[0:3], v8, s[8:11], s30 offen offset:0 sc1
v_mfma_f32_32x32x16_bf16 v[176:191], a[144:147], a[56:59], v[176:191]
v_mfma_f32_32x32x16_bf16 v[192:207], a[148:151], a[40:43], v[192:207]
buffer_load_dwordx4 v12, s[12:15], s31 offen offset:2048 lds
v_mfma_f32_32x32x16_bf16 v[208:223], a[148:151], a[56:59], v[208:223]
v_mfma_f32_32x32x16_bf16 v[224:239], a[152:155], a[40:43], v[224:239]
buffer_load_dwordx4 v13, s[12:15], s31 offen offset:3072 lds
v_mfma_f32_32x32x16_bf16 v[240:255], a[152:155], a[56:59], v[240:255]
s_waitcnt vmcnt(22) lgkmcnt(0)
s_barrier
v_mfma_f32_32x32x16_bf16 v[32:47], a[156:159], a[44:47], v[32:47]
ds_read_b64_tr_b16 a[128:129], v5 offset:0
ds_read_b64_tr_b16 a[130:131], v5 offset:896
v_mfma_f32_32x32x16_bf16 v[48:63], a[156:159], a[60:63], v[48:63]
ds_read_b64_tr_b16 a[132:133], v5 offset:32
ds_read_b64_tr_b16 a[134:135], v5 offset:928
v_mfma_f32_32x32x16_bf16 v[64:79], a[160:163], a[44:47], v[64:79]
ds_read_b64_tr_b16 a[136:137], v5 offset:64
ds_read_b64_tr_b16 a[138:139], v5 offset:960
v_mfma_f32_32x32x16_bf16 v[80:95], a[160:163], a[60:63], v[80:95]
ds_read_b64_tr_b16 a[140:141], v5 offset:96
ds_read_b64_tr_b16 a[142:143], v5 offset:992
v_mfma_f32_32x32x16_bf16 v[96:111], a[164:167], a[44:47], v[96:111]
ds_read_b64_tr_b16 a[144:145], v5 offset:128
ds_read_b64_tr_b16 a[146:147], v5 offset:1024
v_mfma_f32_32x32x16_bf16 v[112:127], a[164:167], a[60:63], v[112:127]
ds_read_b64_tr_b16 a[148:149], v5 offset:160
ds_read_b64_tr_b16 a[150:151], v5 offset:1056
v_mfma_f32_32x32x16_bf16 v[128:143], a[168:171], a[44:47], v[128:143]
ds_read_b64_tr_b16 a[152:153], v5 offset:192
ds_read_b64_tr_b16 a[154:155], v5 offset:1088
v_mfma_f32_32x32x16_bf16 v[144:159], a[168:171], a[60:63], v[144:159]
buffer_load_dwordx4 a[16:19], v9, s[8:11], s30 offen offset:0 sc1
v_mfma_f32_32x32x16_bf16 v[160:175], a[172:175], a[44:47], v[160:175]
buffer_load_dwordx4 a[4:7], v8, s[8:11], s30 offen offset:1024 sc1
v_mfma_f32_32x32x16_bf16 v[176:191], a[172:175], a[60:63], v[176:191]
s_add_u32 m0, s32, 0x1000
s_nop 0
buffer_load_dwordx4 v14, s[12:15], s31 offen offset:0 lds
v_mfma_f32_32x32x16_bf16 v[192:207], a[176:179], a[44:47], v[192:207]
v_mfma_f32_32x32x16_bf16 v[208:223], a[176:179], a[60:63], v[208:223]
buffer_load_dwordx4 v15, s[12:15], s31 offen offset:1024 lds
v_mfma_f32_32x32x16_bf16 v[224:239], a[180:183], a[44:47], v[224:239]
buffer_load_dwordx4 a[20:23], v9, s[8:11], s30 offen offset:1024 sc1
v_mfma_f32_32x32x16_bf16 v[240:255], a[180:183], a[60:63], v[240:255]
s_waitcnt lgkmcnt(0)
v_mfma_f32_32x32x16_bf16 v[32:47], a[128:131], a[64:67], v[32:47]
ds_read_b64_tr_b16 a[156:157], v5 offset:3584
ds_read_b64_tr_b16 a[158:159], v5 offset:4480
v_mfma_f32_32x32x16_bf16 v[48:63], a[128:131], a[80:83], v[48:63]
ds_read_b64_tr_b16 a[160:161], v5 offset:3616
ds_read_b64_tr_b16 a[162:163], v5 offset:4512
v_mfma_f32_32x32x16_bf16 v[64:79], a[132:135], a[64:67], v[64:79]
ds_read_b64_tr_b16 a[164:165], v5 offset:3648
ds_read_b64_tr_b16 a[166:167], v5 offset:4544
v_mfma_f32_32x32x16_bf16 v[80:95], a[132:135], a[80:83], v[80:95]
ds_read_b64_tr_b16 a[168:169], v5 offset:3680
ds_read_b64_tr_b16 a[170:171], v5 offset:4576
v_mfma_f32_32x32x16_bf16 v[96:111], a[136:139], a[64:67], v[96:111]
ds_read_b64_tr_b16 a[172:173], v5 offset:3712
ds_read_b64_tr_b16 a[174:175], v5 offset:4608
v_mfma_f32_32x32x16_bf16 v[112:127], a[136:139], a[80:83], v[112:127]
ds_read_b64_tr_b16 a[176:177], v5 offset:3744
ds_read_b64_tr_b16 a[178:179], v5 offset:4640
v_mfma_f32_32x32x16_bf16 v[128:143], a[140:143], a[64:67], v[128:143]
ds_read_b64_tr_b16 a[180:181], v5 offset:3776
ds_read_b64_tr_b16 a[182:183], v5 offset:4672
v_mfma_f32_32x32x16_bf16 v[144:159], a[140:143], a[80:83], v[144:159]
buffer_load_dwordx4 a[8:11], v8, s[8:11], s30 offen offset:2048 sc1
v_mfma_f32_32x32x16_bf16 v[160:175], a[144:147], a[64:67], v[160:175]
buffer_load_dwordx4 v16, s[12:15], s31 offen offset:2048 lds
v_mfma_f32_32x32x16_bf16 v[176:191], a[144:147], a[80:83], v[176:191]
buffer_load_dwordx4 a[24:27], v9, s[8:11], s30 offen offset:2048 sc1
v_mfma_f32_32x32x16_bf16 v[192:207], a[148:151], a[64:67], v[192:207]
v_mfma_f32_32x32x16_bf16 v[208:223], a[148:151], a[80:83], v[208:223]
buffer_load_dwordx4 a[12:15], v8, s[8:11], s30 offen offset:3072 sc1
v_mfma_f32_32x32x16_bf16 v[224:239], a[152:155], a[64:67], v[224:239]
s_add_u32 s31, s31, 0x70000
s_add_u32 m0, s32, 0x7100
s_nop 0
buffer_load_dwordx4 v10, s[12:15], s31 offen offset:0 lds
v_mfma_f32_32x32x16_bf16 v[240:255], a[152:155], a[80:83], v[240:255]
s_waitcnt lgkmcnt(0)
v_mfma_f32_32x32x16_bf16 v[32:47], a[156:159], a[68:71], v[32:47]
ds_read_b64_tr_b16 a[128:129], v5 offset:7168
ds_read_b64_tr_b16 a[130:131], v5 offset:8064
v_mfma_f32_32x32x16_bf16 v[48:63], a[156:159], a[84:87], v[48:63]
ds_read_b64_tr_b16 a[132:133], v5 offset:7200
ds_read_b64_tr_b16 a[134:135], v5 offset:8096
v_mfma_f32_32x32x16_bf16 v[64:79], a[160:163], a[68:71], v[64:79]
ds_read_b64_tr_b16 a[136:137], v5 offset:7232
ds_read_b64_tr_b16 a[138:139], v5 offset:8128
v_mfma_f32_32x32x16_bf16 v[80:95], a[160:163], a[84:87], v[80:95]
ds_read_b64_tr_b16 a[140:141], v5 offset:7264
ds_read_b64_tr_b16 a[142:143], v5 offset:8160
v_mfma_f32_32x32x16_bf16 v[96:111], a[164:167], a[68:71], v[96:111]
ds_read_b64_tr_b16 a[144:145], v5 offset:7296
ds_read_b64_tr_b16 a[146:147], v5 offset:8192
v_mfma_f32_32x32x16_bf16 v[112:127], a[164:167], a[84:87], v[112:127]
ds_read_b64_tr_b16 a[148:149], v5 offset:7328
ds_read_b64_tr_b16 a[150:151], v5 offset:8224
v_mfma_f32_32x32x16_bf16 v[128:143], a[168:171], a[68:71], v[128:143]
ds_read_b64_tr_b16 a[152:153], v5 offset:7360
ds_read_b64_tr_b16 a[154:155], v5 offset:8256
v_mfma_f32_32x32x16_bf16 v[144:159], a[168:171], a[84:87], v[144:159]
buffer_load_dwordx4 v11, s[12:15], s31 offen offset:1024 lds
v_mfma_f32_32x32x16_bf16 v[160:175], a[172:175], a[68:71], v[160:175]
buffer_load_dwordx4 a[28:31], v9, s[8:11], s30 offen offset:3072 sc1
v_mfma_f32_32x32x16_bf16 v[176:191], a[172:175], a[84:87], v[176:191]
s_add_u32 s30, s30, 4096
buffer_load_dwordx4 a[32:35], v8, s[8:11], s30 offen offset:0 sc1
v_mfma_f32_32x32x16_bf16 v[192:207], a[176:179], a[68:71], v[192:207]
v_mfma_f32_32x32x16_bf16 v[208:223], a[176:179], a[84:87], v[208:223]
buffer_load_dwordx4 v12, s[12:15], s31 offen offset:2048 lds
v_mfma_f32_32x32x16_bf16 v[224:239], a[180:183], a[68:71], v[224:239]
buffer_load_dwordx4 v13, s[12:15], s31 offen offset:3072 lds
v_mfma_f32_32x32x16_bf16 v[240:255], a[180:183], a[84:87], v[240:255]
s_waitcnt lgkmcnt(0)
v_mfma_f32_32x32x16_bf16 v[32:47], a[128:131], a[72:75], v[32:47]
ds_read_b64_tr_b16 a[156:157], v5 offset:10752
ds_read_b64_tr_b16 a[158:159], v5 offset:11648
v_mfma_f32_32x32x16_bf16 v[48:63], a[128:131], a[88:91], v[48:63]
ds_read_b64_tr_b16 a[160:161], v5 offset:10784
ds_read_b64_tr_b16 a[162:163], v5 offset:11680
v_mfma_f32_32x32x16_bf16 v[64:79], a[132:135], a[72:75], v[64:79]
ds_read_b64_tr_b16 a[164:165], v5 offset:10816
ds_read_b64_tr_b16 a[166:167], v5 offset:11712
v_mfma_f32_32x32x16_bf16 v[80:95], a[132:135], a[88:91], v[80:95]
ds_read_b64_tr_b16 a[168:169], v5 offset:10848
ds_read_b64_tr_b16 a[170:171], v5 offset:11744
v_mfma_f32_32x32x16_bf16 v[96:111], a[136:139], a[72:75], v[96:111]
ds_read_b64_tr_b16 a[172:173], v5 offset:10880
ds_read_b64_tr_b16 a[174:175], v5 offset:11776
v_mfma_f32_32x32x16_bf16 v[112:127], a[136:139], a[88:91], v[112:127]
ds_read_b64_tr_b16 a[176:177], v5 offset:10912
ds_read_b64_tr_b16 a[178:179], v5 offset:11808
v_mfma_f32_32x32x16_bf16 v[128:143], a[140:143], a[72:75], v[128:143]
ds_read_b64_tr_b16 a[180:181], v5 offset:10944
ds_read_b64_tr_b16 a[182:183], v5 offset:11840
v_mfma_f32_32x32x16_bf16 v[144:159], a[140:143], a[88:91], v[144:159]
buffer_load_dwordx4 a[48:51], v9, s[8:11], s30 offen offset:0 sc1
v_mfma_f32_32x32x16_bf16 v[160:175], a[144:147], a[72:75], v[160:175]
buffer_load_dwordx4 a[36:39], v8, s[8:11], s30 offen offset:1024 sc1
v_mfma_f32_32x32x16_bf16 v[176:191], a[144:147], a[88:91], v[176:191]
v_mfma_f32_32x32x16_bf16 v[192:207], a[148:151], a[72:75], v[192:207]
s_add_u32 m0, s32, 0x8100
s_nop 0
buffer_load_dwordx4 v14, s[12:15], s31 offen offset:0 lds
v_mfma_f32_32x32x16_bf16 v[208:223], a[148:151], a[88:91], v[208:223]
v_mfma_f32_32x32x16_bf16 v[224:239], a[152:155], a[72:75], v[224:239]
buffer_load_dwordx4 v15, s[12:15], s31 offen offset:1024 lds
v_mfma_f32_32x32x16_bf16 v[240:255], a[152:155], a[88:91], v[240:255]
s_waitcnt vmcnt(26) lgkmcnt(0)
s_barrier
v_mfma_f32_32x32x16_bf16 v[32:47], a[156:159], a[76:79], v[32:47]
ds_read_b64_tr_b16 a[128:129], v5 offset:28928
ds_read_b64_tr_b16 a[130:131], v5 offset:29824
v_mfma_f32_32x32x16_bf16 v[48:63], a[156:159], a[92:95], v[48:63]
ds_read_b64_tr_b16 a[132:133], v5 offset:28960
ds_read_b64_tr_b16 a[134:135], v5 offset:29856
v_mfma_f32_32x32x16_bf16 v[64:79], a[160:163], a[76:79], v[64:79]
ds_read_b64_tr_b16 a[136:137], v5 offset:28992
ds_read_b64_tr_b16 a[138:139], v5 offset:29888
v_mfma_f32_32x32x16_bf16 v[80:95], a[160:163], a[92:95], v[80:95]
ds_read_b64_tr_b16 a[140:141], v5 offset:29024
ds_read_b64_tr_b16 a[142:143], v5 offset:29920
v_mfma_f32_32x32x16_bf16 v[96:111], a[164:167], a[76:79], v[96:111]
ds_read_b64_tr_b16 a[144:145], v5 offset:29056
ds_read_b64_tr_b16 a[146:147], v5 offset:29952
v_mfma_f32_32x32x16_bf16 v[112:127], a[164:167], a[92:95], v[112:127]
ds_read_b64_tr_b16 a[148:149], v5 offset:29088
ds_read_b64_tr_b16 a[150:151], v5 offset:29984
v_mfma_f32_32x32x16_bf16 v[128:143], a[168:171], a[76:79], v[128:143]
ds_read_b64_tr_b16 a[152:153], v5 offset:29120
ds_read_b64_tr_b16 a[154:155], v5 offset:30016
v_mfma_f32_32x32x16_bf16 v[144:159], a[168:171], a[92:95], v[144:159]
buffer_load_dwordx4 a[52:55], v9, s[8:11], s30 offen offset:1024 sc1
v_mfma_f32_32x32x16_bf16 v[160:175], a[172:175], a[76:79], v[160:175]
buffer_load_dwordx4 a[40:43], v8, s[8:11], s30 offen offset:2048 sc1
v_mfma_f32_32x32x16_bf16 v[176:191], a[172:175], a[92:95], v[176:191]
buffer_load_dwordx4 v16, s[12:15], s31 offen offset:2048 lds
v_mfma_f32_32x32x16_bf16 v[192:207], a[176:179], a[76:79], v[192:207]
v_mfma_f32_32x32x16_bf16 v[208:223], a[176:179], a[92:95], v[208:223]
buffer_load_dwordx4 a[56:59], v9, s[8:11], s30 offen offset:2048 sc1
v_mfma_f32_32x32x16_bf16 v[224:239], a[180:183], a[76:79], v[224:239]
buffer_load_dwordx4 a[44:47], v8, s[8:11], s30 offen offset:3072 sc1
v_mfma_f32_32x32x16_bf16 v[240:255], a[180:183], a[92:95], v[240:255]
s_waitcnt lgkmcnt(0)
v_mfma_f32_32x32x16_bf16 v[32:47], a[128:131], a[96:99], v[32:47]
ds_read_b64_tr_b16 a[156:157], v5 offset:32512
ds_read_b64_tr_b16 a[158:159], v5 offset:33408
v_mfma_f32_32x32x16_bf16 v[48:63], a[128:131], a[112:115], v[48:63]
ds_read_b64_tr_b16 a[160:161], v5 offset:32544
ds_read_b64_tr_b16 a[162:163], v5 offset:33440
v_mfma_f32_32x32x16_bf16 v[64:79], a[132:135], a[96:99], v[64:79]
ds_read_b64_tr_b16 a[164:165], v5 offset:32576
ds_read_b64_tr_b16 a[166:167], v5 offset:33472
v_mfma_f32_32x32x16_bf16 v[80:95], a[132:135], a[112:115], v[80:95]
ds_read_b64_tr_b16 a[168:169], v5 offset:32608
ds_read_b64_tr_b16 a[170:171], v5 offset:33504
v_mfma_f32_32x32x16_bf16 v[96:111], a[136:139], a[96:99], v[96:111]
ds_read_b64_tr_b16 a[172:173], v5 offset:32640
ds_read_b64_tr_b16 a[174:175], v5 offset:33536
v_mfma_f32_32x32x16_bf16 v[112:127], a[136:139], a[112:115], v[112:127]
ds_read_b64_tr_b16 a[176:177], v5 offset:32672
ds_read_b64_tr_b16 a[178:179], v5 offset:33568
v_mfma_f32_32x32x16_bf16 v[128:143], a[140:143], a[96:99], v[128:143]
ds_read_b64_tr_b16 a[180:181], v5 offset:32704
ds_read_b64_tr_b16 a[182:183], v5 offset:33600
v_mfma_f32_32x32x16_bf16 v[144:159], a[140:143], a[112:115], v[144:159]
s_add_u32 s31, s31, 0x70000
s_add_u32 m0, s32, 0xe200
s_nop 0
buffer_load_dwordx4 v10, s[12:15], s31 offen offset:0 lds
v_mfma_f32_32x32x16_bf16 v[160:175], a[144:147], a[96:99], v[160:175]
buffer_load_dwordx4 v11, s[12:15], s31 offen offset:1024 lds
v_mfma_f32_32x32x16_bf16 v[176:191], a[144:147], a[112:115], v[176:191]
buffer_load_dwordx4 a[60:63], v9, s[8:11], s30 offen offset:3072 sc1
v_mfma_f32_32x32x16_bf16 v[192:207], a[148:151], a[96:99], v[192:207]
v_mfma_f32_32x32x16_bf16 v[208:223], a[148:151], a[112:115], v[208:223]
s_add_u32 s30, s30, 4096
buffer_load_dwordx4 a[64:67], v8, s[8:11], s30 offen offset:0 sc1
v_mfma_f32_32x32x16_bf16 v[224:239], a[152:155], a[96:99], v[224:239]
buffer_load_dwordx4 v12, s[12:15], s31 offen offset:2048 lds
v_mfma_f32_32x32x16_bf16 v[240:255], a[152:155], a[112:115], v[240:255]
s_waitcnt lgkmcnt(0)
v_mfma_f32_32x32x16_bf16 v[32:47], a[156:159], a[100:103], v[32:47]
ds_read_b64_tr_b16 a[128:129], v5 offset:36096
ds_read_b64_tr_b16 a[130:131], v5 offset:36992
v_mfma_f32_32x32x16_bf16 v[48:63], a[156:159], a[116:119], v[48:63]
ds_read_b64_tr_b16 a[132:133], v5 offset:36128
ds_read_b64_tr_b16 a[134:135], v5 offset:37024
v_mfma_f32_32x32x16_bf16 v[64:79], a[160:163], a[100:103], v[64:79]
ds_read_b64_tr_b16 a[136:137], v5 offset:36160
ds_read_b64_tr_b16 a[138:139], v5 offset:37056
v_mfma_f32_32x32x16_bf16 v[80:95], a[160:163], a[116:119], v[80:95]
ds_read_b64_tr_b16 a[140:141], v5 offset:36192
ds_read_b64_tr_b16 a[142:143], v5 offset:37088
v_mfma_f32_32x32x16_bf16 v[96:111], a[164:167], a[100:103], v[96:111]
ds_read_b64_tr_b16 a[144:145], v5 offset:36224
ds_read_b64_tr_b16 a[146:147], v5 offset:37120
v_mfma_f32_32x32x16_bf16 v[112:127], a[164:167], a[116:119], v[112:127]
ds_read_b64_tr_b16 a[148:149], v5 offset:36256
ds_read_b64_tr_b16 a[150:151], v5 offset:37152
v_mfma_f32_32x32x16_bf16 v[128:143], a[168:171], a[100:103], v[128:143]
ds_read_b64_tr_b16 a[152:153], v5 offset:36288
ds_read_b64_tr_b16 a[154:155], v5 offset:37184
v_mfma_f32_32x32x16_bf16 v[144:159], a[168:171], a[116:119], v[144:159]
buffer_load_dwordx4 v13, s[12:15], s31 offen offset:3072 lds
v_mfma_f32_32x32x16_bf16 v[160:175], a[172:175], a[100:103], v[160:175]
buffer_load_dwordx4 a[80:83], v9, s[8:11], s30 offen offset:0 sc1
v_mfma_f32_32x32x16_bf16 v[176:191], a[172:175], a[116:119], v[176:191]
buffer_load_dwordx4 a[68:71], v8, s[8:11], s30 offen offset:1024 sc1
v_mfma_f32_32x32x16_bf16 v[192:207], a[176:179], a[100:103], v[192:207]
v_mfma_f32_32x32x16_bf16 v[208:223], a[176:179], a[116:119], v[208:223]
s_add_u32 m0, s32, 0xf200
s_nop 0
buffer_load_dwordx4 v14, s[12:15], s31 offen offset:0 lds
v_mfma_f32_32x32x16_bf16 v[224:239], a[180:183], a[100:103], v[224:239]
buffer_load_dwordx4 v15, s[12:15], s31 offen offset:1024 lds
v_mfma_f32_32x32x16_bf16 v[240:255], a[180:183], a[116:119], v[240:255]
s_waitcnt lgkmcnt(0)
v_mfma_f32_32x32x16_bf16 v[32:47], a[128:131], a[104:107], v[32:47]
ds_read_b64_tr_b16 a[156:157], v5 offset:39680
ds_read_b64_tr_b16 a[158:159], v5 offset:40576
v_mfma_f32_32x32x16_bf16 v[48:63], a[128:131], a[120:123], v[48:63]
ds_read_b64_tr_b16 a[160:161], v5 offset:39712
ds_read_b64_tr_b16 a[162:163], v5 offset:40608
v_mfma_f32_32x32x16_bf16 v[64:79], a[132:135], a[104:107], v[64:79]
ds_read_b64_tr_b16 a[164:165], v5 offset:39744
ds_read_b64_tr_b16 a[166:167], v5 offset:40640
v_mfma_f32_32x32x16_bf16 v[80:95], a[132:135], a[120:123], v[80:95]
ds_read_b64_tr_b16 a[168:169], v5 offset:39776
ds_read_b64_tr_b16 a[170:171], v5 offset:40672
v_mfma_f32_32x32x16_bf16 v[96:111], a[136:139], a[104:107], v[96:111]
ds_read_b64_tr_b16 a[172:173], v5 offset:39808
ds_read_b64_tr_b16 a[174:175], v5 offset:40704
v_mfma_f32_32x32x16_bf16 v[112:127], a[136:139], a[120:123], v[112:127]
ds_read_b64_tr_b16 a[176:177], v5 offset:39840
ds_read_b64_tr_b16 a[178:179], v5 offset:40736
v_mfma_f32_32x32x16_bf16 v[128:143], a[140:143], a[104:107], v[128:143]
ds_read_b64_tr_b16 a[180:181], v5 offset:39872
ds_read_b64_tr_b16 a[182:183], v5 offset:40768
v_mfma_f32_32x32x16_bf16 v[144:159], a[140:143], a[120:123], v[144:159]
buffer_load_dwordx4 a[84:87], v9, s[8:11], s30 offen offset:1024 sc1
v_mfma_f32_32x32x16_bf16 v[160:175], a[144:147], a[104:107], v[160:175]
buffer_load_dwordx4 a[72:75], v8, s[8:11], s30 offen offset:2048 sc1
v_mfma_f32_32x32x16_bf16 v[176:191], a[144:147], a[120:123], v[176:191]
v_mfma_f32_32x32x16_bf16 v[192:207], a[148:151], a[104:107], v[192:207]
buffer_load_dwordx4 v16, s[12:15], s31 offen offset:2048 lds
v_mfma_f32_32x32x16_bf16 v[208:223], a[148:151], a[120:123], v[208:223]
v_mfma_f32_32x32x16_bf16 v[224:239], a[152:155], a[104:107], v[224:239]
buffer_load_dwordx4 a[88:91], v9, s[8:11], s30 offen offset:2048 sc1
v_mfma_f32_32x32x16_bf16 v[240:255], a[152:155], a[120:123], v[240:255]
s_waitcnt vmcnt(30) lgkmcnt(0)
s_barrier
v_mfma_f32_32x32x16_bf16 v[32:47], a[156:159], a[108:111], v[32:47]
ds_read_b64_tr_b16 a[128:129], v4 offset:0
ds_read_b64_tr_b16 a[130:131], v4 offset:896
v_mfma_f32_32x32x16_bf16 v[48:63], a[156:159], a[124:127], v[48:63]
ds_read_b64_tr_b16 a[132:133], v4 offset:32
ds_read_b64_tr_b16 a[134:135], v4 offset:928
v_mfma_f32_32x32x16_bf16 v[64:79], a[160:163], a[108:111], v[64:79]
ds_read_b64_tr_b16 a[136:137], v4 offset:64
ds_read_b64_tr_b16 a[138:139], v4 offset:960
v_mfma_f32_32x32x16_bf16 v[80:95], a[160:163], a[124:127], v[80:95]
ds_read_b64_tr_b16 a[140:141], v4 offset:96
ds_read_b64_tr_b16 a[142:143], v4 offset:992
v_mfma_f32_32x32x16_bf16 v[96:111], a[164:167], a[108:111], v[96:111]
ds_read_b64_tr_b16 a[144:145], v4 offset:128
ds_read_b64_tr_b16 a[146:147], v4 offset:1024
v_mfma_f32_32x32x16_bf16 v[112:127], a[164:167], a[124:127], v[112:127]
ds_read_b64_tr_b16 a[148:149], v4 offset:160
ds_read_b64_tr_b16 a[150:151], v4 offset:1056
v_mfma_f32_32x32x16_bf16 v[128:143], a[168:171], a[108:111], v[128:143]
ds_read_b64_tr_b16 a[152:153], v4 offset:192
ds_read_b64_tr_b16 a[154:155], v4 offset:1088
v_mfma_f32_32x32x16_bf16 v[144:159], a[168:171], a[124:127], v[144:159]
buffer_load_dwordx4 a[76:79], v8, s[8:11], s30 offen offset:3072 sc1
v_mfma_f32_32x32x16_bf16 v[160:175], a[172:175], a[108:111], v[160:175]
s_add_u32 s31, s31, 0x70000
s_add_u32 m0, s32, 0x15300
s_nop 0
buffer_load_dwordx4 v10, s[12:15], s31 offen offset:0 lds
v_mfma_f32_32x32x16_bf16 v[176:191], a[172:175], a[124:127], v[176:191]
v_mfma_f32_32x32x16_bf16 v[192:207], a[176:179], a[108:111], v[192:207]
buffer_load_dwordx4 v11, s[12:15], s31 offen offset:1024 lds
v_mfma_f32_32x32x16_bf16 v[208:223], a[176:179], a[124:127], v[208:223]
v_mfma_f32_32x32x16_bf16 v[224:239], a[180:183], a[108:111], v[224:239]
buffer_load_dwordx4 a[92:95], v9, s[8:11], s30 offen offset:3072 sc1
v_mfma_f32_32x32x16_bf16 v[240:255], a[180:183], a[124:127], v[240:255]
s_mov_b32 s33, 2
adaLN_cond__sliding_block_cached__swiglu_ffn__prompt_kernel_loop_44:
s_waitcnt lgkmcnt(0)
v_mfma_f32_32x32x16_bf16 v[32:47], a[128:131], a[0:3], v[32:47]
ds_read_b64_tr_b16 a[156:157], v4 offset:3584
ds_read_b64_tr_b16 a[158:159], v4 offset:4480
v_mfma_f32_32x32x16_bf16 v[48:63], a[128:131], a[16:19], v[48:63]
ds_read_b64_tr_b16 a[160:161], v4 offset:3616
ds_read_b64_tr_b16 a[162:163], v4 offset:4512
v_mfma_f32_32x32x16_bf16 v[64:79], a[132:135], a[0:3], v[64:79]
ds_read_b64_tr_b16 a[164:165], v4 offset:3648
ds_read_b64_tr_b16 a[166:167], v4 offset:4544
v_mfma_f32_32x32x16_bf16 v[80:95], a[132:135], a[16:19], v[80:95]
ds_read_b64_tr_b16 a[168:169], v4 offset:3680
ds_read_b64_tr_b16 a[170:171], v4 offset:4576
v_mfma_f32_32x32x16_bf16 v[96:111], a[136:139], a[0:3], v[96:111]
ds_read_b64_tr_b16 a[172:173], v4 offset:3712
ds_read_b64_tr_b16 a[174:175], v4 offset:4608
v_mfma_f32_32x32x16_bf16 v[112:127], a[136:139], a[16:19], v[112:127]
ds_read_b64_tr_b16 a[176:177], v4 offset:3744
ds_read_b64_tr_b16 a[178:179], v4 offset:4640
v_mfma_f32_32x32x16_bf16 v[128:143], a[140:143], a[0:3], v[128:143]
ds_read_b64_tr_b16 a[180:181], v4 offset:3776
ds_read_b64_tr_b16 a[182:183], v4 offset:4672
v_mfma_f32_32x32x16_bf16 v[144:159], a[140:143], a[16:19], v[144:159]
s_add_u32 s30, s30, 4096
buffer_load_dwordx4 a[96:99], v8, s[8:11], s30 offen offset:0 sc1
v_mfma_f32_32x32x16_bf16 v[160:175], a[144:147], a[0:3], v[160:175]
buffer_load_dwordx4 v12, s[12:15], s31 offen offset:2048 lds
v_mfma_f32_32x32x16_bf16 v[176:191], a[144:147], a[16:19], v[176:191]
v_mfma_f32_32x32x16_bf16 v[192:207], a[148:151], a[0:3], v[192:207]
buffer_load_dwordx4 v13, s[12:15], s31 offen offset:3072 lds
v_mfma_f32_32x32x16_bf16 v[208:223], a[148:151], a[16:19], v[208:223]
v_mfma_f32_32x32x16_bf16 v[224:239], a[152:155], a[0:3], v[224:239]
buffer_load_dwordx4 a[112:115], v9, s[8:11], s30 offen offset:0 sc1
v_mfma_f32_32x32x16_bf16 v[240:255], a[152:155], a[16:19], v[240:255]
s_waitcnt lgkmcnt(0)
v_mfma_f32_32x32x16_bf16 v[32:47], a[156:159], a[4:7], v[32:47]
ds_read_b64_tr_b16 a[128:129], v4 offset:7168
ds_read_b64_tr_b16 a[130:131], v4 offset:8064
v_mfma_f32_32x32x16_bf16 v[48:63], a[156:159], a[20:23], v[48:63]
ds_read_b64_tr_b16 a[132:133], v4 offset:7200
ds_read_b64_tr_b16 a[134:135], v4 offset:8096
v_mfma_f32_32x32x16_bf16 v[64:79], a[160:163], a[4:7], v[64:79]
ds_read_b64_tr_b16 a[136:137], v4 offset:7232
ds_read_b64_tr_b16 a[138:139], v4 offset:8128
v_mfma_f32_32x32x16_bf16 v[80:95], a[160:163], a[20:23], v[80:95]
ds_read_b64_tr_b16 a[140:141], v4 offset:7264
ds_read_b64_tr_b16 a[142:143], v4 offset:8160
v_mfma_f32_32x32x16_bf16 v[96:111], a[164:167], a[4:7], v[96:111]
ds_read_b64_tr_b16 a[144:145], v4 offset:7296
ds_read_b64_tr_b16 a[146:147], v4 offset:8192
v_mfma_f32_32x32x16_bf16 v[112:127], a[164:167], a[20:23], v[112:127]
ds_read_b64_tr_b16 a[148:149], v4 offset:7328
ds_read_b64_tr_b16 a[150:151], v4 offset:8224
v_mfma_f32_32x32x16_bf16 v[128:143], a[168:171], a[4:7], v[128:143]
ds_read_b64_tr_b16 a[152:153], v4 offset:7360
ds_read_b64_tr_b16 a[154:155], v4 offset:8256
v_mfma_f32_32x32x16_bf16 v[144:159], a[168:171], a[20:23], v[144:159]
buffer_load_dwordx4 a[100:103], v8, s[8:11], s30 offen offset:1024 sc1
v_mfma_f32_32x32x16_bf16 v[160:175], a[172:175], a[4:7], v[160:175]
s_add_u32 m0, s32, 0x16300
s_nop 0
buffer_load_dwordx4 v14, s[12:15], s31 offen offset:0 lds
v_mfma_f32_32x32x16_bf16 v[176:191], a[172:175], a[20:23], v[176:191]
v_mfma_f32_32x32x16_bf16 v[192:207], a[176:179], a[4:7], v[192:207]
buffer_load_dwordx4 v15, s[12:15], s31 offen offset:1024 lds
v_mfma_f32_32x32x16_bf16 v[208:223], a[176:179], a[20:23], v[208:223]
v_mfma_f32_32x32x16_bf16 v[224:239], a[180:183], a[4:7], v[224:239]
buffer_load_dwordx4 a[116:119], v9, s[8:11], s30 offen offset:1024 sc1
v_mfma_f32_32x32x16_bf16 v[240:255], a[180:183], a[20:23], v[240:255]
s_waitcnt lgkmcnt(0)
v_mfma_f32_32x32x16_bf16 v[32:47], a[128:131], a[8:11], v[32:47]
ds_read_b64_tr_b16 a[156:157], v4 offset:10752
ds_read_b64_tr_b16 a[158:159], v4 offset:11648
v_mfma_f32_32x32x16_bf16 v[48:63], a[128:131], a[24:27], v[48:63]
ds_read_b64_tr_b16 a[160:161], v4 offset:10784
ds_read_b64_tr_b16 a[162:163], v4 offset:11680
v_mfma_f32_32x32x16_bf16 v[64:79], a[132:135], a[8:11], v[64:79]
ds_read_b64_tr_b16 a[164:165], v4 offset:10816
ds_read_b64_tr_b16 a[166:167], v4 offset:11712
v_mfma_f32_32x32x16_bf16 v[80:95], a[132:135], a[24:27], v[80:95]
ds_read_b64_tr_b16 a[168:169], v4 offset:10848
ds_read_b64_tr_b16 a[170:171], v4 offset:11744
v_mfma_f32_32x32x16_bf16 v[96:111], a[136:139], a[8:11], v[96:111]
ds_read_b64_tr_b16 a[172:173], v4 offset:10880
ds_read_b64_tr_b16 a[174:175], v4 offset:11776
v_mfma_f32_32x32x16_bf16 v[112:127], a[136:139], a[24:27], v[112:127]
ds_read_b64_tr_b16 a[176:177], v4 offset:10912
ds_read_b64_tr_b16 a[178:179], v4 offset:11808
v_mfma_f32_32x32x16_bf16 v[128:143], a[140:143], a[8:11], v[128:143]
ds_read_b64_tr_b16 a[180:181], v4 offset:10944
ds_read_b64_tr_b16 a[182:183], v4 offset:11840
v_mfma_f32_32x32x16_bf16 v[144:159], a[140:143], a[24:27], v[144:159]
buffer_load_dwordx4 a[104:107], v8, s[8:11], s30 offen offset:2048 sc1
v_mfma_f32_32x32x16_bf16 v[160:175], a[144:147], a[8:11], v[160:175]
v_mfma_f32_32x32x16_bf16 v[176:191], a[144:147], a[24:27], v[176:191]
buffer_load_dwordx4 v16, s[12:15], s31 offen offset:2048 lds
v_mfma_f32_32x32x16_bf16 v[192:207], a[148:151], a[8:11], v[192:207]
v_mfma_f32_32x32x16_bf16 v[208:223], a[148:151], a[24:27], v[208:223]
buffer_load_dwordx4 a[120:123], v9, s[8:11], s30 offen offset:2048 sc1
v_mfma_f32_32x32x16_bf16 v[224:239], a[152:155], a[8:11], v[224:239]
v_mfma_f32_32x32x16_bf16 v[240:255], a[152:155], a[24:27], v[240:255]
s_waitcnt vmcnt(30) lgkmcnt(0)
s_barrier
v_mfma_f32_32x32x16_bf16 v[32:47], a[156:159], a[12:15], v[32:47]
ds_read_b64_tr_b16 a[128:129], v4 offset:28928
ds_read_b64_tr_b16 a[130:131], v4 offset:29824
v_mfma_f32_32x32x16_bf16 v[48:63], a[156:159], a[28:31], v[48:63]
ds_read_b64_tr_b16 a[132:133], v4 offset:28960
ds_read_b64_tr_b16 a[134:135], v4 offset:29856
v_mfma_f32_32x32x16_bf16 v[64:79], a[160:163], a[12:15], v[64:79]
ds_read_b64_tr_b16 a[136:137], v4 offset:28992
ds_read_b64_tr_b16 a[138:139], v4 offset:29888
v_mfma_f32_32x32x16_bf16 v[80:95], a[160:163], a[28:31], v[80:95]
ds_read_b64_tr_b16 a[140:141], v4 offset:29024
ds_read_b64_tr_b16 a[142:143], v4 offset:29920
v_mfma_f32_32x32x16_bf16 v[96:111], a[164:167], a[12:15], v[96:111]
ds_read_b64_tr_b16 a[144:145], v4 offset:29056
ds_read_b64_tr_b16 a[146:147], v4 offset:29952
v_mfma_f32_32x32x16_bf16 v[112:127], a[164:167], a[28:31], v[112:127]
ds_read_b64_tr_b16 a[148:149], v4 offset:29088
ds_read_b64_tr_b16 a[150:151], v4 offset:29984
v_mfma_f32_32x32x16_bf16 v[128:143], a[168:171], a[12:15], v[128:143]
ds_read_b64_tr_b16 a[152:153], v4 offset:29120
ds_read_b64_tr_b16 a[154:155], v4 offset:30016
v_mfma_f32_32x32x16_bf16 v[144:159], a[168:171], a[28:31], v[144:159]
buffer_load_dwordx4 a[108:111], v8, s[8:11], s30 offen offset:3072 sc1
v_mfma_f32_32x32x16_bf16 v[160:175], a[172:175], a[12:15], v[160:175]
s_add_u32 s31, s31, 0x70000
s_add_u32 m0, s32, 0x0
s_nop 0
buffer_load_dwordx4 v10, s[12:15], s31 offen offset:0 lds
v_mfma_f32_32x32x16_bf16 v[176:191], a[172:175], a[28:31], v[176:191]
v_mfma_f32_32x32x16_bf16 v[192:207], a[176:179], a[12:15], v[192:207]
buffer_load_dwordx4 v11, s[12:15], s31 offen offset:1024 lds
v_mfma_f32_32x32x16_bf16 v[208:223], a[176:179], a[28:31], v[208:223]
v_mfma_f32_32x32x16_bf16 v[224:239], a[180:183], a[12:15], v[224:239]
buffer_load_dwordx4 a[124:127], v9, s[8:11], s30 offen offset:3072 sc1
v_mfma_f32_32x32x16_bf16 v[240:255], a[180:183], a[28:31], v[240:255]
s_waitcnt lgkmcnt(0)
v_mfma_f32_32x32x16_bf16 v[32:47], a[128:131], a[32:35], v[32:47]
ds_read_b64_tr_b16 a[156:157], v4 offset:32512
ds_read_b64_tr_b16 a[158:159], v4 offset:33408
v_mfma_f32_32x32x16_bf16 v[48:63], a[128:131], a[48:51], v[48:63]
ds_read_b64_tr_b16 a[160:161], v4 offset:32544
ds_read_b64_tr_b16 a[162:163], v4 offset:33440
v_mfma_f32_32x32x16_bf16 v[64:79], a[132:135], a[32:35], v[64:79]
ds_read_b64_tr_b16 a[164:165], v4 offset:32576
ds_read_b64_tr_b16 a[166:167], v4 offset:33472
v_mfma_f32_32x32x16_bf16 v[80:95], a[132:135], a[48:51], v[80:95]
ds_read_b64_tr_b16 a[168:169], v4 offset:32608
ds_read_b64_tr_b16 a[170:171], v4 offset:33504
v_mfma_f32_32x32x16_bf16 v[96:111], a[136:139], a[32:35], v[96:111]
ds_read_b64_tr_b16 a[172:173], v4 offset:32640
ds_read_b64_tr_b16 a[174:175], v4 offset:33536
v_mfma_f32_32x32x16_bf16 v[112:127], a[136:139], a[48:51], v[112:127]
ds_read_b64_tr_b16 a[176:177], v4 offset:32672
ds_read_b64_tr_b16 a[178:179], v4 offset:33568
v_mfma_f32_32x32x16_bf16 v[128:143], a[140:143], a[32:35], v[128:143]
ds_read_b64_tr_b16 a[180:181], v4 offset:32704
ds_read_b64_tr_b16 a[182:183], v4 offset:33600
v_mfma_f32_32x32x16_bf16 v[144:159], a[140:143], a[48:51], v[144:159]
s_add_u32 s30, s30, 4096
buffer_load_dwordx4 a[0:3], v8, s[8:11], s30 offen offset:0 sc1
v_mfma_f32_32x32x16_bf16 v[160:175], a[144:147], a[32:35], v[160:175]
buffer_load_dwordx4 v12, s[12:15], s31 offen offset:2048 lds
v_mfma_f32_32x32x16_bf16 v[176:191], a[144:147], a[48:51], v[176:191]
v_mfma_f32_32x32x16_bf16 v[192:207], a[148:151], a[32:35], v[192:207]
buffer_load_dwordx4 v13, s[12:15], s31 offen offset:3072 lds
v_mfma_f32_32x32x16_bf16 v[208:223], a[148:151], a[48:51], v[208:223]
v_mfma_f32_32x32x16_bf16 v[224:239], a[152:155], a[32:35], v[224:239]
buffer_load_dwordx4 a[16:19], v9, s[8:11], s30 offen offset:0 sc1
v_mfma_f32_32x32x16_bf16 v[240:255], a[152:155], a[48:51], v[240:255]
s_waitcnt lgkmcnt(0)
v_mfma_f32_32x32x16_bf16 v[32:47], a[156:159], a[36:39], v[32:47]
ds_read_b64_tr_b16 a[128:129], v4 offset:36096
ds_read_b64_tr_b16 a[130:131], v4 offset:36992
v_mfma_f32_32x32x16_bf16 v[48:63], a[156:159], a[52:55], v[48:63]
ds_read_b64_tr_b16 a[132:133], v4 offset:36128
ds_read_b64_tr_b16 a[134:135], v4 offset:37024
v_mfma_f32_32x32x16_bf16 v[64:79], a[160:163], a[36:39], v[64:79]
ds_read_b64_tr_b16 a[136:137], v4 offset:36160
ds_read_b64_tr_b16 a[138:139], v4 offset:37056
v_mfma_f32_32x32x16_bf16 v[80:95], a[160:163], a[52:55], v[80:95]
ds_read_b64_tr_b16 a[140:141], v4 offset:36192
ds_read_b64_tr_b16 a[142:143], v4 offset:37088
v_mfma_f32_32x32x16_bf16 v[96:111], a[164:167], a[36:39], v[96:111]
ds_read_b64_tr_b16 a[144:145], v4 offset:36224
ds_read_b64_tr_b16 a[146:147], v4 offset:37120
v_mfma_f32_32x32x16_bf16 v[112:127], a[164:167], a[52:55], v[112:127]
ds_read_b64_tr_b16 a[148:149], v4 offset:36256
ds_read_b64_tr_b16 a[150:151], v4 offset:37152
v_mfma_f32_32x32x16_bf16 v[128:143], a[168:171], a[36:39], v[128:143]
ds_read_b64_tr_b16 a[152:153], v4 offset:36288
ds_read_b64_tr_b16 a[154:155], v4 offset:37184
v_mfma_f32_32x32x16_bf16 v[144:159], a[168:171], a[52:55], v[144:159]
buffer_load_dwordx4 a[4:7], v8, s[8:11], s30 offen offset:1024 sc1
v_mfma_f32_32x32x16_bf16 v[160:175], a[172:175], a[36:39], v[160:175]
s_add_u32 m0, s32, 0x1000
s_nop 0
buffer_load_dwordx4 v14, s[12:15], s31 offen offset:0 lds
v_mfma_f32_32x32x16_bf16 v[176:191], a[172:175], a[52:55], v[176:191]
v_mfma_f32_32x32x16_bf16 v[192:207], a[176:179], a[36:39], v[192:207]
buffer_load_dwordx4 v15, s[12:15], s31 offen offset:1024 lds
v_mfma_f32_32x32x16_bf16 v[208:223], a[176:179], a[52:55], v[208:223]
v_mfma_f32_32x32x16_bf16 v[224:239], a[180:183], a[36:39], v[224:239]
buffer_load_dwordx4 a[20:23], v9, s[8:11], s30 offen offset:1024 sc1
v_mfma_f32_32x32x16_bf16 v[240:255], a[180:183], a[52:55], v[240:255]
s_waitcnt lgkmcnt(0)
v_mfma_f32_32x32x16_bf16 v[32:47], a[128:131], a[40:43], v[32:47]
ds_read_b64_tr_b16 a[156:157], v4 offset:39680
ds_read_b64_tr_b16 a[158:159], v4 offset:40576
v_mfma_f32_32x32x16_bf16 v[48:63], a[128:131], a[56:59], v[48:63]
ds_read_b64_tr_b16 a[160:161], v4 offset:39712
ds_read_b64_tr_b16 a[162:163], v4 offset:40608
v_mfma_f32_32x32x16_bf16 v[64:79], a[132:135], a[40:43], v[64:79]
ds_read_b64_tr_b16 a[164:165], v4 offset:39744
ds_read_b64_tr_b16 a[166:167], v4 offset:40640
v_mfma_f32_32x32x16_bf16 v[80:95], a[132:135], a[56:59], v[80:95]
ds_read_b64_tr_b16 a[168:169], v4 offset:39776
ds_read_b64_tr_b16 a[170:171], v4 offset:40672
v_mfma_f32_32x32x16_bf16 v[96:111], a[136:139], a[40:43], v[96:111]
ds_read_b64_tr_b16 a[172:173], v4 offset:39808
ds_read_b64_tr_b16 a[174:175], v4 offset:40704
v_mfma_f32_32x32x16_bf16 v[112:127], a[136:139], a[56:59], v[112:127]
ds_read_b64_tr_b16 a[176:177], v4 offset:39840
ds_read_b64_tr_b16 a[178:179], v4 offset:40736
v_mfma_f32_32x32x16_bf16 v[128:143], a[140:143], a[40:43], v[128:143]
ds_read_b64_tr_b16 a[180:181], v4 offset:39872
ds_read_b64_tr_b16 a[182:183], v4 offset:40768
v_mfma_f32_32x32x16_bf16 v[144:159], a[140:143], a[56:59], v[144:159]
buffer_load_dwordx4 a[8:11], v8, s[8:11], s30 offen offset:2048 sc1
v_mfma_f32_32x32x16_bf16 v[160:175], a[144:147], a[40:43], v[160:175]
v_mfma_f32_32x32x16_bf16 v[176:191], a[144:147], a[56:59], v[176:191]
buffer_load_dwordx4 v16, s[12:15], s31 offen offset:2048 lds
v_mfma_f32_32x32x16_bf16 v[192:207], a[148:151], a[40:43], v[192:207]
v_mfma_f32_32x32x16_bf16 v[208:223], a[148:151], a[56:59], v[208:223]
buffer_load_dwordx4 a[24:27], v9, s[8:11], s30 offen offset:2048 sc1
v_mfma_f32_32x32x16_bf16 v[224:239], a[152:155], a[40:43], v[224:239]
v_mfma_f32_32x32x16_bf16 v[240:255], a[152:155], a[56:59], v[240:255]
s_waitcnt vmcnt(30) lgkmcnt(0)
s_barrier
v_mfma_f32_32x32x16_bf16 v[32:47], a[156:159], a[44:47], v[32:47]
ds_read_b64_tr_b16 a[128:129], v5 offset:0
ds_read_b64_tr_b16 a[130:131], v5 offset:896
v_mfma_f32_32x32x16_bf16 v[48:63], a[156:159], a[60:63], v[48:63]
ds_read_b64_tr_b16 a[132:133], v5 offset:32
ds_read_b64_tr_b16 a[134:135], v5 offset:928
v_mfma_f32_32x32x16_bf16 v[64:79], a[160:163], a[44:47], v[64:79]
ds_read_b64_tr_b16 a[136:137], v5 offset:64
ds_read_b64_tr_b16 a[138:139], v5 offset:960
v_mfma_f32_32x32x16_bf16 v[80:95], a[160:163], a[60:63], v[80:95]
ds_read_b64_tr_b16 a[140:141], v5 offset:96
ds_read_b64_tr_b16 a[142:143], v5 offset:992
v_mfma_f32_32x32x16_bf16 v[96:111], a[164:167], a[44:47], v[96:111]
ds_read_b64_tr_b16 a[144:145], v5 offset:128
ds_read_b64_tr_b16 a[146:147], v5 offset:1024
v_mfma_f32_32x32x16_bf16 v[112:127], a[164:167], a[60:63], v[112:127]
ds_read_b64_tr_b16 a[148:149], v5 offset:160
ds_read_b64_tr_b16 a[150:151], v5 offset:1056
v_mfma_f32_32x32x16_bf16 v[128:143], a[168:171], a[44:47], v[128:143]
ds_read_b64_tr_b16 a[152:153], v5 offset:192
ds_read_b64_tr_b16 a[154:155], v5 offset:1088
v_mfma_f32_32x32x16_bf16 v[144:159], a[168:171], a[60:63], v[144:159]
buffer_load_dwordx4 a[12:15], v8, s[8:11], s30 offen offset:3072 sc1
v_mfma_f32_32x32x16_bf16 v[160:175], a[172:175], a[44:47], v[160:175]
s_add_u32 s31, s31, 0x70000
s_add_u32 m0, s32, 0x7100
s_nop 0
buffer_load_dwordx4 v10, s[12:15], s31 offen offset:0 lds
v_mfma_f32_32x32x16_bf16 v[176:191], a[172:175], a[60:63], v[176:191]
v_mfma_f32_32x32x16_bf16 v[192:207], a[176:179], a[44:47], v[192:207]
buffer_load_dwordx4 v11, s[12:15], s31 offen offset:1024 lds
v_mfma_f32_32x32x16_bf16 v[208:223], a[176:179], a[60:63], v[208:223]
v_mfma_f32_32x32x16_bf16 v[224:239], a[180:183], a[44:47], v[224:239]
buffer_load_dwordx4 a[28:31], v9, s[8:11], s30 offen offset:3072 sc1
v_mfma_f32_32x32x16_bf16 v[240:255], a[180:183], a[60:63], v[240:255]
s_waitcnt lgkmcnt(0)
v_mfma_f32_32x32x16_bf16 v[32:47], a[128:131], a[64:67], v[32:47]
ds_read_b64_tr_b16 a[156:157], v5 offset:3584
ds_read_b64_tr_b16 a[158:159], v5 offset:4480
v_mfma_f32_32x32x16_bf16 v[48:63], a[128:131], a[80:83], v[48:63]
ds_read_b64_tr_b16 a[160:161], v5 offset:3616
ds_read_b64_tr_b16 a[162:163], v5 offset:4512
v_mfma_f32_32x32x16_bf16 v[64:79], a[132:135], a[64:67], v[64:79]
ds_read_b64_tr_b16 a[164:165], v5 offset:3648
ds_read_b64_tr_b16 a[166:167], v5 offset:4544
v_mfma_f32_32x32x16_bf16 v[80:95], a[132:135], a[80:83], v[80:95]
ds_read_b64_tr_b16 a[168:169], v5 offset:3680
ds_read_b64_tr_b16 a[170:171], v5 offset:4576
v_mfma_f32_32x32x16_bf16 v[96:111], a[136:139], a[64:67], v[96:111]
ds_read_b64_tr_b16 a[172:173], v5 offset:3712
ds_read_b64_tr_b16 a[174:175], v5 offset:4608
v_mfma_f32_32x32x16_bf16 v[112:127], a[136:139], a[80:83], v[112:127]
ds_read_b64_tr_b16 a[176:177], v5 offset:3744
ds_read_b64_tr_b16 a[178:179], v5 offset:4640
v_mfma_f32_32x32x16_bf16 v[128:143], a[140:143], a[64:67], v[128:143]
ds_read_b64_tr_b16 a[180:181], v5 offset:3776
ds_read_b64_tr_b16 a[182:183], v5 offset:4672
v_mfma_f32_32x32x16_bf16 v[144:159], a[140:143], a[80:83], v[144:159]
s_add_u32 s30, s30, 4096
buffer_load_dwordx4 a[32:35], v8, s[8:11], s30 offen offset:0 sc1
v_mfma_f32_32x32x16_bf16 v[160:175], a[144:147], a[64:67], v[160:175]
buffer_load_dwordx4 v12, s[12:15], s31 offen offset:2048 lds
v_mfma_f32_32x32x16_bf16 v[176:191], a[144:147], a[80:83], v[176:191]
v_mfma_f32_32x32x16_bf16 v[192:207], a[148:151], a[64:67], v[192:207]
buffer_load_dwordx4 v13, s[12:15], s31 offen offset:3072 lds
v_mfma_f32_32x32x16_bf16 v[208:223], a[148:151], a[80:83], v[208:223]
v_mfma_f32_32x32x16_bf16 v[224:239], a[152:155], a[64:67], v[224:239]
buffer_load_dwordx4 a[48:51], v9, s[8:11], s30 offen offset:0 sc1
v_mfma_f32_32x32x16_bf16 v[240:255], a[152:155], a[80:83], v[240:255]
s_waitcnt lgkmcnt(0)
v_mfma_f32_32x32x16_bf16 v[32:47], a[156:159], a[68:71], v[32:47]
ds_read_b64_tr_b16 a[128:129], v5 offset:7168
ds_read_b64_tr_b16 a[130:131], v5 offset:8064
v_mfma_f32_32x32x16_bf16 v[48:63], a[156:159], a[84:87], v[48:63]
ds_read_b64_tr_b16 a[132:133], v5 offset:7200
ds_read_b64_tr_b16 a[134:135], v5 offset:8096
v_mfma_f32_32x32x16_bf16 v[64:79], a[160:163], a[68:71], v[64:79]
ds_read_b64_tr_b16 a[136:137], v5 offset:7232
ds_read_b64_tr_b16 a[138:139], v5 offset:8128
v_mfma_f32_32x32x16_bf16 v[80:95], a[160:163], a[84:87], v[80:95]
ds_read_b64_tr_b16 a[140:141], v5 offset:7264
ds_read_b64_tr_b16 a[142:143], v5 offset:8160
v_mfma_f32_32x32x16_bf16 v[96:111], a[164:167], a[68:71], v[96:111]
ds_read_b64_tr_b16 a[144:145], v5 offset:7296
ds_read_b64_tr_b16 a[146:147], v5 offset:8192
v_mfma_f32_32x32x16_bf16 v[112:127], a[164:167], a[84:87], v[112:127]
ds_read_b64_tr_b16 a[148:149], v5 offset:7328
ds_read_b64_tr_b16 a[150:151], v5 offset:8224
v_mfma_f32_32x32x16_bf16 v[128:143], a[168:171], a[68:71], v[128:143]
ds_read_b64_tr_b16 a[152:153], v5 offset:7360
ds_read_b64_tr_b16 a[154:155], v5 offset:8256
v_mfma_f32_32x32x16_bf16 v[144:159], a[168:171], a[84:87], v[144:159]
buffer_load_dwordx4 a[36:39], v8, s[8:11], s30 offen offset:1024 sc1
v_mfma_f32_32x32x16_bf16 v[160:175], a[172:175], a[68:71], v[160:175]
s_add_u32 m0, s32, 0x8100
s_nop 0
buffer_load_dwordx4 v14, s[12:15], s31 offen offset:0 lds
v_mfma_f32_32x32x16_bf16 v[176:191], a[172:175], a[84:87], v[176:191]
v_mfma_f32_32x32x16_bf16 v[192:207], a[176:179], a[68:71], v[192:207]
buffer_load_dwordx4 v15, s[12:15], s31 offen offset:1024 lds
v_mfma_f32_32x32x16_bf16 v[208:223], a[176:179], a[84:87], v[208:223]
v_mfma_f32_32x32x16_bf16 v[224:239], a[180:183], a[68:71], v[224:239]
buffer_load_dwordx4 a[52:55], v9, s[8:11], s30 offen offset:1024 sc1
v_mfma_f32_32x32x16_bf16 v[240:255], a[180:183], a[84:87], v[240:255]
s_waitcnt lgkmcnt(0)
v_mfma_f32_32x32x16_bf16 v[32:47], a[128:131], a[72:75], v[32:47]
ds_read_b64_tr_b16 a[156:157], v5 offset:10752
ds_read_b64_tr_b16 a[158:159], v5 offset:11648
v_mfma_f32_32x32x16_bf16 v[48:63], a[128:131], a[88:91], v[48:63]
ds_read_b64_tr_b16 a[160:161], v5 offset:10784
ds_read_b64_tr_b16 a[162:163], v5 offset:11680
v_mfma_f32_32x32x16_bf16 v[64:79], a[132:135], a[72:75], v[64:79]
ds_read_b64_tr_b16 a[164:165], v5 offset:10816
ds_read_b64_tr_b16 a[166:167], v5 offset:11712
v_mfma_f32_32x32x16_bf16 v[80:95], a[132:135], a[88:91], v[80:95]
ds_read_b64_tr_b16 a[168:169], v5 offset:10848
ds_read_b64_tr_b16 a[170:171], v5 offset:11744
v_mfma_f32_32x32x16_bf16 v[96:111], a[136:139], a[72:75], v[96:111]
ds_read_b64_tr_b16 a[172:173], v5 offset:10880
ds_read_b64_tr_b16 a[174:175], v5 offset:11776
v_mfma_f32_32x32x16_bf16 v[112:127], a[136:139], a[88:91], v[112:127]
ds_read_b64_tr_b16 a[176:177], v5 offset:10912
ds_read_b64_tr_b16 a[178:179], v5 offset:11808
v_mfma_f32_32x32x16_bf16 v[128:143], a[140:143], a[72:75], v[128:143]
ds_read_b64_tr_b16 a[180:181], v5 offset:10944
ds_read_b64_tr_b16 a[182:183], v5 offset:11840
v_mfma_f32_32x32x16_bf16 v[144:159], a[140:143], a[88:91], v[144:159]
buffer_load_dwordx4 a[40:43], v8, s[8:11], s30 offen offset:2048 sc1
v_mfma_f32_32x32x16_bf16 v[160:175], a[144:147], a[72:75], v[160:175]
v_mfma_f32_32x32x16_bf16 v[176:191], a[144:147], a[88:91], v[176:191]
buffer_load_dwordx4 v16, s[12:15], s31 offen offset:2048 lds
v_mfma_f32_32x32x16_bf16 v[192:207], a[148:151], a[72:75], v[192:207]
v_mfma_f32_32x32x16_bf16 v[208:223], a[148:151], a[88:91], v[208:223]
buffer_load_dwordx4 a[56:59], v9, s[8:11], s30 offen offset:2048 sc1
v_mfma_f32_32x32x16_bf16 v[224:239], a[152:155], a[72:75], v[224:239]
v_mfma_f32_32x32x16_bf16 v[240:255], a[152:155], a[88:91], v[240:255]
s_waitcnt vmcnt(30) lgkmcnt(0)
s_barrier
v_mfma_f32_32x32x16_bf16 v[32:47], a[156:159], a[76:79], v[32:47]
ds_read_b64_tr_b16 a[128:129], v5 offset:28928
ds_read_b64_tr_b16 a[130:131], v5 offset:29824
v_mfma_f32_32x32x16_bf16 v[48:63], a[156:159], a[92:95], v[48:63]
ds_read_b64_tr_b16 a[132:133], v5 offset:28960
ds_read_b64_tr_b16 a[134:135], v5 offset:29856
v_mfma_f32_32x32x16_bf16 v[64:79], a[160:163], a[76:79], v[64:79]
ds_read_b64_tr_b16 a[136:137], v5 offset:28992
ds_read_b64_tr_b16 a[138:139], v5 offset:29888
v_mfma_f32_32x32x16_bf16 v[80:95], a[160:163], a[92:95], v[80:95]
ds_read_b64_tr_b16 a[140:141], v5 offset:29024
ds_read_b64_tr_b16 a[142:143], v5 offset:29920
v_mfma_f32_32x32x16_bf16 v[96:111], a[164:167], a[76:79], v[96:111]
ds_read_b64_tr_b16 a[144:145], v5 offset:29056
ds_read_b64_tr_b16 a[146:147], v5 offset:29952
v_mfma_f32_32x32x16_bf16 v[112:127], a[164:167], a[92:95], v[112:127]
ds_read_b64_tr_b16 a[148:149], v5 offset:29088
ds_read_b64_tr_b16 a[150:151], v5 offset:29984
v_mfma_f32_32x32x16_bf16 v[128:143], a[168:171], a[76:79], v[128:143]
ds_read_b64_tr_b16 a[152:153], v5 offset:29120
ds_read_b64_tr_b16 a[154:155], v5 offset:30016
v_mfma_f32_32x32x16_bf16 v[144:159], a[168:171], a[92:95], v[144:159]
buffer_load_dwordx4 a[44:47], v8, s[8:11], s30 offen offset:3072 sc1
v_mfma_f32_32x32x16_bf16 v[160:175], a[172:175], a[76:79], v[160:175]
s_add_u32 s31, s31, 0x70000
s_add_u32 m0, s32, 0xe200
s_nop 0
buffer_load_dwordx4 v10, s[12:15], s31 offen offset:0 lds
v_mfma_f32_32x32x16_bf16 v[176:191], a[172:175], a[92:95], v[176:191]
v_mfma_f32_32x32x16_bf16 v[192:207], a[176:179], a[76:79], v[192:207]
buffer_load_dwordx4 v11, s[12:15], s31 offen offset:1024 lds
v_mfma_f32_32x32x16_bf16 v[208:223], a[176:179], a[92:95], v[208:223]
v_mfma_f32_32x32x16_bf16 v[224:239], a[180:183], a[76:79], v[224:239]
buffer_load_dwordx4 a[60:63], v9, s[8:11], s30 offen offset:3072 sc1
v_mfma_f32_32x32x16_bf16 v[240:255], a[180:183], a[92:95], v[240:255]
s_waitcnt lgkmcnt(0)
v_mfma_f32_32x32x16_bf16 v[32:47], a[128:131], a[96:99], v[32:47]
ds_read_b64_tr_b16 a[156:157], v5 offset:32512
ds_read_b64_tr_b16 a[158:159], v5 offset:33408
v_mfma_f32_32x32x16_bf16 v[48:63], a[128:131], a[112:115], v[48:63]
ds_read_b64_tr_b16 a[160:161], v5 offset:32544
ds_read_b64_tr_b16 a[162:163], v5 offset:33440
v_mfma_f32_32x32x16_bf16 v[64:79], a[132:135], a[96:99], v[64:79]
ds_read_b64_tr_b16 a[164:165], v5 offset:32576
ds_read_b64_tr_b16 a[166:167], v5 offset:33472
v_mfma_f32_32x32x16_bf16 v[80:95], a[132:135], a[112:115], v[80:95]
ds_read_b64_tr_b16 a[168:169], v5 offset:32608
ds_read_b64_tr_b16 a[170:171], v5 offset:33504
v_mfma_f32_32x32x16_bf16 v[96:111], a[136:139], a[96:99], v[96:111]
ds_read_b64_tr_b16 a[172:173], v5 offset:32640
ds_read_b64_tr_b16 a[174:175], v5 offset:33536
v_mfma_f32_32x32x16_bf16 v[112:127], a[136:139], a[112:115], v[112:127]
ds_read_b64_tr_b16 a[176:177], v5 offset:32672
ds_read_b64_tr_b16 a[178:179], v5 offset:33568
v_mfma_f32_32x32x16_bf16 v[128:143], a[140:143], a[96:99], v[128:143]
ds_read_b64_tr_b16 a[180:181], v5 offset:32704
ds_read_b64_tr_b16 a[182:183], v5 offset:33600
v_mfma_f32_32x32x16_bf16 v[144:159], a[140:143], a[112:115], v[144:159]
s_add_u32 s30, s30, 4096
buffer_load_dwordx4 a[64:67], v8, s[8:11], s30 offen offset:0 sc1
v_mfma_f32_32x32x16_bf16 v[160:175], a[144:147], a[96:99], v[160:175]
buffer_load_dwordx4 v12, s[12:15], s31 offen offset:2048 lds
v_mfma_f32_32x32x16_bf16 v[176:191], a[144:147], a[112:115], v[176:191]
v_mfma_f32_32x32x16_bf16 v[192:207], a[148:151], a[96:99], v[192:207]
buffer_load_dwordx4 v13, s[12:15], s31 offen offset:3072 lds
v_mfma_f32_32x32x16_bf16 v[208:223], a[148:151], a[112:115], v[208:223]
v_mfma_f32_32x32x16_bf16 v[224:239], a[152:155], a[96:99], v[224:239]
buffer_load_dwordx4 a[80:83], v9, s[8:11], s30 offen offset:0 sc1
v_mfma_f32_32x32x16_bf16 v[240:255], a[152:155], a[112:115], v[240:255]
s_waitcnt lgkmcnt(0)
v_mfma_f32_32x32x16_bf16 v[32:47], a[156:159], a[100:103], v[32:47]
ds_read_b64_tr_b16 a[128:129], v5 offset:36096
ds_read_b64_tr_b16 a[130:131], v5 offset:36992
v_mfma_f32_32x32x16_bf16 v[48:63], a[156:159], a[116:119], v[48:63]
ds_read_b64_tr_b16 a[132:133], v5 offset:36128
ds_read_b64_tr_b16 a[134:135], v5 offset:37024
v_mfma_f32_32x32x16_bf16 v[64:79], a[160:163], a[100:103], v[64:79]
ds_read_b64_tr_b16 a[136:137], v5 offset:36160
ds_read_b64_tr_b16 a[138:139], v5 offset:37056
v_mfma_f32_32x32x16_bf16 v[80:95], a[160:163], a[116:119], v[80:95]
ds_read_b64_tr_b16 a[140:141], v5 offset:36192
ds_read_b64_tr_b16 a[142:143], v5 offset:37088
v_mfma_f32_32x32x16_bf16 v[96:111], a[164:167], a[100:103], v[96:111]
ds_read_b64_tr_b16 a[144:145], v5 offset:36224
ds_read_b64_tr_b16 a[146:147], v5 offset:37120
v_mfma_f32_32x32x16_bf16 v[112:127], a[164:167], a[116:119], v[112:127]
ds_read_b64_tr_b16 a[148:149], v5 offset:36256
ds_read_b64_tr_b16 a[150:151], v5 offset:37152
v_mfma_f32_32x32x16_bf16 v[128:143], a[168:171], a[100:103], v[128:143]
ds_read_b64_tr_b16 a[152:153], v5 offset:36288
ds_read_b64_tr_b16 a[154:155], v5 offset:37184
v_mfma_f32_32x32x16_bf16 v[144:159], a[168:171], a[116:119], v[144:159]
buffer_load_dwordx4 a[68:71], v8, s[8:11], s30 offen offset:1024 sc1
v_mfma_f32_32x32x16_bf16 v[160:175], a[172:175], a[100:103], v[160:175]
s_add_u32 m0, s32, 0xf200
s_nop 0
buffer_load_dwordx4 v14, s[12:15], s31 offen offset:0 lds
v_mfma_f32_32x32x16_bf16 v[176:191], a[172:175], a[116:119], v[176:191]
v_mfma_f32_32x32x16_bf16 v[192:207], a[176:179], a[100:103], v[192:207]
buffer_load_dwordx4 v15, s[12:15], s31 offen offset:1024 lds
v_mfma_f32_32x32x16_bf16 v[208:223], a[176:179], a[116:119], v[208:223]
v_mfma_f32_32x32x16_bf16 v[224:239], a[180:183], a[100:103], v[224:239]
buffer_load_dwordx4 a[84:87], v9, s[8:11], s30 offen offset:1024 sc1
v_mfma_f32_32x32x16_bf16 v[240:255], a[180:183], a[116:119], v[240:255]
s_waitcnt lgkmcnt(0)
v_mfma_f32_32x32x16_bf16 v[32:47], a[128:131], a[104:107], v[32:47]
ds_read_b64_tr_b16 a[156:157], v5 offset:39680
ds_read_b64_tr_b16 a[158:159], v5 offset:40576
v_mfma_f32_32x32x16_bf16 v[48:63], a[128:131], a[120:123], v[48:63]
ds_read_b64_tr_b16 a[160:161], v5 offset:39712
ds_read_b64_tr_b16 a[162:163], v5 offset:40608
v_mfma_f32_32x32x16_bf16 v[64:79], a[132:135], a[104:107], v[64:79]
ds_read_b64_tr_b16 a[164:165], v5 offset:39744
ds_read_b64_tr_b16 a[166:167], v5 offset:40640
v_mfma_f32_32x32x16_bf16 v[80:95], a[132:135], a[120:123], v[80:95]
ds_read_b64_tr_b16 a[168:169], v5 offset:39776
ds_read_b64_tr_b16 a[170:171], v5 offset:40672
v_mfma_f32_32x32x16_bf16 v[96:111], a[136:139], a[104:107], v[96:111]
ds_read_b64_tr_b16 a[172:173], v5 offset:39808
ds_read_b64_tr_b16 a[174:175], v5 offset:40704
v_mfma_f32_32x32x16_bf16 v[112:127], a[136:139], a[120:123], v[112:127]
ds_read_b64_tr_b16 a[176:177], v5 offset:39840
ds_read_b64_tr_b16 a[178:179], v5 offset:40736
v_mfma_f32_32x32x16_bf16 v[128:143], a[140:143], a[104:107], v[128:143]
ds_read_b64_tr_b16 a[180:181], v5 offset:39872
ds_read_b64_tr_b16 a[182:183], v5 offset:40768
v_mfma_f32_32x32x16_bf16 v[144:159], a[140:143], a[120:123], v[144:159]
buffer_load_dwordx4 a[72:75], v8, s[8:11], s30 offen offset:2048 sc1
v_mfma_f32_32x32x16_bf16 v[160:175], a[144:147], a[104:107], v[160:175]
v_mfma_f32_32x32x16_bf16 v[176:191], a[144:147], a[120:123], v[176:191]
buffer_load_dwordx4 v16, s[12:15], s31 offen offset:2048 lds
v_mfma_f32_32x32x16_bf16 v[192:207], a[148:151], a[104:107], v[192:207]
v_mfma_f32_32x32x16_bf16 v[208:223], a[148:151], a[120:123], v[208:223]
buffer_load_dwordx4 a[88:91], v9, s[8:11], s30 offen offset:2048 sc1
v_mfma_f32_32x32x16_bf16 v[224:239], a[152:155], a[104:107], v[224:239]
v_mfma_f32_32x32x16_bf16 v[240:255], a[152:155], a[120:123], v[240:255]
s_waitcnt vmcnt(30) lgkmcnt(0)
s_barrier
v_mfma_f32_32x32x16_bf16 v[32:47], a[156:159], a[108:111], v[32:47]
ds_read_b64_tr_b16 a[128:129], v4 offset:0
ds_read_b64_tr_b16 a[130:131], v4 offset:896
v_mfma_f32_32x32x16_bf16 v[48:63], a[156:159], a[124:127], v[48:63]
ds_read_b64_tr_b16 a[132:133], v4 offset:32
ds_read_b64_tr_b16 a[134:135], v4 offset:928
v_mfma_f32_32x32x16_bf16 v[64:79], a[160:163], a[108:111], v[64:79]
ds_read_b64_tr_b16 a[136:137], v4 offset:64
ds_read_b64_tr_b16 a[138:139], v4 offset:960
v_mfma_f32_32x32x16_bf16 v[80:95], a[160:163], a[124:127], v[80:95]
ds_read_b64_tr_b16 a[140:141], v4 offset:96
ds_read_b64_tr_b16 a[142:143], v4 offset:992
v_mfma_f32_32x32x16_bf16 v[96:111], a[164:167], a[108:111], v[96:111]
ds_read_b64_tr_b16 a[144:145], v4 offset:128
ds_read_b64_tr_b16 a[146:147], v4 offset:1024
v_mfma_f32_32x32x16_bf16 v[112:127], a[164:167], a[124:127], v[112:127]
ds_read_b64_tr_b16 a[148:149], v4 offset:160
ds_read_b64_tr_b16 a[150:151], v4 offset:1056
v_mfma_f32_32x32x16_bf16 v[128:143], a[168:171], a[108:111], v[128:143]
ds_read_b64_tr_b16 a[152:153], v4 offset:192
ds_read_b64_tr_b16 a[154:155], v4 offset:1088
v_mfma_f32_32x32x16_bf16 v[144:159], a[168:171], a[124:127], v[144:159]
buffer_load_dwordx4 a[76:79], v8, s[8:11], s30 offen offset:3072 sc1
v_mfma_f32_32x32x16_bf16 v[160:175], a[172:175], a[108:111], v[160:175]
s_add_u32 s31, s31, 0x70000
s_add_u32 m0, s32, 0x15300
s_nop 0
buffer_load_dwordx4 v10, s[12:15], s31 offen offset:0 lds
v_mfma_f32_32x32x16_bf16 v[176:191], a[172:175], a[124:127], v[176:191]
v_mfma_f32_32x32x16_bf16 v[192:207], a[176:179], a[108:111], v[192:207]
buffer_load_dwordx4 v11, s[12:15], s31 offen offset:1024 lds
v_mfma_f32_32x32x16_bf16 v[208:223], a[176:179], a[124:127], v[208:223]
v_mfma_f32_32x32x16_bf16 v[224:239], a[180:183], a[108:111], v[224:239]
buffer_load_dwordx4 a[92:95], v9, s[8:11], s30 offen offset:3072 sc1
v_mfma_f32_32x32x16_bf16 v[240:255], a[180:183], a[124:127], v[240:255]
s_sub_u32 s33, s33, 1
s_cmp_lg_u32 s33, 0
s_cbranch_scc1 adaLN_cond__sliding_block_cached__swiglu_ffn__prompt_kernel_loop_44
s_waitcnt lgkmcnt(0)
v_mfma_f32_32x32x16_bf16 v[32:47], a[128:131], a[0:3], v[32:47]
ds_read_b64_tr_b16 a[156:157], v4 offset:3584
ds_read_b64_tr_b16 a[158:159], v4 offset:4480
v_mfma_f32_32x32x16_bf16 v[48:63], a[128:131], a[16:19], v[48:63]
ds_read_b64_tr_b16 a[160:161], v4 offset:3616
ds_read_b64_tr_b16 a[162:163], v4 offset:4512
v_mfma_f32_32x32x16_bf16 v[64:79], a[132:135], a[0:3], v[64:79]
ds_read_b64_tr_b16 a[164:165], v4 offset:3648
ds_read_b64_tr_b16 a[166:167], v4 offset:4544
v_mfma_f32_32x32x16_bf16 v[80:95], a[132:135], a[16:19], v[80:95]
ds_read_b64_tr_b16 a[168:169], v4 offset:3680
ds_read_b64_tr_b16 a[170:171], v4 offset:4576
v_mfma_f32_32x32x16_bf16 v[96:111], a[136:139], a[0:3], v[96:111]
ds_read_b64_tr_b16 a[172:173], v4 offset:3712
ds_read_b64_tr_b16 a[174:175], v4 offset:4608
v_mfma_f32_32x32x16_bf16 v[112:127], a[136:139], a[16:19], v[112:127]
ds_read_b64_tr_b16 a[176:177], v4 offset:3744
ds_read_b64_tr_b16 a[178:179], v4 offset:4640
v_mfma_f32_32x32x16_bf16 v[128:143], a[140:143], a[0:3], v[128:143]
ds_read_b64_tr_b16 a[180:181], v4 offset:3776
ds_read_b64_tr_b16 a[182:183], v4 offset:4672
v_mfma_f32_32x32x16_bf16 v[144:159], a[140:143], a[16:19], v[144:159]
s_add_u32 s30, s30, 4096
buffer_load_dwordx4 a[96:99], v8, s[8:11], s30 offen offset:0 sc1
v_mfma_f32_32x32x16_bf16 v[160:175], a[144:147], a[0:3], v[160:175]
buffer_load_dwordx4 v12, s[12:15], s31 offen offset:2048 lds
v_mfma_f32_32x32x16_bf16 v[176:191], a[144:147], a[16:19], v[176:191]
v_mfma_f32_32x32x16_bf16 v[192:207], a[148:151], a[0:3], v[192:207]
buffer_load_dwordx4 v13, s[12:15], s31 offen offset:3072 lds
v_mfma_f32_32x32x16_bf16 v[208:223], a[148:151], a[16:19], v[208:223]
v_mfma_f32_32x32x16_bf16 v[224:239], a[152:155], a[0:3], v[224:239]
buffer_load_dwordx4 a[112:115], v9, s[8:11], s30 offen offset:0 sc1
v_mfma_f32_32x32x16_bf16 v[240:255], a[152:155], a[16:19], v[240:255]
s_waitcnt lgkmcnt(0)
v_mfma_f32_32x32x16_bf16 v[32:47], a[156:159], a[4:7], v[32:47]
ds_read_b64_tr_b16 a[128:129], v4 offset:7168
ds_read_b64_tr_b16 a[130:131], v4 offset:8064
v_mfma_f32_32x32x16_bf16 v[48:63], a[156:159], a[20:23], v[48:63]
ds_read_b64_tr_b16 a[132:133], v4 offset:7200
ds_read_b64_tr_b16 a[134:135], v4 offset:8096
v_mfma_f32_32x32x16_bf16 v[64:79], a[160:163], a[4:7], v[64:79]
ds_read_b64_tr_b16 a[136:137], v4 offset:7232
ds_read_b64_tr_b16 a[138:139], v4 offset:8128
v_mfma_f32_32x32x16_bf16 v[80:95], a[160:163], a[20:23], v[80:95]
ds_read_b64_tr_b16 a[140:141], v4 offset:7264
ds_read_b64_tr_b16 a[142:143], v4 offset:8160
v_mfma_f32_32x32x16_bf16 v[96:111], a[164:167], a[4:7], v[96:111]
ds_read_b64_tr_b16 a[144:145], v4 offset:7296
ds_read_b64_tr_b16 a[146:147], v4 offset:8192
v_mfma_f32_32x32x16_bf16 v[112:127], a[164:167], a[20:23], v[112:127]
ds_read_b64_tr_b16 a[148:149], v4 offset:7328
ds_read_b64_tr_b16 a[150:151], v4 offset:8224
v_mfma_f32_32x32x16_bf16 v[128:143], a[168:171], a[4:7], v[128:143]
ds_read_b64_tr_b16 a[152:153], v4 offset:7360
ds_read_b64_tr_b16 a[154:155], v4 offset:8256
v_mfma_f32_32x32x16_bf16 v[144:159], a[168:171], a[20:23], v[144:159]
buffer_load_dwordx4 a[100:103], v8, s[8:11], s30 offen offset:1024 sc1
v_mfma_f32_32x32x16_bf16 v[160:175], a[172:175], a[4:7], v[160:175]
s_add_u32 m0, s32, 0x16300
s_nop 0
buffer_load_dwordx4 v14, s[12:15], s31 offen offset:0 lds
v_mfma_f32_32x32x16_bf16 v[176:191], a[172:175], a[20:23], v[176:191]
v_mfma_f32_32x32x16_bf16 v[192:207], a[176:179], a[4:7], v[192:207]
buffer_load_dwordx4 v15, s[12:15], s31 offen offset:1024 lds
v_mfma_f32_32x32x16_bf16 v[208:223], a[176:179], a[20:23], v[208:223]
v_mfma_f32_32x32x16_bf16 v[224:239], a[180:183], a[4:7], v[224:239]
buffer_load_dwordx4 a[116:119], v9, s[8:11], s30 offen offset:1024 sc1
v_mfma_f32_32x32x16_bf16 v[240:255], a[180:183], a[20:23], v[240:255]
s_waitcnt lgkmcnt(0)
v_mfma_f32_32x32x16_bf16 v[32:47], a[128:131], a[8:11], v[32:47]
ds_read_b64_tr_b16 a[156:157], v4 offset:10752
ds_read_b64_tr_b16 a[158:159], v4 offset:11648
v_mfma_f32_32x32x16_bf16 v[48:63], a[128:131], a[24:27], v[48:63]
ds_read_b64_tr_b16 a[160:161], v4 offset:10784
ds_read_b64_tr_b16 a[162:163], v4 offset:11680
v_mfma_f32_32x32x16_bf16 v[64:79], a[132:135], a[8:11], v[64:79]
ds_read_b64_tr_b16 a[164:165], v4 offset:10816
ds_read_b64_tr_b16 a[166:167], v4 offset:11712
v_mfma_f32_32x32x16_bf16 v[80:95], a[132:135], a[24:27], v[80:95]
ds_read_b64_tr_b16 a[168:169], v4 offset:10848
ds_read_b64_tr_b16 a[170:171], v4 offset:11744
v_mfma_f32_32x32x16_bf16 v[96:111], a[136:139], a[8:11], v[96:111]
ds_read_b64_tr_b16 a[172:173], v4 offset:10880
ds_read_b64_tr_b16 a[174:175], v4 offset:11776
v_mfma_f32_32x32x16_bf16 v[112:127], a[136:139], a[24:27], v[112:127]
ds_read_b64_tr_b16 a[176:177], v4 offset:10912
ds_read_b64_tr_b16 a[178:179], v4 offset:11808
v_mfma_f32_32x32x16_bf16 v[128:143], a[140:143], a[8:11], v[128:143]
ds_read_b64_tr_b16 a[180:181], v4 offset:10944
ds_read_b64_tr_b16 a[182:183], v4 offset:11840
v_mfma_f32_32x32x16_bf16 v[144:159], a[140:143], a[24:27], v[144:159]
buffer_load_dwordx4 a[104:107], v8, s[8:11], s30 offen offset:2048 sc1
v_mfma_f32_32x32x16_bf16 v[160:175], a[144:147], a[8:11], v[160:175]
v_mfma_f32_32x32x16_bf16 v[176:191], a[144:147], a[24:27], v[176:191]
buffer_load_dwordx4 v16, s[12:15], s31 offen offset:2048 lds
v_mfma_f32_32x32x16_bf16 v[192:207], a[148:151], a[8:11], v[192:207]
v_mfma_f32_32x32x16_bf16 v[208:223], a[148:151], a[24:27], v[208:223]
buffer_load_dwordx4 a[120:123], v9, s[8:11], s30 offen offset:2048 sc1
v_mfma_f32_32x32x16_bf16 v[224:239], a[152:155], a[8:11], v[224:239]
v_mfma_f32_32x32x16_bf16 v[240:255], a[152:155], a[24:27], v[240:255]
s_waitcnt vmcnt(11) lgkmcnt(0)
s_barrier
v_mfma_f32_32x32x16_bf16 v[32:47], a[156:159], a[12:15], v[32:47]
ds_read_b64_tr_b16 a[128:129], v4 offset:28928
ds_read_b64_tr_b16 a[130:131], v4 offset:29824
v_mfma_f32_32x32x16_bf16 v[48:63], a[156:159], a[28:31], v[48:63]
ds_read_b64_tr_b16 a[132:133], v4 offset:32512
ds_read_b64_tr_b16 a[134:135], v4 offset:33408
v_mfma_f32_32x32x16_bf16 v[64:79], a[160:163], a[12:15], v[64:79]
ds_read_b64_tr_b16 a[136:137], v4 offset:36096
ds_read_b64_tr_b16 a[138:139], v4 offset:36992
v_mfma_f32_32x32x16_bf16 v[80:95], a[160:163], a[28:31], v[80:95]
ds_read_b64_tr_b16 a[140:141], v4 offset:39680
ds_read_b64_tr_b16 a[142:143], v4 offset:40576
v_mfma_f32_32x32x16_bf16 v[96:111], a[164:167], a[12:15], v[96:111]
v_mfma_f32_32x32x16_bf16 v[112:127], a[164:167], a[28:31], v[112:127]
v_mfma_f32_32x32x16_bf16 v[128:143], a[168:171], a[12:15], v[128:143]
v_mfma_f32_32x32x16_bf16 v[144:159], a[168:171], a[28:31], v[144:159]
buffer_load_dwordx4 a[108:111], v8, s[8:11], s30 offen offset:3072 sc1
v_mfma_f32_32x32x16_bf16 v[160:175], a[172:175], a[12:15], v[160:175]
v_mfma_f32_32x32x16_bf16 v[176:191], a[172:175], a[28:31], v[176:191]
v_mfma_f32_32x32x16_bf16 v[192:207], a[176:179], a[12:15], v[192:207]
buffer_load_dwordx4 a[124:127], v9, s[8:11], s30 offen offset:3072 sc1
v_mfma_f32_32x32x16_bf16 v[208:223], a[176:179], a[28:31], v[208:223]
v_mfma_f32_32x32x16_bf16 v[224:239], a[180:183], a[12:15], v[224:239]
v_mfma_f32_32x32x16_bf16 v[240:255], a[180:183], a[28:31], v[240:255]
s_waitcnt lgkmcnt(6)
v_mfma_f32_32x32x16_bf16 v[32:47], a[128:131], a[32:35], v[32:47]
ds_read_b64_tr_b16 a[144:145], v5 offset:0
v_mfma_f32_32x32x16_bf16 v[48:63], a[128:131], a[48:51], v[48:63]
ds_read_b64_tr_b16 a[146:147], v5 offset:896
s_waitcnt lgkmcnt(6)
v_mfma_f32_32x32x16_bf16 v[32:47], a[132:135], a[36:39], v[32:47]
ds_read_b64_tr_b16 a[148:149], v5 offset:3584
v_mfma_f32_32x32x16_bf16 v[48:63], a[132:135], a[52:55], v[48:63]
ds_read_b64_tr_b16 a[150:151], v5 offset:4480
s_waitcnt lgkmcnt(6)
v_mfma_f32_32x32x16_bf16 v[32:47], a[136:139], a[40:43], v[32:47]
ds_read_b64_tr_b16 a[152:153], v5 offset:7168
v_mfma_f32_32x32x16_bf16 v[48:63], a[136:139], a[56:59], v[48:63]
ds_read_b64_tr_b16 a[154:155], v5 offset:8064
s_waitcnt lgkmcnt(6)
v_mfma_f32_32x32x16_bf16 v[32:47], a[140:143], a[44:47], v[32:47]
ds_read_b64_tr_b16 a[156:157], v5 offset:10752
v_mfma_f32_32x32x16_bf16 v[48:63], a[140:143], a[60:63], v[48:63]
ds_read_b64_tr_b16 a[158:159], v5 offset:11648
s_waitcnt vmcnt(0)
s_barrier
s_waitcnt lgkmcnt(6)
v_mfma_f32_32x32x16_bf16 v[32:47], a[144:147], a[64:67], v[32:47]
ds_read_b64_tr_b16 a[128:129], v5 offset:28928
v_mfma_f32_32x32x16_bf16 v[48:63], a[144:147], a[80:83], v[48:63]
ds_read_b64_tr_b16 a[130:131], v5 offset:29824
s_waitcnt lgkmcnt(6)
v_mfma_f32_32x32x16_bf16 v[32:47], a[148:151], a[68:71], v[32:47]
ds_read_b64_tr_b16 a[132:133], v5 offset:32512
v_mfma_f32_32x32x16_bf16 v[48:63], a[148:151], a[84:87], v[48:63]
ds_read_b64_tr_b16 a[134:135], v5 offset:33408
s_waitcnt lgkmcnt(6)
v_mfma_f32_32x32x16_bf16 v[32:47], a[152:155], a[72:75], v[32:47]
ds_read_b64_tr_b16 a[136:137], v5 offset:36096
v_mfma_f32_32x32x16_bf16 v[48:63], a[152:155], a[88:91], v[48:63]
ds_read_b64_tr_b16 a[138:139], v5 offset:36992
s_waitcnt lgkmcnt(6)
v_mfma_f32_32x32x16_bf16 v[32:47], a[156:159], a[76:79], v[32:47]
ds_read_b64_tr_b16 a[140:141], v5 offset:39680
v_mfma_f32_32x32x16_bf16 v[48:63], a[156:159], a[92:95], v[48:63]
ds_read_b64_tr_b16 a[142:143], v5 offset:40576
s_waitcnt lgkmcnt(6)
v_mfma_f32_32x32x16_bf16 v[32:47], a[128:131], a[96:99], v[32:47]
ds_read_b64_tr_b16 a[144:145], v4 offset:28960
v_mfma_f32_32x32x16_bf16 v[48:63], a[128:131], a[112:115], v[48:63]
ds_read_b64_tr_b16 a[146:147], v4 offset:29856
s_waitcnt lgkmcnt(6)
v_mfma_f32_32x32x16_bf16 v[32:47], a[132:135], a[100:103], v[32:47]
ds_read_b64_tr_b16 a[148:149], v4 offset:32544
v_mfma_f32_32x32x16_bf16 v[48:63], a[132:135], a[116:119], v[48:63]
ds_read_b64_tr_b16 a[150:151], v4 offset:33440
s_waitcnt lgkmcnt(6)
v_mfma_f32_32x32x16_bf16 v[32:47], a[136:139], a[104:107], v[32:47]
ds_read_b64_tr_b16 a[152:153], v4 offset:36128
v_mfma_f32_32x32x16_bf16 v[48:63], a[136:139], a[120:123], v[48:63]
ds_read_b64_tr_b16 a[154:155], v4 offset:37024
s_waitcnt lgkmcnt(6)
v_mfma_f32_32x32x16_bf16 v[32:47], a[140:143], a[108:111], v[32:47]
ds_read_b64_tr_b16 a[156:157], v4 offset:39712
v_mfma_f32_32x32x16_bf16 v[48:63], a[140:143], a[124:127], v[48:63]
ds_read_b64_tr_b16 a[158:159], v4 offset:40608
s_waitcnt lgkmcnt(6)
v_mfma_f32_32x32x16_bf16 v[64:79], a[144:147], a[32:35], v[64:79]
ds_read_b64_tr_b16 a[128:129], v5 offset:32
v_mfma_f32_32x32x16_bf16 v[80:95], a[144:147], a[48:51], v[80:95]
ds_read_b64_tr_b16 a[130:131], v5 offset:928
s_waitcnt lgkmcnt(6)
v_mfma_f32_32x32x16_bf16 v[64:79], a[148:151], a[36:39], v[64:79]
ds_read_b64_tr_b16 a[132:133], v5 offset:3616
v_mfma_f32_32x32x16_bf16 v[80:95], a[148:151], a[52:55], v[80:95]
ds_read_b64_tr_b16 a[134:135], v5 offset:4512
s_waitcnt lgkmcnt(6)
v_mfma_f32_32x32x16_bf16 v[64:79], a[152:155], a[40:43], v[64:79]
ds_read_b64_tr_b16 a[136:137], v5 offset:7200
v_exp_f32 v17, v32
v_exp_f32 v18, v33
v_exp_f32 v19, v34
v_exp_f32 v20, v35
v_mul_f32 v32, v32, v40
v_mfma_f32_32x32x16_bf16 v[80:95], a[152:155], a[56:59], v[80:95]
ds_read_b64_tr_b16 a[138:139], v5 offset:8096
v_mul_f32 v33, v33, v41
v_mul_f32 v34, v34, v42
v_mul_f32 v35, v35, v43
v_add_f32 v17, 1.0, v17
v_add_f32 v18, 1.0, v18
s_waitcnt lgkmcnt(6)
v_mfma_f32_32x32x16_bf16 v[64:79], a[156:159], a[44:47], v[64:79]
ds_read_b64_tr_b16 a[140:141], v5 offset:10784
v_add_f32 v19, 1.0, v19
v_add_f32 v20, 1.0, v20
v_rcp_f32 v17, v17
v_rcp_f32 v18, v18
v_rcp_f32 v19, v19
v_mfma_f32_32x32x16_bf16 v[80:95], a[156:159], a[60:63], v[80:95]
ds_read_b64_tr_b16 a[142:143], v5 offset:11680
v_rcp_f32 v20, v20
s_nop 0
v_mul_f32 v32, v32, v17
v_mul_f32 v33, v33, v18
s_waitcnt lgkmcnt(6)
v_mfma_f32_32x32x16_bf16 v[64:79], a[128:131], a[64:67], v[64:79]
ds_read_b64_tr_b16 a[144:145], v5 offset:28960
v_mul_f32 v34, v34, v19
v_mul_f32 v35, v35, v20
v_exp_f32 v17, v36
v_exp_f32 v18, v37
v_exp_f32 v19, v38
v_mfma_f32_32x32x16_bf16 v[80:95], a[128:131], a[80:83], v[80:95]
ds_read_b64_tr_b16 a[146:147], v5 offset:29856
v_exp_f32 v20, v39
v_mul_f32 v36, v36, v44
v_mul_f32 v37, v37, v45
v_mul_f32 v38, v38, v46
v_mul_f32 v39, v39, v47
s_waitcnt lgkmcnt(6)
v_mfma_f32_32x32x16_bf16 v[64:79], a[132:135], a[68:71], v[64:79]
ds_read_b64_tr_b16 a[148:149], v5 offset:32544
v_add_f32 v17, 1.0, v17
v_add_f32 v18, 1.0, v18
v_add_f32 v19, 1.0, v19
v_add_f32 v20, 1.0, v20
v_mfma_f32_32x32x16_bf16 v[80:95], a[132:135], a[84:87], v[80:95]
ds_read_b64_tr_b16 a[150:151], v5 offset:33440
v_rcp_f32 v17, v17
v_rcp_f32 v18, v18
v_rcp_f32 v19, v19
v_rcp_f32 v20, v20
s_nop 0
s_waitcnt lgkmcnt(6)
v_mfma_f32_32x32x16_bf16 v[64:79], a[136:139], a[72:75], v[64:79]
ds_read_b64_tr_b16 a[152:153], v5 offset:36128
v_mul_f32 v36, v36, v17
v_mul_f32 v37, v37, v18
v_mul_f32 v38, v38, v19
v_mul_f32 v39, v39, v20
v_cvt_pk_bf16_f32 v40, v32, v33
v_mfma_f32_32x32x16_bf16 v[80:95], a[136:139], a[88:91], v[80:95]
ds_read_b64_tr_b16 a[154:155], v5 offset:37024
v_cvt_pk_bf16_f32 v41, v34, v35
v_cvt_pk_bf16_f32 v42, v36, v37
v_cvt_pk_bf16_f32 v43, v38, v39
buffer_store_dwordx4 v[40:43], v30, s[16:19], s36 offen offset:0 sc1
s_waitcnt lgkmcnt(6)
v_mfma_f32_32x32x16_bf16 v[64:79], a[140:143], a[76:79], v[64:79]
ds_read_b64_tr_b16 a[156:157], v5 offset:39712
v_exp_f32 v21, v48
v_exp_f32 v22, v49
v_exp_f32 v23, v50
v_exp_f32 v24, v51
v_mul_f32 v48, v48, v56
v_mfma_f32_32x32x16_bf16 v[80:95], a[140:143], a[92:95], v[80:95]
ds_read_b64_tr_b16 a[158:159], v5 offset:40608
v_mul_f32 v49, v49, v57
v_mul_f32 v50, v50, v58
v_mul_f32 v51, v51, v59
v_add_f32 v21, 1.0, v21
v_add_f32 v22, 1.0, v22
s_waitcnt lgkmcnt(6)
v_mfma_f32_32x32x16_bf16 v[64:79], a[144:147], a[96:99], v[64:79]
ds_read_b64_tr_b16 a[128:129], v4 offset:28992
v_add_f32 v23, 1.0, v23
v_add_f32 v24, 1.0, v24
v_rcp_f32 v21, v21
v_rcp_f32 v22, v22
v_rcp_f32 v23, v23
v_mfma_f32_32x32x16_bf16 v[80:95], a[144:147], a[112:115], v[80:95]
ds_read_b64_tr_b16 a[130:131], v4 offset:29888
v_rcp_f32 v24, v24
s_nop 0
v_mul_f32 v48, v48, v21
v_mul_f32 v49, v49, v22
s_waitcnt lgkmcnt(6)
v_mfma_f32_32x32x16_bf16 v[64:79], a[148:151], a[100:103], v[64:79]
ds_read_b64_tr_b16 a[132:133], v4 offset:32576
v_mul_f32 v50, v50, v23
v_mul_f32 v51, v51, v24
v_exp_f32 v21, v52
v_exp_f32 v22, v53
v_exp_f32 v23, v54
v_mfma_f32_32x32x16_bf16 v[80:95], a[148:151], a[116:119], v[80:95]
ds_read_b64_tr_b16 a[134:135], v4 offset:33472
v_exp_f32 v24, v55
v_mul_f32 v52, v52, v60
v_mul_f32 v53, v53, v61
v_mul_f32 v54, v54, v62
v_mul_f32 v55, v55, v63
s_waitcnt lgkmcnt(6)
v_mfma_f32_32x32x16_bf16 v[64:79], a[152:155], a[104:107], v[64:79]
ds_read_b64_tr_b16 a[136:137], v4 offset:36160
v_add_f32 v21, 1.0, v21
v_add_f32 v22, 1.0, v22
v_add_f32 v23, 1.0, v23
v_add_f32 v24, 1.0, v24
v_mfma_f32_32x32x16_bf16 v[80:95], a[152:155], a[120:123], v[80:95]
ds_read_b64_tr_b16 a[138:139], v4 offset:37056
v_rcp_f32 v21, v21
v_rcp_f32 v22, v22
v_rcp_f32 v23, v23
v_rcp_f32 v24, v24
s_nop 0
s_waitcnt lgkmcnt(6)
v_mfma_f32_32x32x16_bf16 v[64:79], a[156:159], a[108:111], v[64:79]
ds_read_b64_tr_b16 a[140:141], v4 offset:39744
v_mul_f32 v52, v52, v21
v_mul_f32 v53, v53, v22
v_mul_f32 v54, v54, v23
v_mul_f32 v55, v55, v24
v_cvt_pk_bf16_f32 v56, v48, v49
v_mfma_f32_32x32x16_bf16 v[80:95], a[156:159], a[124:127], v[80:95]
ds_read_b64_tr_b16 a[142:143], v4 offset:40640
v_cvt_pk_bf16_f32 v57, v50, v51
v_cvt_pk_bf16_f32 v58, v52, v53
v_cvt_pk_bf16_f32 v59, v54, v55
buffer_store_dwordx4 v[56:59], v30, s[16:19], s37 offen offset:0 sc1
s_waitcnt lgkmcnt(6)
v_mfma_f32_32x32x16_bf16 v[96:111], a[128:131], a[32:35], v[96:111]
ds_read_b64_tr_b16 a[144:145], v5 offset:64
v_mfma_f32_32x32x16_bf16 v[112:127], a[128:131], a[48:51], v[112:127]
ds_read_b64_tr_b16 a[146:147], v5 offset:960
s_waitcnt lgkmcnt(6)
v_mfma_f32_32x32x16_bf16 v[96:111], a[132:135], a[36:39], v[96:111]
ds_read_b64_tr_b16 a[148:149], v5 offset:3648
v_mfma_f32_32x32x16_bf16 v[112:127], a[132:135], a[52:55], v[112:127]
ds_read_b64_tr_b16 a[150:151], v5 offset:4544
s_waitcnt lgkmcnt(6)
v_mfma_f32_32x32x16_bf16 v[96:111], a[136:139], a[40:43], v[96:111]
ds_read_b64_tr_b16 a[152:153], v5 offset:7232
v_exp_f32 v17, v64
v_exp_f32 v18, v65
v_exp_f32 v19, v66
v_exp_f32 v20, v67
v_mul_f32 v64, v64, v72
v_mfma_f32_32x32x16_bf16 v[112:127], a[136:139], a[56:59], v[112:127]
ds_read_b64_tr_b16 a[154:155], v5 offset:8128
v_mul_f32 v65, v65, v73
v_mul_f32 v66, v66, v74
v_mul_f32 v67, v67, v75
v_add_f32 v17, 1.0, v17
v_add_f32 v18, 1.0, v18
s_waitcnt lgkmcnt(6)
v_mfma_f32_32x32x16_bf16 v[96:111], a[140:143], a[44:47], v[96:111]
ds_read_b64_tr_b16 a[156:157], v5 offset:10816
v_add_f32 v19, 1.0, v19
v_add_f32 v20, 1.0, v20
v_rcp_f32 v17, v17
v_rcp_f32 v18, v18
v_rcp_f32 v19, v19
v_mfma_f32_32x32x16_bf16 v[112:127], a[140:143], a[60:63], v[112:127]
ds_read_b64_tr_b16 a[158:159], v5 offset:11712
v_rcp_f32 v20, v20
s_nop 0
v_mul_f32 v64, v64, v17
v_mul_f32 v65, v65, v18
s_waitcnt lgkmcnt(6)
v_mfma_f32_32x32x16_bf16 v[96:111], a[144:147], a[64:67], v[96:111]
ds_read_b64_tr_b16 a[128:129], v5 offset:28992
v_mul_f32 v66, v66, v19
v_mul_f32 v67, v67, v20
v_exp_f32 v17, v68
v_exp_f32 v18, v69
v_exp_f32 v19, v70
v_mfma_f32_32x32x16_bf16 v[112:127], a[144:147], a[80:83], v[112:127]
ds_read_b64_tr_b16 a[130:131], v5 offset:29888
v_exp_f32 v20, v71
v_mul_f32 v68, v68, v76
v_mul_f32 v69, v69, v77
v_mul_f32 v70, v70, v78
v_mul_f32 v71, v71, v79
s_waitcnt lgkmcnt(6)
v_mfma_f32_32x32x16_bf16 v[96:111], a[148:151], a[68:71], v[96:111]
ds_read_b64_tr_b16 a[132:133], v5 offset:32576
v_add_f32 v17, 1.0, v17
v_add_f32 v18, 1.0, v18
v_add_f32 v19, 1.0, v19
v_add_f32 v20, 1.0, v20
v_mfma_f32_32x32x16_bf16 v[112:127], a[148:151], a[84:87], v[112:127]
ds_read_b64_tr_b16 a[134:135], v5 offset:33472
v_rcp_f32 v17, v17
v_rcp_f32 v18, v18
v_rcp_f32 v19, v19
v_rcp_f32 v20, v20
s_nop 0
s_waitcnt lgkmcnt(6)
v_mfma_f32_32x32x16_bf16 v[96:111], a[152:155], a[72:75], v[96:111]
ds_read_b64_tr_b16 a[136:137], v5 offset:36160
v_mul_f32 v68, v68, v17
v_mul_f32 v69, v69, v18
v_mul_f32 v70, v70, v19
v_mul_f32 v71, v71, v20
v_cvt_pk_bf16_f32 v72, v64, v65
v_mfma_f32_32x32x16_bf16 v[112:127], a[152:155], a[88:91], v[112:127]
ds_read_b64_tr_b16 a[138:139], v5 offset:37056
v_cvt_pk_bf16_f32 v73, v66, v67
v_cvt_pk_bf16_f32 v74, v68, v69
v_cvt_pk_bf16_f32 v75, v70, v71
buffer_store_dwordx4 v[72:75], v30, s[16:19], s36 offen offset:1024 sc1
s_waitcnt lgkmcnt(6)
v_mfma_f32_32x32x16_bf16 v[96:111], a[156:159], a[76:79], v[96:111]
ds_read_b64_tr_b16 a[140:141], v5 offset:39744
v_exp_f32 v21, v80
v_exp_f32 v22, v81
v_exp_f32 v23, v82
v_exp_f32 v24, v83
v_mul_f32 v80, v80, v88
v_mfma_f32_32x32x16_bf16 v[112:127], a[156:159], a[92:95], v[112:127]
ds_read_b64_tr_b16 a[142:143], v5 offset:40640
v_mul_f32 v81, v81, v89
v_mul_f32 v82, v82, v90
v_mul_f32 v83, v83, v91
v_add_f32 v21, 1.0, v21
v_add_f32 v22, 1.0, v22
s_waitcnt lgkmcnt(6)
v_mfma_f32_32x32x16_bf16 v[96:111], a[128:131], a[96:99], v[96:111]
ds_read_b64_tr_b16 a[144:145], v4 offset:29024
v_add_f32 v23, 1.0, v23
v_add_f32 v24, 1.0, v24
v_rcp_f32 v21, v21
v_rcp_f32 v22, v22
v_rcp_f32 v23, v23
v_mfma_f32_32x32x16_bf16 v[112:127], a[128:131], a[112:115], v[112:127]
ds_read_b64_tr_b16 a[146:147], v4 offset:29920
v_rcp_f32 v24, v24
s_nop 0
v_mul_f32 v80, v80, v21
v_mul_f32 v81, v81, v22
s_waitcnt lgkmcnt(6)
v_mfma_f32_32x32x16_bf16 v[96:111], a[132:135], a[100:103], v[96:111]
ds_read_b64_tr_b16 a[148:149], v4 offset:32608
v_mul_f32 v82, v82, v23
v_mul_f32 v83, v83, v24
v_exp_f32 v21, v84
v_exp_f32 v22, v85
v_exp_f32 v23, v86
v_mfma_f32_32x32x16_bf16 v[112:127], a[132:135], a[116:119], v[112:127]
ds_read_b64_tr_b16 a[150:151], v4 offset:33504
v_exp_f32 v24, v87
v_mul_f32 v84, v84, v92
v_mul_f32 v85, v85, v93
v_mul_f32 v86, v86, v94
v_mul_f32 v87, v87, v95
s_waitcnt lgkmcnt(6)
v_mfma_f32_32x32x16_bf16 v[96:111], a[136:139], a[104:107], v[96:111]
ds_read_b64_tr_b16 a[152:153], v4 offset:36192
v_add_f32 v21, 1.0, v21
v_add_f32 v22, 1.0, v22
v_add_f32 v23, 1.0, v23
v_add_f32 v24, 1.0, v24
v_mfma_f32_32x32x16_bf16 v[112:127], a[136:139], a[120:123], v[112:127]
ds_read_b64_tr_b16 a[154:155], v4 offset:37088
v_rcp_f32 v21, v21
v_rcp_f32 v22, v22
v_rcp_f32 v23, v23
v_rcp_f32 v24, v24
s_nop 0
s_waitcnt lgkmcnt(6)
v_mfma_f32_32x32x16_bf16 v[96:111], a[140:143], a[108:111], v[96:111]
ds_read_b64_tr_b16 a[156:157], v4 offset:39776
v_mul_f32 v84, v84, v21
v_mul_f32 v85, v85, v22
v_mul_f32 v86, v86, v23
v_mul_f32 v87, v87, v24
v_cvt_pk_bf16_f32 v88, v80, v81
v_mfma_f32_32x32x16_bf16 v[112:127], a[140:143], a[124:127], v[112:127]
ds_read_b64_tr_b16 a[158:159], v4 offset:40672
v_cvt_pk_bf16_f32 v89, v82, v83
v_cvt_pk_bf16_f32 v90, v84, v85
v_cvt_pk_bf16_f32 v91, v86, v87
buffer_store_dwordx4 v[88:91], v30, s[16:19], s37 offen offset:1024 sc1
s_waitcnt lgkmcnt(6)
v_mfma_f32_32x32x16_bf16 v[128:143], a[144:147], a[32:35], v[128:143]
ds_read_b64_tr_b16 a[128:129], v5 offset:96
v_mfma_f32_32x32x16_bf16 v[144:159], a[144:147], a[48:51], v[144:159]
ds_read_b64_tr_b16 a[130:131], v5 offset:992
s_waitcnt lgkmcnt(6)
v_mfma_f32_32x32x16_bf16 v[128:143], a[148:151], a[36:39], v[128:143]
ds_read_b64_tr_b16 a[132:133], v5 offset:3680
v_mfma_f32_32x32x16_bf16 v[144:159], a[148:151], a[52:55], v[144:159]
ds_read_b64_tr_b16 a[134:135], v5 offset:4576
s_waitcnt lgkmcnt(6)
v_mfma_f32_32x32x16_bf16 v[128:143], a[152:155], a[40:43], v[128:143]
ds_read_b64_tr_b16 a[136:137], v5 offset:7264
v_exp_f32 v17, v96
v_exp_f32 v18, v97
v_exp_f32 v19, v98
v_exp_f32 v20, v99
v_mul_f32 v96, v96, v104
v_mfma_f32_32x32x16_bf16 v[144:159], a[152:155], a[56:59], v[144:159]
ds_read_b64_tr_b16 a[138:139], v5 offset:8160
v_mul_f32 v97, v97, v105
v_mul_f32 v98, v98, v106
v_mul_f32 v99, v99, v107
v_add_f32 v17, 1.0, v17
v_add_f32 v18, 1.0, v18
s_waitcnt lgkmcnt(6)
v_mfma_f32_32x32x16_bf16 v[128:143], a[156:159], a[44:47], v[128:143]
ds_read_b64_tr_b16 a[140:141], v5 offset:10848
v_add_f32 v19, 1.0, v19
v_add_f32 v20, 1.0, v20
v_rcp_f32 v17, v17
v_rcp_f32 v18, v18
v_rcp_f32 v19, v19
v_mfma_f32_32x32x16_bf16 v[144:159], a[156:159], a[60:63], v[144:159]
ds_read_b64_tr_b16 a[142:143], v5 offset:11744
v_rcp_f32 v20, v20
s_nop 0
v_mul_f32 v96, v96, v17
v_mul_f32 v97, v97, v18
s_waitcnt lgkmcnt(6)
v_mfma_f32_32x32x16_bf16 v[128:143], a[128:131], a[64:67], v[128:143]
ds_read_b64_tr_b16 a[144:145], v5 offset:29024
v_mul_f32 v98, v98, v19
v_mul_f32 v99, v99, v20
v_exp_f32 v17, v100
v_exp_f32 v18, v101
v_exp_f32 v19, v102
v_mfma_f32_32x32x16_bf16 v[144:159], a[128:131], a[80:83], v[144:159]
ds_read_b64_tr_b16 a[146:147], v5 offset:29920
v_exp_f32 v20, v103
v_mul_f32 v100, v100, v108
v_mul_f32 v101, v101, v109
v_mul_f32 v102, v102, v110
v_mul_f32 v103, v103, v111
s_waitcnt lgkmcnt(6)
v_mfma_f32_32x32x16_bf16 v[128:143], a[132:135], a[68:71], v[128:143]
ds_read_b64_tr_b16 a[148:149], v5 offset:32608
v_add_f32 v17, 1.0, v17
v_add_f32 v18, 1.0, v18
v_add_f32 v19, 1.0, v19
v_add_f32 v20, 1.0, v20
v_mfma_f32_32x32x16_bf16 v[144:159], a[132:135], a[84:87], v[144:159]
ds_read_b64_tr_b16 a[150:151], v5 offset:33504
v_rcp_f32 v17, v17
v_rcp_f32 v18, v18
v_rcp_f32 v19, v19
v_rcp_f32 v20, v20
s_nop 0
s_waitcnt lgkmcnt(6)
v_mfma_f32_32x32x16_bf16 v[128:143], a[136:139], a[72:75], v[128:143]
ds_read_b64_tr_b16 a[152:153], v5 offset:36192
v_mul_f32 v100, v100, v17
v_mul_f32 v101, v101, v18
v_mul_f32 v102, v102, v19
v_mul_f32 v103, v103, v20
v_cvt_pk_bf16_f32 v104, v96, v97
v_mfma_f32_32x32x16_bf16 v[144:159], a[136:139], a[88:91], v[144:159]
ds_read_b64_tr_b16 a[154:155], v5 offset:37088
v_cvt_pk_bf16_f32 v105, v98, v99
v_cvt_pk_bf16_f32 v106, v100, v101
v_cvt_pk_bf16_f32 v107, v102, v103
buffer_store_dwordx4 v[104:107], v30, s[16:19], s36 offen offset:2048 sc1
s_waitcnt lgkmcnt(6)
v_mfma_f32_32x32x16_bf16 v[128:143], a[140:143], a[76:79], v[128:143]
ds_read_b64_tr_b16 a[156:157], v5 offset:39776
v_exp_f32 v21, v112
v_exp_f32 v22, v113
v_exp_f32 v23, v114
v_exp_f32 v24, v115
v_mul_f32 v112, v112, v120
v_mfma_f32_32x32x16_bf16 v[144:159], a[140:143], a[92:95], v[144:159]
ds_read_b64_tr_b16 a[158:159], v5 offset:40672
v_mul_f32 v113, v113, v121
v_mul_f32 v114, v114, v122
v_mul_f32 v115, v115, v123
v_add_f32 v21, 1.0, v21
v_add_f32 v22, 1.0, v22
s_waitcnt lgkmcnt(6)
v_mfma_f32_32x32x16_bf16 v[128:143], a[144:147], a[96:99], v[128:143]
ds_read_b64_tr_b16 a[128:129], v4 offset:29056
v_add_f32 v23, 1.0, v23
v_add_f32 v24, 1.0, v24
v_rcp_f32 v21, v21
v_rcp_f32 v22, v22
v_rcp_f32 v23, v23
v_mfma_f32_32x32x16_bf16 v[144:159], a[144:147], a[112:115], v[144:159]
ds_read_b64_tr_b16 a[130:131], v4 offset:29952
v_rcp_f32 v24, v24
s_nop 0
v_mul_f32 v112, v112, v21
v_mul_f32 v113, v113, v22
s_waitcnt lgkmcnt(6)
v_mfma_f32_32x32x16_bf16 v[128:143], a[148:151], a[100:103], v[128:143]
ds_read_b64_tr_b16 a[132:133], v4 offset:32640
v_mul_f32 v114, v114, v23
v_mul_f32 v115, v115, v24
v_exp_f32 v21, v116
v_exp_f32 v22, v117
v_exp_f32 v23, v118
v_mfma_f32_32x32x16_bf16 v[144:159], a[148:151], a[116:119], v[144:159]
ds_read_b64_tr_b16 a[134:135], v4 offset:33536
v_exp_f32 v24, v119
v_mul_f32 v116, v116, v124
v_mul_f32 v117, v117, v125
v_mul_f32 v118, v118, v126
v_mul_f32 v119, v119, v127
s_waitcnt lgkmcnt(6)
v_mfma_f32_32x32x16_bf16 v[128:143], a[152:155], a[104:107], v[128:143]
ds_read_b64_tr_b16 a[136:137], v4 offset:36224
v_add_f32 v21, 1.0, v21
v_add_f32 v22, 1.0, v22
v_add_f32 v23, 1.0, v23
v_add_f32 v24, 1.0, v24
v_mfma_f32_32x32x16_bf16 v[144:159], a[152:155], a[120:123], v[144:159]
ds_read_b64_tr_b16 a[138:139], v4 offset:37120
v_rcp_f32 v21, v21
v_rcp_f32 v22, v22
v_rcp_f32 v23, v23
v_rcp_f32 v24, v24
s_nop 0
s_waitcnt lgkmcnt(6)
v_mfma_f32_32x32x16_bf16 v[128:143], a[156:159], a[108:111], v[128:143]
ds_read_b64_tr_b16 a[140:141], v4 offset:39808
v_mul_f32 v116, v116, v21
v_mul_f32 v117, v117, v22
v_mul_f32 v118, v118, v23
v_mul_f32 v119, v119, v24
v_cvt_pk_bf16_f32 v120, v112, v113
v_mfma_f32_32x32x16_bf16 v[144:159], a[156:159], a[124:127], v[144:159]
ds_read_b64_tr_b16 a[142:143], v4 offset:40704
v_cvt_pk_bf16_f32 v121, v114, v115
v_cvt_pk_bf16_f32 v122, v116, v117
v_cvt_pk_bf16_f32 v123, v118, v119
buffer_store_dwordx4 v[120:123], v30, s[16:19], s37 offen offset:2048 sc1
s_waitcnt lgkmcnt(6)
v_mfma_f32_32x32x16_bf16 v[160:175], a[128:131], a[32:35], v[160:175]
ds_read_b64_tr_b16 a[144:145], v5 offset:128
v_mfma_f32_32x32x16_bf16 v[176:191], a[128:131], a[48:51], v[176:191]
ds_read_b64_tr_b16 a[146:147], v5 offset:1024
s_waitcnt lgkmcnt(6)
v_mfma_f32_32x32x16_bf16 v[160:175], a[132:135], a[36:39], v[160:175]
ds_read_b64_tr_b16 a[148:149], v5 offset:3712
v_mfma_f32_32x32x16_bf16 v[176:191], a[132:135], a[52:55], v[176:191]
ds_read_b64_tr_b16 a[150:151], v5 offset:4608
s_waitcnt lgkmcnt(6)
v_mfma_f32_32x32x16_bf16 v[160:175], a[136:139], a[40:43], v[160:175]
ds_read_b64_tr_b16 a[152:153], v5 offset:7296
v_exp_f32 v17, v128
v_exp_f32 v18, v129
v_exp_f32 v19, v130
v_exp_f32 v20, v131
v_mul_f32 v128, v128, v136
v_mfma_f32_32x32x16_bf16 v[176:191], a[136:139], a[56:59], v[176:191]
ds_read_b64_tr_b16 a[154:155], v5 offset:8192
v_mul_f32 v129, v129, v137
v_mul_f32 v130, v130, v138
v_mul_f32 v131, v131, v139
v_add_f32 v17, 1.0, v17
v_add_f32 v18, 1.0, v18
s_waitcnt lgkmcnt(6)
v_mfma_f32_32x32x16_bf16 v[160:175], a[140:143], a[44:47], v[160:175]
ds_read_b64_tr_b16 a[156:157], v5 offset:10880
v_add_f32 v19, 1.0, v19
v_add_f32 v20, 1.0, v20
v_rcp_f32 v17, v17
v_rcp_f32 v18, v18
v_rcp_f32 v19, v19
v_mfma_f32_32x32x16_bf16 v[176:191], a[140:143], a[60:63], v[176:191]
ds_read_b64_tr_b16 a[158:159], v5 offset:11776
v_rcp_f32 v20, v20
s_nop 0
v_mul_f32 v128, v128, v17
v_mul_f32 v129, v129, v18
s_waitcnt lgkmcnt(6)
v_mfma_f32_32x32x16_bf16 v[160:175], a[144:147], a[64:67], v[160:175]
ds_read_b64_tr_b16 a[128:129], v5 offset:29056
v_mul_f32 v130, v130, v19
v_mul_f32 v131, v131, v20
v_exp_f32 v17, v132
v_exp_f32 v18, v133
v_exp_f32 v19, v134
v_mfma_f32_32x32x16_bf16 v[176:191], a[144:147], a[80:83], v[176:191]
ds_read_b64_tr_b16 a[130:131], v5 offset:29952
v_exp_f32 v20, v135
v_mul_f32 v132, v132, v140
v_mul_f32 v133, v133, v141
v_mul_f32 v134, v134, v142
v_mul_f32 v135, v135, v143
s_waitcnt lgkmcnt(6)
v_mfma_f32_32x32x16_bf16 v[160:175], a[148:151], a[68:71], v[160:175]
ds_read_b64_tr_b16 a[132:133], v5 offset:32640
v_add_f32 v17, 1.0, v17
v_add_f32 v18, 1.0, v18
v_add_f32 v19, 1.0, v19
v_add_f32 v20, 1.0, v20
v_mfma_f32_32x32x16_bf16 v[176:191], a[148:151], a[84:87], v[176:191]
ds_read_b64_tr_b16 a[134:135], v5 offset:33536
v_rcp_f32 v17, v17
v_rcp_f32 v18, v18
v_rcp_f32 v19, v19
v_rcp_f32 v20, v20
s_nop 0
s_waitcnt lgkmcnt(6)
v_mfma_f32_32x32x16_bf16 v[160:175], a[152:155], a[72:75], v[160:175]
ds_read_b64_tr_b16 a[136:137], v5 offset:36224
v_mul_f32 v132, v132, v17
v_mul_f32 v133, v133, v18
v_mul_f32 v134, v134, v19
v_mul_f32 v135, v135, v20
v_cvt_pk_bf16_f32 v136, v128, v129
v_mfma_f32_32x32x16_bf16 v[176:191], a[152:155], a[88:91], v[176:191]
ds_read_b64_tr_b16 a[138:139], v5 offset:37120
v_cvt_pk_bf16_f32 v137, v130, v131
v_cvt_pk_bf16_f32 v138, v132, v133
v_cvt_pk_bf16_f32 v139, v134, v135
buffer_store_dwordx4 v[136:139], v30, s[16:19], s36 offen offset:3072 sc1
s_waitcnt lgkmcnt(6)
v_mfma_f32_32x32x16_bf16 v[160:175], a[156:159], a[76:79], v[160:175]
ds_read_b64_tr_b16 a[140:141], v5 offset:39808
v_exp_f32 v21, v144
v_exp_f32 v22, v145
v_exp_f32 v23, v146
v_exp_f32 v24, v147
v_mul_f32 v144, v144, v152
v_mfma_f32_32x32x16_bf16 v[176:191], a[156:159], a[92:95], v[176:191]
ds_read_b64_tr_b16 a[142:143], v5 offset:40704
v_mul_f32 v145, v145, v153
v_mul_f32 v146, v146, v154
v_mul_f32 v147, v147, v155
v_add_f32 v21, 1.0, v21
v_add_f32 v22, 1.0, v22
s_waitcnt lgkmcnt(6)
v_mfma_f32_32x32x16_bf16 v[160:175], a[128:131], a[96:99], v[160:175]
ds_read_b64_tr_b16 a[144:145], v4 offset:29088
v_add_f32 v23, 1.0, v23
v_add_f32 v24, 1.0, v24
v_rcp_f32 v21, v21
v_rcp_f32 v22, v22
v_rcp_f32 v23, v23
v_mfma_f32_32x32x16_bf16 v[176:191], a[128:131], a[112:115], v[176:191]
ds_read_b64_tr_b16 a[146:147], v4 offset:29984
v_rcp_f32 v24, v24
s_nop 0
v_mul_f32 v144, v144, v21
v_mul_f32 v145, v145, v22
s_waitcnt lgkmcnt(6)
v_mfma_f32_32x32x16_bf16 v[160:175], a[132:135], a[100:103], v[160:175]
ds_read_b64_tr_b16 a[148:149], v4 offset:32672
v_mul_f32 v146, v146, v23
v_mul_f32 v147, v147, v24
v_exp_f32 v21, v148
v_exp_f32 v22, v149
v_exp_f32 v23, v150
v_mfma_f32_32x32x16_bf16 v[176:191], a[132:135], a[116:119], v[176:191]
ds_read_b64_tr_b16 a[150:151], v4 offset:33568
v_exp_f32 v24, v151
v_mul_f32 v148, v148, v156
v_mul_f32 v149, v149, v157
v_mul_f32 v150, v150, v158
v_mul_f32 v151, v151, v159
s_waitcnt lgkmcnt(6)
v_mfma_f32_32x32x16_bf16 v[160:175], a[136:139], a[104:107], v[160:175]
ds_read_b64_tr_b16 a[152:153], v4 offset:36256
v_add_f32 v21, 1.0, v21
v_add_f32 v22, 1.0, v22
v_add_f32 v23, 1.0, v23
v_add_f32 v24, 1.0, v24
v_mfma_f32_32x32x16_bf16 v[176:191], a[136:139], a[120:123], v[176:191]
ds_read_b64_tr_b16 a[154:155], v4 offset:37152
v_rcp_f32 v21, v21
v_rcp_f32 v22, v22
v_rcp_f32 v23, v23
v_rcp_f32 v24, v24
s_nop 0
s_waitcnt lgkmcnt(6)
v_mfma_f32_32x32x16_bf16 v[160:175], a[140:143], a[108:111], v[160:175]
ds_read_b64_tr_b16 a[156:157], v4 offset:39840
v_mul_f32 v148, v148, v21
v_mul_f32 v149, v149, v22
v_mul_f32 v150, v150, v23
v_mul_f32 v151, v151, v24
v_cvt_pk_bf16_f32 v152, v144, v145
v_mfma_f32_32x32x16_bf16 v[176:191], a[140:143], a[124:127], v[176:191]
ds_read_b64_tr_b16 a[158:159], v4 offset:40736
v_cvt_pk_bf16_f32 v153, v146, v147
v_cvt_pk_bf16_f32 v154, v148, v149
v_cvt_pk_bf16_f32 v155, v150, v151
buffer_store_dwordx4 v[152:155], v30, s[16:19], s37 offen offset:3072 sc1
s_waitcnt lgkmcnt(6)
v_mfma_f32_32x32x16_bf16 v[192:207], a[144:147], a[32:35], v[192:207]
ds_read_b64_tr_b16 a[128:129], v5 offset:160
v_mfma_f32_32x32x16_bf16 v[208:223], a[144:147], a[48:51], v[208:223]
ds_read_b64_tr_b16 a[130:131], v5 offset:1056
s_waitcnt lgkmcnt(6)
v_mfma_f32_32x32x16_bf16 v[192:207], a[148:151], a[36:39], v[192:207]
ds_read_b64_tr_b16 a[132:133], v5 offset:3744
v_mfma_f32_32x32x16_bf16 v[208:223], a[148:151], a[52:55], v[208:223]
ds_read_b64_tr_b16 a[134:135], v5 offset:4640
s_waitcnt lgkmcnt(6)
v_mfma_f32_32x32x16_bf16 v[192:207], a[152:155], a[40:43], v[192:207]
ds_read_b64_tr_b16 a[136:137], v5 offset:7328
v_exp_f32 v17, v160
v_exp_f32 v18, v161
v_exp_f32 v19, v162
v_exp_f32 v20, v163
v_mul_f32 v160, v160, v168
v_mfma_f32_32x32x16_bf16 v[208:223], a[152:155], a[56:59], v[208:223]
ds_read_b64_tr_b16 a[138:139], v5 offset:8224
v_mul_f32 v161, v161, v169
v_mul_f32 v162, v162, v170
v_mul_f32 v163, v163, v171
v_add_f32 v17, 1.0, v17
v_add_f32 v18, 1.0, v18
s_waitcnt lgkmcnt(6)
v_mfma_f32_32x32x16_bf16 v[192:207], a[156:159], a[44:47], v[192:207]
ds_read_b64_tr_b16 a[140:141], v5 offset:10912
v_add_f32 v19, 1.0, v19
v_add_f32 v20, 1.0, v20
v_rcp_f32 v17, v17
v_rcp_f32 v18, v18
v_rcp_f32 v19, v19
v_mfma_f32_32x32x16_bf16 v[208:223], a[156:159], a[60:63], v[208:223]
ds_read_b64_tr_b16 a[142:143], v5 offset:11808
v_rcp_f32 v20, v20
s_nop 0
v_mul_f32 v160, v160, v17
v_mul_f32 v161, v161, v18
s_waitcnt lgkmcnt(6)
v_mfma_f32_32x32x16_bf16 v[192:207], a[128:131], a[64:67], v[192:207]
ds_read_b64_tr_b16 a[144:145], v5 offset:29088
v_mul_f32 v162, v162, v19
v_mul_f32 v163, v163, v20
v_exp_f32 v17, v164
v_exp_f32 v18, v165
v_exp_f32 v19, v166
v_mfma_f32_32x32x16_bf16 v[208:223], a[128:131], a[80:83], v[208:223]
ds_read_b64_tr_b16 a[146:147], v5 offset:29984
v_exp_f32 v20, v167
v_mul_f32 v164, v164, v172
v_mul_f32 v165, v165, v173
v_mul_f32 v166, v166, v174
v_mul_f32 v167, v167, v175
s_waitcnt lgkmcnt(6)
v_mfma_f32_32x32x16_bf16 v[192:207], a[132:135], a[68:71], v[192:207]
ds_read_b64_tr_b16 a[148:149], v5 offset:32672
v_add_f32 v17, 1.0, v17
v_add_f32 v18, 1.0, v18
v_add_f32 v19, 1.0, v19
v_add_f32 v20, 1.0, v20
v_mfma_f32_32x32x16_bf16 v[208:223], a[132:135], a[84:87], v[208:223]
ds_read_b64_tr_b16 a[150:151], v5 offset:33568
v_rcp_f32 v17, v17
v_rcp_f32 v18, v18
v_rcp_f32 v19, v19
v_rcp_f32 v20, v20
s_nop 0
s_waitcnt lgkmcnt(6)
v_mfma_f32_32x32x16_bf16 v[192:207], a[136:139], a[72:75], v[192:207]
ds_read_b64_tr_b16 a[152:153], v5 offset:36256
v_mul_f32 v164, v164, v17
v_mul_f32 v165, v165, v18
v_mul_f32 v166, v166, v19
v_mul_f32 v167, v167, v20
v_cvt_pk_bf16_f32 v168, v160, v161
v_mfma_f32_32x32x16_bf16 v[208:223], a[136:139], a[88:91], v[208:223]
ds_read_b64_tr_b16 a[154:155], v5 offset:37152
v_cvt_pk_bf16_f32 v169, v162, v163
v_cvt_pk_bf16_f32 v170, v164, v165
v_cvt_pk_bf16_f32 v171, v166, v167
buffer_store_dwordx4 v[168:171], v31, s[16:19], s36 offen offset:0 sc1
s_waitcnt lgkmcnt(6)
v_mfma_f32_32x32x16_bf16 v[192:207], a[140:143], a[76:79], v[192:207]
ds_read_b64_tr_b16 a[156:157], v5 offset:39840
v_exp_f32 v21, v176
v_exp_f32 v22, v177
v_exp_f32 v23, v178
v_exp_f32 v24, v179
v_mul_f32 v176, v176, v184
v_mfma_f32_32x32x16_bf16 v[208:223], a[140:143], a[92:95], v[208:223]
ds_read_b64_tr_b16 a[158:159], v5 offset:40736
v_mul_f32 v177, v177, v185
v_mul_f32 v178, v178, v186
v_mul_f32 v179, v179, v187
v_add_f32 v21, 1.0, v21
v_add_f32 v22, 1.0, v22
s_waitcnt lgkmcnt(6)
v_mfma_f32_32x32x16_bf16 v[192:207], a[144:147], a[96:99], v[192:207]
ds_read_b64_tr_b16 a[128:129], v4 offset:29120
v_add_f32 v23, 1.0, v23
v_add_f32 v24, 1.0, v24
v_rcp_f32 v21, v21
v_rcp_f32 v22, v22
v_rcp_f32 v23, v23
v_mfma_f32_32x32x16_bf16 v[208:223], a[144:147], a[112:115], v[208:223]
ds_read_b64_tr_b16 a[130:131], v4 offset:30016
v_rcp_f32 v24, v24
s_nop 0
v_mul_f32 v176, v176, v21
v_mul_f32 v177, v177, v22
s_waitcnt lgkmcnt(6)
v_mfma_f32_32x32x16_bf16 v[192:207], a[148:151], a[100:103], v[192:207]
ds_read_b64_tr_b16 a[132:133], v4 offset:32704
v_mul_f32 v178, v178, v23
v_mul_f32 v179, v179, v24
v_exp_f32 v21, v180
v_exp_f32 v22, v181
v_exp_f32 v23, v182
v_mfma_f32_32x32x16_bf16 v[208:223], a[148:151], a[116:119], v[208:223]
ds_read_b64_tr_b16 a[134:135], v4 offset:33600
v_exp_f32 v24, v183
v_mul_f32 v180, v180, v188
v_mul_f32 v181, v181, v189
v_mul_f32 v182, v182, v190
v_mul_f32 v183, v183, v191
s_waitcnt lgkmcnt(6)
v_mfma_f32_32x32x16_bf16 v[192:207], a[152:155], a[104:107], v[192:207]
ds_read_b64_tr_b16 a[136:137], v4 offset:36288
v_add_f32 v21, 1.0, v21
v_add_f32 v22, 1.0, v22
v_add_f32 v23, 1.0, v23
v_add_f32 v24, 1.0, v24
v_mfma_f32_32x32x16_bf16 v[208:223], a[152:155], a[120:123], v[208:223]
ds_read_b64_tr_b16 a[138:139], v4 offset:37184
v_rcp_f32 v21, v21
v_rcp_f32 v22, v22
v_rcp_f32 v23, v23
v_rcp_f32 v24, v24
s_nop 0
s_waitcnt lgkmcnt(6)
v_mfma_f32_32x32x16_bf16 v[192:207], a[156:159], a[108:111], v[192:207]
ds_read_b64_tr_b16 a[140:141], v4 offset:39872
v_mul_f32 v180, v180, v21
v_mul_f32 v181, v181, v22
v_mul_f32 v182, v182, v23
v_mul_f32 v183, v183, v24
v_cvt_pk_bf16_f32 v184, v176, v177
v_mfma_f32_32x32x16_bf16 v[208:223], a[156:159], a[124:127], v[208:223]
ds_read_b64_tr_b16 a[142:143], v4 offset:40768
v_cvt_pk_bf16_f32 v185, v178, v179
v_cvt_pk_bf16_f32 v186, v180, v181
v_cvt_pk_bf16_f32 v187, v182, v183
buffer_store_dwordx4 v[184:187], v31, s[16:19], s37 offen offset:0 sc1
s_waitcnt lgkmcnt(6)
v_mfma_f32_32x32x16_bf16 v[224:239], a[128:131], a[32:35], v[224:239]
ds_read_b64_tr_b16 a[144:145], v5 offset:192
v_mfma_f32_32x32x16_bf16 v[240:255], a[128:131], a[48:51], v[240:255]
ds_read_b64_tr_b16 a[146:147], v5 offset:1088
s_waitcnt lgkmcnt(6)
v_mfma_f32_32x32x16_bf16 v[224:239], a[132:135], a[36:39], v[224:239]
ds_read_b64_tr_b16 a[148:149], v5 offset:3776
v_mfma_f32_32x32x16_bf16 v[240:255], a[132:135], a[52:55], v[240:255]
ds_read_b64_tr_b16 a[150:151], v5 offset:4672
s_waitcnt lgkmcnt(6)
v_mfma_f32_32x32x16_bf16 v[224:239], a[136:139], a[40:43], v[224:239]
ds_read_b64_tr_b16 a[152:153], v5 offset:7360
v_exp_f32 v17, v192
v_exp_f32 v18, v193
v_exp_f32 v19, v194
v_exp_f32 v20, v195
v_mul_f32 v192, v192, v200
v_mfma_f32_32x32x16_bf16 v[240:255], a[136:139], a[56:59], v[240:255]
ds_read_b64_tr_b16 a[154:155], v5 offset:8256
v_mul_f32 v193, v193, v201
v_mul_f32 v194, v194, v202
v_mul_f32 v195, v195, v203
v_add_f32 v17, 1.0, v17
v_add_f32 v18, 1.0, v18
s_waitcnt lgkmcnt(6)
v_mfma_f32_32x32x16_bf16 v[224:239], a[140:143], a[44:47], v[224:239]
ds_read_b64_tr_b16 a[156:157], v5 offset:10944
v_add_f32 v19, 1.0, v19
v_add_f32 v20, 1.0, v20
v_rcp_f32 v17, v17
v_rcp_f32 v18, v18
v_rcp_f32 v19, v19
v_mfma_f32_32x32x16_bf16 v[240:255], a[140:143], a[60:63], v[240:255]
ds_read_b64_tr_b16 a[158:159], v5 offset:11840
v_rcp_f32 v20, v20
s_nop 0
v_mul_f32 v192, v192, v17
v_mul_f32 v193, v193, v18
s_waitcnt lgkmcnt(6)
v_mfma_f32_32x32x16_bf16 v[224:239], a[144:147], a[64:67], v[224:239]
ds_read_b64_tr_b16 a[128:129], v5 offset:29120
v_mul_f32 v194, v194, v19
v_mul_f32 v195, v195, v20
v_exp_f32 v17, v196
v_exp_f32 v18, v197
v_exp_f32 v19, v198
v_mfma_f32_32x32x16_bf16 v[240:255], a[144:147], a[80:83], v[240:255]
ds_read_b64_tr_b16 a[130:131], v5 offset:30016
v_exp_f32 v20, v199
v_mul_f32 v196, v196, v204
v_mul_f32 v197, v197, v205
v_mul_f32 v198, v198, v206
v_mul_f32 v199, v199, v207
s_waitcnt lgkmcnt(6)
v_mfma_f32_32x32x16_bf16 v[224:239], a[148:151], a[68:71], v[224:239]
ds_read_b64_tr_b16 a[132:133], v5 offset:32704
v_add_f32 v17, 1.0, v17
v_add_f32 v18, 1.0, v18
v_add_f32 v19, 1.0, v19
v_add_f32 v20, 1.0, v20
v_mfma_f32_32x32x16_bf16 v[240:255], a[148:151], a[84:87], v[240:255]
ds_read_b64_tr_b16 a[134:135], v5 offset:33600
v_rcp_f32 v17, v17
v_rcp_f32 v18, v18
v_rcp_f32 v19, v19
v_rcp_f32 v20, v20
s_nop 0
s_waitcnt lgkmcnt(6)
v_mfma_f32_32x32x16_bf16 v[224:239], a[152:155], a[72:75], v[224:239]
ds_read_b64_tr_b16 a[136:137], v5 offset:36288
v_mul_f32 v196, v196, v17
v_mul_f32 v197, v197, v18
v_mul_f32 v198, v198, v19
v_mul_f32 v199, v199, v20
v_cvt_pk_bf16_f32 v200, v192, v193
v_mfma_f32_32x32x16_bf16 v[240:255], a[152:155], a[88:91], v[240:255]
ds_read_b64_tr_b16 a[138:139], v5 offset:37184
v_cvt_pk_bf16_f32 v201, v194, v195
v_cvt_pk_bf16_f32 v202, v196, v197
v_cvt_pk_bf16_f32 v203, v198, v199
buffer_store_dwordx4 v[200:203], v31, s[16:19], s36 offen offset:1024 sc1
s_waitcnt lgkmcnt(6)
v_mfma_f32_32x32x16_bf16 v[224:239], a[156:159], a[76:79], v[224:239]
ds_read_b64_tr_b16 a[140:141], v5 offset:39872
v_exp_f32 v21, v208
v_exp_f32 v22, v209
v_exp_f32 v23, v210
v_exp_f32 v24, v211
v_mul_f32 v208, v208, v216
v_mfma_f32_32x32x16_bf16 v[240:255], a[156:159], a[92:95], v[240:255]
ds_read_b64_tr_b16 a[142:143], v5 offset:40768
v_mul_f32 v209, v209, v217
v_mul_f32 v210, v210, v218
v_mul_f32 v211, v211, v219
v_add_f32 v21, 1.0, v21
v_add_f32 v22, 1.0, v22
s_waitcnt lgkmcnt(6)
v_mfma_f32_32x32x16_bf16 v[224:239], a[128:131], a[96:99], v[224:239]
v_add_f32 v23, 1.0, v23
v_add_f32 v24, 1.0, v24
v_rcp_f32 v21, v21
v_rcp_f32 v22, v22
v_rcp_f32 v23, v23
v_mfma_f32_32x32x16_bf16 v[240:255], a[128:131], a[112:115], v[240:255]
v_rcp_f32 v24, v24
s_nop 0
v_mul_f32 v208, v208, v21
v_mul_f32 v209, v209, v22
s_waitcnt lgkmcnt(4)
v_mfma_f32_32x32x16_bf16 v[224:239], a[132:135], a[100:103], v[224:239]
v_mul_f32 v210, v210, v23
v_mul_f32 v211, v211, v24
v_exp_f32 v21, v212
v_exp_f32 v22, v213
v_exp_f32 v23, v214
v_mfma_f32_32x32x16_bf16 v[240:255], a[132:135], a[116:119], v[240:255]
v_exp_f32 v24, v215
v_mul_f32 v212, v212, v220
v_mul_f32 v213, v213, v221
v_mul_f32 v214, v214, v222
v_mul_f32 v215, v215, v223
s_waitcnt lgkmcnt(2)
v_mfma_f32_32x32x16_bf16 v[224:239], a[136:139], a[104:107], v[224:239]
v_add_f32 v21, 1.0, v21
v_add_f32 v22, 1.0, v22
v_add_f32 v23, 1.0, v23
v_add_f32 v24, 1.0, v24
v_mfma_f32_32x32x16_bf16 v[240:255], a[136:139], a[120:123], v[240:255]
v_rcp_f32 v21, v21
v_rcp_f32 v22, v22
v_rcp_f32 v23, v23
v_rcp_f32 v24, v24
s_nop 0
s_waitcnt lgkmcnt(0)
v_mfma_f32_32x32x16_bf16 v[224:239], a[140:143], a[108:111], v[224:239]
v_mul_f32 v212, v212, v21
v_mul_f32 v213, v213, v22
v_mul_f32 v214, v214, v23
v_mul_f32 v215, v215, v24
v_cvt_pk_bf16_f32 v216, v208, v209
v_mfma_f32_32x32x16_bf16 v[240:255], a[140:143], a[124:127], v[240:255]
v_cvt_pk_bf16_f32 v217, v210, v211
v_cvt_pk_bf16_f32 v218, v212, v213
v_cvt_pk_bf16_f32 v219, v214, v215
buffer_store_dwordx4 v[216:219], v31, s[16:19], s37 offen offset:1024 sc1
s_nop 7
s_nop 3
v_exp_f32 v17, v224
v_exp_f32 v18, v225
v_exp_f32 v19, v226
v_exp_f32 v20, v227
v_mul_f32 v224, v224, v232
v_mul_f32 v225, v225, v233
v_mul_f32 v226, v226, v234
v_mul_f32 v227, v227, v235
v_add_f32 v17, 1.0, v17
v_add_f32 v18, 1.0, v18
v_add_f32 v19, 1.0, v19
v_add_f32 v20, 1.0, v20
v_rcp_f32 v17, v17
v_rcp_f32 v18, v18
v_rcp_f32 v19, v19
v_rcp_f32 v20, v20
s_nop 0
v_mul_f32 v224, v224, v17
v_mul_f32 v225, v225, v18
v_mul_f32 v226, v226, v19
v_mul_f32 v227, v227, v20
v_exp_f32 v17, v228
v_exp_f32 v18, v229
v_exp_f32 v19, v230
v_exp_f32 v20, v231
v_mul_f32 v228, v228, v236
v_mul_f32 v229, v229, v237
v_mul_f32 v230, v230, v238
v_mul_f32 v231, v231, v239
v_add_f32 v17, 1.0, v17
v_add_f32 v18, 1.0, v18
v_add_f32 v19, 1.0, v19
v_add_f32 v20, 1.0, v20
v_rcp_f32 v17, v17
v_rcp_f32 v18, v18
v_rcp_f32 v19, v19
v_rcp_f32 v20, v20
s_nop 0
v_mul_f32 v228, v228, v17
v_mul_f32 v229, v229, v18
v_mul_f32 v230, v230, v19
v_mul_f32 v231, v231, v20
v_cvt_pk_bf16_f32 v232, v224, v225
v_cvt_pk_bf16_f32 v233, v226, v227
v_cvt_pk_bf16_f32 v234, v228, v229
v_cvt_pk_bf16_f32 v235, v230, v231
buffer_store_dwordx4 v[232:235], v31, s[16:19], s36 offen offset:2048 sc1
v_exp_f32 v21, v240
v_exp_f32 v22, v241
v_exp_f32 v23, v242
v_exp_f32 v24, v243
v_mul_f32 v240, v240, v248
v_mul_f32 v241, v241, v249
v_mul_f32 v242, v242, v250
v_mul_f32 v243, v243, v251
v_add_f32 v21, 1.0, v21
v_add_f32 v22, 1.0, v22
v_add_f32 v23, 1.0, v23
v_add_f32 v24, 1.0, v24
v_rcp_f32 v21, v21
v_rcp_f32 v22, v22
v_rcp_f32 v23, v23
v_rcp_f32 v24, v24
s_nop 0
v_mul_f32 v240, v240, v21
v_mul_f32 v241, v241, v22
v_mul_f32 v242, v242, v23
v_mul_f32 v243, v243, v24
v_exp_f32 v21, v244
v_exp_f32 v22, v245
v_exp_f32 v23, v246
v_exp_f32 v24, v247
v_mul_f32 v244, v244, v252
v_mul_f32 v245, v245, v253
v_mul_f32 v246, v246, v254
v_mul_f32 v247, v247, v255
v_add_f32 v21, 1.0, v21
v_add_f32 v22, 1.0, v22
v_add_f32 v23, 1.0, v23
v_add_f32 v24, 1.0, v24
v_rcp_f32 v21, v21
v_rcp_f32 v22, v22
v_rcp_f32 v23, v23
v_rcp_f32 v24, v24
s_nop 0
v_mul_f32 v244, v244, v21
v_mul_f32 v245, v245, v22
v_mul_f32 v246, v246, v23
v_mul_f32 v247, v247, v24
v_cvt_pk_bf16_f32 v248, v240, v241
v_cvt_pk_bf16_f32 v249, v242, v243
v_cvt_pk_bf16_f32 v250, v244, v245
v_cvt_pk_bf16_f32 v251, v246, v247
buffer_store_dwordx4 v[248:251], v31, s[16:19], s37 offen offset:2048 sc1
s_waitcnt vmcnt(0)
s_barrier
s_cmp_lg_u32 s26, 0
s_cbranch_scc1 adaLN_cond__sliding_block_cached__swiglu_ffn__prompt_kernel_arr_45
s_lshl_b32 s27, s24, 2
s_add_u32 s27, s27, s22
s_add_u32 s27, s27, 56
s_lshl_b32 s6, s27, 8
s_add_u32 s6, s6, 0x20000
s_add_u32 s6, s6, s90
s_addc_u32 s7, s91, 0
v_mov_b32 v2, 0
v_mov_b32 v3, 1
s_mov_b64 exec, 1
global_atomic_add v2, v3, s[6:7] sc1
s_mov_b64 exec, -1
adaLN_cond__sliding_block_cached__swiglu_ffn__prompt_kernel_arr_45:
v_lshrrev_b32 v14, 5, v1
v_lshlrev_b32 v14, 11, v14
v_bfe_u32 v15, v1, 2, 2
v_lshl_add_u32 v14, v15, 8, v14
v_bfe_u32 v16, v1, 4, 1
v_lshl_add_u32 v14, v16, 5, v14
v_and_b32 v16, 1, v1
v_lshl_add_u32 v14, v16, 4, v14
v_bfe_u32 v16, v1, 1, 1
v_lshl_add_u32 v14, v16, 3, v14
v_xor_b32 v16, 0, v15
v_lshl_add_u32 v4, v16, 6, v14
v_xor_b32 v16, 1, v15
v_lshl_add_u32 v5, v16, 6, v14
v_xor_b32 v16, 2, v15
v_lshl_add_u32 v6, v16, 6, v14
v_xor_b32 v16, 3, v15
v_lshl_add_u32 v7, v16, 6, v14
v_lshlrev_b32 v8, 4, v1
v_add_u32 v9, 0x38000, v8
s_lshl_b32 s28, s25, 8
v_lshrrev_b32 v14, 4, v1
v_bfe_u32 v15, v1, 2, 2
v_xor_b32 v15, v15, v14
v_and_b32 v16, 3, v1
v_lshlrev_b32 v16, 4, v16
v_lshl_add_u32 v16, v15, 6, v16
s_lshl_b32 s27, s26, 4
v_add_u32 v14, s27, v14
v_mul_u32_u24 v14, 2048, v14
v_add3_u32 v10, v14, v16, s28
v_add_u32 v11, 0x1c00, v10
v_add_u32 v12, 0x3800, v10
v_add_u32 v13, 0x5400, v10
s_add_u32 s8, s90, 0x3d00000
s_addc_u32 s9, s91, 0
s_mov_b32 s10, 0xe00000
s_mov_b32 s11, 0x20000
s_mov_b32 s12, s80
s_mov_b32 s13, s81
s_mov_b32 s14, 0x700000
s_mov_b32 s15, 0x20000
s_lshl_b32 s27, s24, 3
s_lshl_b32 s28, s26, 1
s_add_u32 s34, s27, s28
s_mul_i32 s30, s34, 224
s_mul_i32 s28, s22, 56
s_add_u32 s30, s30, s28
s_lshl_b32 s30, s30, 10
s_sub_u32 s30, s30, 4096
s_add_u32 s38, s30, 57344
s_mul_i32 s31, s22, 0x1c0000
s_sub_u32 s31, s31, 0x20000
s_lshl_b32 s32, s26, 12
s_add_u32 s31, s31, 0x20000
s_add_u32 m0, s32, 0x0
s_nop 0
buffer_load_dwordx4 v10, s[12:15], s31 offen offset:0 lds
buffer_load_dwordx4 v11, s[12:15], s31 offen offset:1024 lds
buffer_load_dwordx4 v12, s[12:15], s31 offen offset:2048 lds
buffer_load_dwordx4 v13, s[12:15], s31 offen offset:3072 lds
s_add_u32 s31, s31, 0x20000
s_add_u32 m0, s32, 0x4000
s_nop 0
buffer_load_dwordx4 v10, s[12:15], s31 offen offset:0 lds
buffer_load_dwordx4 v11, s[12:15], s31 offen offset:1024 lds
buffer_load_dwordx4 v12, s[12:15], s31 offen offset:2048 lds
buffer_load_dwordx4 v13, s[12:15], s31 offen offset:3072 lds
s_add_u32 s31, s31, 0x20000
s_add_u32 m0, s32, 0x8000
s_nop 0
buffer_load_dwordx4 v10, s[12:15], s31 offen offset:0 lds
s_cmp_lg_u32 s26, 0
s_cbranch_scc1 adaLN_cond__sliding_block_cached__swiglu_ffn__prompt_kernel_ct_47
s_getpc_b64 s[6:7]
adaLN_cond__sliding_block_cached__swiglu_ffn__prompt_kernel_pc_46:
s_add_u32 s6, s6, adaLN_cond__sliding_block_cached__swiglu_ffn__prompt_kernel_L_down-adaLN_cond__sliding_block_cached__swiglu_ffn__prompt_kernel_pc_46
s_addc_u32 s7, s7, 0
v_lshlrev_b32 v60, 5, v1
v_add_u32 v60, s21, v60
v_lshlrev_b32 v60, 7, v60
v_cmp_gt_u32 vcc, adaLN_cond__sliding_block_cached__swiglu_ffn__prompt_kernel_cend-adaLN_cond__sliding_block_cached__swiglu_ffn__prompt_kernel_L_down, v60
s_and_saveexec_b64 s[4:5], vcc
s_cbranch_execz adaLN_cond__sliding_block_cached__swiglu_ffn__prompt_kernel_ct_47_r
global_load_dword v61, v60, s[6:7]
adaLN_cond__sliding_block_cached__swiglu_ffn__prompt_kernel_ct_47_r:
s_mov_b64 exec, s[4:5]
adaLN_cond__sliding_block_cached__swiglu_ffn__prompt_kernel_ct_47:
adaLN_cond__sliding_block_cached__swiglu_ffn__prompt_kernel_L_down:
s_cmp_lg_u32 s26, 0
s_cbranch_scc1 adaLN_cond__sliding_block_cached__swiglu_ffn__prompt_kernel_ws_50
s_lshl_b32 s27, s24, 2
s_add_u32 s27, s27, s22
s_add_u32 s27, s27, 56
s_lshl_b32 s6, s27, 8
s_add_u32 s6, s6, 0x20000
s_add_u32 s6, s6, s90
s_addc_u32 s7, s91, 0
v_mov_b32 v2, 0
s_mov_b32 s27, 0
s_mov_b64 exec, 1
adaLN_cond__sliding_block_cached__swiglu_ffn__prompt_kernel_wt_48:
global_load_dword v3, v2, s[6:7] offset:0 sc1
s_waitcnt vmcnt(0)
v_readfirstlane_b32 s28, v3
s_add_u32 s27, s27, 1
s_cmp_ge_u32 s28, 8
s_cbranch_scc1 adaLN_cond__sliding_block_cached__swiglu_ffn__prompt_kernel_wd_49
s_cmp_ge_u32 s27, 0x40000
s_cbranch_scc1 adaLN_cond__sliding_block_cached__swiglu_ffn__prompt_kernel_wd_49
s_sleep 2
s_branch adaLN_cond__sliding_block_cached__swiglu_ffn__prompt_kernel_wt_48
adaLN_cond__sliding_block_cached__swiglu_ffn__prompt_kernel_wd_49:
s_mov_b64 exec, -1
adaLN_cond__sliding_block_cached__swiglu_ffn__prompt_kernel_ws_50:
s_barrier
s_add_u32 m0, s32, 0x8000
s_add_u32 s30, s30, 4096
buffer_load_dwordx4 a[0:3], v8, s[8:11], s30 offen offset:0 sc1
buffer_load_dwordx4 a[16:19], v9, s[8:11], s30 offen offset:0 sc1
buffer_load_dwordx4 a[4:7], v8, s[8:11], s30 offen offset:1024 sc1
buffer_load_dwordx4 a[20:23], v9, s[8:11], s30 offen offset:1024 sc1
buffer_load_dwordx4 a[8:11], v8, s[8:11], s30 offen offset:2048 sc1
buffer_load_dwordx4 a[24:27], v9, s[8:11], s30 offen offset:2048 sc1
buffer_load_dwordx4 a[12:15], v8, s[8:11], s30 offen offset:3072 sc1
buffer_load_dwordx4 a[28:31], v9, s[8:11], s30 offen offset:3072 sc1
s_add_u32 s30, s30, 4096
buffer_load_dwordx4 a[32:35], v8, s[8:11], s30 offen offset:0 sc1
buffer_load_dwordx4 a[48:51], v9, s[8:11], s30 offen offset:0 sc1
buffer_load_dwordx4 a[36:39], v8, s[8:11], s30 offen offset:1024 sc1
buffer_load_dwordx4 a[52:55], v9, s[8:11], s30 offen offset:1024 sc1
buffer_load_dwordx4 a[40:43], v8, s[8:11], s30 offen offset:2048 sc1
buffer_load_dwordx4 a[56:59], v9, s[8:11], s30 offen offset:2048 sc1
buffer_load_dwordx4 a[44:47], v8, s[8:11], s30 offen offset:3072 sc1
buffer_load_dwordx4 a[60:63], v9, s[8:11], s30 offen offset:3072 sc1
s_lshl_b32 s27, s22, 22
s_add_u32 s27, s27, 0x4b00000
s_add_u32 s16, s90, s27
s_addc_u32 s17, s91, 0
s_mov_b32 s18, 0x400000
s_mov_b32 s19, 0x20000
s_lshl_b32 s27, s34, 6
s_lshl_b32 s28, s25, 3
s_add_u32 s27, s27, s28
s_lshl_b32 s36, s27, 10
s_add_u32 s37, s36, 0x10000
v_add_u32 v14, 4096, v8
s_waitcnt vmcnt(10)
s_barrier
ds_read_b64_tr_b16 a[128:129], v4 offset:0
ds_read_b64_tr_b16 a[130:131], v4 offset:1024
ds_read_b64_tr_b16 a[132:133], v5 offset:0
ds_read_b64_tr_b16 a[134:135], v5 offset:1024
ds_read_b64_tr_b16 a[136:137], v6 offset:0
ds_read_b64_tr_b16 a[138:139], v6 offset:1024
ds_read_b64_tr_b16 a[140:141], v7 offset:0
ds_read_b64_tr_b16 a[142:143], v7 offset:1024
s_waitcnt lgkmcnt(0)
v_mfma_f32_32x32x16_bf16 v[128:143], a[128:131], a[0:3], 0
ds_read_b64_tr_b16 a[144:145], v4 offset:4096
ds_read_b64_tr_b16 a[146:147], v4 offset:5120
v_mfma_f32_32x32x16_bf16 v[144:159], a[128:131], a[16:19], 0
ds_read_b64_tr_b16 a[148:149], v5 offset:4096
ds_read_b64_tr_b16 a[150:151], v5 offset:5120
v_mfma_f32_32x32x16_bf16 v[160:175], a[132:135], a[0:3], 0
ds_read_b64_tr_b16 a[152:153], v6 offset:4096
ds_read_b64_tr_b16 a[154:155], v6 offset:5120
v_mfma_f32_32x32x16_bf16 v[176:191], a[132:135], a[16:19], 0
ds_read_b64_tr_b16 a[156:157], v7 offset:4096
ds_read_b64_tr_b16 a[158:159], v7 offset:5120
v_mfma_f32_32x32x16_bf16 v[192:207], a[136:139], a[0:3], 0
s_add_u32 s30, s30, 4096
buffer_load_dwordx4 a[64:67], v8, s[8:11], s30 offen offset:0 sc1
v_mfma_f32_32x32x16_bf16 v[208:223], a[136:139], a[16:19], 0
buffer_load_dwordx4 v11, s[12:15], s31 offen offset:1024 lds
v_mfma_f32_32x32x16_bf16 v[224:239], a[140:143], a[0:3], 0
buffer_load_dwordx4 a[80:83], v9, s[8:11], s30 offen offset:0 sc1
v_mfma_f32_32x32x16_bf16 v[240:255], a[140:143], a[16:19], 0
buffer_load_dwordx4 a[68:71], v8, s[8:11], s30 offen offset:1024 sc1
s_waitcnt lgkmcnt(0)
v_mfma_f32_32x32x16_bf16 v[128:143], a[144:147], a[4:7], v[128:143]
ds_read_b64_tr_b16 a[128:129], v4 offset:8192
ds_read_b64_tr_b16 a[130:131], v4 offset:9216
v_mfma_f32_32x32x16_bf16 v[144:159], a[144:147], a[20:23], v[144:159]
ds_read_b64_tr_b16 a[132:133], v5 offset:8192
ds_read_b64_tr_b16 a[134:135], v5 offset:9216
v_mfma_f32_32x32x16_bf16 v[160:175], a[148:151], a[4:7], v[160:175]
ds_read_b64_tr_b16 a[136:137], v6 offset:8192
ds_read_b64_tr_b16 a[138:139], v6 offset:9216
v_mfma_f32_32x32x16_bf16 v[176:191], a[148:151], a[20:23], v[176:191]
ds_read_b64_tr_b16 a[140:141], v7 offset:8192
ds_read_b64_tr_b16 a[142:143], v7 offset:9216
v_mfma_f32_32x32x16_bf16 v[192:207], a[152:155], a[4:7], v[192:207]
buffer_load_dwordx4 v12, s[12:15], s31 offen offset:2048 lds
v_mfma_f32_32x32x16_bf16 v[208:223], a[152:155], a[20:23], v[208:223]
buffer_load_dwordx4 a[84:87], v9, s[8:11], s30 offen offset:1024 sc1
v_mfma_f32_32x32x16_bf16 v[224:239], a[156:159], a[4:7], v[224:239]
buffer_load_dwordx4 a[72:75], v8, s[8:11], s30 offen offset:2048 sc1
v_mfma_f32_32x32x16_bf16 v[240:255], a[156:159], a[20:23], v[240:255]
buffer_load_dwordx4 v13, s[12:15], s31 offen offset:3072 lds
s_waitcnt lgkmcnt(0)
v_mfma_f32_32x32x16_bf16 v[128:143], a[128:131], a[8:11], v[128:143]
ds_read_b64_tr_b16 a[144:145], v4 offset:12288
ds_read_b64_tr_b16 a[146:147], v4 offset:13312
v_mfma_f32_32x32x16_bf16 v[144:159], a[128:131], a[24:27], v[144:159]
ds_read_b64_tr_b16 a[148:149], v5 offset:12288
ds_read_b64_tr_b16 a[150:151], v5 offset:13312
v_mfma_f32_32x32x16_bf16 v[160:175], a[132:135], a[8:11], v[160:175]
ds_read_b64_tr_b16 a[152:153], v6 offset:12288
ds_read_b64_tr_b16 a[154:155], v6 offset:13312
v_mfma_f32_32x32x16_bf16 v[176:191], a[132:135], a[24:27], v[176:191]
ds_read_b64_tr_b16 a[156:157], v7 offset:12288
ds_read_b64_tr_b16 a[158:159], v7 offset:13312
v_mfma_f32_32x32x16_bf16 v[192:207], a[136:139], a[8:11], v[192:207]
buffer_load_dwordx4 a[88:91], v9, s[8:11], s30 offen offset:2048 sc1
v_mfma_f32_32x32x16_bf16 v[208:223], a[136:139], a[24:27], v[208:223]
buffer_load_dwordx4 a[76:79], v8, s[8:11], s30 offen offset:3072 sc1
v_mfma_f32_32x32x16_bf16 v[224:239], a[140:143], a[8:11], v[224:239]
s_add_u32 s31, s31, 0x20000
s_add_u32 m0, s32, 0xc000
s_nop 0
buffer_load_dwordx4 v10, s[12:15], s31 offen offset:0 lds
v_mfma_f32_32x32x16_bf16 v[240:255], a[140:143], a[24:27], v[240:255]
buffer_load_dwordx4 a[92:95], v9, s[8:11], s30 offen offset:3072 sc1
s_waitcnt vmcnt(14) lgkmcnt(0)
s_barrier
v_mfma_f32_32x32x16_bf16 v[128:143], a[144:147], a[12:15], v[128:143]
ds_read_b64_tr_b16 a[128:129], v4 offset:16384
ds_read_b64_tr_b16 a[130:131], v4 offset:17408
v_mfma_f32_32x32x16_bf16 v[144:159], a[144:147], a[28:31], v[144:159]
ds_read_b64_tr_b16 a[132:133], v5 offset:16384
ds_read_b64_tr_b16 a[134:135], v5 offset:17408
v_mfma_f32_32x32x16_bf16 v[160:175], a[148:151], a[12:15], v[160:175]
ds_read_b64_tr_b16 a[136:137], v6 offset:16384
ds_read_b64_tr_b16 a[138:139], v6 offset:17408
v_mfma_f32_32x32x16_bf16 v[176:191], a[148:151], a[28:31], v[176:191]
ds_read_b64_tr_b16 a[140:141], v7 offset:16384
ds_read_b64_tr_b16 a[142:143], v7 offset:17408
v_mfma_f32_32x32x16_bf16 v[192:207], a[152:155], a[12:15], v[192:207]
s_add_u32 s30, s30, 4096
buffer_load_dwordx4 a[96:99], v8, s[8:11], s30 offen offset:0 sc1
v_mfma_f32_32x32x16_bf16 v[208:223], a[152:155], a[28:31], v[208:223]
buffer_load_dwordx4 v11, s[12:15], s31 offen offset:1024 lds
v_mfma_f32_32x32x16_bf16 v[224:239], a[156:159], a[12:15], v[224:239]
buffer_load_dwordx4 a[112:115], v9, s[8:11], s30 offen offset:0 sc1
v_mfma_f32_32x32x16_bf16 v[240:255], a[156:159], a[28:31], v[240:255]
buffer_load_dwordx4 a[100:103], v8, s[8:11], s30 offen offset:1024 sc1
s_waitcnt lgkmcnt(0)
v_mfma_f32_32x32x16_bf16 v[128:143], a[128:131], a[32:35], v[128:143]
ds_read_b64_tr_b16 a[144:145], v4 offset:20480
ds_read_b64_tr_b16 a[146:147], v4 offset:21504
v_mfma_f32_32x32x16_bf16 v[144:159], a[128:131], a[48:51], v[144:159]
ds_read_b64_tr_b16 a[148:149], v5 offset:20480
ds_read_b64_tr_b16 a[150:151], v5 offset:21504
v_mfma_f32_32x32x16_bf16 v[160:175], a[132:135], a[32:35], v[160:175]
ds_read_b64_tr_b16 a[152:153], v6 offset:20480
ds_read_b64_tr_b16 a[154:155], v6 offset:21504
v_mfma_f32_32x32x16_bf16 v[176:191], a[132:135], a[48:51], v[176:191]
ds_read_b64_tr_b16 a[156:157], v7 offset:20480
ds_read_b64_tr_b16 a[158:159], v7 offset:21504
v_mfma_f32_32x32x16_bf16 v[192:207], a[136:139], a[32:35], v[192:207]
buffer_load_dwordx4 v12, s[12:15], s31 offen offset:2048 lds
v_mfma_f32_32x32x16_bf16 v[208:223], a[136:139], a[48:51], v[208:223]
buffer_load_dwordx4 a[116:119], v9, s[8:11], s30 offen offset:1024 sc1
v_mfma_f32_32x32x16_bf16 v[224:239], a[140:143], a[32:35], v[224:239]
buffer_load_dwordx4 a[104:107], v8, s[8:11], s30 offen offset:2048 sc1
v_mfma_f32_32x32x16_bf16 v[240:255], a[140:143], a[48:51], v[240:255]
buffer_load_dwordx4 v13, s[12:15], s31 offen offset:3072 lds
s_waitcnt lgkmcnt(0)
v_mfma_f32_32x32x16_bf16 v[128:143], a[144:147], a[36:39], v[128:143]
ds_read_b64_tr_b16 a[128:129], v4 offset:24576
ds_read_b64_tr_b16 a[130:131], v4 offset:25600
v_mfma_f32_32x32x16_bf16 v[144:159], a[144:147], a[52:55], v[144:159]
ds_read_b64_tr_b16 a[132:133], v5 offset:24576
ds_read_b64_tr_b16 a[134:135], v5 offset:25600
v_mfma_f32_32x32x16_bf16 v[160:175], a[148:151], a[36:39], v[160:175]
ds_read_b64_tr_b16 a[136:137], v6 offset:24576
ds_read_b64_tr_b16 a[138:139], v6 offset:25600
v_mfma_f32_32x32x16_bf16 v[176:191], a[148:151], a[52:55], v[176:191]
ds_read_b64_tr_b16 a[140:141], v7 offset:24576
ds_read_b64_tr_b16 a[142:143], v7 offset:25600
v_mfma_f32_32x32x16_bf16 v[192:207], a[152:155], a[36:39], v[192:207]
buffer_load_dwordx4 a[120:123], v9, s[8:11], s30 offen offset:2048 sc1
v_mfma_f32_32x32x16_bf16 v[208:223], a[152:155], a[52:55], v[208:223]
buffer_load_dwordx4 a[108:111], v8, s[8:11], s30 offen offset:3072 sc1
v_mfma_f32_32x32x16_bf16 v[224:239], a[156:159], a[36:39], v[224:239]
s_add_u32 s31, s31, 0x20000
s_add_u32 m0, s32, 0x0
s_nop 0
buffer_load_dwordx4 v10, s[12:15], s31 offen offset:0 lds
v_mfma_f32_32x32x16_bf16 v[240:255], a[156:159], a[52:55], v[240:255]
buffer_load_dwordx4 a[124:127], v9, s[8:11], s30 offen offset:3072 sc1
s_waitcnt lgkmcnt(0)
v_mfma_f32_32x32x16_bf16 v[128:143], a[128:131], a[40:43], v[128:143]
ds_read_b64_tr_b16 a[144:145], v4 offset:28672
ds_read_b64_tr_b16 a[146:147], v4 offset:29696
v_mfma_f32_32x32x16_bf16 v[144:159], a[128:131], a[56:59], v[144:159]
ds_read_b64_tr_b16 a[148:149], v5 offset:28672
ds_read_b64_tr_b16 a[150:151], v5 offset:29696
v_mfma_f32_32x32x16_bf16 v[160:175], a[132:135], a[40:43], v[160:175]
ds_read_b64_tr_b16 a[152:153], v6 offset:28672
ds_read_b64_tr_b16 a[154:155], v6 offset:29696
v_mfma_f32_32x32x16_bf16 v[176:191], a[132:135], a[56:59], v[176:191]
ds_read_b64_tr_b16 a[156:157], v7 offset:28672
ds_read_b64_tr_b16 a[158:159], v7 offset:29696
v_mfma_f32_32x32x16_bf16 v[192:207], a[136:139], a[40:43], v[192:207]
s_add_u32 s30, s30, 4096
buffer_load_dwordx4 a[0:3], v8, s[8:11], s30 offen offset:0 sc1
v_mfma_f32_32x32x16_bf16 v[208:223], a[136:139], a[56:59], v[208:223]
buffer_load_dwordx4 v11, s[12:15], s31 offen offset:1024 lds
v_mfma_f32_32x32x16_bf16 v[224:239], a[140:143], a[40:43], v[224:239]
buffer_load_dwordx4 a[16:19], v9, s[8:11], s30 offen offset:0 sc1
v_mfma_f32_32x32x16_bf16 v[240:255], a[140:143], a[56:59], v[240:255]
buffer_load_dwordx4 a[4:7], v8, s[8:11], s30 offen offset:1024 sc1
s_waitcnt vmcnt(19) lgkmcnt(0)
s_barrier
v_mfma_f32_32x32x16_bf16 v[128:143], a[144:147], a[44:47], v[128:143]
ds_read_b64_tr_b16 a[128:129], v4 offset:32768
ds_read_b64_tr_b16 a[130:131], v4 offset:33792
v_mfma_f32_32x32x16_bf16 v[144:159], a[144:147], a[60:63], v[144:159]
ds_read_b64_tr_b16 a[132:133], v5 offset:32768
ds_read_b64_tr_b16 a[134:135], v5 offset:33792
v_mfma_f32_32x32x16_bf16 v[160:175], a[148:151], a[44:47], v[160:175]
ds_read_b64_tr_b16 a[136:137], v6 offset:32768
ds_read_b64_tr_b16 a[138:139], v6 offset:33792
v_mfma_f32_32x32x16_bf16 v[176:191], a[148:151], a[60:63], v[176:191]
ds_read_b64_tr_b16 a[140:141], v7 offset:32768
ds_read_b64_tr_b16 a[142:143], v7 offset:33792
v_mfma_f32_32x32x16_bf16 v[192:207], a[152:155], a[44:47], v[192:207]
buffer_load_dwordx4 v12, s[12:15], s31 offen offset:2048 lds
v_mfma_f32_32x32x16_bf16 v[208:223], a[152:155], a[60:63], v[208:223]
buffer_load_dwordx4 a[20:23], v9, s[8:11], s30 offen offset:1024 sc1
v_mfma_f32_32x32x16_bf16 v[224:239], a[156:159], a[44:47], v[224:239]
buffer_load_dwordx4 a[8:11], v8, s[8:11], s30 offen offset:2048 sc1
v_mfma_f32_32x32x16_bf16 v[240:255], a[156:159], a[60:63], v[240:255]
buffer_load_dwordx4 v13, s[12:15], s31 offen offset:3072 lds
s_waitcnt lgkmcnt(0)
v_mfma_f32_32x32x16_bf16 v[128:143], a[128:131], a[64:67], v[128:143]
ds_read_b64_tr_b16 a[144:145], v4 offset:36864
ds_read_b64_tr_b16 a[146:147], v4 offset:37888
v_mfma_f32_32x32x16_bf16 v[144:159], a[128:131], a[80:83], v[144:159]
ds_read_b64_tr_b16 a[148:149], v5 offset:36864
ds_read_b64_tr_b16 a[150:151], v5 offset:37888
v_mfma_f32_32x32x16_bf16 v[160:175], a[132:135], a[64:67], v[160:175]
ds_read_b64_tr_b16 a[152:153], v6 offset:36864
ds_read_b64_tr_b16 a[154:155], v6 offset:37888
v_mfma_f32_32x32x16_bf16 v[176:191], a[132:135], a[80:83], v[176:191]
ds_read_b64_tr_b16 a[156:157], v7 offset:36864
ds_read_b64_tr_b16 a[158:159], v7 offset:37888
v_mfma_f32_32x32x16_bf16 v[192:207], a[136:139], a[64:67], v[192:207]
buffer_load_dwordx4 a[24:27], v9, s[8:11], s30 offen offset:2048 sc1
v_mfma_f32_32x32x16_bf16 v[208:223], a[136:139], a[80:83], v[208:223]
buffer_load_dwordx4 a[12:15], v8, s[8:11], s30 offen offset:3072 sc1
v_mfma_f32_32x32x16_bf16 v[224:239], a[140:143], a[64:67], v[224:239]
s_add_u32 s31, s31, 0x20000
s_add_u32 m0, s32, 0x4000
s_nop 0
buffer_load_dwordx4 v10, s[12:15], s31 offen offset:0 lds
v_mfma_f32_32x32x16_bf16 v[240:255], a[140:143], a[80:83], v[240:255]
buffer_load_dwordx4 a[28:31], v9, s[8:11], s30 offen offset:3072 sc1
s_waitcnt lgkmcnt(0)
v_mfma_f32_32x32x16_bf16 v[128:143], a[144:147], a[68:71], v[128:143]
ds_read_b64_tr_b16 a[128:129], v4 offset:40960
ds_read_b64_tr_b16 a[130:131], v4 offset:41984
v_mfma_f32_32x32x16_bf16 v[144:159], a[144:147], a[84:87], v[144:159]
ds_read_b64_tr_b16 a[132:133], v5 offset:40960
ds_read_b64_tr_b16 a[134:135], v5 offset:41984
v_mfma_f32_32x32x16_bf16 v[160:175], a[148:151], a[68:71], v[160:175]
ds_read_b64_tr_b16 a[136:137], v6 offset:40960
ds_read_b64_tr_b16 a[138:139], v6 offset:41984
v_mfma_f32_32x32x16_bf16 v[176:191], a[148:151], a[84:87], v[176:191]
ds_read_b64_tr_b16 a[140:141], v7 offset:40960
ds_read_b64_tr_b16 a[142:143], v7 offset:41984
v_mfma_f32_32x32x16_bf16 v[192:207], a[152:155], a[68:71], v[192:207]
s_add_u32 s30, s30, 4096
buffer_load_dwordx4 a[32:35], v8, s[8:11], s30 offen offset:0 sc1
v_mfma_f32_32x32x16_bf16 v[208:223], a[152:155], a[84:87], v[208:223]
buffer_load_dwordx4 v11, s[12:15], s31 offen offset:1024 lds
v_mfma_f32_32x32x16_bf16 v[224:239], a[156:159], a[68:71], v[224:239]
buffer_load_dwordx4 a[48:51], v9, s[8:11], s30 offen offset:0 sc1
v_mfma_f32_32x32x16_bf16 v[240:255], a[156:159], a[84:87], v[240:255]
buffer_load_dwordx4 a[36:39], v8, s[8:11], s30 offen offset:1024 sc1
s_waitcnt lgkmcnt(0)
v_mfma_f32_32x32x16_bf16 v[128:143], a[128:131], a[72:75], v[128:143]
ds_read_b64_tr_b16 a[144:145], v4 offset:45056
ds_read_b64_tr_b16 a[146:147], v4 offset:46080
v_mfma_f32_32x32x16_bf16 v[144:159], a[128:131], a[88:91], v[144:159]
ds_read_b64_tr_b16 a[148:149], v5 offset:45056
ds_read_b64_tr_b16 a[150:151], v5 offset:46080
v_mfma_f32_32x32x16_bf16 v[160:175], a[132:135], a[72:75], v[160:175]
ds_read_b64_tr_b16 a[152:153], v6 offset:45056
ds_read_b64_tr_b16 a[154:155], v6 offset:46080
v_mfma_f32_32x32x16_bf16 v[176:191], a[132:135], a[88:91], v[176:191]
ds_read_b64_tr_b16 a[156:157], v7 offset:45056
ds_read_b64_tr_b16 a[158:159], v7 offset:46080
v_mfma_f32_32x32x16_bf16 v[192:207], a[136:139], a[72:75], v[192:207]
buffer_load_dwordx4 v12, s[12:15], s31 offen offset:2048 lds
v_mfma_f32_32x32x16_bf16 v[208:223], a[136:139], a[88:91], v[208:223]
buffer_load_dwordx4 a[52:55], v9, s[8:11], s30 offen offset:1024 sc1
v_mfma_f32_32x32x16_bf16 v[224:239], a[140:143], a[72:75], v[224:239]
buffer_load_dwordx4 a[40:43], v8, s[8:11], s30 offen offset:2048 sc1
v_mfma_f32_32x32x16_bf16 v[240:255], a[140:143], a[88:91], v[240:255]
buffer_load_dwordx4 v13, s[12:15], s31 offen offset:3072 lds
s_waitcnt vmcnt(23) lgkmcnt(0)
s_barrier
v_mfma_f32_32x32x16_bf16 v[128:143], a[144:147], a[76:79], v[128:143]
ds_read_b64_tr_b16 a[128:129], v4 offset:49152
ds_read_b64_tr_b16 a[130:131], v4 offset:50176
v_mfma_f32_32x32x16_bf16 v[144:159], a[144:147], a[92:95], v[144:159]
ds_read_b64_tr_b16 a[132:133], v5 offset:49152
ds_read_b64_tr_b16 a[134:135], v5 offset:50176
v_mfma_f32_32x32x16_bf16 v[160:175], a[148:151], a[76:79], v[160:175]
ds_read_b64_tr_b16 a[136:137], v6 offset:49152
ds_read_b64_tr_b16 a[138:139], v6 offset:50176
v_mfma_f32_32x32x16_bf16 v[176:191], a[148:151], a[92:95], v[176:191]
ds_read_b64_tr_b16 a[140:141], v7 offset:49152
ds_read_b64_tr_b16 a[142:143], v7 offset:50176
v_mfma_f32_32x32x16_bf16 v[192:207], a[152:155], a[76:79], v[192:207]
buffer_load_dwordx4 a[56:59], v9, s[8:11], s30 offen offset:2048 sc1
v_mfma_f32_32x32x16_bf16 v[208:223], a[152:155], a[92:95], v[208:223]
buffer_load_dwordx4 a[44:47], v8, s[8:11], s30 offen offset:3072 sc1
v_mfma_f32_32x32x16_bf16 v[224:239], a[156:159], a[76:79], v[224:239]
s_add_u32 s31, s31, 0x20000
s_add_u32 m0, s32, 0x8000
s_nop 0
buffer_load_dwordx4 v10, s[12:15], s31 offen offset:0 lds
v_mfma_f32_32x32x16_bf16 v[240:255], a[156:159], a[92:95], v[240:255]
buffer_load_dwordx4 a[60:63], v9, s[8:11], s30 offen offset:3072 sc1
s_waitcnt lgkmcnt(0)
v_mfma_f32_32x32x16_bf16 v[128:143], a[128:131], a[96:99], v[128:143]
ds_read_b64_tr_b16 a[144:145], v4 offset:53248
ds_read_b64_tr_b16 a[146:147], v4 offset:54272
v_mfma_f32_32x32x16_bf16 v[144:159], a[128:131], a[112:115], v[144:159]
ds_read_b64_tr_b16 a[148:149], v5 offset:53248
ds_read_b64_tr_b16 a[150:151], v5 offset:54272
v_mfma_f32_32x32x16_bf16 v[160:175], a[132:135], a[96:99], v[160:175]
ds_read_b64_tr_b16 a[152:153], v6 offset:53248
ds_read_b64_tr_b16 a[154:155], v6 offset:54272
v_mfma_f32_32x32x16_bf16 v[176:191], a[132:135], a[112:115], v[176:191]
ds_read_b64_tr_b16 a[156:157], v7 offset:53248
ds_read_b64_tr_b16 a[158:159], v7 offset:54272
v_mfma_f32_32x32x16_bf16 v[192:207], a[136:139], a[96:99], v[192:207]
s_add_u32 s30, s30, 4096
buffer_load_dwordx4 a[64:67], v8, s[8:11], s30 offen offset:0 sc1
v_mfma_f32_32x32x16_bf16 v[208:223], a[136:139], a[112:115], v[208:223]
buffer_load_dwordx4 v11, s[12:15], s31 offen offset:1024 lds
v_mfma_f32_32x32x16_bf16 v[224:239], a[140:143], a[96:99], v[224:239]
buffer_load_dwordx4 a[80:83], v9, s[8:11], s30 offen offset:0 sc1
v_mfma_f32_32x32x16_bf16 v[240:255], a[140:143], a[112:115], v[240:255]
s_waitcnt lgkmcnt(0)
v_mfma_f32_32x32x16_bf16 v[128:143], a[144:147], a[100:103], v[128:143]
ds_read_b64_tr_b16 a[128:129], v4 offset:57344
ds_read_b64_tr_b16 a[130:131], v4 offset:58368
v_mfma_f32_32x32x16_bf16 v[144:159], a[144:147], a[116:119], v[144:159]
ds_read_b64_tr_b16 a[132:133], v5 offset:57344
ds_read_b64_tr_b16 a[134:135], v5 offset:58368
v_mfma_f32_32x32x16_bf16 v[160:175], a[148:151], a[100:103], v[160:175]
ds_read_b64_tr_b16 a[136:137], v6 offset:57344
ds_read_b64_tr_b16 a[138:139], v6 offset:58368
v_mfma_f32_32x32x16_bf16 v[176:191], a[148:151], a[116:119], v[176:191]
ds_read_b64_tr_b16 a[140:141], v7 offset:57344
ds_read_b64_tr_b16 a[142:143], v7 offset:58368
v_mfma_f32_32x32x16_bf16 v[192:207], a[152:155], a[100:103], v[192:207]
buffer_load_dwordx4 a[68:71], v8, s[8:11], s30 offen offset:1024 sc1
v_mfma_f32_32x32x16_bf16 v[208:223], a[152:155], a[116:119], v[208:223]
buffer_load_dwordx4 v12, s[12:15], s31 offen offset:2048 lds
v_mfma_f32_32x32x16_bf16 v[224:239], a[156:159], a[100:103], v[224:239]
buffer_load_dwordx4 a[84:87], v9, s[8:11], s30 offen offset:1024 sc1
v_mfma_f32_32x32x16_bf16 v[240:255], a[156:159], a[116:119], v[240:255]
s_waitcnt lgkmcnt(0)
v_mfma_f32_32x32x16_bf16 v[128:143], a[128:131], a[104:107], v[128:143]
ds_read_b64_tr_b16 a[144:145], v4 offset:61440
ds_read_b64_tr_b16 a[146:147], v4 offset:62464
v_mfma_f32_32x32x16_bf16 v[144:159], a[128:131], a[120:123], v[144:159]
ds_read_b64_tr_b16 a[148:149], v5 offset:61440
ds_read_b64_tr_b16 a[150:151], v5 offset:62464
v_mfma_f32_32x32x16_bf16 v[160:175], a[132:135], a[104:107], v[160:175]
ds_read_b64_tr_b16 a[152:153], v6 offset:61440
ds_read_b64_tr_b16 a[154:155], v6 offset:62464
v_mfma_f32_32x32x16_bf16 v[176:191], a[132:135], a[120:123], v[176:191]
ds_read_b64_tr_b16 a[156:157], v7 offset:61440
ds_read_b64_tr_b16 a[158:159], v7 offset:62464
v_mfma_f32_32x32x16_bf16 v[192:207], a[136:139], a[104:107], v[192:207]
buffer_load_dwordx4 a[72:75], v8, s[8:11], s30 offen offset:2048 sc1
v_mfma_f32_32x32x16_bf16 v[208:223], a[136:139], a[120:123], v[208:223]
buffer_load_dwordx4 v13, s[12:15], s31 offen offset:3072 lds
v_mfma_f32_32x32x16_bf16 v[224:239], a[140:143], a[104:107], v[224:239]
buffer_load_dwordx4 a[88:91], v9, s[8:11], s30 offen offset:2048 sc1
v_mfma_f32_32x32x16_bf16 v[240:255], a[140:143], a[120:123], v[240:255]
s_waitcnt vmcnt(24) lgkmcnt(0)
s_barrier
v_mfma_f32_32x32x16_bf16 v[128:143], a[144:147], a[108:111], v[128:143]
ds_read_b64_tr_b16 a[128:129], v4 offset:0
ds_read_b64_tr_b16 a[130:131], v4 offset:1024
v_mfma_f32_32x32x16_bf16 v[144:159], a[144:147], a[124:127], v[144:159]
ds_read_b64_tr_b16 a[132:133], v5 offset:0
ds_read_b64_tr_b16 a[134:135], v5 offset:1024
v_mfma_f32_32x32x16_bf16 v[160:175], a[148:151], a[108:111], v[160:175]
ds_read_b64_tr_b16 a[136:137], v6 offset:0
ds_read_b64_tr_b16 a[138:139], v6 offset:1024
v_mfma_f32_32x32x16_bf16 v[176:191], a[148:151], a[124:127], v[176:191]
ds_read_b64_tr_b16 a[140:141], v7 offset:0
ds_read_b64_tr_b16 a[142:143], v7 offset:1024
v_mfma_f32_32x32x16_bf16 v[192:207], a[152:155], a[108:111], v[192:207]
buffer_load_dwordx4 a[76:79], v8, s[8:11], s30 offen offset:3072 sc1
v_mfma_f32_32x32x16_bf16 v[208:223], a[152:155], a[124:127], v[208:223]
s_add_u32 s31, s31, 0x20000
s_add_u32 m0, s32, 0xc000
s_nop 0
buffer_load_dwordx4 v10, s[12:15], s31 offen offset:0 lds
v_mfma_f32_32x32x16_bf16 v[224:239], a[156:159], a[108:111], v[224:239]
buffer_load_dwordx4 a[92:95], v9, s[8:11], s30 offen offset:3072 sc1
v_mfma_f32_32x32x16_bf16 v[240:255], a[156:159], a[124:127], v[240:255]
s_waitcnt lgkmcnt(0)
v_mfma_f32_32x32x16_bf16 v[128:143], a[128:131], a[0:3], v[128:143]
ds_read_b64_tr_b16 a[144:145], v4 offset:4096
ds_read_b64_tr_b16 a[146:147], v4 offset:5120
v_mfma_f32_32x32x16_bf16 v[144:159], a[128:131], a[16:19], v[144:159]
ds_read_b64_tr_b16 a[148:149], v5 offset:4096
ds_read_b64_tr_b16 a[150:151], v5 offset:5120
v_mfma_f32_32x32x16_bf16 v[160:175], a[132:135], a[0:3], v[160:175]
ds_read_b64_tr_b16 a[152:153], v6 offset:4096
ds_read_b64_tr_b16 a[154:155], v6 offset:5120
v_mfma_f32_32x32x16_bf16 v[176:191], a[132:135], a[16:19], v[176:191]
ds_read_b64_tr_b16 a[156:157], v7 offset:4096
ds_read_b64_tr_b16 a[158:159], v7 offset:5120
v_mfma_f32_32x32x16_bf16 v[192:207], a[136:139], a[0:3], v[192:207]
s_add_u32 s30, s30, 4096
buffer_load_dwordx4 a[96:99], v8, s[8:11], s30 offen offset:0 sc1
v_mfma_f32_32x32x16_bf16 v[208:223], a[136:139], a[16:19], v[208:223]
buffer_load_dwordx4 v11, s[12:15], s31 offen offset:1024 lds
v_mfma_f32_32x32x16_bf16 v[224:239], a[140:143], a[0:3], v[224:239]
buffer_load_dwordx4 a[112:115], v9, s[8:11], s30 offen offset:0 sc1
v_mfma_f32_32x32x16_bf16 v[240:255], a[140:143], a[16:19], v[240:255]
s_waitcnt lgkmcnt(0)
v_mfma_f32_32x32x16_bf16 v[128:143], a[144:147], a[4:7], v[128:143]
ds_read_b64_tr_b16 a[128:129], v4 offset:8192
ds_read_b64_tr_b16 a[130:131], v4 offset:9216
v_mfma_f32_32x32x16_bf16 v[144:159], a[144:147], a[20:23], v[144:159]
ds_read_b64_tr_b16 a[132:133], v5 offset:8192
ds_read_b64_tr_b16 a[134:135], v5 offset:9216
v_mfma_f32_32x32x16_bf16 v[160:175], a[148:151], a[4:7], v[160:175]
ds_read_b64_tr_b16 a[136:137], v6 offset:8192
ds_read_b64_tr_b16 a[138:139], v6 offset:9216
v_mfma_f32_32x32x16_bf16 v[176:191], a[148:151], a[20:23], v[176:191]
ds_read_b64_tr_b16 a[140:141], v7 offset:8192
ds_read_b64_tr_b16 a[142:143], v7 offset:9216
v_mfma_f32_32x32x16_bf16 v[192:207], a[152:155], a[4:7], v[192:207]
buffer_load_dwordx4 a[100:103], v8, s[8:11], s30 offen offset:1024 sc1
v_mfma_f32_32x32x16_bf16 v[208:223], a[152:155], a[20:23], v[208:223]
buffer_load_dwordx4 v12, s[12:15], s31 offen offset:2048 lds
v_mfma_f32_32x32x16_bf16 v[224:239], a[156:159], a[4:7], v[224:239]
buffer_load_dwordx4 a[116:119], v9, s[8:11], s30 offen offset:1024 sc1
v_mfma_f32_32x32x16_bf16 v[240:255], a[156:159], a[20:23], v[240:255]
s_waitcnt lgkmcnt(0)
v_mfma_f32_32x32x16_bf16 v[128:143], a[128:131], a[8:11], v[128:143]
ds_read_b64_tr_b16 a[144:145], v4 offset:12288
ds_read_b64_tr_b16 a[146:147], v4 offset:13312
v_mfma_f32_32x32x16_bf16 v[144:159], a[128:131], a[24:27], v[144:159]
ds_read_b64_tr_b16 a[148:149], v5 offset:12288
ds_read_b64_tr_b16 a[150:151], v5 offset:13312
v_mfma_f32_32x32x16_bf16 v[160:175], a[132:135], a[8:11], v[160:175]
ds_read_b64_tr_b16 a[152:153], v6 offset:12288
ds_read_b64_tr_b16 a[154:155], v6 offset:13312
v_mfma_f32_32x32x16_bf16 v[176:191], a[132:135], a[24:27], v[176:191]
ds_read_b64_tr_b16 a[156:157], v7 offset:12288
ds_read_b64_tr_b16 a[158:159], v7 offset:13312
v_mfma_f32_32x32x16_bf16 v[192:207], a[136:139], a[8:11], v[192:207]
buffer_load_dwordx4 a[104:107], v8, s[8:11], s30 offen offset:2048 sc1
v_mfma_f32_32x32x16_bf16 v[208:223], a[136:139], a[24:27], v[208:223]
buffer_load_dwordx4 v13, s[12:15], s31 offen offset:3072 lds
v_mfma_f32_32x32x16_bf16 v[224:239], a[140:143], a[8:11], v[224:239]
buffer_load_dwordx4 a[120:123], v9, s[8:11], s30 offen offset:2048 sc1
v_mfma_f32_32x32x16_bf16 v[240:255], a[140:143], a[24:27], v[240:255]
s_waitcnt vmcnt(24) lgkmcnt(0)
s_barrier
v_mfma_f32_32x32x16_bf16 v[128:143], a[144:147], a[12:15], v[128:143]
ds_read_b64_tr_b16 a[128:129], v4 offset:16384
ds_read_b64_tr_b16 a[130:131], v4 offset:17408
v_mfma_f32_32x32x16_bf16 v[144:159], a[144:147], a[28:31], v[144:159]
ds_read_b64_tr_b16 a[132:133], v5 offset:16384
ds_read_b64_tr_b16 a[134:135], v5 offset:17408
v_mfma_f32_32x32x16_bf16 v[160:175], a[148:151], a[12:15], v[160:175]
ds_read_b64_tr_b16 a[136:137], v6 offset:16384
ds_read_b64_tr_b16 a[138:139], v6 offset:17408
v_mfma_f32_32x32x16_bf16 v[176:191], a[148:151], a[28:31], v[176:191]
ds_read_b64_tr_b16 a[140:141], v7 offset:16384
ds_read_b64_tr_b16 a[142:143], v7 offset:17408
v_mfma_f32_32x32x16_bf16 v[192:207], a[152:155], a[12:15], v[192:207]
buffer_load_dwordx4 a[108:111], v8, s[8:11], s30 offen offset:3072 sc1
v_mfma_f32_32x32x16_bf16 v[208:223], a[152:155], a[28:31], v[208:223]
s_add_u32 s31, s31, 0x20000
s_add_u32 m0, s32, 0x0
s_nop 0
buffer_load_dwordx4 v10, s[12:15], s31 offen offset:0 lds
v_mfma_f32_32x32x16_bf16 v[224:239], a[156:159], a[12:15], v[224:239]
buffer_load_dwordx4 a[124:127], v9, s[8:11], s30 offen offset:3072 sc1
v_mfma_f32_32x32x16_bf16 v[240:255], a[156:159], a[28:31], v[240:255]
s_waitcnt lgkmcnt(0)
v_mfma_f32_32x32x16_bf16 v[128:143], a[128:131], a[32:35], v[128:143]
ds_read_b64_tr_b16 a[144:145], v4 offset:20480
ds_read_b64_tr_b16 a[146:147], v4 offset:21504
v_mfma_f32_32x32x16_bf16 v[144:159], a[128:131], a[48:51], v[144:159]
ds_read_b64_tr_b16 a[148:149], v5 offset:20480
ds_read_b64_tr_b16 a[150:151], v5 offset:21504
v_mfma_f32_32x32x16_bf16 v[160:175], a[132:135], a[32:35], v[160:175]
ds_read_b64_tr_b16 a[152:153], v6 offset:20480
ds_read_b64_tr_b16 a[154:155], v6 offset:21504
v_mfma_f32_32x32x16_bf16 v[176:191], a[132:135], a[48:51], v[176:191]
ds_read_b64_tr_b16 a[156:157], v7 offset:20480
ds_read_b64_tr_b16 a[158:159], v7 offset:21504
v_mfma_f32_32x32x16_bf16 v[192:207], a[136:139], a[32:35], v[192:207]
s_add_u32 s30, s30, 4096
buffer_load_dwordx4 a[0:3], v8, s[8:11], s30 offen offset:0 sc1
v_mfma_f32_32x32x16_bf16 v[208:223], a[136:139], a[48:51], v[208:223]
buffer_load_dwordx4 v11, s[12:15], s31 offen offset:1024 lds
v_mfma_f32_32x32x16_bf16 v[224:239], a[140:143], a[32:35], v[224:239]
buffer_load_dwordx4 a[16:19], v9, s[8:11], s30 offen offset:0 sc1
v_mfma_f32_32x32x16_bf16 v[240:255], a[140:143], a[48:51], v[240:255]
s_waitcnt lgkmcnt(0)
v_mfma_f32_32x32x16_bf16 v[128:143], a[144:147], a[36:39], v[128:143]
ds_read_b64_tr_b16 a[128:129], v4 offset:24576
ds_read_b64_tr_b16 a[130:131], v4 offset:25600
v_mfma_f32_32x32x16_bf16 v[144:159], a[144:147], a[52:55], v[144:159]
ds_read_b64_tr_b16 a[132:133], v5 offset:24576
ds_read_b64_tr_b16 a[134:135], v5 offset:25600
v_mfma_f32_32x32x16_bf16 v[160:175], a[148:151], a[36:39], v[160:175]
ds_read_b64_tr_b16 a[136:137], v6 offset:24576
ds_read_b64_tr_b16 a[138:139], v6 offset:25600
v_mfma_f32_32x32x16_bf16 v[176:191], a[148:151], a[52:55], v[176:191]
ds_read_b64_tr_b16 a[140:141], v7 offset:24576
ds_read_b64_tr_b16 a[142:143], v7 offset:25600
v_mfma_f32_32x32x16_bf16 v[192:207], a[152:155], a[36:39], v[192:207]
buffer_load_dwordx4 a[4:7], v8, s[8:11], s30 offen offset:1024 sc1
v_mfma_f32_32x32x16_bf16 v[208:223], a[152:155], a[52:55], v[208:223]
buffer_load_dwordx4 v12, s[12:15], s31 offen offset:2048 lds
v_mfma_f32_32x32x16_bf16 v[224:239], a[156:159], a[36:39], v[224:239]
buffer_load_dwordx4 a[20:23], v9, s[8:11], s30 offen offset:1024 sc1
v_mfma_f32_32x32x16_bf16 v[240:255], a[156:159], a[52:55], v[240:255]
s_waitcnt lgkmcnt(0)
v_mfma_f32_32x32x16_bf16 v[128:143], a[128:131], a[40:43], v[128:143]
ds_read_b64_tr_b16 a[144:145], v4 offset:28672
ds_read_b64_tr_b16 a[146:147], v4 offset:29696
v_mfma_f32_32x32x16_bf16 v[144:159], a[128:131], a[56:59], v[144:159]
ds_read_b64_tr_b16 a[148:149], v5 offset:28672
ds_read_b64_tr_b16 a[150:151], v5 offset:29696
v_mfma_f32_32x32x16_bf16 v[160:175], a[132:135], a[40:43], v[160:175]
ds_read_b64_tr_b16 a[152:153], v6 offset:28672
ds_read_b64_tr_b16 a[154:155], v6 offset:29696
v_mfma_f32_32x32x16_bf16 v[176:191], a[132:135], a[56:59], v[176:191]
ds_read_b64_tr_b16 a[156:157], v7 offset:28672
ds_read_b64_tr_b16 a[158:159], v7 offset:29696
v_mfma_f32_32x32x16_bf16 v[192:207], a[136:139], a[40:43], v[192:207]
buffer_load_dwordx4 a[8:11], v8, s[8:11], s30 offen offset:2048 sc1
v_mfma_f32_32x32x16_bf16 v[208:223], a[136:139], a[56:59], v[208:223]
buffer_load_dwordx4 v13, s[12:15], s31 offen offset:3072 lds
v_mfma_f32_32x32x16_bf16 v[224:239], a[140:143], a[40:43], v[224:239]
buffer_load_dwordx4 a[24:27], v9, s[8:11], s30 offen offset:2048 sc1
v_mfma_f32_32x32x16_bf16 v[240:255], a[140:143], a[56:59], v[240:255]
s_waitcnt vmcnt(24) lgkmcnt(0)
s_barrier
v_mfma_f32_32x32x16_bf16 v[128:143], a[144:147], a[44:47], v[128:143]
ds_read_b64_tr_b16 a[128:129], v4 offset:32768
ds_read_b64_tr_b16 a[130:131], v4 offset:33792
v_mfma_f32_32x32x16_bf16 v[144:159], a[144:147], a[60:63], v[144:159]
ds_read_b64_tr_b16 a[132:133], v5 offset:32768
ds_read_b64_tr_b16 a[134:135], v5 offset:33792
v_mfma_f32_32x32x16_bf16 v[160:175], a[148:151], a[44:47], v[160:175]
ds_read_b64_tr_b16 a[136:137], v6 offset:32768
ds_read_b64_tr_b16 a[138:139], v6 offset:33792
v_mfma_f32_32x32x16_bf16 v[176:191], a[148:151], a[60:63], v[176:191]
ds_read_b64_tr_b16 a[140:141], v7 offset:32768
ds_read_b64_tr_b16 a[142:143], v7 offset:33792
v_mfma_f32_32x32x16_bf16 v[192:207], a[152:155], a[44:47], v[192:207]
buffer_load_dwordx4 a[12:15], v8, s[8:11], s30 offen offset:3072 sc1
v_mfma_f32_32x32x16_bf16 v[208:223], a[152:155], a[60:63], v[208:223]
s_add_u32 s31, s31, 0x20000
s_add_u32 m0, s32, 0x4000
s_nop 0
buffer_load_dwordx4 v10, s[12:15], s31 offen offset:0 lds
v_mfma_f32_32x32x16_bf16 v[224:239], a[156:159], a[44:47], v[224:239]
buffer_load_dwordx4 a[28:31], v9, s[8:11], s30 offen offset:3072 sc1
v_mfma_f32_32x32x16_bf16 v[240:255], a[156:159], a[60:63], v[240:255]
s_waitcnt lgkmcnt(0)
v_mfma_f32_32x32x16_bf16 v[128:143], a[128:131], a[64:67], v[128:143]
ds_read_b64_tr_b16 a[144:145], v4 offset:36864
ds_read_b64_tr_b16 a[146:147], v4 offset:37888
v_mfma_f32_32x32x16_bf16 v[144:159], a[128:131], a[80:83], v[144:159]
ds_read_b64_tr_b16 a[148:149], v5 offset:36864
ds_read_b64_tr_b16 a[150:151], v5 offset:37888
v_mfma_f32_32x32x16_bf16 v[160:175], a[132:135], a[64:67], v[160:175]
ds_read_b64_tr_b16 a[152:153], v6 offset:36864
ds_read_b64_tr_b16 a[154:155], v6 offset:37888
v_mfma_f32_32x32x16_bf16 v[176:191], a[132:135], a[80:83], v[176:191]
ds_read_b64_tr_b16 a[156:157], v7 offset:36864
ds_read_b64_tr_b16 a[158:159], v7 offset:37888
v_mfma_f32_32x32x16_bf16 v[192:207], a[136:139], a[64:67], v[192:207]
s_add_u32 s30, s30, 4096
buffer_load_dwordx4 a[32:35], v8, s[8:11], s30 offen offset:0 sc1
v_mfma_f32_32x32x16_bf16 v[208:223], a[136:139], a[80:83], v[208:223]
buffer_load_dwordx4 v11, s[12:15], s31 offen offset:1024 lds
v_mfma_f32_32x32x16_bf16 v[224:239], a[140:143], a[64:67], v[224:239]
buffer_load_dwordx4 a[48:51], v9, s[8:11], s30 offen offset:0 sc1
v_mfma_f32_32x32x16_bf16 v[240:255], a[140:143], a[80:83], v[240:255]
s_waitcnt lgkmcnt(0)
v_mfma_f32_32x32x16_bf16 v[128:143], a[144:147], a[68:71], v[128:143]
ds_read_b64_tr_b16 a[128:129], v4 offset:40960
ds_read_b64_tr_b16 a[130:131], v4 offset:41984
v_mfma_f32_32x32x16_bf16 v[144:159], a[144:147], a[84:87], v[144:159]
ds_read_b64_tr_b16 a[132:133], v5 offset:40960
ds_read_b64_tr_b16 a[134:135], v5 offset:41984
v_mfma_f32_32x32x16_bf16 v[160:175], a[148:151], a[68:71], v[160:175]
ds_read_b64_tr_b16 a[136:137], v6 offset:40960
ds_read_b64_tr_b16 a[138:139], v6 offset:41984
v_mfma_f32_32x32x16_bf16 v[176:191], a[148:151], a[84:87], v[176:191]
ds_read_b64_tr_b16 a[140:141], v7 offset:40960
ds_read_b64_tr_b16 a[142:143], v7 offset:41984
v_mfma_f32_32x32x16_bf16 v[192:207], a[152:155], a[68:71], v[192:207]
buffer_load_dwordx4 a[36:39], v8, s[8:11], s30 offen offset:1024 sc1
v_mfma_f32_32x32x16_bf16 v[208:223], a[152:155], a[84:87], v[208:223]
buffer_load_dwordx4 v12, s[12:15], s31 offen offset:2048 lds
v_mfma_f32_32x32x16_bf16 v[224:239], a[156:159], a[68:71], v[224:239]
buffer_load_dwordx4 a[52:55], v9, s[8:11], s30 offen offset:1024 sc1
v_mfma_f32_32x32x16_bf16 v[240:255], a[156:159], a[84:87], v[240:255]
s_waitcnt lgkmcnt(0)
v_mfma_f32_32x32x16_bf16 v[128:143], a[128:131], a[72:75], v[128:143]
ds_read_b64_tr_b16 a[144:145], v4 offset:45056
ds_read_b64_tr_b16 a[146:147], v4 offset:46080
v_mfma_f32_32x32x16_bf16 v[144:159], a[128:131], a[88:91], v[144:159]
ds_read_b64_tr_b16 a[148:149], v5 offset:45056
ds_read_b64_tr_b16 a[150:151], v5 offset:46080
v_mfma_f32_32x32x16_bf16 v[160:175], a[132:135], a[72:75], v[160:175]
ds_read_b64_tr_b16 a[152:153], v6 offset:45056
ds_read_b64_tr_b16 a[154:155], v6 offset:46080
v_mfma_f32_32x32x16_bf16 v[176:191], a[132:135], a[88:91], v[176:191]
ds_read_b64_tr_b16 a[156:157], v7 offset:45056
ds_read_b64_tr_b16 a[158:159], v7 offset:46080
v_mfma_f32_32x32x16_bf16 v[192:207], a[136:139], a[72:75], v[192:207]
buffer_load_dwordx4 a[40:43], v8, s[8:11], s30 offen offset:2048 sc1
v_mfma_f32_32x32x16_bf16 v[208:223], a[136:139], a[88:91], v[208:223]
buffer_load_dwordx4 v13, s[12:15], s31 offen offset:3072 lds
v_mfma_f32_32x32x16_bf16 v[224:239], a[140:143], a[72:75], v[224:239]
buffer_load_dwordx4 a[56:59], v9, s[8:11], s30 offen offset:2048 sc1
v_mfma_f32_32x32x16_bf16 v[240:255], a[140:143], a[88:91], v[240:255]
s_waitcnt vmcnt(24) lgkmcnt(0)
s_barrier
v_mfma_f32_32x32x16_bf16 v[128:143], a[144:147], a[76:79], v[128:143]
ds_read_b64_tr_b16 a[128:129], v4 offset:49152
ds_read_b64_tr_b16 a[130:131], v4 offset:50176
v_mfma_f32_32x32x16_bf16 v[144:159], a[144:147], a[92:95], v[144:159]
ds_read_b64_tr_b16 a[132:133], v5 offset:49152
ds_read_b64_tr_b16 a[134:135], v5 offset:50176
v_mfma_f32_32x32x16_bf16 v[160:175], a[148:151], a[76:79], v[160:175]
ds_read_b64_tr_b16 a[136:137], v6 offset:49152
ds_read_b64_tr_b16 a[138:139], v6 offset:50176
v_mfma_f32_32x32x16_bf16 v[176:191], a[148:151], a[92:95], v[176:191]
ds_read_b64_tr_b16 a[140:141], v7 offset:49152
ds_read_b64_tr_b16 a[142:143], v7 offset:50176
v_mfma_f32_32x32x16_bf16 v[192:207], a[152:155], a[76:79], v[192:207]
buffer_load_dwordx4 a[44:47], v8, s[8:11], s30 offen offset:3072 sc1
v_mfma_f32_32x32x16_bf16 v[208:223], a[152:155], a[92:95], v[208:223]
s_add_u32 s31, s31, 0x20000
s_add_u32 m0, s32, 0x8000
s_nop 0
buffer_load_dwordx4 v10, s[12:15], s31 offen offset:0 lds
v_mfma_f32_32x32x16_bf16 v[224:239], a[156:159], a[76:79], v[224:239]
buffer_load_dwordx4 a[60:63], v9, s[8:11], s30 offen offset:3072 sc1
v_mfma_f32_32x32x16_bf16 v[240:255], a[156:159], a[92:95], v[240:255]
s_waitcnt lgkmcnt(0)
v_mfma_f32_32x32x16_bf16 v[128:143], a[128:131], a[96:99], v[128:143]
ds_read_b64_tr_b16 a[144:145], v4 offset:53248
ds_read_b64_tr_b16 a[146:147], v4 offset:54272
v_mfma_f32_32x32x16_bf16 v[144:159], a[128:131], a[112:115], v[144:159]
ds_read_b64_tr_b16 a[148:149], v5 offset:53248
ds_read_b64_tr_b16 a[150:151], v5 offset:54272
v_mfma_f32_32x32x16_bf16 v[160:175], a[132:135], a[96:99], v[160:175]
ds_read_b64_tr_b16 a[152:153], v6 offset:53248
ds_read_b64_tr_b16 a[154:155], v6 offset:54272
v_mfma_f32_32x32x16_bf16 v[176:191], a[132:135], a[112:115], v[176:191]
ds_read_b64_tr_b16 a[156:157], v7 offset:53248
ds_read_b64_tr_b16 a[158:159], v7 offset:54272
v_mfma_f32_32x32x16_bf16 v[192:207], a[136:139], a[96:99], v[192:207]
s_add_u32 s30, s30, 4096
buffer_load_dwordx4 a[64:67], v8, s[8:11], s30 offen offset:0 sc1
v_mfma_f32_32x32x16_bf16 v[208:223], a[136:139], a[112:115], v[208:223]
buffer_load_dwordx4 v11, s[12:15], s31 offen offset:1024 lds
v_mfma_f32_32x32x16_bf16 v[224:239], a[140:143], a[96:99], v[224:239]
buffer_load_dwordx4 a[80:83], v9, s[8:11], s30 offen offset:0 sc1
v_mfma_f32_32x32x16_bf16 v[240:255], a[140:143], a[112:115], v[240:255]
s_waitcnt lgkmcnt(0)
v_mfma_f32_32x32x16_bf16 v[128:143], a[144:147], a[100:103], v[128:143]
ds_read_b64_tr_b16 a[128:129], v4 offset:57344
ds_read_b64_tr_b16 a[130:131], v4 offset:58368
v_mfma_f32_32x32x16_bf16 v[144:159], a[144:147], a[116:119], v[144:159]
ds_read_b64_tr_b16 a[132:133], v5 offset:57344
ds_read_b64_tr_b16 a[134:135], v5 offset:58368
v_mfma_f32_32x32x16_bf16 v[160:175], a[148:151], a[100:103], v[160:175]
ds_read_b64_tr_b16 a[136:137], v6 offset:57344
ds_read_b64_tr_b16 a[138:139], v6 offset:58368
v_mfma_f32_32x32x16_bf16 v[176:191], a[148:151], a[116:119], v[176:191]
ds_read_b64_tr_b16 a[140:141], v7 offset:57344
ds_read_b64_tr_b16 a[142:143], v7 offset:58368
v_mfma_f32_32x32x16_bf16 v[192:207], a[152:155], a[100:103], v[192:207]
buffer_load_dwordx4 a[68:71], v8, s[8:11], s30 offen offset:1024 sc1
v_mfma_f32_32x32x16_bf16 v[208:223], a[152:155], a[116:119], v[208:223]
buffer_load_dwordx4 v12, s[12:15], s31 offen offset:2048 lds
v_mfma_f32_32x32x16_bf16 v[224:239], a[156:159], a[100:103], v[224:239]
buffer_load_dwordx4 a[84:87], v9, s[8:11], s30 offen offset:1024 sc1
v_mfma_f32_32x32x16_bf16 v[240:255], a[156:159], a[116:119], v[240:255]
s_waitcnt lgkmcnt(0)
v_mfma_f32_32x32x16_bf16 v[128:143], a[128:131], a[104:107], v[128:143]
ds_read_b64_tr_b16 a[144:145], v4 offset:61440
ds_read_b64_tr_b16 a[146:147], v4 offset:62464
v_mfma_f32_32x32x16_bf16 v[144:159], a[128:131], a[120:123], v[144:159]
ds_read_b64_tr_b16 a[148:149], v5 offset:61440
ds_read_b64_tr_b16 a[150:151], v5 offset:62464
v_mfma_f32_32x32x16_bf16 v[160:175], a[132:135], a[104:107], v[160:175]
ds_read_b64_tr_b16 a[152:153], v6 offset:61440
ds_read_b64_tr_b16 a[154:155], v6 offset:62464
v_mfma_f32_32x32x16_bf16 v[176:191], a[132:135], a[120:123], v[176:191]
ds_read_b64_tr_b16 a[156:157], v7 offset:61440
ds_read_b64_tr_b16 a[158:159], v7 offset:62464
v_mfma_f32_32x32x16_bf16 v[192:207], a[136:139], a[104:107], v[192:207]
buffer_load_dwordx4 a[72:75], v8, s[8:11], s30 offen offset:2048 sc1
v_mfma_f32_32x32x16_bf16 v[208:223], a[136:139], a[120:123], v[208:223]
buffer_load_dwordx4 v13, s[12:15], s31 offen offset:3072 lds
v_mfma_f32_32x32x16_bf16 v[224:239], a[140:143], a[104:107], v[224:239]
buffer_load_dwordx4 a[88:91], v9, s[8:11], s30 offen offset:2048 sc1
v_mfma_f32_32x32x16_bf16 v[240:255], a[140:143], a[120:123], v[240:255]
s_waitcnt vmcnt(24) lgkmcnt(0)
s_barrier
v_mfma_f32_32x32x16_bf16 v[128:143], a[144:147], a[108:111], v[128:143]
ds_read_b64_tr_b16 a[128:129], v4 offset:0
ds_read_b64_tr_b16 a[130:131], v4 offset:1024
v_mfma_f32_32x32x16_bf16 v[144:159], a[144:147], a[124:127], v[144:159]
ds_read_b64_tr_b16 a[132:133], v5 offset:0
ds_read_b64_tr_b16 a[134:135], v5 offset:1024
v_mfma_f32_32x32x16_bf16 v[160:175], a[148:151], a[108:111], v[160:175]
ds_read_b64_tr_b16 a[136:137], v6 offset:0
ds_read_b64_tr_b16 a[138:139], v6 offset:1024
v_mfma_f32_32x32x16_bf16 v[176:191], a[148:151], a[124:127], v[176:191]
ds_read_b64_tr_b16 a[140:141], v7 offset:0
ds_read_b64_tr_b16 a[142:143], v7 offset:1024
v_mfma_f32_32x32x16_bf16 v[192:207], a[152:155], a[108:111], v[192:207]
buffer_load_dwordx4 a[76:79], v8, s[8:11], s30 offen offset:3072 sc1
v_mfma_f32_32x32x16_bf16 v[208:223], a[152:155], a[124:127], v[208:223]
s_add_u32 s31, s31, 0x20000
s_add_u32 m0, s32, 0xc000
s_nop 0
buffer_load_dwordx4 v10, s[12:15], s31 offen offset:0 lds
v_mfma_f32_32x32x16_bf16 v[224:239], a[156:159], a[108:111], v[224:239]
buffer_load_dwordx4 a[92:95], v9, s[8:11], s30 offen offset:3072 sc1
v_mfma_f32_32x32x16_bf16 v[240:255], a[156:159], a[124:127], v[240:255]
s_waitcnt lgkmcnt(0)
v_mfma_f32_32x32x16_bf16 v[128:143], a[128:131], a[0:3], v[128:143]
ds_read_b64_tr_b16 a[144:145], v4 offset:4096
ds_read_b64_tr_b16 a[146:147], v4 offset:5120
v_mfma_f32_32x32x16_bf16 v[144:159], a[128:131], a[16:19], v[144:159]
ds_read_b64_tr_b16 a[148:149], v5 offset:4096
ds_read_b64_tr_b16 a[150:151], v5 offset:5120
v_mfma_f32_32x32x16_bf16 v[160:175], a[132:135], a[0:3], v[160:175]
ds_read_b64_tr_b16 a[152:153], v6 offset:4096
ds_read_b64_tr_b16 a[154:155], v6 offset:5120
v_mfma_f32_32x32x16_bf16 v[176:191], a[132:135], a[16:19], v[176:191]
ds_read_b64_tr_b16 a[156:157], v7 offset:4096
ds_read_b64_tr_b16 a[158:159], v7 offset:5120
v_mfma_f32_32x32x16_bf16 v[192:207], a[136:139], a[0:3], v[192:207]
s_add_u32 s30, s30, 4096
buffer_load_dwordx4 a[96:99], v8, s[8:11], s30 offen offset:0 sc1
v_mfma_f32_32x32x16_bf16 v[208:223], a[136:139], a[16:19], v[208:223]
buffer_load_dwordx4 v11, s[12:15], s31 offen offset:1024 lds
v_mfma_f32_32x32x16_bf16 v[224:239], a[140:143], a[0:3], v[224:239]
buffer_load_dwordx4 a[112:115], v9, s[8:11], s30 offen offset:0 sc1
v_mfma_f32_32x32x16_bf16 v[240:255], a[140:143], a[16:19], v[240:255]
s_waitcnt lgkmcnt(0)
v_mfma_f32_32x32x16_bf16 v[128:143], a[144:147], a[4:7], v[128:143]
ds_read_b64_tr_b16 a[128:129], v4 offset:8192
ds_read_b64_tr_b16 a[130:131], v4 offset:9216
v_mfma_f32_32x32x16_bf16 v[144:159], a[144:147], a[20:23], v[144:159]
ds_read_b64_tr_b16 a[132:133], v5 offset:8192
ds_read_b64_tr_b16 a[134:135], v5 offset:9216
v_mfma_f32_32x32x16_bf16 v[160:175], a[148:151], a[4:7], v[160:175]
ds_read_b64_tr_b16 a[136:137], v6 offset:8192
ds_read_b64_tr_b16 a[138:139], v6 offset:9216
v_mfma_f32_32x32x16_bf16 v[176:191], a[148:151], a[20:23], v[176:191]
ds_read_b64_tr_b16 a[140:141], v7 offset:8192
ds_read_b64_tr_b16 a[142:143], v7 offset:9216
v_mfma_f32_32x32x16_bf16 v[192:207], a[152:155], a[4:7], v[192:207]
buffer_load_dwordx4 a[100:103], v8, s[8:11], s30 offen offset:1024 sc1
v_mfma_f32_32x32x16_bf16 v[208:223], a[152:155], a[20:23], v[208:223]
buffer_load_dwordx4 v12, s[12:15], s31 offen offset:2048 lds
v_mfma_f32_32x32x16_bf16 v[224:239], a[156:159], a[4:7], v[224:239]
buffer_load_dwordx4 a[116:119], v9, s[8:11], s30 offen offset:1024 sc1
v_mfma_f32_32x32x16_bf16 v[240:255], a[156:159], a[20:23], v[240:255]
s_waitcnt lgkmcnt(0)
v_mfma_f32_32x32x16_bf16 v[128:143], a[128:131], a[8:11], v[128:143]
ds_read_b64_tr_b16 a[144:145], v4 offset:12288
ds_read_b64_tr_b16 a[146:147], v4 offset:13312
v_mfma_f32_32x32x16_bf16 v[144:159], a[128:131], a[24:27], v[144:159]
ds_read_b64_tr_b16 a[148:149], v5 offset:12288
ds_read_b64_tr_b16 a[150:151], v5 offset:13312
v_mfma_f32_32x32x16_bf16 v[160:175], a[132:135], a[8:11], v[160:175]
ds_read_b64_tr_b16 a[152:153], v6 offset:12288
ds_read_b64_tr_b16 a[154:155], v6 offset:13312
v_mfma_f32_32x32x16_bf16 v[176:191], a[132:135], a[24:27], v[176:191]
ds_read_b64_tr_b16 a[156:157], v7 offset:12288
ds_read_b64_tr_b16 a[158:159], v7 offset:13312
v_mfma_f32_32x32x16_bf16 v[192:207], a[136:139], a[8:11], v[192:207]
buffer_load_dwordx4 a[104:107], v8, s[8:11], s30 offen offset:2048 sc1
v_mfma_f32_32x32x16_bf16 v[208:223], a[136:139], a[24:27], v[208:223]
buffer_load_dwordx4 v13, s[12:15], s31 offen offset:3072 lds
v_mfma_f32_32x32x16_bf16 v[224:239], a[140:143], a[8:11], v[224:239]
buffer_load_dwordx4 a[120:123], v9, s[8:11], s30 offen offset:2048 sc1
v_mfma_f32_32x32x16_bf16 v[240:255], a[140:143], a[24:27], v[240:255]
s_waitcnt vmcnt(24) lgkmcnt(0)
s_barrier
v_mfma_f32_32x32x16_bf16 v[128:143], a[144:147], a[12:15], v[128:143]
ds_read_b64_tr_b16 a[128:129], v4 offset:16384
ds_read_b64_tr_b16 a[130:131], v4 offset:17408
v_mfma_f32_32x32x16_bf16 v[144:159], a[144:147], a[28:31], v[144:159]
ds_read_b64_tr_b16 a[132:133], v5 offset:16384
ds_read_b64_tr_b16 a[134:135], v5 offset:17408
v_mfma_f32_32x32x16_bf16 v[160:175], a[148:151], a[12:15], v[160:175]
ds_read_b64_tr_b16 a[136:137], v6 offset:16384
ds_read_b64_tr_b16 a[138:139], v6 offset:17408
v_mfma_f32_32x32x16_bf16 v[176:191], a[148:151], a[28:31], v[176:191]
ds_read_b64_tr_b16 a[140:141], v7 offset:16384
ds_read_b64_tr_b16 a[142:143], v7 offset:17408
v_mfma_f32_32x32x16_bf16 v[192:207], a[152:155], a[12:15], v[192:207]
buffer_load_dwordx4 a[108:111], v8, s[8:11], s30 offen offset:3072 sc1
v_mfma_f32_32x32x16_bf16 v[208:223], a[152:155], a[28:31], v[208:223]
s_add_u32 s31, s31, 0x20000
s_add_u32 m0, s32, 0x0
s_nop 0
buffer_load_dwordx4 v10, s[12:15], s31 offen offset:0 lds
v_mfma_f32_32x32x16_bf16 v[224:239], a[156:159], a[12:15], v[224:239]
buffer_load_dwordx4 a[124:127], v9, s[8:11], s30 offen offset:3072 sc1
v_mfma_f32_32x32x16_bf16 v[240:255], a[156:159], a[28:31], v[240:255]
s_waitcnt lgkmcnt(0)
v_mfma_f32_32x32x16_bf16 v[128:143], a[128:131], a[32:35], v[128:143]
ds_read_b64_tr_b16 a[144:145], v4 offset:20480
ds_read_b64_tr_b16 a[146:147], v4 offset:21504
v_mfma_f32_32x32x16_bf16 v[144:159], a[128:131], a[48:51], v[144:159]
ds_read_b64_tr_b16 a[148:149], v5 offset:20480
ds_read_b64_tr_b16 a[150:151], v5 offset:21504
v_mfma_f32_32x32x16_bf16 v[160:175], a[132:135], a[32:35], v[160:175]
ds_read_b64_tr_b16 a[152:153], v6 offset:20480
ds_read_b64_tr_b16 a[154:155], v6 offset:21504
v_mfma_f32_32x32x16_bf16 v[176:191], a[132:135], a[48:51], v[176:191]
ds_read_b64_tr_b16 a[156:157], v7 offset:20480
ds_read_b64_tr_b16 a[158:159], v7 offset:21504
v_mfma_f32_32x32x16_bf16 v[192:207], a[136:139], a[32:35], v[192:207]
s_add_u32 s30, s30, 4096
buffer_load_dwordx4 a[0:3], v8, s[8:11], s30 offen offset:0 sc1
v_mfma_f32_32x32x16_bf16 v[208:223], a[136:139], a[48:51], v[208:223]
buffer_load_dwordx4 v11, s[12:15], s31 offen offset:1024 lds
v_mfma_f32_32x32x16_bf16 v[224:239], a[140:143], a[32:35], v[224:239]
buffer_load_dwordx4 a[16:19], v9, s[8:11], s30 offen offset:0 sc1
v_mfma_f32_32x32x16_bf16 v[240:255], a[140:143], a[48:51], v[240:255]
s_waitcnt lgkmcnt(0)
v_mfma_f32_32x32x16_bf16 v[128:143], a[144:147], a[36:39], v[128:143]
ds_read_b64_tr_b16 a[128:129], v4 offset:24576
ds_read_b64_tr_b16 a[130:131], v4 offset:25600
v_mfma_f32_32x32x16_bf16 v[144:159], a[144:147], a[52:55], v[144:159]
ds_read_b64_tr_b16 a[132:133], v5 offset:24576
ds_read_b64_tr_b16 a[134:135], v5 offset:25600
v_mfma_f32_32x32x16_bf16 v[160:175], a[148:151], a[36:39], v[160:175]
ds_read_b64_tr_b16 a[136:137], v6 offset:24576
ds_read_b64_tr_b16 a[138:139], v6 offset:25600
v_mfma_f32_32x32x16_bf16 v[176:191], a[148:151], a[52:55], v[176:191]
ds_read_b64_tr_b16 a[140:141], v7 offset:24576
ds_read_b64_tr_b16 a[142:143], v7 offset:25600
v_mfma_f32_32x32x16_bf16 v[192:207], a[152:155], a[36:39], v[192:207]
buffer_load_dwordx4 a[4:7], v8, s[8:11], s30 offen offset:1024 sc1
v_mfma_f32_32x32x16_bf16 v[208:223], a[152:155], a[52:55], v[208:223]
buffer_load_dwordx4 v12, s[12:15], s31 offen offset:2048 lds
v_mfma_f32_32x32x16_bf16 v[224:239], a[156:159], a[36:39], v[224:239]
buffer_load_dwordx4 a[20:23], v9, s[8:11], s30 offen offset:1024 sc1
v_mfma_f32_32x32x16_bf16 v[240:255], a[156:159], a[52:55], v[240:255]
s_waitcnt lgkmcnt(0)
v_mfma_f32_32x32x16_bf16 v[128:143], a[128:131], a[40:43], v[128:143]
ds_read_b64_tr_b16 a[144:145], v4 offset:28672
ds_read_b64_tr_b16 a[146:147], v4 offset:29696
v_mfma_f32_32x32x16_bf16 v[144:159], a[128:131], a[56:59], v[144:159]
ds_read_b64_tr_b16 a[148:149], v5 offset:28672
ds_read_b64_tr_b16 a[150:151], v5 offset:29696
v_mfma_f32_32x32x16_bf16 v[160:175], a[132:135], a[40:43], v[160:175]
ds_read_b64_tr_b16 a[152:153], v6 offset:28672
ds_read_b64_tr_b16 a[154:155], v6 offset:29696
v_mfma_f32_32x32x16_bf16 v[176:191], a[132:135], a[56:59], v[176:191]
ds_read_b64_tr_b16 a[156:157], v7 offset:28672
ds_read_b64_tr_b16 a[158:159], v7 offset:29696
v_mfma_f32_32x32x16_bf16 v[192:207], a[136:139], a[40:43], v[192:207]
buffer_load_dwordx4 a[8:11], v8, s[8:11], s30 offen offset:2048 sc1
v_mfma_f32_32x32x16_bf16 v[208:223], a[136:139], a[56:59], v[208:223]
buffer_load_dwordx4 v13, s[12:15], s31 offen offset:3072 lds
v_mfma_f32_32x32x16_bf16 v[224:239], a[140:143], a[40:43], v[224:239]
buffer_load_dwordx4 a[24:27], v9, s[8:11], s30 offen offset:2048 sc1
v_mfma_f32_32x32x16_bf16 v[240:255], a[140:143], a[56:59], v[240:255]
s_waitcnt vmcnt(24) lgkmcnt(0)
s_barrier
v_mfma_f32_32x32x16_bf16 v[128:143], a[144:147], a[44:47], v[128:143]
ds_read_b64_tr_b16 a[128:129], v4 offset:32768
ds_read_b64_tr_b16 a[130:131], v4 offset:33792
v_mfma_f32_32x32x16_bf16 v[144:159], a[144:147], a[60:63], v[144:159]
ds_read_b64_tr_b16 a[132:133], v5 offset:32768
ds_read_b64_tr_b16 a[134:135], v5 offset:33792
v_mfma_f32_32x32x16_bf16 v[160:175], a[148:151], a[44:47], v[160:175]
ds_read_b64_tr_b16 a[136:137], v6 offset:32768
ds_read_b64_tr_b16 a[138:139], v6 offset:33792
v_mfma_f32_32x32x16_bf16 v[176:191], a[148:151], a[60:63], v[176:191]
ds_read_b64_tr_b16 a[140:141], v7 offset:32768
ds_read_b64_tr_b16 a[142:143], v7 offset:33792
v_mfma_f32_32x32x16_bf16 v[192:207], a[152:155], a[44:47], v[192:207]
buffer_load_dwordx4 a[12:15], v8, s[8:11], s30 offen offset:3072 sc1
v_mfma_f32_32x32x16_bf16 v[208:223], a[152:155], a[60:63], v[208:223]
s_add_u32 s31, s31, 0x20000
s_add_u32 m0, s32, 0x4000
s_nop 0
buffer_load_dwordx4 v10, s[12:15], s31 offen offset:0 lds
v_mfma_f32_32x32x16_bf16 v[224:239], a[156:159], a[44:47], v[224:239]
buffer_load_dwordx4 a[28:31], v9, s[8:11], s30 offen offset:3072 sc1
v_mfma_f32_32x32x16_bf16 v[240:255], a[156:159], a[60:63], v[240:255]
s_waitcnt lgkmcnt(0)
v_mfma_f32_32x32x16_bf16 v[128:143], a[128:131], a[64:67], v[128:143]
ds_read_b64_tr_b16 a[144:145], v4 offset:36864
ds_read_b64_tr_b16 a[146:147], v4 offset:37888
v_mfma_f32_32x32x16_bf16 v[144:159], a[128:131], a[80:83], v[144:159]
ds_read_b64_tr_b16 a[148:149], v5 offset:36864
ds_read_b64_tr_b16 a[150:151], v5 offset:37888
v_mfma_f32_32x32x16_bf16 v[160:175], a[132:135], a[64:67], v[160:175]
ds_read_b64_tr_b16 a[152:153], v6 offset:36864
ds_read_b64_tr_b16 a[154:155], v6 offset:37888
v_mfma_f32_32x32x16_bf16 v[176:191], a[132:135], a[80:83], v[176:191]
ds_read_b64_tr_b16 a[156:157], v7 offset:36864
ds_read_b64_tr_b16 a[158:159], v7 offset:37888
v_mfma_f32_32x32x16_bf16 v[192:207], a[136:139], a[64:67], v[192:207]
s_add_u32 s30, s30, 4096
buffer_load_dwordx4 a[32:35], v8, s[8:11], s30 offen offset:0 sc1
v_mfma_f32_32x32x16_bf16 v[208:223], a[136:139], a[80:83], v[208:223]
buffer_load_dwordx4 v11, s[12:15], s31 offen offset:1024 lds
v_mfma_f32_32x32x16_bf16 v[224:239], a[140:143], a[64:67], v[224:239]
buffer_load_dwordx4 a[48:51], v9, s[8:11], s30 offen offset:0 sc1
v_mfma_f32_32x32x16_bf16 v[240:255], a[140:143], a[80:83], v[240:255]
s_waitcnt lgkmcnt(0)
v_mfma_f32_32x32x16_bf16 v[128:143], a[144:147], a[68:71], v[128:143]
ds_read_b64_tr_b16 a[128:129], v4 offset:40960
ds_read_b64_tr_b16 a[130:131], v4 offset:41984
v_mfma_f32_32x32x16_bf16 v[144:159], a[144:147], a[84:87], v[144:159]
ds_read_b64_tr_b16 a[132:133], v5 offset:40960
ds_read_b64_tr_b16 a[134:135], v5 offset:41984
v_mfma_f32_32x32x16_bf16 v[160:175], a[148:151], a[68:71], v[160:175]
ds_read_b64_tr_b16 a[136:137], v6 offset:40960
ds_read_b64_tr_b16 a[138:139], v6 offset:41984
v_mfma_f32_32x32x16_bf16 v[176:191], a[148:151], a[84:87], v[176:191]
ds_read_b64_tr_b16 a[140:141], v7 offset:40960
ds_read_b64_tr_b16 a[142:143], v7 offset:41984
v_mfma_f32_32x32x16_bf16 v[192:207], a[152:155], a[68:71], v[192:207]
buffer_load_dwordx4 a[36:39], v8, s[8:11], s30 offen offset:1024 sc1
v_mfma_f32_32x32x16_bf16 v[208:223], a[152:155], a[84:87], v[208:223]
buffer_load_dwordx4 v12, s[12:15], s31 offen offset:2048 lds
v_mfma_f32_32x32x16_bf16 v[224:239], a[156:159], a[68:71], v[224:239]
buffer_load_dwordx4 a[52:55], v9, s[8:11], s30 offen offset:1024 sc1
v_mfma_f32_32x32x16_bf16 v[240:255], a[156:159], a[84:87], v[240:255]
s_waitcnt lgkmcnt(0)
v_mfma_f32_32x32x16_bf16 v[128:143], a[128:131], a[72:75], v[128:143]
ds_read_b64_tr_b16 a[144:145], v4 offset:45056
ds_read_b64_tr_b16 a[146:147], v4 offset:46080
v_mfma_f32_32x32x16_bf16 v[144:159], a[128:131], a[88:91], v[144:159]
ds_read_b64_tr_b16 a[148:149], v5 offset:45056
ds_read_b64_tr_b16 a[150:151], v5 offset:46080
v_mfma_f32_32x32x16_bf16 v[160:175], a[132:135], a[72:75], v[160:175]
ds_read_b64_tr_b16 a[152:153], v6 offset:45056
ds_read_b64_tr_b16 a[154:155], v6 offset:46080
v_mfma_f32_32x32x16_bf16 v[176:191], a[132:135], a[88:91], v[176:191]
ds_read_b64_tr_b16 a[156:157], v7 offset:45056
ds_read_b64_tr_b16 a[158:159], v7 offset:46080
v_mfma_f32_32x32x16_bf16 v[192:207], a[136:139], a[72:75], v[192:207]
buffer_load_dwordx4 a[40:43], v8, s[8:11], s30 offen offset:2048 sc1
v_mfma_f32_32x32x16_bf16 v[208:223], a[136:139], a[88:91], v[208:223]
buffer_load_dwordx4 v13, s[12:15], s31 offen offset:3072 lds
v_mfma_f32_32x32x16_bf16 v[224:239], a[140:143], a[72:75], v[224:239]
buffer_load_dwordx4 a[56:59], v9, s[8:11], s30 offen offset:2048 sc1
v_mfma_f32_32x32x16_bf16 v[240:255], a[140:143], a[88:91], v[240:255]
s_waitcnt vmcnt(9) lgkmcnt(0)
s_barrier
v_mfma_f32_32x32x16_bf16 v[128:143], a[144:147], a[76:79], v[128:143]
ds_read_b64_tr_b16 a[128:129], v4 offset:49152
ds_read_b64_tr_b16 a[130:131], v4 offset:50176
v_mfma_f32_32x32x16_bf16 v[144:159], a[144:147], a[92:95], v[144:159]
ds_read_b64_tr_b16 a[132:133], v4 offset:53248
ds_read_b64_tr_b16 a[134:135], v4 offset:54272
v_mfma_f32_32x32x16_bf16 v[160:175], a[148:151], a[76:79], v[160:175]
ds_read_b64_tr_b16 a[136:137], v4 offset:57344
ds_read_b64_tr_b16 a[138:139], v4 offset:58368
v_mfma_f32_32x32x16_bf16 v[176:191], a[148:151], a[92:95], v[176:191]
ds_read_b64_tr_b16 a[140:141], v4 offset:61440
ds_read_b64_tr_b16 a[142:143], v4 offset:62464
v_mfma_f32_32x32x16_bf16 v[192:207], a[152:155], a[76:79], v[192:207]
buffer_load_dwordx4 a[44:47], v8, s[8:11], s30 offen offset:3072 sc1
v_mfma_f32_32x32x16_bf16 v[208:223], a[152:155], a[92:95], v[208:223]
v_mfma_f32_32x32x16_bf16 v[224:239], a[156:159], a[76:79], v[224:239]
buffer_load_dwordx4 a[60:63], v9, s[8:11], s30 offen offset:3072 sc1
v_mfma_f32_32x32x16_bf16 v[240:255], a[156:159], a[92:95], v[240:255]
s_waitcnt lgkmcnt(6)
v_mfma_f32_32x32x16_bf16 v[128:143], a[128:131], a[96:99], v[128:143]
ds_read_b64_tr_b16 a[144:145], v4 offset:0
v_mfma_f32_32x32x16_bf16 v[144:159], a[128:131], a[112:115], v[144:159]
ds_read_b64_tr_b16 a[146:147], v4 offset:1024
s_waitcnt lgkmcnt(6)
v_mfma_f32_32x32x16_bf16 v[128:143], a[132:135], a[100:103], v[128:143]
ds_read_b64_tr_b16 a[148:149], v4 offset:4096
v_mfma_f32_32x32x16_bf16 v[144:159], a[132:135], a[116:119], v[144:159]
ds_read_b64_tr_b16 a[150:151], v4 offset:5120
s_waitcnt lgkmcnt(6)
v_mfma_f32_32x32x16_bf16 v[128:143], a[136:139], a[104:107], v[128:143]
ds_read_b64_tr_b16 a[152:153], v4 offset:8192
v_mfma_f32_32x32x16_bf16 v[144:159], a[136:139], a[120:123], v[144:159]
ds_read_b64_tr_b16 a[154:155], v4 offset:9216
s_waitcnt lgkmcnt(6)
v_mfma_f32_32x32x16_bf16 v[128:143], a[140:143], a[108:111], v[128:143]
ds_read_b64_tr_b16 a[156:157], v4 offset:12288
v_mfma_f32_32x32x16_bf16 v[144:159], a[140:143], a[124:127], v[144:159]
ds_read_b64_tr_b16 a[158:159], v4 offset:13312
s_waitcnt vmcnt(0)
s_barrier
s_waitcnt lgkmcnt(6)
v_mfma_f32_32x32x16_bf16 v[128:143], a[144:147], a[0:3], v[128:143]
ds_read_b64_tr_b16 a[128:129], v4 offset:16384
v_mfma_f32_32x32x16_bf16 v[144:159], a[144:147], a[16:19], v[144:159]
ds_read_b64_tr_b16 a[130:131], v4 offset:17408
s_waitcnt lgkmcnt(6)
v_mfma_f32_32x32x16_bf16 v[128:143], a[148:151], a[4:7], v[128:143]
ds_read_b64_tr_b16 a[132:133], v4 offset:20480
v_mfma_f32_32x32x16_bf16 v[144:159], a[148:151], a[20:23], v[144:159]
ds_read_b64_tr_b16 a[134:135], v4 offset:21504
s_waitcnt lgkmcnt(6)
v_mfma_f32_32x32x16_bf16 v[128:143], a[152:155], a[8:11], v[128:143]
ds_read_b64_tr_b16 a[136:137], v4 offset:24576
v_mfma_f32_32x32x16_bf16 v[144:159], a[152:155], a[24:27], v[144:159]
ds_read_b64_tr_b16 a[138:139], v4 offset:25600
s_waitcnt lgkmcnt(6)
v_mfma_f32_32x32x16_bf16 v[128:143], a[156:159], a[12:15], v[128:143]
ds_read_b64_tr_b16 a[140:141], v4 offset:28672
v_mfma_f32_32x32x16_bf16 v[144:159], a[156:159], a[28:31], v[144:159]
ds_read_b64_tr_b16 a[142:143], v4 offset:29696
s_waitcnt lgkmcnt(6)
v_mfma_f32_32x32x16_bf16 v[128:143], a[128:131], a[32:35], v[128:143]
ds_read_b64_tr_b16 a[144:145], v5 offset:49152
v_mfma_f32_32x32x16_bf16 v[144:159], a[128:131], a[48:51], v[144:159]
ds_read_b64_tr_b16 a[146:147], v5 offset:50176
s_waitcnt lgkmcnt(6)
v_mfma_f32_32x32x16_bf16 v[128:143], a[132:135], a[36:39], v[128:143]
ds_read_b64_tr_b16 a[148:149], v5 offset:53248
v_mfma_f32_32x32x16_bf16 v[144:159], a[132:135], a[52:55], v[144:159]
ds_read_b64_tr_b16 a[150:151], v5 offset:54272
s_waitcnt lgkmcnt(6)
v_mfma_f32_32x32x16_bf16 v[128:143], a[136:139], a[40:43], v[128:143]
ds_read_b64_tr_b16 a[152:153], v5 offset:57344
v_mfma_f32_32x32x16_bf16 v[144:159], a[136:139], a[56:59], v[144:159]
ds_read_b64_tr_b16 a[154:155], v5 offset:58368
s_waitcnt lgkmcnt(6)
v_mfma_f32_32x32x16_bf16 v[128:143], a[140:143], a[44:47], v[128:143]
ds_read_b64_tr_b16 a[156:157], v5 offset:61440
v_mfma_f32_32x32x16_bf16 v[144:159], a[140:143], a[60:63], v[144:159]
ds_read_b64_tr_b16 a[158:159], v5 offset:62464
s_waitcnt lgkmcnt(6)
v_mfma_f32_32x32x16_bf16 v[160:175], a[144:147], a[96:99], v[160:175]
ds_read_b64_tr_b16 a[128:129], v5 offset:0
v_mfma_f32_32x32x16_bf16 v[176:191], a[144:147], a[112:115], v[176:191]
ds_read_b64_tr_b16 a[130:131], v5 offset:1024
s_waitcnt lgkmcnt(6)
v_mfma_f32_32x32x16_bf16 v[160:175], a[148:151], a[100:103], v[160:175]
ds_read_b64_tr_b16 a[132:133], v5 offset:4096
v_mfma_f32_32x32x16_bf16 v[176:191], a[148:151], a[116:119], v[176:191]
ds_read_b64_tr_b16 a[134:135], v5 offset:5120
s_waitcnt lgkmcnt(6)
v_mfma_f32_32x32x16_bf16 v[160:175], a[152:155], a[104:107], v[160:175]
ds_read_b64_tr_b16 a[136:137], v5 offset:8192
v_cvt_pk_bf16_f32 v16, v128, v129
v_mfma_f32_32x32x16_bf16 v[176:191], a[152:155], a[120:123], v[176:191]
ds_read_b64_tr_b16 a[138:139], v5 offset:9216
v_cvt_pk_bf16_f32 v17, v130, v131
s_waitcnt lgkmcnt(6)
v_mfma_f32_32x32x16_bf16 v[160:175], a[156:159], a[108:111], v[160:175]
ds_read_b64_tr_b16 a[140:141], v5 offset:12288
v_cvt_pk_bf16_f32 v18, v132, v133
v_mfma_f32_32x32x16_bf16 v[176:191], a[156:159], a[124:127], v[176:191]
ds_read_b64_tr_b16 a[142:143], v5 offset:13312
v_cvt_pk_bf16_f32 v19, v134, v135
s_waitcnt lgkmcnt(6)
v_mfma_f32_32x32x16_bf16 v[160:175], a[128:131], a[0:3], v[160:175]
ds_read_b64_tr_b16 a[144:145], v5 offset:16384
buffer_store_dwordx4 v[16:19], v8, s[16:19], s36 offen offset:0 sc1
v_mfma_f32_32x32x16_bf16 v[176:191], a[128:131], a[16:19], v[176:191]
ds_read_b64_tr_b16 a[146:147], v5 offset:17408
v_cvt_pk_bf16_f32 v20, v136, v137
s_waitcnt lgkmcnt(6)
v_mfma_f32_32x32x16_bf16 v[160:175], a[132:135], a[4:7], v[160:175]
ds_read_b64_tr_b16 a[148:149], v5 offset:20480
v_cvt_pk_bf16_f32 v21, v138, v139
v_mfma_f32_32x32x16_bf16 v[176:191], a[132:135], a[20:23], v[176:191]
ds_read_b64_tr_b16 a[150:151], v5 offset:21504
v_cvt_pk_bf16_f32 v22, v140, v141
s_waitcnt lgkmcnt(6)
v_mfma_f32_32x32x16_bf16 v[160:175], a[136:139], a[8:11], v[160:175]
ds_read_b64_tr_b16 a[152:153], v5 offset:24576
v_cvt_pk_bf16_f32 v23, v142, v143
v_mfma_f32_32x32x16_bf16 v[176:191], a[136:139], a[24:27], v[176:191]
ds_read_b64_tr_b16 a[154:155], v5 offset:25600
buffer_store_dwordx4 v[20:23], v8, s[16:19], s36 offen offset:1024 sc1
s_waitcnt lgkmcnt(6)
v_mfma_f32_32x32x16_bf16 v[160:175], a[140:143], a[12:15], v[160:175]
ds_read_b64_tr_b16 a[156:157], v5 offset:28672
v_cvt_pk_bf16_f32 v24, v144, v145
v_mfma_f32_32x32x16_bf16 v[176:191], a[140:143], a[28:31], v[176:191]
ds_read_b64_tr_b16 a[158:159], v5 offset:29696
v_cvt_pk_bf16_f32 v25, v146, v147
s_waitcnt lgkmcnt(6)
v_mfma_f32_32x32x16_bf16 v[160:175], a[144:147], a[32:35], v[160:175]
ds_read_b64_tr_b16 a[128:129], v6 offset:49152
v_cvt_pk_bf16_f32 v26, v148, v149
v_mfma_f32_32x32x16_bf16 v[176:191], a[144:147], a[48:51], v[176:191]
ds_read_b64_tr_b16 a[130:131], v6 offset:50176
v_cvt_pk_bf16_f32 v27, v150, v151
s_waitcnt lgkmcnt(6)
v_mfma_f32_32x32x16_bf16 v[160:175], a[148:151], a[36:39], v[160:175]
ds_read_b64_tr_b16 a[132:133], v6 offset:53248
buffer_store_dwordx4 v[24:27], v8, s[16:19], s37 offen offset:0 sc1
v_mfma_f32_32x32x16_bf16 v[176:191], a[148:151], a[52:55], v[176:191]
ds_read_b64_tr_b16 a[134:135], v6 offset:54272
v_cvt_pk_bf16_f32 v28, v152, v153
s_waitcnt lgkmcnt(6)
v_mfma_f32_32x32x16_bf16 v[160:175], a[152:155], a[40:43], v[160:175]
ds_read_b64_tr_b16 a[136:137], v6 offset:57344
v_cvt_pk_bf16_f32 v29, v154, v155
v_mfma_f32_32x32x16_bf16 v[176:191], a[152:155], a[56:59], v[176:191]
ds_read_b64_tr_b16 a[138:139], v6 offset:58368
v_cvt_pk_bf16_f32 v30, v156, v157
s_waitcnt lgkmcnt(6)
v_mfma_f32_32x32x16_bf16 v[160:175], a[156:159], a[44:47], v[160:175]
ds_read_b64_tr_b16 a[140:141], v6 offset:61440
v_cvt_pk_bf16_f32 v31, v158, v159
v_mfma_f32_32x32x16_bf16 v[176:191], a[156:159], a[60:63], v[176:191]
ds_read_b64_tr_b16 a[142:143], v6 offset:62464
buffer_store_dwordx4 v[28:31], v8, s[16:19], s37 offen offset:1024 sc1
s_waitcnt lgkmcnt(6)
v_mfma_f32_32x32x16_bf16 v[192:207], a[128:131], a[96:99], v[192:207]
ds_read_b64_tr_b16 a[144:145], v6 offset:0
v_mfma_f32_32x32x16_bf16 v[208:223], a[128:131], a[112:115], v[208:223]
ds_read_b64_tr_b16 a[146:147], v6 offset:1024
s_waitcnt lgkmcnt(6)
v_mfma_f32_32x32x16_bf16 v[192:207], a[132:135], a[100:103], v[192:207]
ds_read_b64_tr_b16 a[148:149], v6 offset:4096
v_mfma_f32_32x32x16_bf16 v[208:223], a[132:135], a[116:119], v[208:223]
ds_read_b64_tr_b16 a[150:151], v6 offset:5120
s_waitcnt lgkmcnt(6)
v_mfma_f32_32x32x16_bf16 v[192:207], a[136:139], a[104:107], v[192:207]
ds_read_b64_tr_b16 a[152:153], v6 offset:8192
v_cvt_pk_bf16_f32 v32, v160, v161
v_mfma_f32_32x32x16_bf16 v[208:223], a[136:139], a[120:123], v[208:223]
ds_read_b64_tr_b16 a[154:155], v6 offset:9216
v_cvt_pk_bf16_f32 v33, v162, v163
s_waitcnt lgkmcnt(6)
v_mfma_f32_32x32x16_bf16 v[192:207], a[140:143], a[108:111], v[192:207]
ds_read_b64_tr_b16 a[156:157], v6 offset:12288
v_cvt_pk_bf16_f32 v34, v164, v165
v_mfma_f32_32x32x16_bf16 v[208:223], a[140:143], a[124:127], v[208:223]
ds_read_b64_tr_b16 a[158:159], v6 offset:13312
v_cvt_pk_bf16_f32 v35, v166, v167
s_waitcnt lgkmcnt(6)
v_mfma_f32_32x32x16_bf16 v[192:207], a[144:147], a[0:3], v[192:207]
ds_read_b64_tr_b16 a[128:129], v6 offset:16384
buffer_store_dwordx4 v[32:35], v8, s[16:19], s36 offen offset:2048 sc1
v_mfma_f32_32x32x16_bf16 v[208:223], a[144:147], a[16:19], v[208:223]
ds_read_b64_tr_b16 a[130:131], v6 offset:17408
v_cvt_pk_bf16_f32 v36, v168, v169
s_waitcnt lgkmcnt(6)
v_mfma_f32_32x32x16_bf16 v[192:207], a[148:151], a[4:7], v[192:207]
ds_read_b64_tr_b16 a[132:133], v6 offset:20480
v_cvt_pk_bf16_f32 v37, v170, v171
v_mfma_f32_32x32x16_bf16 v[208:223], a[148:151], a[20:23], v[208:223]
ds_read_b64_tr_b16 a[134:135], v6 offset:21504
v_cvt_pk_bf16_f32 v38, v172, v173
s_waitcnt lgkmcnt(6)
v_mfma_f32_32x32x16_bf16 v[192:207], a[152:155], a[8:11], v[192:207]
ds_read_b64_tr_b16 a[136:137], v6 offset:24576
v_cvt_pk_bf16_f32 v39, v174, v175
v_mfma_f32_32x32x16_bf16 v[208:223], a[152:155], a[24:27], v[208:223]
ds_read_b64_tr_b16 a[138:139], v6 offset:25600
buffer_store_dwordx4 v[36:39], v8, s[16:19], s36 offen offset:3072 sc1
s_waitcnt lgkmcnt(6)
v_mfma_f32_32x32x16_bf16 v[192:207], a[156:159], a[12:15], v[192:207]
ds_read_b64_tr_b16 a[140:141], v6 offset:28672
v_cvt_pk_bf16_f32 v40, v176, v177
v_mfma_f32_32x32x16_bf16 v[208:223], a[156:159], a[28:31], v[208:223]
ds_read_b64_tr_b16 a[142:143], v6 offset:29696
v_cvt_pk_bf16_f32 v41, v178, v179
s_waitcnt lgkmcnt(6)
v_mfma_f32_32x32x16_bf16 v[192:207], a[128:131], a[32:35], v[192:207]
ds_read_b64_tr_b16 a[144:145], v7 offset:49152
v_cvt_pk_bf16_f32 v42, v180, v181
v_mfma_f32_32x32x16_bf16 v[208:223], a[128:131], a[48:51], v[208:223]
ds_read_b64_tr_b16 a[146:147], v7 offset:50176
v_cvt_pk_bf16_f32 v43, v182, v183
s_waitcnt lgkmcnt(6)
v_mfma_f32_32x32x16_bf16 v[192:207], a[132:135], a[36:39], v[192:207]
ds_read_b64_tr_b16 a[148:149], v7 offset:53248
buffer_store_dwordx4 v[40:43], v8, s[16:19], s37 offen offset:2048 sc1
v_mfma_f32_32x32x16_bf16 v[208:223], a[132:135], a[52:55], v[208:223]
ds_read_b64_tr_b16 a[150:151], v7 offset:54272
v_cvt_pk_bf16_f32 v44, v184, v185
s_waitcnt lgkmcnt(6)
v_mfma_f32_32x32x16_bf16 v[192:207], a[136:139], a[40:43], v[192:207]
ds_read_b64_tr_b16 a[152:153], v7 offset:57344
v_cvt_pk_bf16_f32 v45, v186, v187
v_mfma_f32_32x32x16_bf16 v[208:223], a[136:139], a[56:59], v[208:223]
ds_read_b64_tr_b16 a[154:155], v7 offset:58368
v_cvt_pk_bf16_f32 v46, v188, v189
s_waitcnt lgkmcnt(6)
v_mfma_f32_32x32x16_bf16 v[192:207], a[140:143], a[44:47], v[192:207]
ds_read_b64_tr_b16 a[156:157], v7 offset:61440
v_cvt_pk_bf16_f32 v47, v190, v191
v_mfma_f32_32x32x16_bf16 v[208:223], a[140:143], a[60:63], v[208:223]
ds_read_b64_tr_b16 a[158:159], v7 offset:62464
buffer_store_dwordx4 v[44:47], v8, s[16:19], s37 offen offset:3072 sc1
s_waitcnt lgkmcnt(6)
v_mfma_f32_32x32x16_bf16 v[224:239], a[144:147], a[96:99], v[224:239]
ds_read_b64_tr_b16 a[128:129], v7 offset:0
v_mfma_f32_32x32x16_bf16 v[240:255], a[144:147], a[112:115], v[240:255]
ds_read_b64_tr_b16 a[130:131], v7 offset:1024
s_waitcnt lgkmcnt(6)
v_mfma_f32_32x32x16_bf16 v[224:239], a[148:151], a[100:103], v[224:239]
ds_read_b64_tr_b16 a[132:133], v7 offset:4096
v_mfma_f32_32x32x16_bf16 v[240:255], a[148:151], a[116:119], v[240:255]
ds_read_b64_tr_b16 a[134:135], v7 offset:5120
s_waitcnt lgkmcnt(6)
v_mfma_f32_32x32x16_bf16 v[224:239], a[152:155], a[104:107], v[224:239]
ds_read_b64_tr_b16 a[136:137], v7 offset:8192
v_cvt_pk_bf16_f32 v16, v192, v193
v_mfma_f32_32x32x16_bf16 v[240:255], a[152:155], a[120:123], v[240:255]
ds_read_b64_tr_b16 a[138:139], v7 offset:9216
v_cvt_pk_bf16_f32 v17, v194, v195
s_waitcnt lgkmcnt(6)
v_mfma_f32_32x32x16_bf16 v[224:239], a[156:159], a[108:111], v[224:239]
ds_read_b64_tr_b16 a[140:141], v7 offset:12288
v_cvt_pk_bf16_f32 v18, v196, v197
v_mfma_f32_32x32x16_bf16 v[240:255], a[156:159], a[124:127], v[240:255]
ds_read_b64_tr_b16 a[142:143], v7 offset:13312
v_cvt_pk_bf16_f32 v19, v198, v199
s_waitcnt lgkmcnt(6)
v_mfma_f32_32x32x16_bf16 v[224:239], a[128:131], a[0:3], v[224:239]
ds_read_b64_tr_b16 a[144:145], v7 offset:16384
buffer_store_dwordx4 v[16:19], v14, s[16:19], s36 offen offset:0 sc1
v_mfma_f32_32x32x16_bf16 v[240:255], a[128:131], a[16:19], v[240:255]
ds_read_b64_tr_b16 a[146:147], v7 offset:17408
v_cvt_pk_bf16_f32 v20, v200, v201
s_waitcnt lgkmcnt(6)
v_mfma_f32_32x32x16_bf16 v[224:239], a[132:135], a[4:7], v[224:239]
ds_read_b64_tr_b16 a[148:149], v7 offset:20480
v_cvt_pk_bf16_f32 v21, v202, v203
v_mfma_f32_32x32x16_bf16 v[240:255], a[132:135], a[20:23], v[240:255]
ds_read_b64_tr_b16 a[150:151], v7 offset:21504
v_cvt_pk_bf16_f32 v22, v204, v205
s_waitcnt lgkmcnt(6)
v_mfma_f32_32x32x16_bf16 v[224:239], a[136:139], a[8:11], v[224:239]
ds_read_b64_tr_b16 a[152:153], v7 offset:24576
v_cvt_pk_bf16_f32 v23, v206, v207
v_mfma_f32_32x32x16_bf16 v[240:255], a[136:139], a[24:27], v[240:255]
ds_read_b64_tr_b16 a[154:155], v7 offset:25600
buffer_store_dwordx4 v[20:23], v14, s[16:19], s36 offen offset:1024 sc1
s_waitcnt lgkmcnt(6)
v_mfma_f32_32x32x16_bf16 v[224:239], a[140:143], a[12:15], v[224:239]
ds_read_b64_tr_b16 a[156:157], v7 offset:28672
v_cvt_pk_bf16_f32 v24, v208, v209
v_mfma_f32_32x32x16_bf16 v[240:255], a[140:143], a[28:31], v[240:255]
ds_read_b64_tr_b16 a[158:159], v7 offset:29696
v_cvt_pk_bf16_f32 v25, v210, v211
s_waitcnt lgkmcnt(6)
v_mfma_f32_32x32x16_bf16 v[224:239], a[144:147], a[32:35], v[224:239]
v_cvt_pk_bf16_f32 v26, v212, v213
v_mfma_f32_32x32x16_bf16 v[240:255], a[144:147], a[48:51], v[240:255]
v_cvt_pk_bf16_f32 v27, v214, v215
s_waitcnt lgkmcnt(4)
v_mfma_f32_32x32x16_bf16 v[224:239], a[148:151], a[36:39], v[224:239]
buffer_store_dwordx4 v[24:27], v14, s[16:19], s37 offen offset:0 sc1
v_mfma_f32_32x32x16_bf16 v[240:255], a[148:151], a[52:55], v[240:255]
v_cvt_pk_bf16_f32 v28, v216, v217
s_waitcnt lgkmcnt(2)
v_mfma_f32_32x32x16_bf16 v[224:239], a[152:155], a[40:43], v[224:239]
v_cvt_pk_bf16_f32 v29, v218, v219
v_mfma_f32_32x32x16_bf16 v[240:255], a[152:155], a[56:59], v[240:255]
v_cvt_pk_bf16_f32 v30, v220, v221
s_waitcnt lgkmcnt(0)
v_mfma_f32_32x32x16_bf16 v[224:239], a[156:159], a[44:47], v[224:239]
v_cvt_pk_bf16_f32 v31, v222, v223
v_mfma_f32_32x32x16_bf16 v[240:255], a[156:159], a[60:63], v[240:255]
buffer_store_dwordx4 v[28:31], v14, s[16:19], s37 offen offset:1024 sc1
s_nop 7
s_nop 3
v_cvt_pk_bf16_f32 v32, v224, v225
v_cvt_pk_bf16_f32 v33, v226, v227
v_cvt_pk_bf16_f32 v34, v228, v229
v_cvt_pk_bf16_f32 v35, v230, v231
buffer_store_dwordx4 v[32:35], v14, s[16:19], s36 offen offset:2048 sc1
v_cvt_pk_bf16_f32 v36, v232, v233
v_cvt_pk_bf16_f32 v37, v234, v235
v_cvt_pk_bf16_f32 v38, v236, v237
v_cvt_pk_bf16_f32 v39, v238, v239
buffer_store_dwordx4 v[36:39], v14, s[16:19], s36 offen offset:3072 sc1
v_cvt_pk_bf16_f32 v40, v240, v241
v_cvt_pk_bf16_f32 v41, v242, v243
v_cvt_pk_bf16_f32 v42, v244, v245
v_cvt_pk_bf16_f32 v43, v246, v247
buffer_store_dwordx4 v[40:43], v14, s[16:19], s37 offen offset:2048 sc1
v_cvt_pk_bf16_f32 v44, v248, v249
v_cvt_pk_bf16_f32 v45, v250, v251
v_cvt_pk_bf16_f32 v46, v252, v253
v_cvt_pk_bf16_f32 v47, v254, v255
buffer_store_dwordx4 v[44:47], v14, s[16:19], s37 offen offset:3072 sc1
s_waitcnt vmcnt(0)
s_barrier
s_cmp_lg_u32 s26, 0
s_cbranch_scc1 adaLN_cond__sliding_block_cached__swiglu_ffn__prompt_kernel_arr_51
s_add_u32 s27, s24, 88
s_lshl_b32 s6, s27, 8
s_add_u32 s6, s6, 0x20000
s_add_u32 s6, s6, s90
s_addc_u32 s7, s91, 0
v_mov_b32 v2, 0
v_mov_b32 v3, 1
s_mov_b64 exec, 1
global_atomic_add v2, v3, s[6:7] sc1
s_mov_b64 exec, -1
adaLN_cond__sliding_block_cached__swiglu_ffn__prompt_kernel_arr_51:
v_lshrrev_b32 v2, 6, v0
v_and_b32 v3, 7, v1
v_lshrrev_b32 v4, 3, v1
v_lshrrev_b32 v5, 1, v4
v_lshlrev_b32 v5, 10, v5
v_and_b32 v6, 1, v4
v_lshl_add_u32 v5, v6, 9, v5
v_lshl_add_u32 v5, v3, 4, v5
v_lshl_add_u32 v5, v2, 14, v5
v_lshlrev_b32 v6, 11, v4
v_lshl_add_u32 v6, v3, 4, v6
v_lshl_add_u32 v6, v2, 9, v6
v_lshrrev_b32 v240, 3, v1
v_mul_u32_u24 v240, 144, v240
v_and_b32 v241, 7, v1
v_lshl_add_u32 v240, v241, 4, v240
v_mul_u32_u24 v241, 144, v241
v_lshrrev_b32 v29, 3, v1
v_lshl_add_u32 v241, v29, 4, v241
s_mul_i32 s27, s26, 4608
s_add_u32 s27, s27, 126976
v_add_u32 v240, s27, v240
v_add_u32 v241, s27, v241
v_lshlrev_b32 v7, 4, v0
v_lshlrev_b32 v8, 10, v2
v_lshl_add_u32 v8, v4, 5, v8
v_add_u32 v8, 147456, v8
v_add_u32 v11, 147456, v7
v_lshlrev_b32 v9, 5, v3
v_add_u32 v9, 159744, v9
v_lshl_add_u32 v10, v2, 3, v9
s_lshl_b32 s45, s24, 5
s_lshl_b32 s46, s22, 3
s_add_u32 s45, s45, s46
s_add_u32 s45, s45, s25
s_lshr_b32 s40, s45, 2
s_lshl_b32 s40, s40, 16
s_and_b32 s46, s45, 3
s_lshl_b32 s46, s46, 7
s_add_u32 s40, s40, s46
s_add_u32 s41, s40, 4096
s_add_u32 s42, s40, 8192
s_add_u32 s43, s40, 12288
s_lshl_b32 s44, s45, 14
s_add_u32 s8, s90, 0x10000
s_addc_u32 s9, s91, 0
s_mov_b32 s10, 0x10000
s_mov_b32 s11, 0x20000
s_mov_b32 s27, 12288
buffer_load_dwordx4 v[168:171], v7, s[8:11], s27 offen sc1
s_mov_b32 s27, 28672
buffer_load_dwordx4 v[172:175], v7, s[8:11], s27 offen sc1
s_mov_b32 s27, 45056
buffer_load_dwordx4 v[176:179], v7, s[8:11], s27 offen sc1
s_mov_b32 s27, 61440
buffer_load_dwordx4 v[180:183], v7, s[8:11], s27 offen sc1
s_add_u32 s12, s90, 0x3500000
s_addc_u32 s13, s91, 0
s_mov_b32 s14, 0x400000
s_mov_b32 s15, 0x20000
buffer_load_dwordx4 v[64:67], v5, s[12:15], s40 offen sc1
buffer_load_dwordx4 v[68:71], v5, s[12:15], s41 offen sc1
buffer_load_dwordx4 v[72:75], v5, s[12:15], s42 offen sc1
buffer_load_dwordx4 v[76:79], v5, s[12:15], s43 offen sc1
s_waitcnt vmcnt(4)
v_add_f32 v168, v168, v172
v_add_f32 v169, v169, v173
v_add_f32 v170, v170, v174
v_add_f32 v171, v171, v175
v_add_f32 v168, v168, v176
v_add_f32 v169, v169, v177
v_add_f32 v170, v170, v178
v_add_f32 v171, v171, v179
v_add_f32 v168, v168, v180
v_add_f32 v169, v169, v181
v_add_f32 v170, v170, v182
v_add_f32 v171, v171, v183
v_cvt_pk_bf16_f32 v172, v168, v169
v_cvt_pk_bf16_f32 v173, v170, v171
v_lshlrev_b32 v168, 16, v172
v_and_b32 v169, 0xffff0000, v172
v_lshlrev_b32 v170, 16, v173
v_and_b32 v171, 0xffff0000, v173
v_mul_f32 v168, 0x3ef5fdf0, v168
v_mul_f32 v169, 0x3ef5fdf0, v169
v_mul_f32 v170, 0x3ef5fdf0, v170
v_mul_f32 v171, 0x3ef5fdf0, v171
ds_write_b128 v11, v[168:171] offset:0
s_waitcnt lgkmcnt(0)
s_barrier
ds_read_b128 v[144:147], v8 offset:0
ds_read_b128 v[148:151], v8 offset:16
ds_read_b128 v[152:155], v8 offset:256
ds_read_b128 v[156:159], v8 offset:272
ds_read_b128 v[160:163], v8 offset:512
ds_read_b128 v[164:167], v8 offset:528
ds_read_b128 v[168:171], v8 offset:768
ds_read_b128 v[172:175], v8 offset:784
s_waitcnt vmcnt(0) lgkmcnt(0)
v_lshlrev_b32 v32, 16, v64
v_and_b32 v33, 0xffff0000, v64
v_lshlrev_b32 v34, 16, v65
v_and_b32 v35, 0xffff0000, v65
v_lshlrev_b32 v36, 16, v66
v_and_b32 v37, 0xffff0000, v66
v_lshlrev_b32 v38, 16, v67
v_and_b32 v39, 0xffff0000, v67
v_lshlrev_b32 v40, 16, v68
v_and_b32 v41, 0xffff0000, v68
v_lshlrev_b32 v42, 16, v69
v_and_b32 v43, 0xffff0000, v69
v_lshlrev_b32 v44, 16, v70
v_and_b32 v45, 0xffff0000, v70
v_lshlrev_b32 v46, 16, v71
v_and_b32 v47, 0xffff0000, v71
v_lshlrev_b32 v48, 16, v72
v_and_b32 v49, 0xffff0000, v72
v_lshlrev_b32 v50, 16, v73
v_and_b32 v51, 0xffff0000, v73
v_lshlrev_b32 v52, 16, v74
v_and_b32 v53, 0xffff0000, v74
v_lshlrev_b32 v54, 16, v75
v_and_b32 v55, 0xffff0000, v75
v_lshlrev_b32 v56, 16, v76
v_and_b32 v57, 0xffff0000, v76
v_lshlrev_b32 v58, 16, v77
v_and_b32 v59, 0xffff0000, v77
v_lshlrev_b32 v60, 16, v78
v_and_b32 v61, 0xffff0000, v78
v_lshlrev_b32 v62, 16, v79
v_and_b32 v63, 0xffff0000, v79
s_mov_b32 s46, 0x00003f80
s_mov_b32 s47, 0x3f800000
s_waitcnt lgkmcnt(0)
s_cmp_lg_u32 s26, 0
s_cbranch_scc1 adaLN_cond__sliding_block_cached__swiglu_ffn__prompt_kernel_ws_54
s_add_u32 s27, s24, 88
s_lshl_b32 s6, s27, 8
s_add_u32 s6, s6, 0x20000
s_add_u32 s6, s6, s90
s_addc_u32 s7, s91, 0
v_mov_b32 v2, 0
s_mov_b32 s27, 0
s_mov_b64 exec, 1
adaLN_cond__sliding_block_cached__swiglu_ffn__prompt_kernel_wt_52:
global_load_dword v3, v2, s[6:7] offset:0 sc1
s_waitcnt vmcnt(0)
v_readfirstlane_b32 s28, v3
s_add_u32 s27, s27, 1
s_cmp_ge_u32 s28, 32
s_cbranch_scc1 adaLN_cond__sliding_block_cached__swiglu_ffn__prompt_kernel_wd_53
s_cmp_ge_u32 s27, 0x40000
s_cbranch_scc1 adaLN_cond__sliding_block_cached__swiglu_ffn__prompt_kernel_wd_53
s_sleep 2
s_branch adaLN_cond__sliding_block_cached__swiglu_ffn__prompt_kernel_wt_52
adaLN_cond__sliding_block_cached__swiglu_ffn__prompt_kernel_wd_53:
s_mov_b64 exec, -1
adaLN_cond__sliding_block_cached__swiglu_ffn__prompt_kernel_ws_54:
s_barrier
s_add_u32 s12, s90, 0x4b00000
s_addc_u32 s13, s91, 0
s_mov_b32 s14, 0x1000000
s_mov_b32 s15, 0x20000
s_add_u32 s27, s40, 0x0
buffer_load_dwordx4 v[80:83], v5, s[12:15], s27 offen sc1
s_add_u32 s27, s40, 0x400000
buffer_load_dwordx4 v[96:99], v5, s[12:15], s27 offen sc1
s_add_u32 s27, s40, 0x800000
buffer_load_dwordx4 v[112:115], v5, s[12:15], s27 offen sc1
s_add_u32 s27, s40, 0xc00000
buffer_load_dwordx4 v[128:131], v5, s[12:15], s27 offen sc1
s_add_u32 s27, s41, 0x0
buffer_load_dwordx4 v[84:87], v5, s[12:15], s27 offen sc1
s_add_u32 s27, s41, 0x400000
buffer_load_dwordx4 v[100:103], v5, s[12:15], s27 offen sc1
s_add_u32 s27, s41, 0x800000
buffer_load_dwordx4 v[116:119], v5, s[12:15], s27 offen sc1
s_add_u32 s27, s41, 0xc00000
buffer_load_dwordx4 v[132:135], v5, s[12:15], s27 offen sc1
s_add_u32 s27, s42, 0x0
buffer_load_dwordx4 v[88:91], v5, s[12:15], s27 offen sc1
s_add_u32 s27, s42, 0x400000
buffer_load_dwordx4 v[104:107], v5, s[12:15], s27 offen sc1
s_add_u32 s27, s42, 0x800000
buffer_load_dwordx4 v[120:123], v5, s[12:15], s27 offen sc1
s_add_u32 s27, s42, 0xc00000
buffer_load_dwordx4 v[136:139], v5, s[12:15], s27 offen sc1
s_add_u32 s27, s43, 0x0
buffer_load_dwordx4 v[92:95], v5, s[12:15], s27 offen sc1
s_add_u32 s27, s43, 0x400000
buffer_load_dwordx4 v[108:111], v5, s[12:15], s27 offen sc1
s_add_u32 s27, s43, 0x800000
buffer_load_dwordx4 v[124:127], v5, s[12:15], s27 offen sc1
s_add_u32 s27, s43, 0xc00000
buffer_load_dwordx4 v[140:143], v5, s[12:15], s27 offen sc1
s_waitcnt vmcnt(12)
v_dot2_f32_bf16 v20, v80, s46, 0
v_dot2_f32_bf16 v21, v80, s47, 0
v_dot2_f32_bf16 v20, v96, s46, v20
v_dot2_f32_bf16 v21, v96, s47, v21
v_dot2_f32_bf16 v20, v112, s46, v20
v_dot2_f32_bf16 v21, v112, s47, v21
v_dot2_f32_bf16 v20, v128, s46, v20
v_dot2_f32_bf16 v21, v128, s47, v21
v_dot2_f32_bf16 v22, v81, s46, 0
v_dot2_f32_bf16 v23, v81, s47, 0
v_dot2_f32_bf16 v22, v97, s46, v22
v_dot2_f32_bf16 v23, v97, s47, v23
v_dot2_f32_bf16 v22, v113, s46, v22
v_dot2_f32_bf16 v23, v113, s47, v23
v_dot2_f32_bf16 v22, v129, s46, v22
v_dot2_f32_bf16 v23, v129, s47, v23
v_fmac_f32 v32, v20, v144
v_fmac_f32 v33, v21, v145
v_dot2_f32_bf16 v20, v82, s46, 0
v_dot2_f32_bf16 v21, v82, s47, 0
v_dot2_f32_bf16 v20, v98, s46, v20
v_dot2_f32_bf16 v21, v98, s47, v21
v_dot2_f32_bf16 v20, v114, s46, v20
v_dot2_f32_bf16 v21, v114, s47, v21
v_dot2_f32_bf16 v20, v130, s46, v20
v_dot2_f32_bf16 v21, v130, s47, v21
v_fmac_f32 v34, v22, v146
v_fmac_f32 v35, v23, v147
v_dot2_f32_bf16 v22, v83, s46, 0
v_dot2_f32_bf16 v23, v83, s47, 0
v_dot2_f32_bf16 v22, v99, s46, v22
v_dot2_f32_bf16 v23, v99, s47, v23
v_dot2_f32_bf16 v22, v115, s46, v22
v_dot2_f32_bf16 v23, v115, s47, v23
v_dot2_f32_bf16 v22, v131, s46, v22
v_dot2_f32_bf16 v23, v131, s47, v23
v_fmac_f32 v36, v20, v148
v_fmac_f32 v37, v21, v149
s_nop 2
v_fmac_f32 v38, v22, v150
v_fmac_f32 v39, v23, v151
v_cvt_pk_bf16_f32 v64, v32, v33
v_cvt_pk_bf16_f32 v65, v34, v35
v_cvt_pk_bf16_f32 v66, v36, v37
v_cvt_pk_bf16_f32 v67, v38, v39
s_waitcnt vmcnt(8)
v_dot2_f32_bf16 v20, v84, s46, 0
v_dot2_f32_bf16 v21, v84, s47, 0
v_dot2_f32_bf16 v20, v100, s46, v20
v_dot2_f32_bf16 v21, v100, s47, v21
v_dot2_f32_bf16 v20, v116, s46, v20
v_dot2_f32_bf16 v21, v116, s47, v21
v_dot2_f32_bf16 v20, v132, s46, v20
v_dot2_f32_bf16 v21, v132, s47, v21
v_dot2_f32_bf16 v22, v85, s46, 0
v_dot2_f32_bf16 v23, v85, s47, 0
v_dot2_f32_bf16 v22, v101, s46, v22
v_dot2_f32_bf16 v23, v101, s47, v23
v_dot2_f32_bf16 v22, v117, s46, v22
v_dot2_f32_bf16 v23, v117, s47, v23
v_dot2_f32_bf16 v22, v133, s46, v22
v_dot2_f32_bf16 v23, v133, s47, v23
v_fmac_f32 v40, v20, v152
v_fmac_f32 v41, v21, v153
v_dot2_f32_bf16 v20, v86, s46, 0
v_dot2_f32_bf16 v21, v86, s47, 0
v_dot2_f32_bf16 v20, v102, s46, v20
v_dot2_f32_bf16 v21, v102, s47, v21
v_dot2_f32_bf16 v20, v118, s46, v20
v_dot2_f32_bf16 v21, v118, s47, v21
v_dot2_f32_bf16 v20, v134, s46, v20
v_dot2_f32_bf16 v21, v134, s47, v21
v_fmac_f32 v42, v22, v154
v_fmac_f32 v43, v23, v155
v_dot2_f32_bf16 v22, v87, s46, 0
v_dot2_f32_bf16 v23, v87, s47, 0
v_dot2_f32_bf16 v22, v103, s46, v22
v_dot2_f32_bf16 v23, v103, s47, v23
v_dot2_f32_bf16 v22, v119, s46, v22
v_dot2_f32_bf16 v23, v119, s47, v23
v_dot2_f32_bf16 v22, v135, s46, v22
v_dot2_f32_bf16 v23, v135, s47, v23
v_fmac_f32 v44, v20, v156
v_fmac_f32 v45, v21, v157
s_nop 2
v_fmac_f32 v46, v22, v158
v_fmac_f32 v47, v23, v159
v_cvt_pk_bf16_f32 v68, v40, v41
v_cvt_pk_bf16_f32 v69, v42, v43
v_cvt_pk_bf16_f32 v70, v44, v45
v_cvt_pk_bf16_f32 v71, v46, v47
s_waitcnt vmcnt(4)
v_dot2_f32_bf16 v20, v88, s46, 0
v_dot2_f32_bf16 v21, v88, s47, 0
v_dot2_f32_bf16 v20, v104, s46, v20
v_dot2_f32_bf16 v21, v104, s47, v21
v_dot2_f32_bf16 v20, v120, s46, v20
v_dot2_f32_bf16 v21, v120, s47, v21
v_dot2_f32_bf16 v20, v136, s46, v20
v_dot2_f32_bf16 v21, v136, s47, v21
v_dot2_f32_bf16 v22, v89, s46, 0
v_dot2_f32_bf16 v23, v89, s47, 0
v_dot2_f32_bf16 v22, v105, s46, v22
v_dot2_f32_bf16 v23, v105, s47, v23
v_dot2_f32_bf16 v22, v121, s46, v22
v_dot2_f32_bf16 v23, v121, s47, v23
v_dot2_f32_bf16 v22, v137, s46, v22
v_dot2_f32_bf16 v23, v137, s47, v23
v_fmac_f32 v48, v20, v160
v_fmac_f32 v49, v21, v161
v_dot2_f32_bf16 v20, v90, s46, 0
v_dot2_f32_bf16 v21, v90, s47, 0
v_dot2_f32_bf16 v20, v106, s46, v20
v_dot2_f32_bf16 v21, v106, s47, v21
v_dot2_f32_bf16 v20, v122, s46, v20
v_dot2_f32_bf16 v21, v122, s47, v21
v_dot2_f32_bf16 v20, v138, s46, v20
v_dot2_f32_bf16 v21, v138, s47, v21
v_fmac_f32 v50, v22, v162
v_fmac_f32 v51, v23, v163
v_dot2_f32_bf16 v22, v91, s46, 0
v_dot2_f32_bf16 v23, v91, s47, 0
v_dot2_f32_bf16 v22, v107, s46, v22
v_dot2_f32_bf16 v23, v107, s47, v23
v_dot2_f32_bf16 v22, v123, s46, v22
v_dot2_f32_bf16 v23, v123, s47, v23
v_dot2_f32_bf16 v22, v139, s46, v22
v_dot2_f32_bf16 v23, v139, s47, v23
v_fmac_f32 v52, v20, v164
v_fmac_f32 v53, v21, v165
s_nop 2
v_fmac_f32 v54, v22, v166
v_fmac_f32 v55, v23, v167
v_cvt_pk_bf16_f32 v72, v48, v49
v_cvt_pk_bf16_f32 v73, v50, v51
v_cvt_pk_bf16_f32 v74, v52, v53
v_cvt_pk_bf16_f32 v75, v54, v55
s_waitcnt vmcnt(0)
v_dot2_f32_bf16 v20, v92, s46, 0
v_dot2_f32_bf16 v21, v92, s47, 0
v_dot2_f32_bf16 v20, v108, s46, v20
v_dot2_f32_bf16 v21, v108, s47, v21
v_dot2_f32_bf16 v20, v124, s46, v20
v_dot2_f32_bf16 v21, v124, s47, v21
v_dot2_f32_bf16 v20, v140, s46, v20
v_dot2_f32_bf16 v21, v140, s47, v21
v_dot2_f32_bf16 v22, v93, s46, 0
v_dot2_f32_bf16 v23, v93, s47, 0
v_dot2_f32_bf16 v22, v109, s46, v22
v_dot2_f32_bf16 v23, v109, s47, v23
v_dot2_f32_bf16 v22, v125, s46, v22
v_dot2_f32_bf16 v23, v125, s47, v23
v_dot2_f32_bf16 v22, v141, s46, v22
v_dot2_f32_bf16 v23, v141, s47, v23
v_fmac_f32 v56, v20, v168
v_fmac_f32 v57, v21, v169
v_dot2_f32_bf16 v20, v94, s46, 0
v_dot2_f32_bf16 v21, v94, s47, 0
v_dot2_f32_bf16 v20, v110, s46, v20
v_dot2_f32_bf16 v21, v110, s47, v21
v_dot2_f32_bf16 v20, v126, s46, v20
v_dot2_f32_bf16 v21, v126, s47, v21
v_dot2_f32_bf16 v20, v142, s46, v20
v_dot2_f32_bf16 v21, v142, s47, v21
v_fmac_f32 v58, v22, v170
v_fmac_f32 v59, v23, v171
v_dot2_f32_bf16 v22, v95, s46, 0
v_dot2_f32_bf16 v23, v95, s47, 0
v_dot2_f32_bf16 v22, v111, s46, v22
v_dot2_f32_bf16 v23, v111, s47, v23
v_dot2_f32_bf16 v22, v127, s46, v22
v_dot2_f32_bf16 v23, v127, s47, v23
v_dot2_f32_bf16 v22, v143, s46, v22
v_dot2_f32_bf16 v23, v143, s47, v23
v_fmac_f32 v60, v20, v172
v_fmac_f32 v61, v21, v173
s_nop 2
v_fmac_f32 v62, v22, v174
v_fmac_f32 v63, v23, v175
v_cvt_pk_bf16_f32 v76, v56, v57
v_cvt_pk_bf16_f32 v77, v58, v59
v_cvt_pk_bf16_f32 v78, v60, v61
v_cvt_pk_bf16_f32 v79, v62, v63
s_mov_b32 s12, s86
s_mov_b32 s13, s87
s_mov_b32 s14, 0x400000
s_mov_b32 s15, 0x20000
ds_write_b128 v240, v[64:67] offset:0
ds_write_b128 v240, v[68:71] offset:1152
ds_write_b128 v240, v[72:75] offset:2304
ds_write_b128 v240, v[76:79] offset:3456
s_waitcnt lgkmcnt(0)
ds_read_b128 v[64:67], v241 offset:0
ds_read_b128 v[68:71], v241 offset:1152
ds_read_b128 v[72:75], v241 offset:2304
ds_read_b128 v[76:79], v241 offset:3456
s_waitcnt lgkmcnt(0)
buffer_store_dwordx4 v[64:67], v6, s[12:15], s44 offen offset:0 sc1
buffer_store_dwordx4 v[68:71], v6, s[12:15], s44 offen offset:128 sc1
buffer_store_dwordx4 v[72:75], v6, s[12:15], s44 offen offset:256 sc1
buffer_store_dwordx4 v[76:79], v6, s[12:15], s44 offen offset:384 sc1
s_endpgm
adaLN_cond__sliding_block_cached__swiglu_ffn__prompt_kernel_slow:
s_mov_b32 s59, 1
s_lshl_b32 s27, s22, 17
s_add_u32 s28, s27, 0x5b00000
s_add_u32 s44, s90, s28
s_addc_u32 s45, s91, 0
s_mov_b32 s46, 0x20000
s_mov_b32 s47, 0x20000
s_mov_b32 s58, 0
adaLN_cond__sliding_block_cached__swiglu_ffn__prompt_kernel_slow_55:
s_add_u32 s27, s58, 4096
buffer_load_dwordx4 a[128:131], v8, s[44:47], s58 offen offset:0 sc1
buffer_load_dwordx4 a[132:135], v8, s[44:47], s58 offen offset:1024 sc1
buffer_load_dwordx4 a[136:139], v8, s[44:47], s58 offen offset:2048 sc1
buffer_load_dwordx4 a[140:143], v8, s[44:47], s58 offen offset:3072 sc1
buffer_load_dwordx4 a[144:147], v8, s[44:47], s27 offen offset:0 sc1
buffer_load_dwordx4 a[148:151], v8, s[44:47], s27 offen offset:1024 sc1
buffer_load_dwordx4 a[152:155], v8, s[44:47], s27 offen offset:2048 sc1
buffer_load_dwordx4 a[156:159], v8, s[44:47], s27 offen offset:3072 sc1
s_waitcnt vmcnt(0)
v_mfma_f32_32x32x16_bf16 v[128:143], a[128:131], v[64:67], 0
v_mfma_f32_32x32x16_bf16 v[128:143], a[132:135], v[68:71], v[128:143]
v_mfma_f32_32x32x16_bf16 v[128:143], a[136:139], v[72:75], v[128:143]
v_mfma_f32_32x32x16_bf16 v[128:143], a[140:143], v[76:79], v[128:143]
v_mfma_f32_32x32x16_bf16 v[128:143], a[144:147], v[80:83], v[128:143]
v_mfma_f32_32x32x16_bf16 v[128:143], a[148:151], v[84:87], v[128:143]
v_mfma_f32_32x32x16_bf16 v[128:143], a[152:155], v[88:91], v[128:143]
v_mfma_f32_32x32x16_bf16 v[128:143], a[156:159], v[92:95], v[128:143]
v_mfma_f32_32x32x16_bf16 v[144:159], a[128:131], v[96:99], 0
v_mfma_f32_32x32x16_bf16 v[144:159], a[132:135], v[100:103], v[144:159]
v_mfma_f32_32x32x16_bf16 v[144:159], a[136:139], v[104:107], v[144:159]
v_mfma_f32_32x32x16_bf16 v[144:159], a[140:143], v[108:111], v[144:159]
v_mfma_f32_32x32x16_bf16 v[144:159], a[144:147], v[112:115], v[144:159]
v_mfma_f32_32x32x16_bf16 v[144:159], a[148:151], v[116:119], v[144:159]
v_mfma_f32_32x32x16_bf16 v[144:159], a[152:155], v[120:123], v[144:159]
v_mfma_f32_32x32x16_bf16 v[144:159], a[156:159], v[124:127], v[144:159]
s_nop 7
s_nop 7
v_max3_f32 v37, v37, v128, v129
v_max3_f32 v37, v37, v130, v131
v_max3_f32 v37, v37, v132, v133
v_max3_f32 v37, v37, v134, v135
v_max3_f32 v37, v37, v136, v137
v_max3_f32 v37, v37, v138, v139
v_max3_f32 v37, v37, v140, v141
v_max3_f32 v37, v37, v142, v143
v_max3_f32 v38, v38, v144, v145
v_max3_f32 v38, v38, v146, v147
v_max3_f32 v38, v38, v148, v149
v_max3_f32 v38, v38, v150, v151
v_max3_f32 v38, v38, v152, v153
v_max3_f32 v38, v38, v154, v155
v_max3_f32 v38, v38, v156, v157
v_max3_f32 v38, v38, v158, v159
s_add_u32 s58, s58, 8192
s_cmp_lt_u32 s58, 0x20000
s_cbranch_scc1 adaLN_cond__sliding_block_cached__swiglu_ffn__prompt_kernel_slow_55
v_add_u32 v16, 65536, v8
v_add_u32 v17, 114688, v8
v_accvgpr_write_b32 a0, 0
v_accvgpr_write_b32 a1, 0
v_accvgpr_write_b32 a2, 0
v_accvgpr_write_b32 a3, 0
v_accvgpr_write_b32 a4, 0
v_accvgpr_write_b32 a5, 0
v_accvgpr_write_b32 a6, 0
v_accvgpr_write_b32 a7, 0
v_accvgpr_write_b32 a8, 0
v_accvgpr_write_b32 a9, 0
v_accvgpr_write_b32 a10, 0
v_accvgpr_write_b32 a11, 0
v_accvgpr_write_b32 a12, 0
v_accvgpr_write_b32 a13, 0
v_accvgpr_write_b32 a14, 0
v_accvgpr_write_b32 a15, 0
v_accvgpr_write_b32 a16, 0
v_accvgpr_write_b32 a17, 0
v_accvgpr_write_b32 a18, 0
v_accvgpr_write_b32 a19, 0
v_accvgpr_write_b32 a20, 0
v_accvgpr_write_b32 a21, 0
v_accvgpr_write_b32 a22, 0
v_accvgpr_write_b32 a23, 0
v_accvgpr_write_b32 a24, 0
v_accvgpr_write_b32 a25, 0
v_accvgpr_write_b32 a26, 0
v_accvgpr_write_b32 a27, 0
v_accvgpr_write_b32 a28, 0
v_accvgpr_write_b32 a29, 0
v_accvgpr_write_b32 a30, 0
v_accvgpr_write_b32 a31, 0
v_accvgpr_write_b32 a32, 0
v_accvgpr_write_b32 a33, 0
v_accvgpr_write_b32 a34, 0
v_accvgpr_write_b32 a35, 0
v_accvgpr_write_b32 a36, 0
v_accvgpr_write_b32 a37, 0
v_accvgpr_write_b32 a38, 0
v_accvgpr_write_b32 a39, 0
v_accvgpr_write_b32 a40, 0
v_accvgpr_write_b32 a41, 0
v_accvgpr_write_b32 a42, 0
v_accvgpr_write_b32 a43, 0
v_accvgpr_write_b32 a44, 0
v_accvgpr_write_b32 a45, 0
v_accvgpr_write_b32 a46, 0
v_accvgpr_write_b32 a47, 0
v_accvgpr_write_b32 a48, 0
v_accvgpr_write_b32 a49, 0
v_accvgpr_write_b32 a50, 0
v_accvgpr_write_b32 a51, 0
v_accvgpr_write_b32 a52, 0
v_accvgpr_write_b32 a53, 0
v_accvgpr_write_b32 a54, 0
v_accvgpr_write_b32 a55, 0
v_accvgpr_write_b32 a56, 0
v_accvgpr_write_b32 a57, 0
v_accvgpr_write_b32 a58, 0
v_accvgpr_write_b32 a59, 0
v_accvgpr_write_b32 a60, 0
v_accvgpr_write_b32 a61, 0
v_accvgpr_write_b32 a62, 0
v_accvgpr_write_b32 a63, 0
v_accvgpr_write_b32 a64, 0
v_accvgpr_write_b32 a65, 0
v_accvgpr_write_b32 a66, 0
v_accvgpr_write_b32 a67, 0
v_accvgpr_write_b32 a68, 0
v_accvgpr_write_b32 a69, 0
v_accvgpr_write_b32 a70, 0
v_accvgpr_write_b32 a71, 0
v_accvgpr_write_b32 a72, 0
v_accvgpr_write_b32 a73, 0
v_accvgpr_write_b32 a74, 0
v_accvgpr_write_b32 a75, 0
v_accvgpr_write_b32 a76, 0
v_accvgpr_write_b32 a77, 0
v_accvgpr_write_b32 a78, 0
v_accvgpr_write_b32 a79, 0
v_accvgpr_write_b32 a80, 0
v_accvgpr_write_b32 a81, 0
v_accvgpr_write_b32 a82, 0
v_accvgpr_write_b32 a83, 0
v_accvgpr_write_b32 a84, 0
v_accvgpr_write_b32 a85, 0
v_accvgpr_write_b32 a86, 0
v_accvgpr_write_b32 a87, 0
v_accvgpr_write_b32 a88, 0
v_accvgpr_write_b32 a89, 0
v_accvgpr_write_b32 a90, 0
v_accvgpr_write_b32 a91, 0
v_accvgpr_write_b32 a92, 0
v_accvgpr_write_b32 a93, 0
v_accvgpr_write_b32 a94, 0
v_accvgpr_write_b32 a95, 0
v_accvgpr_write_b32 a192, 0
v_accvgpr_write_b32 a193, 0
v_accvgpr_write_b32 a194, 0
v_accvgpr_write_b32 a195, 0
v_accvgpr_write_b32 a196, 0
v_accvgpr_write_b32 a197, 0
v_accvgpr_write_b32 a198, 0
v_accvgpr_write_b32 a199, 0
v_accvgpr_write_b32 a200, 0
v_accvgpr_write_b32 a201, 0
v_accvgpr_write_b32 a202, 0
v_accvgpr_write_b32 a203, 0
v_accvgpr_write_b32 a204, 0
v_accvgpr_write_b32 a205, 0
v_accvgpr_write_b32 a206, 0
v_accvgpr_write_b32 a207, 0
v_accvgpr_write_b32 a208, 0
v_accvgpr_write_b32 a209, 0
v_accvgpr_write_b32 a210, 0
v_accvgpr_write_b32 a211, 0
v_accvgpr_write_b32 a212, 0
v_accvgpr_write_b32 a213, 0
v_accvgpr_write_b32 a214, 0
v_accvgpr_write_b32 a215, 0
v_accvgpr_write_b32 a216, 0
v_accvgpr_write_b32 a217, 0
v_accvgpr_write_b32 a218, 0
v_accvgpr_write_b32 a219, 0
v_accvgpr_write_b32 a220, 0
v_accvgpr_write_b32 a221, 0
v_accvgpr_write_b32 a222, 0
v_accvgpr_write_b32 a223, 0
s_mov_b32 s8, s90
s_mov_b32 s9, s91
s_mov_b32 s10, 0
s_mov_b32 s12, s90
s_mov_b32 s13, s91
s_mov_b32 s14, 0
s_mov_b32 s54, s90
s_mov_b32 s55, s91
s_mov_b32 s56, 0
s_mov_b32 s57, s90
s_mov_b32 s61, s91
s_mov_b32 s63, 0
s_barrier
s_mov_b32 s52, 0
s_add_u32 m0, s32, 65536
s_nop 0
buffer_load_dwordx4 v28, s[44:47], s52 offen offset:0 sc1 lds
buffer_load_dwordx4 v28, s[44:47], s52 offen offset:1024 sc1 lds
buffer_load_dwordx4 v28, s[44:47], s52 offen offset:2048 sc1 lds
buffer_load_dwordx4 v28, s[44:47], s52 offen offset:3072 sc1 lds
s_mov_b32 s53, 0
s_add_u32 m0, s32, 114688
s_nop 0
buffer_load_dwordx4 v28, s[48:51], s53 offen offset:0 sc1 lds
buffer_load_dwordx4 v28, s[48:51], s53 offen offset:1024 sc1 lds
buffer_load_dwordx4 v28, s[48:51], s53 offen offset:2048 sc1 lds
buffer_load_dwordx4 v28, s[48:51], s53 offen offset:3072 sc1 lds
s_mov_b32 s52, 16384
s_add_u32 m0, s32, 81920
s_nop 0
buffer_load_dwordx4 v28, s[44:47], s52 offen offset:0 sc1 lds
buffer_load_dwordx4 v28, s[44:47], s52 offen offset:1024 sc1 lds
buffer_load_dwordx4 v28, s[44:47], s52 offen offset:2048 sc1 lds
buffer_load_dwordx4 v28, s[44:47], s52 offen offset:3072 sc1 lds
s_mov_b32 s53, 16384
s_add_u32 m0, s32, 131072
s_nop 0
buffer_load_dwordx4 v28, s[48:51], s53 offen offset:0 sc1 lds
buffer_load_dwordx4 v28, s[48:51], s53 offen offset:1024 sc1 lds
buffer_load_dwordx4 v28, s[48:51], s53 offen offset:2048 sc1 lds
buffer_load_dwordx4 v28, s[48:51], s53 offen offset:3072 sc1 lds
s_mov_b32 s52, 32768
s_add_u32 m0, s32, 98304
s_nop 0
buffer_load_dwordx4 v28, s[44:47], s52 offen offset:0 sc1 lds
buffer_load_dwordx4 v28, s[44:47], s52 offen offset:1024 sc1 lds
buffer_load_dwordx4 v28, s[44:47], s52 offen offset:2048 sc1 lds
buffer_load_dwordx4 v28, s[44:47], s52 offen offset:3072 sc1 lds
s_mov_b32 s53, 32768
s_add_u32 m0, s32, 147456
s_nop 0
buffer_load_dwordx4 v28, s[48:51], s53 offen offset:0 sc1 lds
buffer_load_dwordx4 v28, s[48:51], s53 offen offset:1024 sc1 lds
buffer_load_dwordx4 v28, s[48:51], s53 offen offset:2048 sc1 lds
buffer_load_dwordx4 v28, s[48:51], s53 offen offset:3072 sc1 lds
s_waitcnt vmcnt(0)
s_branch adaLN_cond__sliding_block_cached__swiglu_ffn__prompt_kernel_pro
adaLN_cond__sliding_block_cached__swiglu_ffn__prompt_kernel_cend:
adaLN_cond__sliding_block_cached__swiglu_ffn__prompt_kernel_end:
s_endpgm
.section .rodata,"a"
.p2align 6
.amdhsa_kernel adaLN_cond__sliding_block_cached__swiglu_ffn__prompt_kernel
  .amdhsa_next_free_vgpr 512
  .amdhsa_next_free_sgpr 102
  .amdhsa_accum_offset 256
  .amdhsa_group_segment_fixed_size 0
  .amdhsa_kernarg_size 112
  .amdhsa_user_sgpr_count 2
  .amdhsa_user_sgpr_kernarg_segment_ptr 1
  .amdhsa_system_sgpr_workgroup_id_x 1
  .amdhsa_float_denorm_mode_32 3
  .amdhsa_float_denorm_mode_16_64 3
.end_amdhsa_kernel
```
